```python
import torch

def _softmax(x, axis=-1):
    return torch.softmax(x, dim=axis)
def _gelu(x):
    return torch.nn.functional.gelu(x, approximate="tanh")
def _silu(x):
    return torch.nn.functional.silu(x)
def _sigmoid(x):
    return torch.sigmoid(x)
def _layernorm(x, axis=-1, eps=1e-5):
    m = x.mean(dim=axis, keepdim=True)
    v = x.var(dim=axis, keepdim=True, unbiased=False)
    return (x - m) / torch.sqrt(v + eps)
def _scatter_add(tgt, idx, src, axis=0):
    return tgt.clone().index_add_(axis, idx, src)
def _segment_sum(src, seg, n):
    out = torch.zeros((n,) + src.shape[1:], dtype=src.dtype)
    return out.index_add_(0, seg, src)
def _pad(x, pw):
    flat = tuple(v for pair in reversed(pw) for v in pair)
    return torch.nn.functional.pad(x, flat)

kernel_name = 'standalone__mha_softmax__near_ridge'

def setup_inputs():

    _w = (lambda a: (lambda t: t.to(torch.bfloat16) if t.is_floating_point() else t)(torch.as_tensor(a)))
    B, H, Sq, Sk, D = 8, 32, 432, 2048, 128
    return {
        "q": _w((lambda *s: torch.randn(*s, dtype=torch.bfloat16) * 0.8)(B, H, Sq, D)),
        "k": _w((lambda *s: torch.randn(*s, dtype=torch.bfloat16) * 0.8)(B, H, Sk, D)),
        "v": _w((lambda *s: torch.randn(*s, dtype=torch.bfloat16) * 0.05)(B, H, Sk, D)),
    }

def reference(q, k, v):
    scale = q.shape[-1] ** -0.5
    scores = torch.einsum("bhqd,bhkd->bhqk", q, k) * scale
    p = _softmax(scores, axis=-1)
    return torch.einsum("bhqk,bhkd->bhqd", p, v)
```

```asm
; @launch grid=(256,1,1) block=(256,1,1) lds=161280
.amdgcn_target "amdgcn-amd-amdhsa--gfx950"
.text
.globl standalone__mha_softmax__near_ridge_kernel
.p2align 8
.type standalone__mha_softmax__near_ridge_kernel,@function
standalone__mha_softmax__near_ridge_kernel:
    s_cmp_ge_u32 s2, 256
    s_cbranch_scc1 L_end
    s_load_dwordx4 s[4:7], s[0:1], 0
    s_load_dwordx4 s[8:11], s[0:1], 16
    s_getpc_b64 s[38:39]
L_pc:
    s_bfe_u32 s32, s2, 0x30003
    s_lshl_b32 s32, s32, 13
    v_lshlrev_b32 v2, 5, v0
    v_add_u32 v2, s32, v2
    v_min_u32 v2, L_slow-L_pc, v2
    v_mov_b32 v3, s39
    v_add_co_u32 v2, vcc, s38, v2
    s_nop 1
    v_addc_co_u32 v3, vcc, 0, v3, vcc
    global_load_dword v95, v[2:3], off
    v_lshrrev_b32 v1, 6, v0
    v_and_b32 v0, 63, v0
    v_readfirstlane_b32 s28, v1
    v_lshlrev_b32 v254, 4, v0
    v_and_b32 v2, 48, v0
    v_xor_b32 v57, v2, v254
    s_and_b32 s3, s2, 7
    s_lshl_b32 s3, s3, 5
    s_lshr_b32 s35, s2, 3
    s_or_b32 s3, s3, s35
    s_mul_i32 s35, s3, 110592
    s_lshl_b32 s3, s3, 19
    s_mov_b32 s18, 524288
    s_mov_b32 s19, 0x20000
    s_mov_b32 s14, 110592
    s_mov_b32 s15, 0x20000
    s_mul_i32 s33, s28, 28672
    s_add_u32 s78, s33, 24576
    s_min_u32 s78, s78, 106496
    s_mul_i32 s68, s28, 2112
    s_lshl_b32 s87, s28, 10
    s_cmp_eq_u32 s28, 3
    s_cselect_b32 s87, 0, s87
    s_lshl_b32 s70, s28, 11
    s_sub_u32 s70, s70, s87
    v_add_u32 v254, s87, v254
    s_mul_i32 s77, s28, 4352
    s_add_u32 s77, s77, 39936
    s_waitcnt lgkmcnt(0)
    s_add_u32 s16, s6, s3
    s_addc_u32 s17, s7, 0
    s_add_u32 s12, s4, s35
    s_addc_u32 s13, s5, 0
    s_add_u32 m0, s68, 6400
    s_add_u32 s37, s70, 0
    buffer_load_dwordx4 v254, s[16:19], s37 offen offset:0 nt lds
    s_add_u32 m0, m0, 32
    s_nop 0
    buffer_load_dwordx4 v254, s[16:19], s37 offen offset:1024 nt lds
    s_add_u32 m0, s77, 0
    s_sub_u32 s36, s78, 0
    buffer_load_dwordx4 v57, s[12:15], s36 offen offset:0 nt lds
    s_add_u32 m0, m0, 64
    s_nop 0
    buffer_load_dwordx4 v57, s[12:15], s36 offen offset:1024 nt lds
    s_add_u32 m0, m0, 64
    s_nop 0
    buffer_load_dwordx4 v57, s[12:15], s36 offen offset:2048 nt lds
    s_add_u32 m0, m0, 64
    s_nop 0
    buffer_load_dwordx4 v57, s[12:15], s36 offen offset:3072 nt lds
    s_add_u32 m0, s68, 14848
    s_add_u32 s37, s70, 8192
    buffer_load_dwordx4 v254, s[16:19], s37 offen offset:0 nt lds
    s_add_u32 m0, m0, 32
    s_nop 0
    buffer_load_dwordx4 v254, s[16:19], s37 offen offset:1024 nt lds
    s_add_u32 s20, s8, s3
    s_addc_u32 s21, s9, 0
    s_add_u32 s24, s10, s35
    s_addc_u32 s25, s11, 0
    s_mov_b32 s22, 524288
    s_mov_b32 s23, 0x20000
    s_mov_b32 s26, 110592
    s_mov_b32 s27, 0x20000
    s_mul_i32 s69, s28, 2080
    s_add_u32 m0, s77, 17408
    s_sub_u32 s36, s78, 4096
    buffer_load_dwordx4 v57, s[12:15], s36 offen offset:0 nt lds
    s_add_u32 m0, m0, 64
    s_nop 0
    buffer_load_dwordx4 v57, s[12:15], s36 offen offset:1024 nt lds
    s_add_u32 m0, m0, 64
    s_nop 0
    buffer_load_dwordx4 v57, s[12:15], s36 offen offset:2048 nt lds
    s_add_u32 m0, m0, 64
    s_nop 0
    buffer_load_dwordx4 v57, s[12:15], s36 offen offset:3072 nt lds
    s_add_u32 m0, s69, 23296
    s_add_u32 s37, s70, 0
    buffer_load_dwordx4 v254, s[20:23], s37 offen offset:0 nt lds
    s_add_u32 m0, m0, 16
    s_nop 0
    buffer_load_dwordx4 v254, s[20:23], s37 offen offset:1024 nt lds
    s_add_u32 m0, s69, 31616
    s_add_u32 s37, s70, 8192
    buffer_load_dwordx4 v254, s[20:23], s37 offen offset:0 nt lds
    s_add_u32 m0, m0, 16
    s_nop 0
    buffer_load_dwordx4 v254, s[20:23], s37 offen offset:1024 nt lds
    s_mov_b32 s100, 0x3e0293ee
    s_mov_b32 s101, 0x3e0293ee
    s_mul_i32 s76, s28, 13568
    s_add_u32 s76, s76, 107008
    s_mov_b32 s31, 67072
    s_mov_b32 s71, 4294900224
    s_mov_b32 s72, 33536
    s_mov_b32 s29, 13
    s_mov_b32 s34, 33536
    s_mov_b32 s79, 0xff800000
    s_mov_b32 s3, 0xffff0000
    s_sub_u32 s6, s33, s87
    s_mul_i32 s4, s28, 5280
    s_add_u32 s4, s4, 6400
    s_mul_i32 s64, s28, 5120
    s_sub_u32 s64, s64, s87
    s_add_u32 s64, s64, 65536
    s_add_u32 s65, s64, 4096
    s_mul_i32 s5, s28, 5200
    s_add_u32 s5, s5, 23296
    s_mul_i32 s66, s28, 5120
    s_sub_u32 s66, s66, s87
    s_add_u32 s66, s66, 65536
    s_add_u32 s67, s66, 4096
    s_add_u32 s10, s64, 442368
    s_add_u32 s11, s66, 442368
    s_add_u32 s0, s16, s70
    s_addc_u32 s1, s17, 0
    s_add_u32 s38, s20, s70
    s_addc_u32 s39, s21, 0
    s_movk_i32 s7, 4096
    s_add_u32 s35, s76, 13056
    v_mov_b32 v60, 0x00400000
    v_add_u32 v59, s35, v2
    v_lshlrev_b32 v56, 2, v1
    v_add_u32 v56, 6144, v56
    v_bfe_u32 v3, v0, 2, 2
    v_mul_u32_u24 v62, 1088, v3
    v_and_b32 v3, 3, v0
    v_lshl_add_u32 v62, v3, 8, v62
    v_lshlrev_b32 v3, 4, v3
    v_xor_b32 v3, v2, v3
    v_add3_u32 v63, v62, v3, s76
    v_add3_u32 v62, v62, v3, s77
    v_and_b32 v3, 7, v0
    v_mul_u32_u24 v252, 1056, v3
    v_and_b32 v3, 8, v0
    v_lshl_add_u32 v252, v3, 5, v252
    v_add_u32 v252, v2, v252
    v_add_u32 v252, 6400, v252
    v_and_b32 v3, 1, v0
    v_lshlrev_b32 v4, 3, v3
    v_and_b32 v3, 2, v0
    v_lshl_add_u32 v4, v3, 6, v4
    v_bfe_u32 v3, v0, 2, 3
    v_mul_u32_u24 v253, 1040, v3
    v_and_b32 v3, 32, v0
    v_lshl_add_u32 v253, v3, 3, v253
    v_add_u32_e64 v253, v4, v253
    v_add_u32 v253, 23296, v253
    v_mul_u32_u24 v255, 80, v2
    v_and_b32 v3, 0xf0, v254
    v_add3_u32 v255, v255, v3, s76
    s_cmp_eq_u32 s28, 3
    s_cbranch_scc1 L_wave_b
L_wave_a:
    v_mov_b32 v244, 0
    v_mov_b32 v245, 0
    v_mov_b32 v246, 0
    v_mov_b32 v247, 0
    v_mov_b32_e64 v248, 1.0
    s_nop 1
    v_mov_b32_dpp v246, v248 quad_perm:[0,1,2,3] row_mask:0x8 bank_mask:0xf
    v_bfe_u32 v248, v254, 5, 3
    v_cmp_eq_u32 vcc, 0, v248
    v_mov_b32 v251, 0x3f803f80
    s_nop 0
    v_cndmask_b32 v248, 0, v251, vcc
    v_cndmask_b32 v249, 0, v251, vcc
    v_cndmask_b32 v250, 0, v251, vcc
    v_cndmask_b32 v251, 0, v251, vcc
    s_waitcnt vmcnt(10)
    ds_read_b128 v[192:195], v62 offset:0
    ds_read_b128 v[196:199], v62 offset:64
    ds_read_b128 v[200:203], v62 offset:128
    ds_read_b128 v[204:207], v62 offset:192
    v_mov_b32_dpp v248, v248 row_ror:12 row_mask:0xf bank_mask:0xf
    v_mov_b32_dpp v249, v249 row_ror:12 row_mask:0xf bank_mask:0xf
    v_mov_b32_dpp v250, v250 row_ror:12 row_mask:0xf bank_mask:0xf
    v_mov_b32_dpp v251, v251 row_ror:12 row_mask:0xf bank_mask:0xf
    s_add_u32 m0, s77, 34816
    s_sub_u32 s36, s78, 24576
    s_waitcnt lgkmcnt(3)
    v_lshlrev_b32 v48, 16, v192
    v_and_b32 v49, s3, v192
    v_lshlrev_b32 v50, 16, v193
    v_and_b32 v51, s3, v193
    v_lshlrev_b32 v52, 16, v194
    v_and_b32 v53, s3, v194
    v_lshlrev_b32 v54, 16, v195
    v_and_b32_e64 v55, s3, v195
    v_pk_mul_f32 v[48:49], v[48:49], s[100:101]
    v_pk_mul_f32 v[50:51], v[50:51], s[100:101]
    v_pk_mul_f32 v[52:53], v[52:53], s[100:101]
    v_pk_mul_f32 v[54:55], v[54:55], s[100:101]
    v_cvt_pk_bf16_f32 v192, v48, v49
    v_accvgpr_write_b32 a96, v192
    v_cvt_pk_bf16_f32 v193, v50, v51
    v_accvgpr_write_b32 a97, v193
    v_cvt_pk_bf16_f32 v194, v52, v53
    v_accvgpr_write_b32 a98, v194
    v_cvt_pk_bf16_f32 v195, v54, v55
    v_accvgpr_write_b32 a99, v195
    s_waitcnt lgkmcnt(2)
    v_lshlrev_b32 v48, 16, v196
    v_and_b32 v49, s3, v196
    v_lshlrev_b32 v50, 16, v197
    v_and_b32 v51, s3, v197
    v_lshlrev_b32 v52, 16, v198
    v_and_b32 v53, s3, v198
    v_lshlrev_b32 v54, 16, v199
    v_and_b32_e64 v55, s3, v199
    v_pk_mul_f32 v[48:49], v[48:49], s[100:101]
    v_pk_mul_f32 v[50:51], v[50:51], s[100:101]
    v_pk_mul_f32 v[52:53], v[52:53], s[100:101]
    v_pk_mul_f32 v[54:55], v[54:55], s[100:101]
    v_cvt_pk_bf16_f32 v196, v48, v49
    v_accvgpr_write_b32 a100, v196
    v_cvt_pk_bf16_f32 v197, v50, v51
    v_accvgpr_write_b32 a101, v197
    v_cvt_pk_bf16_f32 v198, v52, v53
    v_accvgpr_write_b32 a102, v198
    v_cvt_pk_bf16_f32 v199, v54, v55
    v_accvgpr_write_b32 a103, v199
    s_waitcnt lgkmcnt(1)
    v_lshlrev_b32 v48, 16, v200
    v_and_b32 v49, s3, v200
    v_lshlrev_b32 v50, 16, v201
    v_and_b32 v51, s3, v201
    v_lshlrev_b32 v52, 16, v202
    v_and_b32 v53, s3, v202
    v_lshlrev_b32 v54, 16, v203
    v_and_b32_e64 v55, s3, v203
    v_pk_mul_f32 v[48:49], v[48:49], s[100:101]
    v_pk_mul_f32 v[50:51], v[50:51], s[100:101]
    v_pk_mul_f32 v[52:53], v[52:53], s[100:101]
    v_pk_mul_f32 v[54:55], v[54:55], s[100:101]
    v_cvt_pk_bf16_f32 v200, v48, v49
    v_accvgpr_write_b32 a104, v200
    v_cvt_pk_bf16_f32 v201, v50, v51
    v_accvgpr_write_b32 a105, v201
    v_cvt_pk_bf16_f32 v202, v52, v53
    v_accvgpr_write_b32 a106, v202
    v_cvt_pk_bf16_f32 v203, v54, v55
    v_accvgpr_write_b32 a107, v203
    s_waitcnt lgkmcnt(0)
    v_lshlrev_b32 v48, 16, v204
    v_and_b32 v49, s3, v204
    v_lshlrev_b32 v50, 16, v205
    v_and_b32 v51, s3, v205
    v_lshlrev_b32 v52, 16, v206
    v_and_b32 v53, s3, v206
    v_lshlrev_b32 v54, 16, v207
    v_and_b32_e64 v55, s3, v207
    v_pk_mul_f32 v[48:49], v[48:49], s[100:101]
    v_pk_mul_f32 v[50:51], v[50:51], s[100:101]
    v_pk_mul_f32 v[52:53], v[52:53], s[100:101]
    v_pk_mul_f32 v[54:55], v[54:55], s[100:101]
    v_cvt_pk_bf16_f32 v204, v48, v49
    v_accvgpr_write_b32 a108, v204
    v_cvt_pk_bf16_f32 v205, v50, v51
    v_accvgpr_write_b32 a109, v205
    v_cvt_pk_bf16_f32 v206, v52, v53
    v_accvgpr_write_b32 a110, v206
    v_cvt_pk_bf16_f32 v207, v54, v55
    v_accvgpr_write_b32 a111, v207
    s_waitcnt vmcnt(8)
    s_barrier
    ds_read_b128 a[112:115], v252 offset:0
    ds_read_b128 a[116:119], v252 offset:64
    ds_read_b128 a[120:123], v252 offset:128
    ds_read_b128 a[124:127], v252 offset:192
    ds_read_b128 a[128:131], v252 offset:512
    ds_read_b128 a[132:135], v252 offset:576
    ds_read_b128 a[136:139], v252 offset:640
    ds_read_b128 a[140:143], v252 offset:704
    ds_read_b128 a[144:147], v252 offset:8448
    ds_read_b128 a[148:151], v252 offset:8512
    ds_read_b128 a[152:155], v252 offset:8576
    ds_read_b128 a[156:159], v252 offset:8640
    ds_read_b128 a[160:163], v252 offset:8960
    ds_read_b128 a[164:167], v252 offset:9024
    ds_read_b128 a[168:171], v252 offset:9088
    ds_read_b128 a[172:175], v252 offset:9152
    s_waitcnt lgkmcnt(15)
    v_mfma_f32_16x16x32_bf16 v[208:211], a[112:115], a[96:99], 0
    s_waitcnt lgkmcnt(14)
    v_mfma_f32_16x16x32_bf16 v[208:211], a[116:119], a[100:103], v[208:211]
    s_waitcnt lgkmcnt(13)
    v_mfma_f32_16x16x32_bf16 v[208:211], a[120:123], a[104:107], v[208:211]
    s_waitcnt lgkmcnt(12)
    v_mfma_f32_16x16x32_bf16 v[208:211], a[124:127], a[108:111], v[208:211]
    s_waitcnt lgkmcnt(8)
    v_mfma_f32_16x16x32_bf16 v[212:215], a[140:143], a[108:111], 0
    v_mfma_f32_16x16x32_bf16 v[212:215], a[136:139], a[104:107], v[212:215]
    s_nop 4
    v_max3_f32 v58, v208, v209, v210
    v_mfma_f32_16x16x32_bf16 v[212:215], a[132:135], a[100:103], v[212:215]
    v_mfma_f32_16x16x32_bf16 v[212:215], a[128:131], a[96:99], v[212:215]
    s_waitcnt lgkmcnt(7)
    v_mfma_f32_16x16x32_bf16 v[216:219], a[144:147], a[96:99], 0
    s_waitcnt lgkmcnt(6)
    v_mfma_f32_16x16x32_bf16 v[216:219], a[148:151], a[100:103], v[216:219]
    s_waitcnt lgkmcnt(0)
    s_nop 2
    v_max3_f32 v58, v58, v211, v212
    v_mfma_f32_16x16x32_bf16 v[216:219], a[152:155], a[104:107], v[216:219]
    v_max3_f32 v58, v58, v213, v214
    v_max_f32 v58, v58, v215
    v_mfma_f32_16x16x32_bf16 v[216:219], a[156:159], a[108:111], v[216:219]
    v_mov_b32 v61, v58
    v_mfma_f32_16x16x32_bf16 v[220:223], a[172:175], a[108:111], 0
    s_nop 0
    v_permlane32_swap_b32 v58, v61
    v_max_f32 v58, v58, v61
    v_mfma_f32_16x16x32_bf16 v[220:223], a[168:171], a[104:107], v[220:223]
    v_mov_b32 v61, v58
    v_mfma_f32_16x16x32_bf16 v[220:223], a[164:167], a[100:103], v[220:223]
    s_nop 0
    v_permlane16_swap_b32 v58, v61
    v_max_f32 v58, v58, v61
    v_mfma_f32_16x16x32_bf16 v[220:223], a[160:163], a[96:99], v[220:223]
    s_nop 0
    v_max_f32_dpp v58, v58, v58 row_ror:8 row_mask:0xf bank_mask:0xf
    v_bfe_u32 v61, v254, 4, 1
    v_mul_u32_u24 v61, 0xaaaa, v61
    v_max_f32_dpp v58, v58, v58 row_ror:4 row_mask:0xf bank_mask:0xf
    v_add_u32 v61, 0x4444, v61
    s_nop 0
    v_max_f32_dpp v58, v58, v58 row_ror:2 row_mask:0xf bank_mask:0xf
    s_nop 1
    v_max_f32_dpp v58, v58, v58 row_ror:1 row_mask:0xf bank_mask:0xf
    ds_write_b32 v56, v58
    s_waitcnt lgkmcnt(0)
    s_barrier
    v_mov_b32 v56, 6144
    ds_read_b128 v[240:243], v56
    s_waitcnt lgkmcnt(0)
    v_max3_f32 v58, v240, v241, v242
    v_max_f32 v58, v58, v243
    v_sub_f32_e64 v58, 0xc0000000, v58
    v_and_or_b32 v240, v58, s3, v61
    v_and_or_b32 v241, v58, s3, v61
    v_and_or_b32 v242, v58, s3, v61
    v_and_or_b32 v243, v58, s3, v61
    v_add_f32 v208, v208, v240
    v_add_f32 v209, v209, v240
    v_add_f32 v210, v210, v240
    v_add_f32 v211, v211, v240
    v_exp_f32 v208, v208
    v_exp_f32 v209, v209
    v_exp_f32 v210, v210
    v_cvt_pk_bf16_f32 v232, v208, v209
    v_exp_f32 v211, v211
    v_add_f32 v212, v212, v240
    v_cvt_pk_bf16_f32 v233, v210, v211
    v_add_f32 v213, v213, v240
    v_add_f32 v214, v214, v240
    v_add_f32 v215, v215, v240
    v_exp_f32 v212, v212
    v_exp_f32 v213, v213
    v_exp_f32 v214, v214
    v_cvt_pk_bf16_f32 v234, v212, v213
    v_exp_f32 v215, v215
    v_add_f32 v216, v216, v240
    v_cvt_pk_bf16_f32 v235, v214, v215
    v_add_f32 v217, v217, v240
    v_add_f32 v218, v218, v240
    v_add_f32 v219, v219, v240
    v_exp_f32 v216, v216
    v_exp_f32 v217, v217
    v_exp_f32 v218, v218
    v_cvt_pk_bf16_f32 v236, v216, v217
    v_exp_f32 v219, v219
    v_add_f32 v220, v220, v240
    v_cvt_pk_bf16_f32 v237, v218, v219
    v_mov_b32 v58, 0
    v_add_f32 v221, v221, v240
    v_add_f32 v222, v222, v240
    v_add_f32 v223, v223, v240
    v_exp_f32 v220, v220
    v_exp_f32 v221, v221
    v_exp_f32 v222, v222
    v_cvt_pk_bf16_f32 v238, v220, v221
    v_exp_f32_e64 v223, v223
    s_waitcnt vmcnt(4)
    v_cvt_pk_bf16_f32 v239, v222, v223
    s_nop 1
    v_smfmac_f32_16x16x64_bf16 v[244:247], v[248:251], v[232:239], v240
    ds_read_b128 v[160:163], v62 offset:17408
    ds_read_b128 v[164:167], v62 offset:17472
    ds_read_b128 v[168:171], v62 offset:17536
    ds_read_b128 v[172:175], v62 offset:17600
    v_mov_b32_dpp v248, v248 row_ror:14 row_mask:0xf bank_mask:0xf
    v_mov_b32_dpp v249, v249 row_ror:14 row_mask:0xf bank_mask:0xf
    v_mov_b32_dpp v250, v250 row_ror:14 row_mask:0xf bank_mask:0xf
    v_mov_b32_dpp v251, v251 row_ror:14 row_mask:0xf bank_mask:0xf
    v_add_f32_dpp v58, v244, v245 quad_perm:[0,1,2,3] row_mask:0x8 bank_mask:0xf
    s_waitcnt lgkmcnt(3)
    v_lshlrev_b32 v176, 16, v160
    v_and_b32 v177, s3, v160
    v_lshlrev_b32 v178, 16, v161
    v_and_b32 v179, s3, v161
    v_lshlrev_b32 v180, 16, v162
    v_and_b32 v181, s3, v162
    v_lshlrev_b32 v182, 16, v163
    v_and_b32_e64 v183, s3, v163
    v_pk_mul_f32 v[176:177], v[176:177], s[100:101]
    v_pk_mul_f32 v[178:179], v[178:179], s[100:101]
    v_pk_mul_f32 v[180:181], v[180:181], s[100:101]
    v_pk_mul_f32 v[182:183], v[182:183], s[100:101]
    v_cvt_pk_bf16_f32 v160, v176, v177
    v_accvgpr_write_b32 a80, v160
    buffer_load_dwordx4 v57, s[12:15], s36 offen offset:0 nt lds
    s_add_u32 m0, m0, 64
    s_nop 0
    buffer_load_dwordx4 v57, s[12:15], s36 offen offset:1024 nt lds
    v_cvt_pk_bf16_f32 v161, v178, v179
    v_accvgpr_write_b32 a81, v161
    v_cvt_pk_bf16_f32 v162, v180, v181
    v_accvgpr_write_b32 a82, v162
    s_add_u32 m0, m0, 64
    v_cvt_pk_bf16_f32 v163, v182, v183
    v_accvgpr_write_b32 a83, v163
    s_waitcnt lgkmcnt(2)
    v_lshlrev_b32 v176, 16, v164
    v_and_b32 v177, s3, v164
    v_mfma_f32_16x16x32_bf16 v[208:211], a[112:115], a[80:83], v[240:243]
    buffer_load_dwordx4 v57, s[12:15], s36 offen offset:2048 nt lds
    v_lshlrev_b32 v178, 16, v165
    v_mfma_f32_16x16x32_bf16 v[212:215], a[128:131], a[80:83], v[240:243]
    s_add_u32 m0, m0, 64
    v_and_b32 v179, s3, v165
    v_lshlrev_b32 v180, 16, v166
    v_mfma_f32_16x16x32_bf16 v[216:219], a[144:147], a[80:83], v[240:243]
    v_and_b32 v181, s3, v166
    v_lshlrev_b32 v182, 16, v167
    v_mfma_f32_16x16x32_bf16 v[220:223], a[160:163], a[80:83], v[240:243]
    v_and_b32_e64 v183, s3, v167
    v_pk_mul_f32 v[176:177], v[176:177], s[100:101]
    v_pk_mul_f32 v[178:179], v[178:179], s[100:101]
    v_pk_mul_f32 v[180:181], v[180:181], s[100:101]
    v_pk_mul_f32 v[182:183], v[182:183], s[100:101]
    v_cvt_pk_bf16_f32 v164, v176, v177
    v_accvgpr_write_b32 a84, v164
    v_cvt_pk_bf16_f32 v165, v178, v179
    v_accvgpr_write_b32 a85, v165
    v_cvt_pk_bf16_f32 v166, v180, v181
    v_accvgpr_write_b32 a86, v166
    v_cvt_pk_bf16_f32 v167, v182, v183
    v_accvgpr_write_b32 a87, v167
    buffer_load_dwordx4 v57, s[12:15], s36 offen offset:3072 nt lds
    s_nop 0
    v_mfma_f32_16x16x32_bf16 v[208:211], a[116:119], a[84:87], v[208:211]
    s_add_u32 m0, s77, 52224
    s_waitcnt lgkmcnt(1)
    v_lshlrev_b32 v176, 16, v168
    v_and_b32 v177, s3, v168
    v_mfma_f32_16x16x32_bf16 v[212:215], a[132:135], a[84:87], v[212:215]
    s_sub_u32 s36, s78, 8192
    v_lshlrev_b32 v178, 16, v169
    v_and_b32 v179, s3, v169
    v_mfma_f32_16x16x32_bf16 v[216:219], a[148:151], a[84:87], v[216:219]
    v_lshlrev_b32 v180, 16, v170
    v_and_b32 v181, s3, v170
    v_mfma_f32_16x16x32_bf16 v[220:223], a[164:167], a[84:87], v[220:223]
    v_lshlrev_b32 v182, 16, v171
    v_and_b32 v183, s3, v171
    v_pk_mul_f32 v[176:177], v[176:177], s[100:101]
    v_pk_mul_f32 v[178:179], v[178:179], s[100:101]
    v_pk_mul_f32 v[180:181], v[180:181], s[100:101]
    v_pk_mul_f32 v[182:183], v[182:183], s[100:101]
    v_cvt_pk_bf16_f32 v168, v176, v177
    v_accvgpr_write_b32 a88, v168
    v_cvt_pk_bf16_f32 v169, v178, v179
    v_accvgpr_write_b32 a89, v169
    v_cvt_pk_bf16_f32 v170, v180, v181
    v_accvgpr_write_b32 a90, v170
    v_cvt_pk_bf16_f32 v171, v182, v183
    v_accvgpr_write_b32 a91, v171
    s_waitcnt lgkmcnt(0)
    v_lshlrev_b32 v176, 16, v172
    v_and_b32 v177, s3, v172
    v_mfma_f32_16x16x32_bf16 v[208:211], a[120:123], a[88:91], v[208:211]
    s_waitcnt vmcnt(4)
    v_lshlrev_b32 v178, 16, v173
    v_and_b32_e64 v179, s3, v173
    v_mfma_f32_16x16x32_bf16 v[212:215], a[136:139], a[88:91], v[212:215]
    s_barrier
    ds_read_b64_tr_b16 a[176:177], v253 offset:0
    ds_read_b64_tr_b16 a[178:179], v253 offset:512
    v_mfma_f32_16x16x32_bf16 v[216:219], a[152:155], a[88:91], v[216:219]
    ds_read_b64_tr_b16 a[180:181], v253 offset:8320
    ds_read_b64_tr_b16 a[182:183], v253 offset:8832
    v_mfma_f32_16x16x32_bf16 v[220:223], a[168:171], a[88:91], v[220:223]
    ds_read_b64_tr_b16 a[184:185], v253 offset:16
    ds_read_b64_tr_b16 a[186:187], v253 offset:528
    ds_read_b64_tr_b16 a[188:189], v253 offset:8336
    ds_read_b64_tr_b16 a[190:191], v253 offset:8848
    ds_read_b64_tr_b16 a[192:193], v253 offset:32
    ds_read_b64_tr_b16 a[194:195], v253 offset:544
    ds_read_b64_tr_b16 a[196:197], v253 offset:8352
    ds_read_b64_tr_b16 a[198:199], v253 offset:8864
    ds_read_b64_tr_b16 a[200:201], v253 offset:48
    ds_read_b64_tr_b16 a[202:203], v253 offset:560
    ds_read_b64_tr_b16 a[204:205], v253 offset:8368
    ds_read_b64_tr_b16 a[206:207], v253 offset:8880
    ds_read_b64_tr_b16 a[208:209], v253 offset:64
    ds_read_b64_tr_b16 a[210:211], v253 offset:576
    ds_read_b64_tr_b16 a[212:213], v253 offset:8384
    ds_read_b64_tr_b16 a[214:215], v253 offset:8896
    ds_read_b64_tr_b16 a[216:217], v253 offset:80
    ds_read_b64_tr_b16 a[218:219], v253 offset:592
    ds_read_b64_tr_b16 a[220:221], v253 offset:8400
    ds_read_b64_tr_b16 a[222:223], v253 offset:8912
    ds_read_b64_tr_b16 a[224:225], v253 offset:96
    ds_read_b64_tr_b16 a[226:227], v253 offset:608
    ds_read_b64_tr_b16 a[228:229], v253 offset:8416
    ds_read_b64_tr_b16 a[230:231], v253 offset:8928
    ds_read_b64_tr_b16 a[232:233], v253 offset:112
    ds_read_b64_tr_b16 a[234:235], v253 offset:624
    ds_read_b64_tr_b16 a[236:237], v253 offset:8432
    ds_read_b64_tr_b16 a[238:239], v253 offset:8944
    v_lshlrev_b32 v180, 16, v174
    v_and_b32 v181, s3, v174
    v_lshlrev_b32 v182, 16, v175
    v_and_b32 v183, s3, v175
    v_pk_mul_f32 v[176:177], v[176:177], s[100:101]
    v_pk_mul_f32 v[178:179], v[178:179], s[100:101]
    v_pk_mul_f32 v[180:181], v[180:181], s[100:101]
    v_pk_mul_f32 v[182:183], v[182:183], s[100:101]
    v_cvt_pk_bf16_f32 v172, v176, v177
    v_accvgpr_write_b32 a92, v172
    v_cvt_pk_bf16_f32 v173, v178, v179
    v_accvgpr_write_b32 a93, v173
    v_cvt_pk_bf16_f32 v174, v180, v181
    v_accvgpr_write_b32 a94, v174
    v_cvt_pk_bf16_f32 v175, v182, v183
    v_accvgpr_write_b32 a95, v175
    s_waitcnt lgkmcnt(15)
    v_accvgpr_read_b32 v32, a176
    v_accvgpr_read_b32 v33, a178
    v_mfma_f32_16x16x32_bf16 v[208:211], a[124:127], a[92:95], v[208:211]
    buffer_load_dwordx4 v57, s[12:15], s36 offen offset:0 nt lds
    s_add_u32 m0, m0, 64
    v_mfma_f32_16x16x32_bf16 v[212:215], a[140:143], a[92:95], v[212:215]
    buffer_load_dwordx4 v57, s[12:15], s36 offen offset:1024 nt lds
    v_accvgpr_read_b32 v34, a181
    v_mfma_f32_16x16x32_bf16 v[216:219], a[156:159], a[92:95], v[216:219]
    s_add_u32 m0, m0, 64
    v_max3_f32 v48, |v32|, |v33|, |v34|
    v_accvgpr_read_b32 v35, a184
    v_mfma_f32_16x16x32_bf16 v[220:223], a[172:175], a[92:95], v[220:223]
    v_accvgpr_read_b32 v36, a186
    v_accvgpr_read_b32 v37, a189
    v_max3_f32 v49, |v35|, |v36|, |v37|
    v_accvgpr_read_b32 v38, a192
    v_accvgpr_read_b32 v39, a194
    v_accvgpr_read_b32 v40, a197
    v_max3_f32 v50, |v38|, |v39|, |v40|
    v_accvgpr_read_b32 v41, a200
    v_accvgpr_read_b32 v42, a202
    v_accvgpr_read_b32 v43, a205
    v_max3_f32 v51, |v41|, |v42|, |v43|
    v_accvgpr_read_b32 v32, a208
    s_waitcnt lgkmcnt(14)
    v_accvgpr_read_b32 v33, a210
    s_waitcnt lgkmcnt(13)
    v_accvgpr_read_b32 v34, a213
    v_max3_f32 v52, |v32|, |v33|, |v34|
    s_waitcnt lgkmcnt(11)
    v_accvgpr_read_b32 v35, a216
    s_waitcnt lgkmcnt(10)
    v_accvgpr_read_b32 v36, a218
    s_waitcnt lgkmcnt(9)
    v_accvgpr_read_b32 v37, a221
    v_max3_f32 v53, |v35|, |v36|, |v37|
    s_waitcnt lgkmcnt(7)
    v_accvgpr_read_b32 v38, a224
    s_waitcnt lgkmcnt(6)
    v_accvgpr_read_b32 v39, a226
    s_waitcnt lgkmcnt(5)
    v_accvgpr_read_b32 v40, a229
    v_max3_f32 v54, |v38|, |v39|, |v40|
    s_waitcnt lgkmcnt(3)
    v_accvgpr_read_b32 v41, a232
    buffer_load_dwordx4 v57, s[12:15], s36 offen offset:2048 nt lds
    s_waitcnt lgkmcnt(2)
    v_accvgpr_read_b32 v42, a234
    s_waitcnt lgkmcnt(1)
    v_accvgpr_read_b32 v43, a237
    v_max3_f32 v55, |v41|, |v42|, |v43|
    v_min3_f32 v61, v48, v49, v50
    v_min3_f32 v61, v61, v51, v52
    v_min3_f32 v61, v61, v53, v54
    v_min_f32 v61, v61, v55
    v_mov_b32 v48, v61
    s_add_u32 m0, m0, 64
    v_exp_f32 v208, v208
    v_permlane32_swap_b32 v61, v48
    v_min_f32 v61, v61, v48
    v_mov_b32 v48, v61
    v_exp_f32 v209, v209
    s_nop 0
    v_permlane16_swap_b32 v61, v48
    v_min_f32 v61, v61, v48
    v_cvt_pk_bf16_f32 v224, v208, v209
    v_exp_f32 v210, v210
    v_min_f32_dpp v61, v61, v61 row_ror:8 row_mask:0xf bank_mask:0xf
    v_exp_f32 v211, v211
    s_nop 0
    v_min_f32_dpp v61, v61, v61 row_ror:4 row_mask:0xf bank_mask:0xf
    v_cvt_pk_bf16_f32 v225, v210, v211
    v_exp_f32 v212, v212
    buffer_load_dwordx4 v57, s[12:15], s36 offen offset:3072 nt lds
    v_min_f32_dpp v61, v61, v61 row_ror:2 row_mask:0xf bank_mask:0xf
    v_exp_f32 v213, v213
    s_nop 0
    v_min_f32_dpp v61, v61, v61 row_ror:1 row_mask:0xf bank_mask:0xf
    v_min_f32 v61, 0x5b800000, v61
    v_mul_f32 v61, 0x41800000, v61
    v_exp_f32_e64 v214, v214
    s_nop 0
    v_mfma_f32_16x16x4_f32 v[204:207], v58, v61, 0
    s_waitcnt vmcnt(4)
    s_add_u32 m0, s76, 0
    s_sub_u32 s36, s78, 12288
    ds_read_b128 v[0:3], v62 offset:34816
    ds_read_b128 v[4:7], v62 offset:34880
    ds_read_b128 v[8:11], v62 offset:34944
    ds_read_b128 v[12:15], v62 offset:35008
    s_nop 2
    v_and_or_b32 v204, v204, s79, v60
    v_and_or_b32 v205, v205, s79, v60
    v_and_or_b32 v206, v206, s79, v60
    v_and_or_b32 v207, v207, s79, v60
    v_accvgpr_write_b32 a252, v204
    v_accvgpr_write_b32 a253, v205
    v_mfma_f32_16x16x32_bf16 v[192:195], v[232:235], a[176:179], v[204:207]
    ds_write_b128 v59, v[204:207] offset:384
    v_mfma_f32_16x16x32_bf16 v[192:195], v[236:239], a[180:183], v[192:195]
    v_accvgpr_write_b32 a254, v206
    v_accvgpr_write_b32 a255, v207
    v_mfma_f32_16x16x32_bf16 v[196:199], v[236:239], a[188:191], v[204:207]
    v_mov_b32 v58, 0
    v_cvt_pk_bf16_f32 v226, v212, v213
    v_mfma_f32_16x16x32_bf16 v[196:199], v[232:235], a[184:187], v[196:199]
    v_exp_f32 v215, v215
    v_mfma_f32_16x16x32_bf16 v[200:203], v[232:235], a[192:195], v[204:207]
    v_exp_f32 v216, v216
    v_mfma_f32_16x16x32_bf16 v[200:203], v[236:239], a[196:199], v[200:203]
    v_cvt_pk_bf16_f32 v227, v214, v215
    s_waitcnt lgkmcnt(4)
    v_lshlrev_b32 v16, 16, v0
    v_mfma_f32_16x16x32_bf16 a[240:243], v[236:239], a[212:215], a[252:255]
    buffer_load_dwordx4 v57, s[12:15], s36 offen offset:0 nt lds
    v_and_b32 v17, s3, v0
    v_mfma_f32_16x16x32_bf16 a[240:243], v[232:235], a[208:211], a[240:243]
    s_add_u32 m0, m0, 64
    v_exp_f32 v217, v217
    v_mfma_f32_16x16x32_bf16 a[244:247], v[232:235], a[216:219], a[252:255]
    v_cvt_pk_bf16_f32 v228, v216, v217
    v_lshlrev_b32 v18, 16, v1
    v_mfma_f32_16x16x32_bf16 a[244:247], v[236:239], a[220:223], a[244:247]
    v_exp_f32 v218, v218
    v_mfma_f32_16x16x32_bf16 a[248:251], v[236:239], a[228:231], a[252:255]
    v_exp_f32 v219, v219
    v_mfma_f32_16x16x32_bf16 a[248:251], v[232:235], a[224:227], a[248:251]
    v_cvt_pk_bf16_f32 v229, v218, v219
    v_and_b32 v19, s3, v1
    v_mfma_f32_16x16x32_bf16 a[252:255], v[232:235], a[232:235], a[252:255]
    v_exp_f32 v220, v220
    v_mfma_f32_16x16x32_bf16 a[252:255], v[236:239], a[236:239], a[252:255]
    v_exp_f32 v221, v221
    v_mfma_f32_16x16x32_bf16 v[204:207], v[236:239], a[204:207], v[204:207]
    v_cvt_pk_bf16_f32 v230, v220, v221
    v_lshlrev_b32 v20, 16, v2
    v_mfma_f32_16x16x32_bf16 v[204:207], v[232:235], a[200:203], v[204:207]
    v_exp_f32 v222, v222
    v_exp_f32 v223, v223
    v_and_b32 v21, s3, v2
    v_cvt_pk_bf16_f32 v231, v222, v223
    v_lshlrev_b32 v22, 16, v3
    v_and_b32_e64 v23, s3, v3
    v_smfmac_f32_16x16x64_bf16 v[244:247], v[248:251], v[224:231], v240
    v_pk_mul_f32 v[16:17], v[16:17], s[100:101]
    v_pk_mul_f32 v[18:19], v[18:19], s[100:101]
    v_pk_mul_f32 v[20:21], v[20:21], s[100:101]
    v_pk_mul_f32 v[22:23], v[22:23], s[100:101]
    v_cvt_pk_bf16_f32 v0, v16, v17
    v_accvgpr_write_b32 a0, v0
    v_cvt_pk_bf16_f32 v1, v18, v19
    s_nop 0
    v_add_f32_dpp v58, v246, v247 quad_perm:[0,1,2,3] row_mask:0x4 bank_mask:0xf
    v_accvgpr_write_b32 a1, v1
    v_cvt_pk_bf16_f32 v2, v20, v21
    v_mfma_f32_16x16x4_f32 v[172:175], v58, v61, 0
    v_accvgpr_write_b32 a2, v2
    v_cvt_pk_bf16_f32 v3, v22, v23
    s_nop 7
    v_and_or_b32 v172, v172, s79, v60
    v_and_or_b32 v173, v173, s79, v60
    v_and_or_b32 v174, v174, s79, v60
    v_and_or_b32 v175, v175, s79, v60
    v_accvgpr_write_b32 a3, v3
    s_waitcnt lgkmcnt(0)
    v_lshlrev_b32 v16, 16, v4
    v_mfma_f32_16x16x32_bf16 v[160:163], v[224:227], a[176:179], v[172:175]
    ds_write_b128 v59, v[172:175] offset:320
    v_mfma_f32_16x16x32_bf16 v[208:211], a[112:115], a[0:3], v[240:243]
    buffer_load_dwordx4 v57, s[12:15], s36 offen offset:1024 nt lds
    ds_write_b128 v62, a[0:3] offset:34816
    s_add_u32 m0, m0, 64
    v_mfma_f32_16x16x32_bf16 v[212:215], a[128:131], a[0:3], v[240:243]
    v_and_b32 v17, s3, v4
    v_lshlrev_b32 v18, 16, v5
    v_mfma_f32_16x16x32_bf16 v[216:219], a[144:147], a[0:3], v[240:243]
    v_and_b32 v19, s3, v5
    v_lshlrev_b32 v20, 16, v6
    v_mfma_f32_16x16x32_bf16 v[220:223], a[160:163], a[0:3], v[240:243]
    v_and_b32 v21, s3, v6
    v_lshlrev_b32 v22, 16, v7
    v_mfma_f32_16x16x32_bf16 v[160:163], v[228:231], a[180:183], v[160:163]
    v_and_b32 v23, s3, v7
    v_pk_mul_f32 v[16:17], v[16:17], s[100:101]
    v_pk_mul_f32 v[18:19], v[18:19], s[100:101]
    v_pk_mul_f32 v[20:21], v[20:21], s[100:101]
    v_pk_mul_f32 v[22:23], v[22:23], s[100:101]
    v_mfma_f32_16x16x32_bf16 v[164:167], v[228:231], a[188:191], v[172:175]
    v_cvt_pk_bf16_f32 v4, v16, v17
    v_accvgpr_write_b32 a4, v4
    v_mfma_f32_16x16x32_bf16 v[164:167], v[224:227], a[184:187], v[164:167]
    v_cvt_pk_bf16_f32 v5, v18, v19
    v_accvgpr_write_b32 a5, v5
    v_mfma_f32_16x16x32_bf16 v[168:171], v[224:227], a[192:195], v[172:175]
    v_cvt_pk_bf16_f32 v6, v20, v21
    v_accvgpr_write_b32 a6, v6
    v_mfma_f32_16x16x32_bf16 v[168:171], v[228:231], a[196:199], v[168:171]
    v_cvt_pk_bf16_f32 v7, v22, v23
    v_accvgpr_write_b32 a7, v7
    v_mfma_f32_16x16x32_bf16 v[176:179], v[228:231], a[212:215], v[172:175]
    ds_write_b128 v62, a[4:7] offset:34880
    v_mfma_f32_16x16x32_bf16 v[208:211], a[116:119], a[4:7], v[208:211]
    v_lshlrev_b32 v16, 16, v8
    v_and_b32 v17, s3, v8
    v_mfma_f32_16x16x32_bf16 v[212:215], a[132:135], a[4:7], v[212:215]
    v_lshlrev_b32 v18, 16, v9
    v_and_b32 v19, s3, v9
    v_mfma_f32_16x16x32_bf16 v[216:219], a[148:151], a[4:7], v[216:219]
    v_lshlrev_b32 v20, 16, v10
    v_and_b32 v21, s3, v10
    v_mfma_f32_16x16x32_bf16 v[220:223], a[164:167], a[4:7], v[220:223]
    buffer_load_dwordx4 v57, s[12:15], s36 offen offset:2048 nt lds
    v_lshlrev_b32 v22, 16, v11
    v_mfma_f32_16x16x32_bf16 v[176:179], v[224:227], a[208:211], v[176:179]
    s_add_u32 m0, m0, 64
    v_and_b32_e64 v23, s3, v11
    v_pk_mul_f32 v[16:17], v[16:17], s[100:101]
    v_pk_mul_f32 v[18:19], v[18:19], s[100:101]
    v_pk_mul_f32 v[20:21], v[20:21], s[100:101]
    v_pk_mul_f32 v[22:23], v[22:23], s[100:101]
    v_mfma_f32_16x16x32_bf16 v[180:183], v[224:227], a[216:219], v[172:175]
    v_mov_b32_dpp v248, v248 row_ror:6 row_mask:0xf bank_mask:0xf
    v_mov_b32_dpp v249, v249 row_ror:6 row_mask:0xf bank_mask:0xf
    v_mfma_f32_16x16x32_bf16 v[180:183], v[228:231], a[220:223], v[180:183]
    v_mov_b32_dpp v250, v250 row_ror:6 row_mask:0xf bank_mask:0xf
    v_cvt_pk_bf16_f32 v8, v16, v17
    v_mfma_f32_16x16x32_bf16 v[184:187], v[228:231], a[228:231], v[172:175]
    v_mov_b32_dpp v251, v251 row_ror:6 row_mask:0xf bank_mask:0xf
    v_accvgpr_write_b32 a8, v8
    v_mfma_f32_16x16x32_bf16 v[184:187], v[224:227], a[224:227], v[184:187]
    v_cvt_pk_bf16_f32 v9, v18, v19
    v_mov_b32 v58, 0
    v_mfma_f32_16x16x32_bf16 v[188:191], v[224:227], a[232:235], v[172:175]
    v_accvgpr_write_b32 a9, v9
    v_cvt_pk_bf16_f32 v10, v20, v21
    v_mfma_f32_16x16x32_bf16 v[188:191], v[228:231], a[236:239], v[188:191]
    v_accvgpr_write_b32 a10, v10
    v_cvt_pk_bf16_f32 v11, v22, v23
    v_mfma_f32_16x16x32_bf16 v[172:175], v[228:231], a[204:207], v[172:175]
    v_accvgpr_write_b32 a11, v11
    v_lshlrev_b32 v16, 16, v12
    v_mfma_f32_16x16x32_bf16 v[172:175], v[224:227], a[200:203], v[172:175]
    ds_write_b128 v62, a[8:11] offset:34944
    v_mfma_f32_16x16x32_bf16 v[208:211], a[120:123], a[8:11], v[208:211]
    v_and_b32 v17, s3, v12
    v_lshlrev_b32 v18, 16, v13
    v_mfma_f32_16x16x32_bf16 v[212:215], a[136:139], a[8:11], v[212:215]
    v_and_b32 v19, s3, v13
    v_lshlrev_b32 v20, 16, v14
    v_mfma_f32_16x16x32_bf16 v[216:219], a[152:155], a[8:11], v[216:219]
    v_and_b32 v21, s3, v14
    v_lshlrev_b32 v22, 16, v15
    v_mfma_f32_16x16x32_bf16 v[220:223], a[168:171], a[8:11], v[220:223]
    v_and_b32_e64 v23, s3, v15
    v_pk_mul_f32 v[16:17], v[16:17], s[100:101]
    v_pk_mul_f32 v[18:19], v[18:19], s[100:101]
    v_pk_mul_f32 v[20:21], v[20:21], s[100:101]
    v_pk_mul_f32 v[22:23], v[22:23], s[100:101]
    v_cvt_pk_bf16_f32 v12, v16, v17
    v_accvgpr_write_b32 a12, v12
    v_cvt_pk_bf16_f32 v13, v18, v19
    v_accvgpr_write_b32 a13, v13
    v_cvt_pk_bf16_f32 v14, v20, v21
    v_accvgpr_write_b32 a14, v14
    v_cvt_pk_bf16_f32 v15, v22, v23
    v_accvgpr_write_b32 a15, v15
    s_nop 1
    v_mfma_f32_16x16x32_bf16 v[208:211], a[124:127], a[12:15], v[208:211]
    buffer_load_dwordx4 v57, s[12:15], s36 offen offset:3072 nt lds
    ds_write_b128 v62, a[12:15] offset:35008
    s_add_u32 m0, s76, 4352
    s_sub_u32 s36, s78, 16384
    v_mfma_f32_16x16x32_bf16 v[212:215], a[140:143], a[12:15], v[212:215]
    s_nop 2
    v_exp_f32 v208, v208
    v_mfma_f32_16x16x32_bf16 v[216:219], a[156:159], a[12:15], v[216:219]
    v_exp_f32 v209, v209
    v_mfma_f32_16x16x32_bf16 v[220:223], a[172:175], a[12:15], v[220:223]
    v_cvt_pk_bf16_f32 v232, v208, v209
    v_exp_f32 v210, v210
    v_exp_f32 v211, v211
    v_exp_f32 v212, v212
    v_cvt_pk_bf16_f32 v233, v210, v211
    v_exp_f32 v213, v213
    v_exp_f32 v214, v214
    v_cvt_pk_bf16_f32 v234, v212, v213
    v_exp_f32 v215, v215
    v_exp_f32 v216, v216
    v_cvt_pk_bf16_f32 v235, v214, v215
    v_exp_f32 v217, v217
    v_exp_f32 v218, v218
    v_cvt_pk_bf16_f32 v236, v216, v217
    v_exp_f32 v219, v219
    v_exp_f32 v220, v220
    v_cvt_pk_bf16_f32 v237, v218, v219
    v_exp_f32 v221, v221
    v_exp_f32 v222, v222
    v_cvt_pk_bf16_f32 v238, v220, v221
    v_exp_f32 v223, v223
    s_waitcnt vmcnt(4)
    v_cvt_pk_bf16_f32 v239, v222, v223
    s_nop 1
    v_smfmac_f32_16x16x64_bf16 v[244:247], v[248:251], v[232:239], v240
    ds_read_b128 v[128:131], v62 offset:52224
    ds_read_b128 v[132:135], v62 offset:52288
    ds_read_b128 v[136:139], v62 offset:52352
    ds_read_b128 v[140:143], v62 offset:52416
    v_mov_b32_dpp v248, v248 row_ror:8 row_mask:0xf bank_mask:0xf
    v_mov_b32_dpp v249, v249 row_ror:8 row_mask:0xf bank_mask:0xf
    v_mov_b32_dpp v250, v250 row_ror:8 row_mask:0xf bank_mask:0xf
    v_mov_b32_dpp v251, v251 row_ror:8 row_mask:0xf bank_mask:0xf
    v_add_f32_dpp v58, v244, v245 quad_perm:[0,1,2,3] row_mask:0x1 bank_mask:0xf
    s_nop 1
    v_mfma_f32_16x16x4_f32 v[12:15], v58, v61, 0
    v_mov_b32_e64 v58, 0
    s_nop 8
    v_and_or_b32 v12, v12, s79, v60
    v_and_or_b32 v13, v13, s79, v60
    v_and_or_b32 v14, v14, s79, v60
    v_and_or_b32 v15, v15, s79, v60
    s_nop 1
    v_mfma_f32_16x16x32_bf16 v[0:3], v[232:235], a[176:179], v[12:15]
    ds_write_b128 v59, v[12:15] offset:0
    v_mfma_f32_16x16x32_bf16 v[0:3], v[236:239], a[180:183], v[0:3]
    s_waitcnt lgkmcnt(4)
    v_lshlrev_b32 v144, 16, v128
    v_and_b32 v145, s3, v128
    v_mfma_f32_16x16x32_bf16 v[4:7], v[236:239], a[188:191], v[12:15]
    buffer_load_dwordx4 v57, s[12:15], s36 offen offset:0 nt lds
    v_lshlrev_b32 v146, 16, v129
    v_mfma_f32_16x16x32_bf16 v[4:7], v[232:235], a[184:187], v[4:7]
    s_add_u32 m0, m0, 64
    v_and_b32 v147, s3, v129
    v_lshlrev_b32 v148, 16, v130
    v_mfma_f32_16x16x32_bf16 v[8:11], v[232:235], a[192:195], v[12:15]
    v_and_b32 v149, s3, v130
    v_lshlrev_b32 v150, 16, v131
    v_mfma_f32_16x16x32_bf16 v[8:11], v[236:239], a[196:199], v[8:11]
    v_and_b32_e64 v151, s3, v131
    v_pk_mul_f32 v[144:145], v[144:145], s[100:101]
    v_pk_mul_f32 v[146:147], v[146:147], s[100:101]
    v_pk_mul_f32 v[148:149], v[148:149], s[100:101]
    v_pk_mul_f32 v[150:151], v[150:151], s[100:101]
    v_mfma_f32_16x16x32_bf16 v[16:19], v[236:239], a[212:215], v[12:15]
    v_cvt_pk_bf16_f32 v128, v144, v145
    v_accvgpr_write_b32 a64, v128
    v_mfma_f32_16x16x32_bf16 v[16:19], v[232:235], a[208:211], v[16:19]
    v_cvt_pk_bf16_f32 v129, v146, v147
    v_accvgpr_write_b32 a65, v129
    v_mfma_f32_16x16x32_bf16 v[20:23], v[232:235], a[216:219], v[12:15]
    v_cvt_pk_bf16_f32 v130, v148, v149
    v_accvgpr_write_b32 a66, v130
    v_mfma_f32_16x16x32_bf16 v[20:23], v[236:239], a[220:223], v[20:23]
    v_cvt_pk_bf16_f32 v131, v150, v151
    v_accvgpr_write_b32 a67, v131
    v_mfma_f32_16x16x32_bf16 v[24:27], v[236:239], a[228:231], v[12:15]
    buffer_load_dwordx4 v57, s[12:15], s36 offen offset:1024 nt lds
    s_waitcnt lgkmcnt(0)
    v_lshlrev_b32 v144, 16, v132
    v_mfma_f32_16x16x32_bf16 v[208:211], a[112:115], a[64:67], v[240:243]
    s_add_u32 m0, m0, 64
    v_and_b32 v145, s3, v132
    v_lshlrev_b32 v146, 16, v133
    v_mfma_f32_16x16x32_bf16 v[212:215], a[128:131], a[64:67], v[240:243]
    v_and_b32 v147, s3, v133
    v_lshlrev_b32 v148, 16, v134
    v_mfma_f32_16x16x32_bf16 v[216:219], a[144:147], a[64:67], v[240:243]
    v_and_b32 v149, s3, v134
    v_lshlrev_b32 v150, 16, v135
    v_mfma_f32_16x16x32_bf16 v[220:223], a[160:163], a[64:67], v[240:243]
    v_and_b32 v151, s3, v135
    v_pk_mul_f32 v[144:145], v[144:145], s[100:101]
    v_pk_mul_f32 v[146:147], v[146:147], s[100:101]
    v_pk_mul_f32 v[148:149], v[148:149], s[100:101]
    v_pk_mul_f32 v[150:151], v[150:151], s[100:101]
    v_mfma_f32_16x16x32_bf16 v[24:27], v[232:235], a[224:227], v[24:27]
    v_cvt_pk_bf16_f32 v132, v144, v145
    v_accvgpr_write_b32 a68, v132
    v_mfma_f32_16x16x32_bf16 v[28:31], v[232:235], a[232:235], v[12:15]
    v_cvt_pk_bf16_f32 v133, v146, v147
    v_accvgpr_write_b32 a69, v133
    v_mfma_f32_16x16x32_bf16 v[28:31], v[236:239], a[236:239], v[28:31]
    v_cvt_pk_bf16_f32 v134, v148, v149
    v_accvgpr_write_b32 a70, v134
    v_mfma_f32_16x16x32_bf16 v[12:15], v[236:239], a[204:207], v[12:15]
    v_cvt_pk_bf16_f32 v135, v150, v151
    v_accvgpr_write_b32 a71, v135
    v_mfma_f32_16x16x32_bf16 v[12:15], v[232:235], a[200:203], v[12:15]
    v_lshlrev_b32 v144, 16, v136
    v_and_b32 v145, s3, v136
    v_mfma_f32_16x16x32_bf16 v[208:211], a[116:119], a[68:71], v[208:211]
    v_lshlrev_b32 v146, 16, v137
    v_and_b32 v147, s3, v137
    v_mfma_f32_16x16x32_bf16 v[212:215], a[132:135], a[68:71], v[212:215]
    buffer_load_dwordx4 v57, s[12:15], s36 offen offset:2048 nt lds
    v_lshlrev_b32 v148, 16, v138
    v_mfma_f32_16x16x32_bf16 v[216:219], a[148:151], a[68:71], v[216:219]
    s_add_u32 m0, m0, 64
    v_and_b32 v149, s3, v138
    v_lshlrev_b32 v150, 16, v139
    v_mfma_f32_16x16x32_bf16 v[220:223], a[164:167], a[68:71], v[220:223]
    v_and_b32_e64 v151, s3, v139
    v_pk_mul_f32 v[144:145], v[144:145], s[100:101]
    v_pk_mul_f32 v[146:147], v[146:147], s[100:101]
    v_pk_mul_f32 v[148:149], v[148:149], s[100:101]
    v_pk_mul_f32 v[150:151], v[150:151], s[100:101]
    v_cvt_pk_bf16_f32 v136, v144, v145
    v_accvgpr_write_b32 a72, v136
    v_cvt_pk_bf16_f32 v137, v146, v147
    v_accvgpr_write_b32 a73, v137
    v_cvt_pk_bf16_f32 v138, v148, v149
    v_accvgpr_write_b32 a74, v138
    v_cvt_pk_bf16_f32 v139, v150, v151
    v_accvgpr_write_b32 a75, v139
    v_lshlrev_b32 v144, 16, v140
    v_and_b32 v145, s3, v140
    v_mfma_f32_16x16x32_bf16 v[208:211], a[120:123], a[72:75], v[208:211]
    v_lshlrev_b32 v146, 16, v141
    v_and_b32 v147, s3, v141
    v_mfma_f32_16x16x32_bf16 v[212:215], a[136:139], a[72:75], v[212:215]
    v_lshlrev_b32 v148, 16, v142
    v_and_b32 v149, s3, v142
    v_mfma_f32_16x16x32_bf16 v[216:219], a[152:155], a[72:75], v[216:219]
    v_lshlrev_b32 v150, 16, v143
    v_and_b32 v151, s3, v143
    v_mfma_f32_16x16x32_bf16 v[220:223], a[168:171], a[72:75], v[220:223]
    buffer_load_dwordx4 v57, s[12:15], s36 offen offset:3072 nt lds
    v_pk_mul_f32 v[144:145], v[144:145], s[100:101]
    v_pk_mul_f32 v[146:147], v[146:147], s[100:101]
    v_pk_mul_f32 v[148:149], v[148:149], s[100:101]
    v_pk_mul_f32 v[150:151], v[150:151], s[100:101]
    v_cvt_pk_bf16_f32 v140, v144, v145
    v_accvgpr_write_b32 a76, v140
    v_cvt_pk_bf16_f32 v141, v146, v147
    v_accvgpr_write_b32 a77, v141
    v_cvt_pk_bf16_f32 v142, v148, v149
    v_accvgpr_write_b32 a78, v142
    v_cvt_pk_bf16_f32 v143, v150, v151
    v_accvgpr_write_b32 a79, v143
    s_add_u32 m0, s76, 8704
    s_sub_u32 s36, s78, 20480
    v_mfma_f32_16x16x32_bf16 v[208:211], a[124:127], a[76:79], v[208:211]
    v_mfma_f32_16x16x32_bf16 v[212:215], a[140:143], a[76:79], v[212:215]
    v_mfma_f32_16x16x32_bf16 v[216:219], a[156:159], a[76:79], v[216:219]
    v_mfma_f32_16x16x32_bf16 v[220:223], a[172:175], a[76:79], v[220:223]
    s_nop 4
    v_exp_f32 v208, v208
    v_exp_f32 v209, v209
    v_exp_f32 v210, v210
    v_cvt_pk_bf16_f32 v224, v208, v209
    v_exp_f32 v211, v211
    v_exp_f32 v212, v212
    v_cvt_pk_bf16_f32 v225, v210, v211
    v_exp_f32 v213, v213
    v_exp_f32 v214, v214
    v_cvt_pk_bf16_f32 v226, v212, v213
    v_exp_f32 v215, v215
    v_exp_f32 v216, v216
    v_cvt_pk_bf16_f32 v227, v214, v215
    v_exp_f32 v217, v217
    v_exp_f32 v218, v218
    v_cvt_pk_bf16_f32 v228, v216, v217
    v_exp_f32 v219, v219
    v_exp_f32 v220, v220
    v_cvt_pk_bf16_f32 v229, v218, v219
    v_exp_f32 v221, v221
    v_exp_f32 v222, v222
    v_cvt_pk_bf16_f32 v230, v220, v221
    v_exp_f32_e64 v223, v223
    s_waitcnt vmcnt(4)
    v_cvt_pk_bf16_f32 v231, v222, v223
    s_nop 1
    v_smfmac_f32_16x16x64_bf16 v[244:247], v[248:251], v[224:231], v240
    ds_read_b128 v[96:99], v63 offset:0
    ds_read_b128 v[100:103], v63 offset:64
    ds_read_b128 v[104:107], v63 offset:128
    ds_read_b128 v[108:111], v63 offset:192
    v_mov_b32_dpp v248, v248 row_ror:14 row_mask:0xf bank_mask:0xf
    v_mov_b32_dpp v249, v249 row_ror:14 row_mask:0xf bank_mask:0xf
    v_mov_b32_dpp v250, v250 row_ror:14 row_mask:0xf bank_mask:0xf
    v_mov_b32_dpp v251, v251 row_ror:14 row_mask:0xf bank_mask:0xf
    v_add_f32_dpp v58, v244, v245 quad_perm:[0,1,2,3] row_mask:0x4 bank_mask:0xf
    s_nop 1
    v_mfma_f32_16x16x4_f32 v[140:143], v58, v61, 0
    v_mov_b32_e64 v58, 0
    s_nop 8
    v_and_or_b32 v140, v140, s79, v60
    v_and_or_b32 v141, v141, s79, v60
    v_and_or_b32 v142, v142, s79, v60
    v_and_or_b32 v143, v143, s79, v60
    s_nop 1
    v_mfma_f32_16x16x32_bf16 v[128:131], v[224:227], a[176:179], v[140:143]
    ds_write_b128 v59, v[140:143] offset:256
    v_mfma_f32_16x16x32_bf16 v[128:131], v[228:231], a[180:183], v[128:131]
    s_waitcnt lgkmcnt(4)
    v_lshlrev_b32 v112, 16, v96
    v_and_b32 v113, s3, v96
    v_mfma_f32_16x16x32_bf16 v[132:135], v[228:231], a[188:191], v[140:143]
    buffer_load_dwordx4 v57, s[12:15], s36 offen offset:0 nt lds
    v_lshlrev_b32 v114, 16, v97
    v_mfma_f32_16x16x32_bf16 v[132:135], v[224:227], a[184:187], v[132:135]
    s_add_u32 m0, m0, 64
    v_and_b32 v115, s3, v97
    v_lshlrev_b32 v116, 16, v98
    v_mfma_f32_16x16x32_bf16 v[136:139], v[224:227], a[192:195], v[140:143]
    v_and_b32 v117, s3, v98
    v_lshlrev_b32 v118, 16, v99
    v_mfma_f32_16x16x32_bf16 v[136:139], v[228:231], a[196:199], v[136:139]
    v_and_b32_e64 v119, s3, v99
    v_pk_mul_f32 v[112:113], v[112:113], s[100:101]
    v_pk_mul_f32 v[114:115], v[114:115], s[100:101]
    v_pk_mul_f32 v[116:117], v[116:117], s[100:101]
    v_pk_mul_f32 v[118:119], v[118:119], s[100:101]
    v_mfma_f32_16x16x32_bf16 v[144:147], v[228:231], a[212:215], v[140:143]
    v_cvt_pk_bf16_f32 v96, v112, v113
    v_accvgpr_write_b32 a48, v96
    v_mfma_f32_16x16x32_bf16 v[144:147], v[224:227], a[208:211], v[144:147]
    v_cvt_pk_bf16_f32 v97, v114, v115
    v_accvgpr_write_b32 a49, v97
    v_mfma_f32_16x16x32_bf16 v[148:151], v[224:227], a[216:219], v[140:143]
    v_cvt_pk_bf16_f32 v98, v116, v117
    v_accvgpr_write_b32 a50, v98
    v_mfma_f32_16x16x32_bf16 v[148:151], v[228:231], a[220:223], v[148:151]
    v_cvt_pk_bf16_f32 v99, v118, v119
    v_accvgpr_write_b32 a51, v99
    v_mfma_f32_16x16x32_bf16 v[152:155], v[228:231], a[228:231], v[140:143]
    buffer_load_dwordx4 v57, s[12:15], s36 offen offset:1024 nt lds
    s_waitcnt lgkmcnt(0)
    v_lshlrev_b32 v112, 16, v100
    v_mfma_f32_16x16x32_bf16 v[208:211], a[112:115], a[48:51], v[240:243]
    s_add_u32 m0, m0, 64
    v_and_b32 v113, s3, v100
    v_lshlrev_b32 v114, 16, v101
    v_mfma_f32_16x16x32_bf16 v[212:215], a[128:131], a[48:51], v[240:243]
    v_and_b32 v115, s3, v101
    v_lshlrev_b32 v116, 16, v102
    v_mfma_f32_16x16x32_bf16 v[216:219], a[144:147], a[48:51], v[240:243]
    v_and_b32 v117, s3, v102
    v_lshlrev_b32 v118, 16, v103
    v_mfma_f32_16x16x32_bf16 v[220:223], a[160:163], a[48:51], v[240:243]
    v_and_b32 v119, s3, v103
    v_pk_mul_f32 v[112:113], v[112:113], s[100:101]
    v_pk_mul_f32 v[114:115], v[114:115], s[100:101]
    v_pk_mul_f32 v[116:117], v[116:117], s[100:101]
    v_pk_mul_f32 v[118:119], v[118:119], s[100:101]
    v_mfma_f32_16x16x32_bf16 v[152:155], v[224:227], a[224:227], v[152:155]
    v_cvt_pk_bf16_f32 v100, v112, v113
    v_accvgpr_write_b32 a52, v100
    v_mfma_f32_16x16x32_bf16 v[156:159], v[224:227], a[232:235], v[140:143]
    v_cvt_pk_bf16_f32 v101, v114, v115
    v_accvgpr_write_b32 a53, v101
    v_mfma_f32_16x16x32_bf16 v[156:159], v[228:231], a[236:239], v[156:159]
    v_cvt_pk_bf16_f32 v102, v116, v117
    v_accvgpr_write_b32 a54, v102
    v_mfma_f32_16x16x32_bf16 v[140:143], v[228:231], a[204:207], v[140:143]
    v_cvt_pk_bf16_f32 v103, v118, v119
    v_accvgpr_write_b32 a55, v103
    v_mfma_f32_16x16x32_bf16 v[140:143], v[224:227], a[200:203], v[140:143]
    v_lshlrev_b32 v112, 16, v104
    v_and_b32 v113, s3, v104
    v_mfma_f32_16x16x32_bf16 v[208:211], a[116:119], a[52:55], v[208:211]
    v_lshlrev_b32 v114, 16, v105
    v_and_b32 v115, s3, v105
    v_mfma_f32_16x16x32_bf16 v[212:215], a[132:135], a[52:55], v[212:215]
    buffer_load_dwordx4 v57, s[12:15], s36 offen offset:2048 nt lds
    v_lshlrev_b32 v116, 16, v106
    v_mfma_f32_16x16x32_bf16 v[216:219], a[148:151], a[52:55], v[216:219]
    s_add_u32 m0, m0, 64
    v_and_b32 v117, s3, v106
    v_lshlrev_b32 v118, 16, v107
    v_mfma_f32_16x16x32_bf16 v[220:223], a[164:167], a[52:55], v[220:223]
    v_and_b32_e64 v119, s3, v107
    v_pk_mul_f32 v[112:113], v[112:113], s[100:101]
    v_pk_mul_f32 v[114:115], v[114:115], s[100:101]
    v_pk_mul_f32 v[116:117], v[116:117], s[100:101]
    v_pk_mul_f32 v[118:119], v[118:119], s[100:101]
    v_cvt_pk_bf16_f32 v104, v112, v113
    v_accvgpr_write_b32 a56, v104
    v_cvt_pk_bf16_f32 v105, v114, v115
    v_accvgpr_write_b32 a57, v105
    v_cvt_pk_bf16_f32 v106, v116, v117
    v_accvgpr_write_b32 a58, v106
    v_cvt_pk_bf16_f32 v107, v118, v119
    v_accvgpr_write_b32 a59, v107
    v_lshlrev_b32 v112, 16, v108
    v_and_b32 v113, s3, v108
    v_mfma_f32_16x16x32_bf16 v[208:211], a[120:123], a[56:59], v[208:211]
    v_lshlrev_b32 v114, 16, v109
    v_and_b32 v115, s3, v109
    v_mfma_f32_16x16x32_bf16 v[212:215], a[136:139], a[56:59], v[212:215]
    v_lshlrev_b32 v116, 16, v110
    v_and_b32 v117, s3, v110
    v_mfma_f32_16x16x32_bf16 v[216:219], a[152:155], a[56:59], v[216:219]
    v_lshlrev_b32 v118, 16, v111
    v_and_b32 v119, s3, v111
    v_mfma_f32_16x16x32_bf16 v[220:223], a[168:171], a[56:59], v[220:223]
    buffer_load_dwordx4 v57, s[12:15], s36 offen offset:3072 nt lds
    v_pk_mul_f32 v[112:113], v[112:113], s[100:101]
    v_pk_mul_f32 v[114:115], v[114:115], s[100:101]
    v_pk_mul_f32 v[116:117], v[116:117], s[100:101]
    v_pk_mul_f32 v[118:119], v[118:119], s[100:101]
    v_cvt_pk_bf16_f32 v108, v112, v113
    v_accvgpr_write_b32 a60, v108
    v_cvt_pk_bf16_f32 v109, v114, v115
    v_accvgpr_write_b32 a61, v109
    v_cvt_pk_bf16_f32 v110, v116, v117
    v_accvgpr_write_b32 a62, v110
    v_cvt_pk_bf16_f32 v111, v118, v119
    v_accvgpr_write_b32 a63, v111
    s_add_u32 m0, s68, 39936
    s_add_u32 s8, s0, 16384
    v_mfma_f32_16x16x32_bf16 v[208:211], a[124:127], a[60:63], v[208:211]
    s_addc_u32 s9, s1, 0
    v_mfma_f32_16x16x32_bf16 v[212:215], a[140:143], a[60:63], v[212:215]
    v_mfma_f32_16x16x32_bf16 v[216:219], a[156:159], a[60:63], v[216:219]
    v_mfma_f32_16x16x32_bf16 v[220:223], a[172:175], a[60:63], v[220:223]
    s_nop 3
    v_exp_f32 v208, v208
    v_exp_f32 v209, v209
    v_exp_f32 v210, v210
    v_cvt_pk_bf16_f32 v232, v208, v209
    v_exp_f32 v211, v211
    v_exp_f32 v212, v212
    v_cvt_pk_bf16_f32 v233, v210, v211
    v_exp_f32 v213, v213
    v_exp_f32 v214, v214
    v_cvt_pk_bf16_f32 v234, v212, v213
    v_exp_f32 v215, v215
    v_exp_f32 v216, v216
    v_cvt_pk_bf16_f32 v235, v214, v215
    v_exp_f32 v217, v217
    v_exp_f32 v218, v218
    v_cvt_pk_bf16_f32 v236, v216, v217
    v_exp_f32 v219, v219
    v_exp_f32 v220, v220
    v_cvt_pk_bf16_f32 v237, v218, v219
    v_exp_f32 v221, v221
    v_exp_f32 v222, v222
    v_cvt_pk_bf16_f32 v238, v220, v221
    v_exp_f32 v223, v223
    s_waitcnt vmcnt(4)
    v_cvt_pk_bf16_f32 v239, v222, v223
    s_nop 1
    v_smfmac_f32_16x16x64_bf16 v[244:247], v[248:251], v[232:239], v240
    ds_read_b128 v[64:67], v63 offset:4352
    ds_read_b128 v[68:71], v63 offset:4416
    ds_read_b128 v[72:75], v63 offset:4480
    ds_read_b128 v[76:79], v63 offset:4544
    v_mov_b32_dpp v248, v248 row_ror:14 row_mask:0xf bank_mask:0xf
    v_mov_b32_dpp v249, v249 row_ror:14 row_mask:0xf bank_mask:0xf
    v_mov_b32_dpp v250, v250 row_ror:14 row_mask:0xf bank_mask:0xf
    v_mov_b32_dpp v251, v251 row_ror:14 row_mask:0xf bank_mask:0xf
    v_add_f32_dpp v58, v246, v247 quad_perm:[0,1,2,3] row_mask:0x2 bank_mask:0xf
    s_nop 1
    v_mfma_f32_16x16x4_f32 v[108:111], v58, v61, 0
    v_mov_b32_e64 v58, 0
    s_nop 8
    v_and_or_b32 v108, v108, s79, v60
    v_and_or_b32 v109, v109, s79, v60
    v_and_or_b32 v110, v110, s79, v60
    v_and_or_b32 v111, v111, s79, v60
    s_nop 1
    v_mfma_f32_16x16x32_bf16 v[96:99], v[232:235], a[176:179], v[108:111]
    ds_write_b128 v59, v[108:111] offset:192
    v_mfma_f32_16x16x32_bf16 v[96:99], v[236:239], a[180:183], v[96:99]
    s_waitcnt lgkmcnt(4)
    v_lshlrev_b32 v80, 16, v64
    v_and_b32 v81, s3, v64
    v_mfma_f32_16x16x32_bf16 v[100:103], v[236:239], a[188:191], v[108:111]
    global_load_lds_dwordx4 v254, s[8:9] offset:0 nt
    v_lshlrev_b32 v82, 16, v65
    v_mfma_f32_16x16x32_bf16 v[100:103], v[232:235], a[184:187], v[100:103]
    s_add_u32 m0, m0, 32
    v_and_b32 v83, s3, v65
    v_lshlrev_b32 v84, 16, v66
    v_mfma_f32_16x16x32_bf16 v[104:107], v[232:235], a[192:195], v[108:111]
    v_and_b32 v85, s3, v66
    v_lshlrev_b32 v86, 16, v67
    v_mfma_f32_16x16x32_bf16 v[104:107], v[236:239], a[196:199], v[104:107]
    v_and_b32_e64 v87, s3, v67
    v_pk_mul_f32 v[80:81], v[80:81], s[100:101]
    v_pk_mul_f32 v[82:83], v[82:83], s[100:101]
    v_pk_mul_f32 v[84:85], v[84:85], s[100:101]
    v_pk_mul_f32 v[86:87], v[86:87], s[100:101]
    v_mfma_f32_16x16x32_bf16 v[112:115], v[236:239], a[212:215], v[108:111]
    v_cvt_pk_bf16_f32 v64, v80, v81
    v_accvgpr_write_b32 a32, v64
    v_mfma_f32_16x16x32_bf16 v[112:115], v[232:235], a[208:211], v[112:115]
    v_cvt_pk_bf16_f32 v65, v82, v83
    v_accvgpr_write_b32 a33, v65
    v_mfma_f32_16x16x32_bf16 v[116:119], v[232:235], a[216:219], v[108:111]
    v_cvt_pk_bf16_f32 v66, v84, v85
    v_accvgpr_write_b32 a34, v66
    v_mfma_f32_16x16x32_bf16 v[116:119], v[236:239], a[220:223], v[116:119]
    v_cvt_pk_bf16_f32 v67, v86, v87
    v_accvgpr_write_b32 a35, v67
    v_mfma_f32_16x16x32_bf16 v[120:123], v[236:239], a[228:231], v[108:111]
    global_load_lds_dwordx4 v254, s[8:9] offset:1024 nt
    s_waitcnt lgkmcnt(0)
    v_lshlrev_b32 v80, 16, v68
    v_mfma_f32_16x16x32_bf16 v[208:211], a[112:115], a[32:35], v[240:243]
    s_add_u32 m0, s69, 56832
    v_and_b32 v81, s3, v68
    v_lshlrev_b32 v82, 16, v69
    v_mfma_f32_16x16x32_bf16 v[212:215], a[128:131], a[32:35], v[240:243]
    s_add_u32 s8, s38, 16384
    v_and_b32 v83, s3, v69
    v_lshlrev_b32 v84, 16, v70
    v_mfma_f32_16x16x32_bf16 v[216:219], a[144:147], a[32:35], v[240:243]
    s_addc_u32 s9, s39, 0
    v_and_b32 v85, s3, v70
    v_lshlrev_b32 v86, 16, v71
    v_mfma_f32_16x16x32_bf16 v[220:223], a[160:163], a[32:35], v[240:243]
    v_and_b32 v87, s3, v71
    v_pk_mul_f32 v[80:81], v[80:81], s[100:101]
    v_pk_mul_f32 v[82:83], v[82:83], s[100:101]
    v_pk_mul_f32 v[84:85], v[84:85], s[100:101]
    v_pk_mul_f32 v[86:87], v[86:87], s[100:101]
    v_mfma_f32_16x16x32_bf16 v[120:123], v[232:235], a[224:227], v[120:123]
    v_cvt_pk_bf16_f32 v68, v80, v81
    v_accvgpr_write_b32 a36, v68
    v_mfma_f32_16x16x32_bf16 v[124:127], v[232:235], a[232:235], v[108:111]
    v_cvt_pk_bf16_f32 v69, v82, v83
    v_accvgpr_write_b32 a37, v69
    v_mfma_f32_16x16x32_bf16 v[124:127], v[236:239], a[236:239], v[124:127]
    v_cvt_pk_bf16_f32 v70, v84, v85
    v_accvgpr_write_b32 a38, v70
    v_mfma_f32_16x16x32_bf16 v[108:111], v[236:239], a[204:207], v[108:111]
    v_cvt_pk_bf16_f32 v71, v86, v87
    v_accvgpr_write_b32 a39, v71
    v_mfma_f32_16x16x32_bf16 v[108:111], v[232:235], a[200:203], v[108:111]
    v_lshlrev_b32 v80, 16, v72
    v_and_b32 v81, s3, v72
    v_mfma_f32_16x16x32_bf16 v[208:211], a[116:119], a[36:39], v[208:211]
    v_lshlrev_b32 v82, 16, v73
    v_and_b32 v83, s3, v73
    v_mfma_f32_16x16x32_bf16 v[212:215], a[132:135], a[36:39], v[212:215]
    global_load_lds_dwordx4 v254, s[8:9] offset:0 nt
    v_lshlrev_b32 v84, 16, v74
    v_mfma_f32_16x16x32_bf16 v[216:219], a[148:151], a[36:39], v[216:219]
    s_add_u32 m0, m0, 16
    v_and_b32 v85, s3, v74
    v_lshlrev_b32 v86, 16, v75
    v_mfma_f32_16x16x32_bf16 v[220:223], a[164:167], a[36:39], v[220:223]
    v_and_b32_e64 v87, s3, v75
    v_pk_mul_f32 v[80:81], v[80:81], s[100:101]
    v_pk_mul_f32 v[82:83], v[82:83], s[100:101]
    v_pk_mul_f32 v[84:85], v[84:85], s[100:101]
    v_pk_mul_f32 v[86:87], v[86:87], s[100:101]
    v_cvt_pk_bf16_f32 v72, v80, v81
    v_accvgpr_write_b32 a40, v72
    v_cvt_pk_bf16_f32 v73, v82, v83
    v_accvgpr_write_b32 a41, v73
    v_cvt_pk_bf16_f32 v74, v84, v85
    v_accvgpr_write_b32 a42, v74
    v_cvt_pk_bf16_f32 v75, v86, v87
    v_accvgpr_write_b32 a43, v75
    v_lshlrev_b32 v80, 16, v76
    v_and_b32 v81, s3, v76
    v_mfma_f32_16x16x32_bf16 v[208:211], a[120:123], a[40:43], v[208:211]
    v_lshlrev_b32 v82, 16, v77
    v_and_b32 v83, s3, v77
    v_mfma_f32_16x16x32_bf16 v[212:215], a[136:139], a[40:43], v[212:215]
    v_lshlrev_b32 v84, 16, v78
    v_and_b32 v85, s3, v78
    v_mfma_f32_16x16x32_bf16 v[216:219], a[152:155], a[40:43], v[216:219]
    v_lshlrev_b32 v86, 16, v79
    v_and_b32 v87, s3, v79
    v_mfma_f32_16x16x32_bf16 v[220:223], a[168:171], a[40:43], v[220:223]
    global_load_lds_dwordx4 v254, s[8:9] offset:1024 nt
    v_pk_mul_f32 v[80:81], v[80:81], s[100:101]
    v_pk_mul_f32 v[82:83], v[82:83], s[100:101]
    v_pk_mul_f32 v[84:85], v[84:85], s[100:101]
    v_pk_mul_f32 v[86:87], v[86:87], s[100:101]
    v_cvt_pk_bf16_f32 v76, v80, v81
    v_accvgpr_write_b32 a44, v76
    v_cvt_pk_bf16_f32 v77, v82, v83
    v_accvgpr_write_b32 a45, v77
    v_cvt_pk_bf16_f32 v78, v84, v85
    v_accvgpr_write_b32 a46, v78
    v_cvt_pk_bf16_f32 v79, v86, v87
    v_accvgpr_write_b32 a47, v79
    s_add_u32 m0, s68, 48384
    s_add_u32 s8, s0, 24576
    v_mfma_f32_16x16x32_bf16 v[208:211], a[124:127], a[44:47], v[208:211]
    s_addc_u32 s9, s1, 0
    v_mfma_f32_16x16x32_bf16 v[212:215], a[140:143], a[44:47], v[212:215]
    v_mfma_f32_16x16x32_bf16 v[216:219], a[156:159], a[44:47], v[216:219]
    v_mfma_f32_16x16x32_bf16 v[220:223], a[172:175], a[44:47], v[220:223]
    s_nop 3
    v_exp_f32 v208, v208
    v_exp_f32 v209, v209
    v_exp_f32 v210, v210
    v_cvt_pk_bf16_f32 v224, v208, v209
    v_exp_f32 v211, v211
    v_exp_f32 v212, v212
    v_cvt_pk_bf16_f32 v225, v210, v211
    v_exp_f32 v213, v213
    v_exp_f32 v214, v214
    v_cvt_pk_bf16_f32 v226, v212, v213
    v_exp_f32 v215, v215
    v_exp_f32 v216, v216
    v_cvt_pk_bf16_f32 v227, v214, v215
    v_exp_f32 v217, v217
    v_exp_f32 v218, v218
    v_cvt_pk_bf16_f32 v228, v216, v217
    v_exp_f32 v219, v219
    v_exp_f32 v220, v220
    v_cvt_pk_bf16_f32 v229, v218, v219
    v_exp_f32 v221, v221
    v_exp_f32 v222, v222
    v_cvt_pk_bf16_f32 v230, v220, v221
    v_exp_f32 v223, v223
    s_waitcnt vmcnt(4)
    v_cvt_pk_bf16_f32 v231, v222, v223
    s_nop 1
    v_smfmac_f32_16x16x64_bf16 v[244:247], v[248:251], v[224:231], v240
    ds_read_b128 v[32:35], v63 offset:8704
    ds_read_b128 v[36:39], v63 offset:8768
    ds_read_b128 v[40:43], v63 offset:8832
    ds_read_b128 v[44:47], v63 offset:8896
    v_mov_b32_dpp v248, v248 row_ror:14 row_mask:0xf bank_mask:0xf
    v_mov_b32_dpp v249, v249 row_ror:14 row_mask:0xf bank_mask:0xf
    v_mov_b32_dpp v250, v250 row_ror:14 row_mask:0xf bank_mask:0xf
    v_mov_b32_dpp v251, v251 row_ror:14 row_mask:0xf bank_mask:0xf
    v_add_f32_dpp v58, v244, v245 quad_perm:[0,1,2,3] row_mask:0x2 bank_mask:0xf
    s_nop 1
    v_mfma_f32_16x16x4_f32 v[76:79], v58, v61, 0
    v_mov_b32_e64 v58, 0
    s_nop 8
    v_and_or_b32 v76, v76, s79, v60
    v_and_or_b32 v77, v77, s79, v60
    v_and_or_b32 v78, v78, s79, v60
    v_and_or_b32 v79, v79, s79, v60
    s_nop 1
    v_mfma_f32_16x16x32_bf16 v[64:67], v[224:227], a[176:179], v[76:79]
    ds_write_b128 v59, v[76:79] offset:128
    v_mfma_f32_16x16x32_bf16 v[64:67], v[228:231], a[180:183], v[64:67]
    s_waitcnt lgkmcnt(4)
    v_lshlrev_b32 v48, 16, v32
    v_and_b32 v49, s3, v32
    v_mfma_f32_16x16x32_bf16 v[68:71], v[228:231], a[188:191], v[76:79]
    global_load_lds_dwordx4 v254, s[8:9] offset:0 nt
    v_lshlrev_b32 v50, 16, v33
    v_mfma_f32_16x16x32_bf16 v[68:71], v[224:227], a[184:187], v[68:71]
    s_add_u32 m0, m0, 32
    v_and_b32 v51, s3, v33
    v_lshlrev_b32 v52, 16, v34
    v_mfma_f32_16x16x32_bf16 v[72:75], v[224:227], a[192:195], v[76:79]
    v_and_b32 v53, s3, v34
    v_lshlrev_b32 v54, 16, v35
    v_mfma_f32_16x16x32_bf16 v[72:75], v[228:231], a[196:199], v[72:75]
    v_and_b32_e64 v55, s3, v35
    v_pk_mul_f32 v[48:49], v[48:49], s[100:101]
    v_pk_mul_f32 v[50:51], v[50:51], s[100:101]
    v_pk_mul_f32 v[52:53], v[52:53], s[100:101]
    v_pk_mul_f32 v[54:55], v[54:55], s[100:101]
    v_mfma_f32_16x16x32_bf16 v[80:83], v[228:231], a[212:215], v[76:79]
    v_cvt_pk_bf16_f32 v32, v48, v49
    v_accvgpr_write_b32 a16, v32
    v_mfma_f32_16x16x32_bf16 v[80:83], v[224:227], a[208:211], v[80:83]
    v_cvt_pk_bf16_f32 v33, v50, v51
    v_accvgpr_write_b32 a17, v33
    v_mfma_f32_16x16x32_bf16 v[84:87], v[224:227], a[216:219], v[76:79]
    v_cvt_pk_bf16_f32 v34, v52, v53
    v_accvgpr_write_b32 a18, v34
    v_mfma_f32_16x16x32_bf16 v[84:87], v[228:231], a[220:223], v[84:87]
    global_load_lds_dwordx4 v254, s[8:9] offset:1024 nt
    v_cvt_pk_bf16_f32 v35, v54, v55
    v_mfma_f32_16x16x32_bf16 v[88:91], v[228:231], a[228:231], v[76:79]
    s_add_u32 m0, s69, 65152
    v_accvgpr_write_b32 a19, v35
    s_waitcnt lgkmcnt(0)
    v_lshlrev_b32 v48, 16, v36
    v_mfma_f32_16x16x32_bf16 v[88:91], v[224:227], a[224:227], v[88:91]
    s_add_u32 s8, s38, 24576
    v_and_b32 v49, s3, v36
    v_lshlrev_b32 v50, 16, v37
    v_mfma_f32_16x16x32_bf16 v[208:211], a[112:115], a[16:19], v[240:243]
    s_addc_u32 s9, s39, 0
    v_and_b32 v51, s3, v37
    v_lshlrev_b32 v52, 16, v38
    v_mfma_f32_16x16x32_bf16 v[212:215], a[128:131], a[16:19], v[240:243]
    v_and_b32 v53, s3, v38
    v_lshlrev_b32 v54, 16, v39
    v_mfma_f32_16x16x32_bf16 v[216:219], a[144:147], a[16:19], v[240:243]
    v_and_b32 v55, s3, v39
    v_pk_mul_f32 v[48:49], v[48:49], s[100:101]
    v_pk_mul_f32 v[50:51], v[50:51], s[100:101]
    v_pk_mul_f32 v[52:53], v[52:53], s[100:101]
    v_pk_mul_f32 v[54:55], v[54:55], s[100:101]
    v_mfma_f32_16x16x32_bf16 v[220:223], a[160:163], a[16:19], v[240:243]
    v_cvt_pk_bf16_f32 v36, v48, v49
    v_accvgpr_write_b32 a20, v36
    v_mfma_f32_16x16x32_bf16 v[92:95], v[224:227], a[232:235], v[76:79]
    v_cvt_pk_bf16_f32 v37, v50, v51
    v_accvgpr_write_b32 a21, v37
    v_mfma_f32_16x16x32_bf16 v[92:95], v[228:231], a[236:239], v[92:95]
    v_cvt_pk_bf16_f32 v38, v52, v53
    v_accvgpr_write_b32 a22, v38
    v_mfma_f32_16x16x32_bf16 v[76:79], v[228:231], a[204:207], v[76:79]
    v_cvt_pk_bf16_f32 v39, v54, v55
    v_accvgpr_write_b32 a23, v39
    v_mfma_f32_16x16x32_bf16 v[76:79], v[224:227], a[200:203], v[76:79]
    global_load_lds_dwordx4 v254, s[8:9] offset:0 nt
    v_lshlrev_b32 v48, 16, v40
    v_mfma_f32_16x16x32_bf16 v[208:211], a[116:119], a[20:23], v[208:211]
    s_add_u32 m0, m0, 16
    v_and_b32 v49, s3, v40
    v_lshlrev_b32 v50, 16, v41
    v_mfma_f32_16x16x32_bf16 v[212:215], a[132:135], a[20:23], v[212:215]
    v_and_b32 v51, s3, v41
    v_lshlrev_b32 v52, 16, v42
    v_mfma_f32_16x16x32_bf16 v[216:219], a[148:151], a[20:23], v[216:219]
    v_and_b32 v53, s3, v42
    v_lshlrev_b32 v54, 16, v43
    v_mfma_f32_16x16x32_bf16 v[220:223], a[164:167], a[20:23], v[220:223]
    v_and_b32_e64 v55, s3, v43
    v_pk_mul_f32 v[48:49], v[48:49], s[100:101]
    v_pk_mul_f32 v[50:51], v[50:51], s[100:101]
    v_pk_mul_f32 v[52:53], v[52:53], s[100:101]
    v_pk_mul_f32 v[54:55], v[54:55], s[100:101]
    v_cvt_pk_bf16_f32 v40, v48, v49
    v_accvgpr_write_b32 a24, v40
    v_cvt_pk_bf16_f32 v41, v50, v51
    v_accvgpr_write_b32 a25, v41
    v_cvt_pk_bf16_f32 v42, v52, v53
    v_accvgpr_write_b32 a26, v42
    v_cvt_pk_bf16_f32 v43, v54, v55
    v_accvgpr_write_b32 a27, v43
    v_lshlrev_b32 v48, 16, v44
    v_and_b32 v49, s3, v44
    v_mfma_f32_16x16x32_bf16 v[208:211], a[120:123], a[24:27], v[208:211]
    global_load_lds_dwordx4 v254, s[8:9] offset:1024 nt
    v_lshlrev_b32 v50, 16, v45
    v_mfma_f32_16x16x32_bf16 v[212:215], a[136:139], a[24:27], v[212:215]
    s_add_u32 m0, s68, 73472
    v_and_b32 v51, s3, v45
    v_lshlrev_b32 v52, 16, v46
    v_mfma_f32_16x16x32_bf16 v[216:219], a[152:155], a[24:27], v[216:219]
    s_add_u32 s8, s0, 32768
    v_and_b32 v53, s3, v46
    v_lshlrev_b32 v54, 16, v47
    v_mfma_f32_16x16x32_bf16 v[220:223], a[168:171], a[24:27], v[220:223]
    s_addc_u32 s9, s1, 0
    v_and_b32_e64 v55, s3, v47
    v_pk_mul_f32 v[48:49], v[48:49], s[100:101]
    v_pk_mul_f32 v[50:51], v[50:51], s[100:101]
    v_pk_mul_f32 v[52:53], v[52:53], s[100:101]
    v_pk_mul_f32 v[54:55], v[54:55], s[100:101]
    v_cvt_pk_bf16_f32 v44, v48, v49
    v_accvgpr_write_b32 a28, v44
    v_cvt_pk_bf16_f32 v45, v50, v51
    v_accvgpr_write_b32 a29, v45
    v_cvt_pk_bf16_f32 v46, v52, v53
    v_accvgpr_write_b32 a30, v46
    v_cvt_pk_bf16_f32 v47, v54, v55
    v_accvgpr_write_b32 a31, v47
    v_mov_b32 v228, 0
    v_mov_b32 v229, 0
    v_mfma_f32_16x16x32_bf16 v[208:211], a[124:127], a[28:31], v[208:211]
    v_mov_b32 v230, 0
    v_mov_b32_e64 v231, 0
    v_mfma_f32_16x16x32_bf16 v[212:215], a[140:143], a[28:31], v[212:215]
    v_mfma_f32_16x16x32_bf16 v[216:219], a[156:159], a[28:31], v[216:219]
    s_nop 3
    s_waitcnt vmcnt(6)
    v_mfma_f32_16x16x32_bf16 v[220:223], a[172:175], a[28:31], v[220:223]
    s_barrier
    ds_read_b128 a[112:115], v252 offset:33536
    ds_read_b128 a[116:119], v252 offset:33600
    ds_read_b128 a[120:123], v252 offset:33664
    ds_read_b128 a[124:127], v252 offset:33728
    ds_read_b128 a[128:131], v252 offset:34048
    ds_read_b128 a[132:135], v252 offset:34112
    ds_read_b128 a[136:139], v252 offset:34176
    ds_read_b128 a[140:143], v252 offset:34240
    v_exp_f32 v208, v208
    v_exp_f32 v209, v209
    v_exp_f32 v210, v210
    v_cvt_pk_bf16_f32 v232, v208, v209
    v_exp_f32 v211, v211
    v_exp_f32 v212, v212
    v_cvt_pk_bf16_f32 v233, v210, v211
    v_exp_f32 v213, v213
    v_exp_f32 v214, v214
    v_cvt_pk_bf16_f32 v234, v212, v213
    v_exp_f32 v215, v215
    v_exp_f32 v216, v216
    v_cvt_pk_bf16_f32 v235, v214, v215
    v_exp_f32 v217, v217
    v_exp_f32 v218, v218
    v_cvt_pk_bf16_f32 v236, v216, v217
    s_waitcnt lgkmcnt(7)
    v_mfma_f32_16x16x32_bf16 v[208:211], a[112:115], a[16:19], v[240:243]
    s_waitcnt lgkmcnt(6)
    v_exp_f32 v219, v219
    v_mfma_f32_16x16x32_bf16 v[208:211], a[116:119], a[20:23], v[208:211]
    s_waitcnt lgkmcnt(5)
    v_exp_f32 v220, v220
    v_mfma_f32_16x16x32_bf16 v[208:211], a[120:123], a[24:27], v[208:211]
    s_waitcnt lgkmcnt(4)
    v_exp_f32 v221, v221
    v_mfma_f32_16x16x32_bf16 v[208:211], a[124:127], a[28:31], v[208:211]
    s_waitcnt lgkmcnt(0)
    v_cvt_pk_bf16_f32 v237, v218, v219
    v_cvt_pk_bf16_f32 v238, v220, v221
    v_mfma_f32_16x16x32_bf16 v[212:215], a[140:143], a[28:31], v[240:243]
    v_exp_f32 v222, v222
    v_mfma_f32_16x16x32_bf16 v[212:215], a[136:139], a[24:27], v[212:215]
    v_exp_f32 v223, v223
    v_mfma_f32_16x16x32_bf16 v[212:215], a[132:135], a[20:23], v[212:215]
    v_exp_f32 v208, v208
    v_mfma_f32_16x16x32_bf16 v[212:215], a[128:131], a[16:19], v[212:215]
    v_exp_f32 v209, v209
    v_mfma_f32_16x16x32_bf16 v[216:219], a[112:115], a[32:35], v[240:243]
    v_cvt_pk_bf16_f32 v239, v222, v223
    v_cvt_pk_bf16_f32 v224, v208, v209
    v_mfma_f32_16x16x32_bf16 v[216:219], a[116:119], a[36:39], v[216:219]
    v_exp_f32 v210, v210
    v_mfma_f32_16x16x32_bf16 v[216:219], a[120:123], a[40:43], v[216:219]
    v_exp_f32 v211, v211
    v_mfma_f32_16x16x32_bf16 v[216:219], a[124:127], a[44:47], v[216:219]
    v_exp_f32 v212, v212
    v_mfma_f32_16x16x32_bf16 v[220:223], a[140:143], a[44:47], v[240:243]
    v_exp_f32 v213, v213
    v_mfma_f32_16x16x32_bf16 v[220:223], a[136:139], a[40:43], v[220:223]
    v_cvt_pk_bf16_f32 v225, v210, v211
    v_cvt_pk_bf16_f32 v226, v212, v213
    v_mfma_f32_16x16x32_bf16 v[220:223], a[132:135], a[36:39], v[220:223]
    v_exp_f32 v214, v214
    v_mfma_f32_16x16x32_bf16 v[220:223], a[128:131], a[32:35], v[220:223]
    v_exp_f32 v215, v215
    v_mfma_f32_16x16x32_bf16 v[208:211], a[112:115], a[48:51], v[240:243]
    v_exp_f32 v216, v216
    v_mfma_f32_16x16x32_bf16 v[208:211], a[116:119], a[52:55], v[208:211]
    v_exp_f32 v217, v217
    v_mfma_f32_16x16x32_bf16 v[208:211], a[120:123], a[56:59], v[208:211]
    v_exp_f32 v218, v218
    v_mfma_f32_16x16x32_bf16 v[208:211], a[124:127], a[60:63], v[208:211]
    v_exp_f32 v219, v219
    v_cvt_pk_bf16_f32 v227, v214, v215
    v_smfmac_f32_16x16x64_bf16 v[244:247], v[248:251], v[232:239], v240
    v_exp_f32 v220, v220
    v_exp_f32 v221, v221
    v_mfma_f32_16x16x32_bf16 v[212:215], a[140:143], a[60:63], v[240:243]
    v_exp_f32 v222, v222
    v_mfma_f32_16x16x32_bf16 v[212:215], a[136:139], a[56:59], v[212:215]
    v_exp_f32 v223, v223
    v_mfma_f32_16x16x32_bf16 v[212:215], a[132:135], a[52:55], v[212:215]
    v_exp_f32 v208, v208
    v_mfma_f32_16x16x32_bf16 v[212:215], a[128:131], a[48:51], v[212:215]
    v_add_f32_dpp v58, v246, v247 quad_perm:[0,1,2,3] row_mask:0x1 bank_mask:0xf
    v_smfmac_f32_16x16x64_bf16 v[244:247], v[248:251], v[224:231], v240
    v_exp_f32 v209, v209
    v_mov_b32_dpp v248, v248 row_ror:2 row_mask:0xf bank_mask:0xf
    v_mfma_f32_16x16x4_f32 v[44:47], v58, v61, 0
    v_mov_b32_dpp v249, v249 row_ror:2 row_mask:0xf bank_mask:0xf
    v_mov_b32_dpp v250, v250 row_ror:2 row_mask:0xf bank_mask:0xf
    s_nop 7
    v_and_or_b32 v44, v44, s79, v60
    v_and_or_b32 v45, v45, s79, v60
    v_and_or_b32 v46, v46, s79, v60
    v_and_or_b32 v47, v47, s79, v60
    v_exp_f32 v210, v210
    s_nop 0
    v_mfma_f32_16x16x32_bf16 v[32:35], v[232:235], a[176:179], v[44:47]
    ds_write_b128 v59, v[44:47] offset:64
    v_mfma_f32_16x16x32_bf16 v[32:35], v[236:239], a[180:183], v[32:35]
    v_exp_f32 v211, v211
    v_mfma_f32_16x16x32_bf16 v[36:39], v[236:239], a[188:191], v[44:47]
    v_exp_f32 v212, v212
    v_mfma_f32_16x16x32_bf16 v[36:39], v[232:235], a[184:187], v[36:39]
    v_exp_f32_e64 v213, v213
    v_mfma_f32_16x16x32_bf16 v[40:43], v[232:235], a[192:195], v[44:47]
    s_nop 1
    s_waitcnt vmcnt(4)
    s_barrier
    ds_read_b64_tr_b16 a[176:177], v253 offset:33536
    v_mfma_f32_16x16x32_bf16 v[40:43], v[236:239], a[196:199], v[40:43]
    ds_read_b64_tr_b16 a[178:179], v253 offset:34048
    ds_read_b64_tr_b16 a[184:185], v253 offset:33552
    v_mfma_f32_16x16x32_bf16 v[48:51], v[236:239], a[212:215], v[44:47]
    ds_read_b64_tr_b16 a[186:187], v253 offset:34064
    ds_read_b64_tr_b16 a[192:193], v253 offset:33568
    v_mfma_f32_16x16x32_bf16 v[48:51], v[232:235], a[208:211], v[48:51]
    ds_read_b64_tr_b16 a[194:195], v253 offset:34080
    ds_read_b64_tr_b16 a[208:209], v253 offset:33600
    v_mfma_f32_16x16x32_bf16 v[52:55], v[232:235], a[216:219], v[44:47]
    ds_read_b64_tr_b16 a[210:211], v253 offset:34112
    ds_read_b64_tr_b16 a[216:217], v253 offset:33616
    v_mfma_f32_16x16x32_bf16 v[52:55], v[236:239], a[220:223], v[52:55]
    ds_read_b64_tr_b16 a[218:219], v253 offset:34128
    global_load_lds_dwordx4 v254, s[8:9] offset:0 nt
    v_mfma_f32_16x16x32_bf16 v[56:59], v[236:239], a[228:231], v[44:47]
    s_waitcnt vmcnt(1)
    s_barrier
    ds_read_b128 a[144:147], v252 offset:41984
    v_mfma_f32_16x16x32_bf16 v[56:59], v[232:235], a[224:227], v[56:59]
    s_add_u32 m0, m0, 32
    ds_read_b64_tr_b16 a[224:225], v253 offset:33632
    ds_read_b64_tr_b16 a[226:227], v253 offset:34144
    v_mfma_f32_16x16x32_bf16 v[60:63], v[232:235], a[232:235], v[44:47]
    ds_read_b64_tr_b16 a[232:233], v253 offset:33648
    ds_read_b64_tr_b16 a[234:235], v253 offset:34160
    v_mfma_f32_16x16x32_bf16 v[60:63], v[236:239], a[236:239], v[60:63]
    ds_read_b128 a[148:151], v252 offset:42048
    ds_read_b128 a[152:155], v252 offset:42112
    v_mfma_f32_16x16x32_bf16 v[44:47], v[236:239], a[204:207], v[44:47]
    ds_read_b128 a[156:159], v252 offset:42176
    ds_read_b128 a[160:163], v252 offset:42496
    v_mfma_f32_16x16x32_bf16 v[44:47], v[232:235], a[200:203], v[44:47]
    s_waitcnt lgkmcnt(15)
    ds_read_b64_tr_b16 a[200:201], v253 offset:33584
    ds_read_b64_tr_b16 a[202:203], v253 offset:34096
    v_mfma_f32_16x16x32_bf16 v[32:35], v[224:227], a[176:179], v[32:35]
    s_waitcnt lgkmcnt(15)
    ds_read_b128 a[164:167], v252 offset:42560
    ds_read_b128 a[168:171], v252 offset:42624
    v_mfma_f32_16x16x32_bf16 v[36:39], v[224:227], a[184:187], v[36:39]
    s_waitcnt lgkmcnt(15)
    ds_read_b128 a[172:175], v252 offset:42688
    ds_read_b64_tr_b16 a[180:181], v253 offset:41856
    v_mfma_f32_16x16x32_bf16 v[40:43], v[224:227], a[192:195], v[40:43]
    s_waitcnt lgkmcnt(15)
    ds_read_b64_tr_b16 a[182:183], v253 offset:42368
    ds_read_b64_tr_b16 a[188:189], v253 offset:41872
    v_mfma_f32_16x16x32_bf16 v[48:51], v[224:227], a[208:211], v[48:51]
    s_waitcnt lgkmcnt(15)
    ds_read_b64_tr_b16 a[190:191], v253 offset:42384
    ds_read_b64_tr_b16 a[196:197], v253 offset:41888
    v_mfma_f32_16x16x32_bf16 v[52:55], v[224:227], a[216:219], v[52:55]
    s_waitcnt lgkmcnt(15)
    ds_read_b64_tr_b16 a[198:199], v253 offset:42400
    ds_read_b64_tr_b16 a[204:205], v253 offset:41904
    v_mfma_f32_16x16x32_bf16 v[56:59], v[224:227], a[224:227], v[56:59]
    s_waitcnt lgkmcnt(15)
    ds_read_b64_tr_b16 a[206:207], v253 offset:42416
    ds_read_b64_tr_b16 a[212:213], v253 offset:41920
    v_mfma_f32_16x16x32_bf16 v[60:63], v[224:227], a[232:235], v[60:63]
    s_waitcnt lgkmcnt(12)
    ds_read_b64_tr_b16 a[214:215], v253 offset:42432
    ds_read_b64_tr_b16 a[220:221], v253 offset:41936
    ds_read_b64_tr_b16 a[222:223], v253 offset:42448
    ds_read_b64_tr_b16 a[228:229], v253 offset:41952
    ds_read_b64_tr_b16 a[230:231], v253 offset:42464
    ds_read_b64_tr_b16 a[236:237], v253 offset:41968
    ds_read_b64_tr_b16 a[238:239], v253 offset:42480
    v_add_u32 v252, 67072, v252
    v_mfma_f32_16x16x32_bf16 v[44:47], v[224:227], a[200:203], v[44:47]
    global_load_lds_dwordx4 v254, s[8:9] offset:1024 nt
    v_add_u32 v253, 67072, v253
    s_add_u32 m0, s69, 90368
    s_add_u32 s8, s38, 32768
    s_addc_u32 s9, s39, 0
    global_load_lds_dwordx4 v254, s[8:9] offset:0 nt
    v_cvt_pk_bf16_f32 v232, v216, v217
    v_cvt_pk_bf16_f32 v233, v218, v219
    v_mfma_f32_16x16x32_bf16 v[216:219], a[144:147], a[48:51], v[240:243]
    s_add_u32 m0, m0, 16
    s_nop 0
    global_load_lds_dwordx4 v254, s[8:9] offset:1024 nt
    v_cvt_pk_bf16_f32 v234, v220, v221
    v_mfma_f32_16x16x32_bf16 v[216:219], a[148:151], a[52:55], v[216:219]
    s_add_u32 m0, s68, 81920
    v_cvt_pk_bf16_f32 v235, v222, v223
    v_mov_b32_dpp v251, v251 row_ror:2 row_mask:0xf bank_mask:0xf
    v_mfma_f32_16x16x32_bf16 v[216:219], a[152:155], a[56:59], v[216:219]
    s_add_u32 s8, s0, 40960
    v_mov_b32 v236, 0
    v_mov_b32 v237, 0
    v_mfma_f32_16x16x32_bf16 v[216:219], a[156:159], a[60:63], v[216:219]
    s_waitcnt lgkmcnt(15)
    s_addc_u32 s9, s1, 0
    global_load_lds_dwordx4 v254, s[8:9] offset:0 nt
    v_mov_b32 v238, 0
    v_mfma_f32_16x16x32_bf16 v[220:223], a[172:175], a[60:63], v[240:243]
    s_add_u32 m0, m0, 32
    v_mov_b32 v239, 0
    v_cvt_pk_bf16_f32 v224, v208, v209
    v_mfma_f32_16x16x32_bf16 v[220:223], a[168:171], a[56:59], v[220:223]
    v_cvt_pk_bf16_f32 v225, v210, v211
    v_cvt_pk_bf16_f32 v226, v212, v213
    v_mfma_f32_16x16x32_bf16 v[220:223], a[164:167], a[52:55], v[220:223]
    v_exp_f32 v214, v214
    v_mfma_f32_16x16x32_bf16 v[220:223], a[160:163], a[48:51], v[220:223]
    v_exp_f32 v215, v215
    v_mfma_f32_16x16x32_bf16 v[64:67], v[232:235], a[176:179], v[64:67]
    v_exp_f32 v216, v216
    v_mfma_f32_16x16x32_bf16 v[68:71], v[232:235], a[184:187], v[68:71]
    global_load_lds_dwordx4 v254, s[8:9] offset:1024 nt
    v_cvt_pk_bf16_f32 v227, v214, v215
    v_mfma_f32_16x16x32_bf16 v[72:75], v[232:235], a[192:195], v[72:75]
    s_add_u32 m0, s69, 98688
    v_exp_f32 v217, v217
    v_mfma_f32_16x16x32_bf16 v[76:79], v[232:235], a[200:203], v[76:79]
    s_add_u32 s8, s38, 40960
    v_exp_f32 v218, v218
    v_mfma_f32_16x16x32_bf16 v[80:83], v[232:235], a[208:211], v[80:83]
    s_addc_u32 s9, s39, 0
    v_exp_f32 v219, v219
    v_mfma_f32_16x16x32_bf16 v[84:87], v[232:235], a[216:219], v[84:87]
    v_cvt_pk_bf16_f32 v228, v216, v217
    v_cvt_pk_bf16_f32 v229, v218, v219
    v_mfma_f32_16x16x32_bf16 v[88:91], v[232:235], a[224:227], v[88:91]
    v_exp_f32 v220, v220
    v_mfma_f32_16x16x32_bf16 v[92:95], v[232:235], a[232:235], v[92:95]
    v_exp_f32 v221, v221
    v_mfma_f32_16x16x32_bf16 v[208:211], a[112:115], a[64:67], v[240:243]
    v_exp_f32 v222, v222
    v_mfma_f32_16x16x32_bf16 v[208:211], a[116:119], a[68:71], v[208:211]
    v_exp_f32 v223, v223
    v_mfma_f32_16x16x32_bf16 v[208:211], a[120:123], a[72:75], v[208:211]
    v_cvt_pk_bf16_f32 v230, v220, v221
    v_cvt_pk_bf16_f32 v231, v222, v223
    v_mfma_f32_16x16x32_bf16 v[208:211], a[124:127], a[76:79], v[208:211]
    v_mfma_f32_16x16x32_bf16 v[212:215], a[140:143], a[76:79], v[240:243]
    v_mfma_f32_16x16x32_bf16 v[212:215], a[136:139], a[72:75], v[212:215]
    v_smfmac_f32_16x16x64_bf16 v[244:247], v[248:251], v[232:239], v240
    s_nop 4
    v_exp_f32 v208, v208
    v_mov_b32_dpp v248, v248 row_ror:2 row_mask:0xf bank_mask:0xf
    v_mfma_f32_16x16x32_bf16 v[212:215], a[132:135], a[68:71], v[212:215]
    global_load_lds_dwordx4 v254, s[8:9] offset:0 nt
    v_mov_b32_dpp v249, v249 row_ror:2 row_mask:0xf bank_mask:0xf
    v_mfma_f32_16x16x32_bf16 v[212:215], a[128:131], a[64:67], v[212:215]
    s_add_u32 m0, m0, 16
    v_mov_b32_dpp v250, v250 row_ror:2 row_mask:0xf bank_mask:0xf
    v_mov_b32_dpp v251, v251 row_ror:2 row_mask:0xf bank_mask:0xf
    v_mfma_f32_16x16x32_bf16 v[216:219], a[144:147], a[64:67], v[240:243]
    v_exp_f32 v209, v209
    v_mfma_f32_16x16x32_bf16 v[216:219], a[148:151], a[68:71], v[216:219]
    v_exp_f32 v210, v210
    v_mfma_f32_16x16x32_bf16 v[216:219], a[152:155], a[72:75], v[216:219]
    v_exp_f32 v211, v211
    v_mfma_f32_16x16x32_bf16 v[216:219], a[156:159], a[76:79], v[216:219]
    v_cvt_pk_bf16_f32 v232, v208, v209
    v_cvt_pk_bf16_f32 v233, v210, v211
    v_mfma_f32_16x16x32_bf16 v[220:223], a[172:175], a[76:79], v[240:243]
    global_load_lds_dwordx4 v254, s[8:9] offset:1024 nt
    v_mfma_f32_16x16x32_bf16 v[220:223], a[168:171], a[72:75], v[220:223]
    v_exp_f32 v212, v212
    v_mfma_f32_16x16x32_bf16 v[220:223], a[164:167], a[68:71], v[220:223]
    v_exp_f32 v213, v213
    v_mfma_f32_16x16x32_bf16 v[220:223], a[160:163], a[64:67], v[220:223]
    v_exp_f32 v214, v214
    v_mfma_f32_16x16x32_bf16 v[96:99], v[224:227], a[176:179], v[96:99]
    s_waitcnt lgkmcnt(0)
    v_exp_f32 v215, v215
    v_mfma_f32_16x16x32_bf16 v[96:99], v[228:231], a[180:183], v[96:99]
    v_cvt_pk_bf16_f32 v234, v212, v213
    v_cvt_pk_bf16_f32 v235, v214, v215
    v_mfma_f32_16x16x32_bf16 v[100:103], v[228:231], a[188:191], v[100:103]
    v_exp_f32 v216, v216
    v_mfma_f32_16x16x32_bf16 v[100:103], v[224:227], a[184:187], v[100:103]
    v_exp_f32 v217, v217
    v_mfma_f32_16x16x32_bf16 v[104:107], v[224:227], a[192:195], v[104:107]
    v_exp_f32 v218, v218
    v_mfma_f32_16x16x32_bf16 v[104:107], v[228:231], a[196:199], v[104:107]
    v_exp_f32 v219, v219
    v_mfma_f32_16x16x32_bf16 v[108:111], v[228:231], a[204:207], v[108:111]
    v_cvt_pk_bf16_f32 v236, v216, v217
    v_cvt_pk_bf16_f32 v237, v218, v219
    v_mfma_f32_16x16x32_bf16 v[108:111], v[224:227], a[200:203], v[108:111]
    v_exp_f32 v220, v220
    v_mfma_f32_16x16x32_bf16 v[112:115], v[224:227], a[208:211], v[112:115]
    v_exp_f32 v221, v221
    v_mfma_f32_16x16x32_bf16 v[208:211], a[112:115], a[80:83], v[240:243]
    v_exp_f32 v222, v222
    v_mfma_f32_16x16x32_bf16 v[112:115], v[228:231], a[212:215], v[112:115]
    v_exp_f32 v223, v223
    v_mfma_f32_16x16x32_bf16 v[208:211], a[116:119], a[84:87], v[208:211]
    v_cvt_pk_bf16_f32 v238, v220, v221
    v_cvt_pk_bf16_f32 v239, v222, v223
    v_mfma_f32_16x16x32_bf16 v[116:119], v[228:231], a[220:223], v[116:119]
    v_mfma_f32_16x16x32_bf16 v[208:211], a[120:123], a[88:91], v[208:211]
    v_mfma_f32_16x16x32_bf16 v[116:119], v[224:227], a[216:219], v[116:119]
    v_mfma_f32_16x16x32_bf16 v[208:211], a[124:127], a[92:95], v[208:211]
    v_mfma_f32_16x16x32_bf16 v[120:123], v[224:227], a[224:227], v[120:123]
    v_mfma_f32_16x16x32_bf16 v[120:123], v[228:231], a[228:231], v[120:123]
    v_mfma_f32_16x16x32_bf16 v[124:127], v[228:231], a[236:239], v[124:127]
    s_nop 4
    v_exp_f32 v208, v208
    v_mfma_f32_16x16x32_bf16 v[124:127], v[224:227], a[232:235], v[124:127]
    v_exp_f32 v209, v209
    v_mfma_f32_16x16x32_bf16 v[212:215], a[140:143], a[92:95], v[240:243]
    v_exp_f32 v210, v210
    v_mfma_f32_16x16x32_bf16 v[212:215], a[136:139], a[88:91], v[212:215]
    v_exp_f32 v211, v211
    v_mfma_f32_16x16x32_bf16 v[212:215], a[132:135], a[84:87], v[212:215]
    v_mfma_f32_16x16x32_bf16 v[212:215], a[128:131], a[80:83], v[212:215]
    v_mfma_f32_16x16x32_bf16 v[216:219], a[144:147], a[80:83], v[240:243]
    v_mfma_f32_16x16x32_bf16 v[216:219], a[148:151], a[84:87], v[216:219]
    v_smfmac_f32_16x16x64_bf16 v[244:247], v[248:251], v[224:231], v240
    s_nop 4
    v_exp_f32 v212, v212
    v_mov_b32_dpp v248, v248 row_ror:2 row_mask:0xf bank_mask:0xf
    v_mfma_f32_16x16x32_bf16 v[216:219], a[152:155], a[88:91], v[216:219]
    v_mov_b32_dpp v249, v249 row_ror:2 row_mask:0xf bank_mask:0xf
    v_mov_b32_dpp v250, v250 row_ror:2 row_mask:0xf bank_mask:0xf
    v_mfma_f32_16x16x32_bf16 v[216:219], a[156:159], a[92:95], v[216:219]
    v_mov_b32_dpp v251, v251 row_ror:2 row_mask:0xf bank_mask:0xf
    v_cvt_pk_bf16_f32 v224, v208, v209
    v_mfma_f32_16x16x32_bf16 v[220:223], a[172:175], a[92:95], v[240:243]
    v_exp_f32 v213, v213
    v_mfma_f32_16x16x32_bf16 v[220:223], a[168:171], a[88:91], v[220:223]
    v_cvt_pk_bf16_f32 v225, v210, v211
    v_cvt_pk_bf16_f32 v226, v212, v213
    v_mfma_f32_16x16x32_bf16 v[220:223], a[164:167], a[84:87], v[220:223]
    v_exp_f32 v214, v214
    v_mfma_f32_16x16x32_bf16 v[220:223], a[160:163], a[80:83], v[220:223]
    v_exp_f32 v215, v215
    v_mfma_f32_16x16x32_bf16 v[128:131], v[232:235], a[176:179], v[128:131]
    v_exp_f32 v216, v216
    v_mfma_f32_16x16x32_bf16 v[128:131], v[236:239], a[180:183], v[128:131]
    v_exp_f32 v217, v217
    v_mfma_f32_16x16x32_bf16 v[132:135], v[236:239], a[188:191], v[132:135]
    v_cvt_pk_bf16_f32 v227, v214, v215
    v_cvt_pk_bf16_f32 v228, v216, v217
    v_mfma_f32_16x16x32_bf16 v[208:211], a[112:115], a[96:99], v[240:243]
    v_exp_f32 v218, v218
    v_mfma_f32_16x16x32_bf16 v[132:135], v[232:235], a[184:187], v[132:135]
    v_exp_f32 v219, v219
    v_mfma_f32_16x16x32_bf16 v[208:211], a[116:119], a[100:103], v[208:211]
    v_exp_f32 v220, v220
    v_mfma_f32_16x16x32_bf16 v[136:139], v[232:235], a[192:195], v[136:139]
    v_exp_f32 v221, v221
    v_mfma_f32_16x16x32_bf16 v[208:211], a[120:123], a[104:107], v[208:211]
    v_cvt_pk_bf16_f32 v229, v218, v219
    v_cvt_pk_bf16_f32 v230, v220, v221
    v_mfma_f32_16x16x32_bf16 v[136:139], v[236:239], a[196:199], v[136:139]
    v_exp_f32 v222, v222
    v_mfma_f32_16x16x32_bf16 v[208:211], a[124:127], a[108:111], v[208:211]
    v_exp_f32 v223, v223
    v_mfma_f32_16x16x32_bf16 v[140:143], v[236:239], a[204:207], v[140:143]
    v_cvt_pk_bf16_f32 v231, v222, v223
    v_mfma_f32_16x16x32_bf16 v[140:143], v[232:235], a[200:203], v[140:143]
    v_mfma_f32_16x16x32_bf16 v[144:147], v[232:235], a[208:211], v[144:147]
    s_nop 2
    v_exp_f32 v208, v208
    v_mfma_f32_16x16x32_bf16 v[144:147], v[236:239], a[212:215], v[144:147]
    v_exp_f32 v209, v209
    v_mfma_f32_16x16x32_bf16 v[148:151], v[236:239], a[220:223], v[148:151]
    v_exp_f32 v210, v210
    v_mfma_f32_16x16x32_bf16 v[148:151], v[232:235], a[216:219], v[148:151]
    v_exp_f32 v211, v211
    v_mfma_f32_16x16x32_bf16 v[152:155], v[232:235], a[224:227], v[152:155]
    v_mfma_f32_16x16x32_bf16 v[212:215], a[140:143], a[108:111], v[240:243]
    v_mfma_f32_16x16x32_bf16 v[152:155], v[236:239], a[228:231], v[152:155]
    v_mfma_f32_16x16x32_bf16 v[212:215], a[136:139], a[104:107], v[212:215]
    v_mfma_f32_16x16x32_bf16 v[156:159], v[236:239], a[236:239], v[156:159]
    v_mfma_f32_16x16x32_bf16 v[212:215], a[132:135], a[100:103], v[212:215]
    v_mfma_f32_16x16x32_bf16 v[156:159], v[232:235], a[232:235], v[156:159]
    v_mfma_f32_16x16x32_bf16 v[212:215], a[128:131], a[96:99], v[212:215]
    v_mfma_f32_16x16x32_bf16 v[216:219], a[144:147], a[96:99], v[240:243]
    v_mfma_f32_16x16x32_bf16 v[216:219], a[148:151], a[100:103], v[216:219]
    v_smfmac_f32_16x16x64_bf16 v[244:247], v[248:251], v[232:239], v240
    s_nop 4
    v_exp_f32 v212, v212
    v_mov_b32_dpp v248, v248 row_ror:2 row_mask:0xf bank_mask:0xf
    v_mfma_f32_16x16x32_bf16 v[216:219], a[152:155], a[104:107], v[216:219]
    v_mov_b32_dpp v249, v249 row_ror:2 row_mask:0xf bank_mask:0xf
    v_mov_b32_dpp v250, v250 row_ror:2 row_mask:0xf bank_mask:0xf
    v_mfma_f32_16x16x32_bf16 v[216:219], a[156:159], a[108:111], v[216:219]
    v_mov_b32_dpp v251, v251 row_ror:2 row_mask:0xf bank_mask:0xf
    v_cvt_pk_bf16_f32 v232, v208, v209
    v_mfma_f32_16x16x32_bf16 v[220:223], a[172:175], a[108:111], v[240:243]
    v_exp_f32 v213, v213
    v_mfma_f32_16x16x32_bf16 v[220:223], a[168:171], a[104:107], v[220:223]
    v_cvt_pk_bf16_f32 v233, v210, v211
    v_cvt_pk_bf16_f32 v234, v212, v213
    v_mfma_f32_16x16x32_bf16 v[220:223], a[164:167], a[100:103], v[220:223]
    v_exp_f32 v214, v214
    v_mfma_f32_16x16x32_bf16 v[220:223], a[160:163], a[96:99], v[220:223]
    v_exp_f32 v215, v215
    v_mfma_f32_16x16x32_bf16 v[160:163], v[224:227], a[176:179], v[160:163]
    v_exp_f32 v216, v216
    v_mfma_f32_16x16x32_bf16 v[160:163], v[228:231], a[180:183], v[160:163]
    v_exp_f32 v217, v217
    v_mfma_f32_16x16x32_bf16 v[164:167], v[228:231], a[188:191], v[164:167]
    v_cvt_pk_bf16_f32 v235, v214, v215
    v_cvt_pk_bf16_f32 v236, v216, v217
    v_mfma_f32_16x16x32_bf16 v[164:167], v[224:227], a[184:187], v[164:167]
    v_exp_f32 v218, v218
    v_mfma_f32_16x16x32_bf16 v[168:171], v[224:227], a[192:195], v[168:171]
    v_exp_f32 v219, v219
    v_mfma_f32_16x16x32_bf16 v[168:171], v[228:231], a[196:199], v[168:171]
    v_cvt_pk_bf16_f32 v237, v218, v219
    v_mfma_f32_16x16x32_bf16 v[172:175], v[228:231], a[204:207], v[172:175]
    v_mfma_f32_16x16x32_bf16 v[172:175], v[224:227], a[200:203], v[172:175]
    v_mfma_f32_16x16x32_bf16 v[176:179], v[224:227], a[208:211], v[176:179]
    v_mfma_f32_16x16x32_bf16 v[176:179], v[228:231], a[212:215], v[176:179]
    v_mfma_f32_16x16x32_bf16 v[180:183], v[228:231], a[220:223], v[180:183]
    v_mfma_f32_16x16x32_bf16 v[180:183], v[224:227], a[216:219], v[180:183]
    v_mfma_f32_16x16x32_bf16 v[184:187], v[224:227], a[224:227], v[184:187]
    v_mfma_f32_16x16x32_bf16 v[184:187], v[228:231], a[228:231], v[184:187]
    v_mfma_f32_16x16x32_bf16 v[188:191], v[228:231], a[236:239], v[188:191]
    v_mfma_f32_16x16x32_bf16 v[188:191], v[224:227], a[232:235], v[188:191]
    v_smfmac_f32_16x16x64_bf16 v[244:247], v[248:251], v[224:231], v240
    v_mfma_f32_16x16x32_bf16 v[208:211], a[144:147], a[0:3], v[240:243]
    s_waitcnt vmcnt(6)
    v_exp_f32 v220, v220
    v_mfma_f32_16x16x32_bf16 v[208:211], a[148:151], a[4:7], v[208:211]
    s_barrier
    v_mfma_f32_16x16x32_bf16 v[208:211], a[152:155], a[8:11], v[208:211]
    v_exp_f32 v221, v221
    v_mfma_f32_16x16x32_bf16 v[208:211], a[156:159], a[12:15], v[208:211]
    v_mov_b32_dpp v248, v248 row_ror:2 row_mask:0xf bank_mask:0xf
    v_cvt_pk_bf16_f32 v238, v220, v221
    v_mfma_f32_16x16x32_bf16 v[212:215], a[172:175], a[12:15], v[240:243]
    v_exp_f32 v222, v222
    v_mfma_f32_16x16x32_bf16 v[212:215], a[168:171], a[8:11], v[212:215]
    ds_read_b128 a[112:115], v252 offset:0
    v_mfma_f32_16x16x32_bf16 v[212:215], a[164:167], a[4:7], v[212:215]
    v_exp_f32 v223, v223
    v_mfma_f32_16x16x32_bf16 v[212:215], a[160:163], a[0:3], v[212:215]
    s_add_u32 m0, s68, 6400
    v_mov_b32_dpp v249, v249 row_ror:2 row_mask:0xf bank_mask:0xf
    v_cvt_pk_bf16_f32 v239, v222, v223
    v_mfma_f32_16x16x32_bf16 v[192:195], v[232:235], a[176:179], v[192:195]
    s_add_u32 s8, s0, 49152
    v_exp_f32 v208, v208
    v_mfma_f32_16x16x32_bf16 v[192:195], v[236:239], a[180:183], v[192:195]
    s_addc_u32 s9, s1, 0
    ds_read_b128 a[116:119], v252 offset:64
    global_load_lds_dwordx4 v254, s[8:9] offset:0 nt
    v_mfma_f32_16x16x32_bf16 v[196:199], v[236:239], a[188:191], v[196:199]
    v_exp_f32 v209, v209
    v_mfma_f32_16x16x32_bf16 v[196:199], v[232:235], a[184:187], v[196:199]
    v_mov_b32_dpp v250, v250 row_ror:2 row_mask:0xf bank_mask:0xf
    v_cvt_pk_bf16_f32 v228, v208, v209
    v_mfma_f32_16x16x32_bf16 v[200:203], v[232:235], a[192:195], v[200:203]
    v_exp_f32 v210, v210
    v_mfma_f32_16x16x32_bf16 v[200:203], v[236:239], a[196:199], v[200:203]
    s_add_u32 m0, m0, 32
    ds_read_b128 a[120:123], v252 offset:128
    global_load_lds_dwordx4 v254, s[8:9] offset:1024 nt
    v_mfma_f32_16x16x32_bf16 v[204:207], v[236:239], a[204:207], v[204:207]
    v_exp_f32 v211, v211
    v_mfma_f32_16x16x32_bf16 v[204:207], v[232:235], a[200:203], v[204:207]
    v_mov_b32_dpp v251, v251 row_ror:2 row_mask:0xf bank_mask:0xf
    v_cvt_pk_bf16_f32 v229, v210, v211
    v_mfma_f32_16x16x32_bf16 a[240:243], v[232:235], a[208:211], a[240:243]
    v_exp_f32 v212, v212
    v_mfma_f32_16x16x32_bf16 a[240:243], v[236:239], a[212:215], a[240:243]
    ds_read_b128 a[124:127], v252 offset:192
    v_mfma_f32_16x16x32_bf16 a[244:247], v[236:239], a[220:223], a[244:247]
    v_exp_f32 v213, v213
    v_mfma_f32_16x16x32_bf16 a[244:247], v[232:235], a[216:219], a[244:247]
    ds_read_b128 a[140:143], v252 offset:704
    v_cvt_pk_bf16_f32 v230, v212, v213
    v_mfma_f32_16x16x32_bf16 a[248:251], v[232:235], a[224:227], a[248:251]
    v_exp_f32 v214, v214
    v_mfma_f32_16x16x32_bf16 a[248:251], v[236:239], a[228:231], a[248:251]
    ds_read_b128 a[136:139], v252 offset:640
    ds_read_b128 a[132:135], v252 offset:576
    v_mfma_f32_16x16x32_bf16 a[252:255], v[236:239], a[236:239], a[252:255]
    s_add_u32 m0, s69, 23296
    v_exp_f32 v215, v215
    v_mfma_f32_16x16x32_bf16 a[252:255], v[232:235], a[232:235], a[252:255]
    s_add_u32 s8, s38, 49152
    ds_read_b128 a[128:131], v252 offset:512
    v_cvt_pk_bf16_f32 v231, v214, v215
    v_smfmac_f32_16x16x64_bf16 v[244:247], v[248:251], v[232:239], v240
    s_waitcnt lgkmcnt(5)
    ds_read_b128 v[224:227], v254 offset:3072
    v_mfma_f32_16x16x32_bf16 v[208:211], a[112:115], a[16:19], v[240:243]
    s_addc_u32 s9, s39, 0
    global_load_lds_dwordx4 v254, s[8:9] offset:0 nt
    v_mfma_f32_16x16x32_bf16 v[208:211], a[116:119], a[20:23], v[208:211]
    s_add_u32 m0, m0, 16
    v_mfma_f32_16x16x32_bf16 v[208:211], a[120:123], a[24:27], v[208:211]
    s_waitcnt lgkmcnt(5)
    global_load_lds_dwordx4 v254, s[8:9] offset:1024 nt
    v_mfma_f32_16x16x32_bf16 v[208:211], a[124:127], a[28:31], v[208:211]
    s_waitcnt lgkmcnt(4)
    v_mfma_f32_16x16x32_bf16 v[212:215], a[140:143], a[28:31], v[240:243]
    s_waitcnt lgkmcnt(3)
    v_mov_b32_dpp v248, v248 row_ror:4 row_mask:0xf bank_mask:0xf
    v_mfma_f32_16x16x32_bf16 v[212:215], a[136:139], a[24:27], v[212:215]
    s_waitcnt lgkmcnt(2)
    v_mov_b32_dpp v249, v249 row_ror:4 row_mask:0xf bank_mask:0xf
    v_mfma_f32_16x16x32_bf16 v[212:215], a[132:135], a[20:23], v[212:215]
    s_waitcnt lgkmcnt(1)
    v_mov_b32_dpp v250, v250 row_ror:4 row_mask:0xf bank_mask:0xf
    v_mfma_f32_16x16x32_bf16 v[212:215], a[128:131], a[16:19], v[212:215]
    s_add_u32 m0, s68, 14848
    v_mov_b32_dpp v251, v251 row_ror:4 row_mask:0xf bank_mask:0xf
    v_mfma_f32_16x16x32_bf16 v[216:219], a[144:147], a[16:19], v[240:243]
    s_add_u32 s8, s0, 57344
    v_exp_f32 v208, v208
    v_mfma_f32_16x16x32_bf16 v[216:219], a[148:151], a[20:23], v[216:219]
    s_addc_u32 s9, s1, 0
    global_load_lds_dwordx4 v254, s[8:9] offset:0 nt
    v_mfma_f32_16x16x32_bf16 v[216:219], a[152:155], a[24:27], v[216:219]
    v_exp_f32 v209, v209
    v_mfma_f32_16x16x32_bf16 v[216:219], a[156:159], a[28:31], v[216:219]
    v_cvt_pk_bf16_f32 v232, v208, v209
    v_mfma_f32_16x16x32_bf16 v[220:223], a[172:175], a[28:31], v[240:243]
    s_waitcnt vmcnt(5)
    v_exp_f32 v210, v210
    v_mfma_f32_16x16x32_bf16 v[220:223], a[168:171], a[24:27], v[220:223]
    s_barrier
    v_mfma_f32_16x16x32_bf16 v[220:223], a[164:167], a[20:23], v[220:223]
    s_add_u32 m0, m0, 32
    v_exp_f32 v211, v211
    v_mfma_f32_16x16x32_bf16 v[220:223], a[160:163], a[16:19], v[220:223]
    s_waitcnt lgkmcnt(0)
    global_load_lds_dwordx4 v254, s[8:9] offset:1024 nt
    v_cvt_pk_bf16_f32 v233, v210, v211
    v_mfma_f32_16x16x32_bf16 v[0:3], v[224:227], a[176:179], v[0:3]
    v_exp_f32 v212, v212
    v_mfma_f32_16x16x32_bf16 v[0:3], v[228:231], a[180:183], v[0:3]
    ds_read_b64_tr_b16 a[176:177], v253 offset:0
    v_mfma_f32_16x16x32_bf16 v[4:7], v[228:231], a[188:191], v[4:7]
    v_exp_f32 v213, v213
    v_mfma_f32_16x16x32_bf16 v[4:7], v[224:227], a[184:187], v[4:7]
    s_add_u32 m0, s69, 31616
    ds_read_b64_tr_b16 a[178:179], v253 offset:512
    v_cvt_pk_bf16_f32 v234, v212, v213
    v_mfma_f32_16x16x32_bf16 v[8:11], v[224:227], a[192:195], v[8:11]
    s_add_u32 s8, s38, 57344
    v_exp_f32 v214, v214
    v_mfma_f32_16x16x32_bf16 v[8:11], v[228:231], a[196:199], v[8:11]
    s_addc_u32 s9, s39, 0
    ds_read_b64_tr_b16 a[184:185], v253 offset:16
    global_load_lds_dwordx4 v254, s[8:9] offset:0 nt
    v_mfma_f32_16x16x32_bf16 v[12:15], v[228:231], a[204:207], v[12:15]
    v_exp_f32 v215, v215
    v_mfma_f32_16x16x32_bf16 v[12:15], v[224:227], a[200:203], v[12:15]
    ds_read_b64_tr_b16 a[186:187], v253 offset:528
    v_cvt_pk_bf16_f32 v235, v214, v215
    v_mfma_f32_16x16x32_bf16 v[16:19], v[224:227], a[208:211], v[16:19]
    v_exp_f32 v216, v216
    v_mfma_f32_16x16x32_bf16 v[16:19], v[228:231], a[212:215], v[16:19]
    ds_read_b64_tr_b16 a[192:193], v253 offset:32
    v_mfma_f32_16x16x32_bf16 v[20:23], v[228:231], a[220:223], v[20:23]
    v_exp_f32 v217, v217
    v_mfma_f32_16x16x32_bf16 v[20:23], v[224:227], a[216:219], v[20:23]
    ds_read_b64_tr_b16 a[194:195], v253 offset:544
    v_cvt_pk_bf16_f32 v236, v216, v217
    v_mfma_f32_16x16x32_bf16 v[24:27], v[224:227], a[224:227], v[24:27]
    v_exp_f32 v218, v218
    v_mfma_f32_16x16x32_bf16 v[24:27], v[228:231], a[228:231], v[24:27]
    s_add_u32 m0, m0, 16
    ds_read_b64_tr_b16 a[200:201], v253 offset:48
    global_load_lds_dwordx4 v254, s[8:9] offset:1024 nt
    v_mfma_f32_16x16x32_bf16 v[28:31], v[228:231], a[236:239], v[28:31]
    v_exp_f32 v219, v219
    v_mfma_f32_16x16x32_bf16 v[28:31], v[224:227], a[232:235], v[28:31]
    ds_read_b64_tr_b16 a[202:203], v253 offset:560
    v_cvt_pk_bf16_f32 v237, v218, v219
    v_smfmac_f32_16x16x64_bf16 v[244:247], v[248:251], v[224:231], v240
    ds_read_b64_tr_b16 a[208:209], v253 offset:64
    v_mfma_f32_16x16x32_bf16 v[208:211], a[112:115], a[32:35], v[240:243]
    v_exp_f32 v220, v220
    v_mfma_f32_16x16x32_bf16 v[208:211], a[116:119], a[36:39], v[208:211]
    ds_read_b64_tr_b16 a[210:211], v253 offset:576
    v_mfma_f32_16x16x32_bf16 v[208:211], a[120:123], a[40:43], v[208:211]
    v_exp_f32 v221, v221
    v_mfma_f32_16x16x32_bf16 v[208:211], a[124:127], a[44:47], v[208:211]
    v_mov_b32_dpp v248, v248 row_ror:2 row_mask:0xf bank_mask:0xf
    v_cvt_pk_bf16_f32 v238, v220, v221
    v_mfma_f32_16x16x32_bf16 v[212:215], a[140:143], a[44:47], v[240:243]
    v_exp_f32 v222, v222
    v_mfma_f32_16x16x32_bf16 v[212:215], a[136:139], a[40:43], v[212:215]
    ds_read_b64_tr_b16 a[216:217], v253 offset:80
    v_mfma_f32_16x16x32_bf16 v[212:215], a[132:135], a[36:39], v[212:215]
    v_exp_f32 v223, v223
    v_mfma_f32_16x16x32_bf16 v[212:215], a[128:131], a[32:35], v[212:215]
    v_mov_b32_dpp v249, v249 row_ror:2 row_mask:0xf bank_mask:0xf
    v_cvt_pk_bf16_f32 v239, v222, v223
    v_mfma_f32_16x16x32_bf16 v[216:219], a[144:147], a[32:35], v[240:243]
    v_exp_f32 v208, v208
    v_mfma_f32_16x16x32_bf16 v[216:219], a[148:151], a[36:39], v[216:219]
    ds_read_b64_tr_b16 a[218:219], v253 offset:592
    v_mfma_f32_16x16x32_bf16 v[216:219], a[152:155], a[40:43], v[216:219]
    v_exp_f32 v209, v209
    v_mfma_f32_16x16x32_bf16 v[216:219], a[156:159], a[44:47], v[216:219]
    v_mov_b32_dpp v250, v250 row_ror:2 row_mask:0xf bank_mask:0xf
    v_cvt_pk_bf16_f32 v224, v208, v209
    v_mfma_f32_16x16x32_bf16 v[220:223], a[172:175], a[44:47], v[240:243]
    v_exp_f32 v210, v210
    v_mfma_f32_16x16x32_bf16 v[220:223], a[168:171], a[40:43], v[220:223]
    ds_read_b64_tr_b16 a[224:225], v253 offset:96
    v_mfma_f32_16x16x32_bf16 v[220:223], a[164:167], a[36:39], v[220:223]
    v_exp_f32 v211, v211
    v_mfma_f32_16x16x32_bf16 v[220:223], a[160:163], a[32:35], v[220:223]
    s_waitcnt lgkmcnt(2)
    v_mov_b32_dpp v251, v251 row_ror:2 row_mask:0xf bank_mask:0xf
    v_cvt_pk_bf16_f32 v225, v210, v211
    v_mfma_f32_16x16x32_bf16 v[32:35], v[232:235], a[176:179], v[32:35]
    v_exp_f32 v212, v212
    v_mfma_f32_16x16x32_bf16 v[32:35], v[236:239], a[180:183], v[32:35]
    ds_read_b64_tr_b16 a[226:227], v253 offset:608
    v_mfma_f32_16x16x32_bf16 v[36:39], v[236:239], a[188:191], v[36:39]
    v_exp_f32 v213, v213
    v_mfma_f32_16x16x32_bf16 v[36:39], v[232:235], a[184:187], v[36:39]
    ds_read_b64_tr_b16 a[232:233], v253 offset:112
    v_cvt_pk_bf16_f32 v226, v212, v213
    v_mfma_f32_16x16x32_bf16 v[40:43], v[232:235], a[192:195], v[40:43]
    v_exp_f32 v214, v214
    v_mfma_f32_16x16x32_bf16 v[40:43], v[236:239], a[196:199], v[40:43]
    ds_read_b64_tr_b16 a[234:235], v253 offset:624
    v_mfma_f32_16x16x32_bf16 v[44:47], v[236:239], a[204:207], v[44:47]
    v_exp_f32 v215, v215
    v_mfma_f32_16x16x32_bf16 v[44:47], v[232:235], a[200:203], v[44:47]
    ds_read_b128 a[144:147], v252 offset:8448
    v_cvt_pk_bf16_f32 v227, v214, v215
    v_mfma_f32_16x16x32_bf16 v[48:51], v[232:235], a[208:211], v[48:51]
    v_exp_f32 v216, v216
    v_mfma_f32_16x16x32_bf16 v[48:51], v[236:239], a[212:215], v[48:51]
    ds_read_b128 a[148:151], v252 offset:8512
    v_mfma_f32_16x16x32_bf16 v[52:55], v[236:239], a[220:223], v[52:55]
    s_waitcnt lgkmcnt(5)
    v_exp_f32 v217, v217
    v_mfma_f32_16x16x32_bf16 v[52:55], v[232:235], a[216:219], v[52:55]
    s_waitcnt lgkmcnt(4)
    ds_read_b128 a[152:155], v252 offset:8576
    v_cvt_pk_bf16_f32 v228, v216, v217
    v_mfma_f32_16x16x32_bf16 v[56:59], v[232:235], a[224:227], v[56:59]
    v_exp_f32 v218, v218
    v_mfma_f32_16x16x32_bf16 v[56:59], v[236:239], a[228:231], v[56:59]
    ds_read_b128 a[156:159], v252 offset:8640
    v_mfma_f32_16x16x32_bf16 v[60:63], v[236:239], a[236:239], v[60:63]
    s_waitcnt lgkmcnt(4)
    v_exp_f32 v219, v219
    v_mfma_f32_16x16x32_bf16 v[60:63], v[232:235], a[232:235], v[60:63]
    ds_read_b128 a[172:175], v252 offset:9152
    v_cvt_pk_bf16_f32 v229, v218, v219
    v_smfmac_f32_16x16x64_bf16 v[244:247], v[248:251], v[232:239], v240
    ds_read_b128 a[168:171], v252 offset:9088
    v_mfma_f32_16x16x32_bf16 v[208:211], a[112:115], a[48:51], v[240:243]
    v_exp_f32 v220, v220
    v_mfma_f32_16x16x32_bf16 v[208:211], a[116:119], a[52:55], v[208:211]
    ds_read_b128 a[164:167], v252 offset:9024
    v_mfma_f32_16x16x32_bf16 v[208:211], a[120:123], a[56:59], v[208:211]
    v_exp_f32 v221, v221
    v_mfma_f32_16x16x32_bf16 v[208:211], a[124:127], a[60:63], v[208:211]
    v_mov_b32_dpp v248, v248 row_ror:2 row_mask:0xf bank_mask:0xf
    v_cvt_pk_bf16_f32 v230, v220, v221
    v_mfma_f32_16x16x32_bf16 v[212:215], a[140:143], a[60:63], v[240:243]
    v_exp_f32 v222, v222
    v_mfma_f32_16x16x32_bf16 v[212:215], a[136:139], a[56:59], v[212:215]
    ds_read_b128 a[160:163], v252 offset:8960
    v_mfma_f32_16x16x32_bf16 v[212:215], a[132:135], a[52:55], v[212:215]
    v_exp_f32 v223, v223
    v_mfma_f32_16x16x32_bf16 v[212:215], a[128:131], a[48:51], v[212:215]
    s_waitcnt lgkmcnt(4)
    v_mov_b32_dpp v249, v249 row_ror:2 row_mask:0xf bank_mask:0xf
    v_cvt_pk_bf16_f32 v231, v222, v223
    v_mfma_f32_16x16x32_bf16 v[216:219], a[144:147], a[48:51], v[240:243]
    v_exp_f32 v208, v208
    v_mfma_f32_16x16x32_bf16 v[216:219], a[148:151], a[52:55], v[216:219]
    v_mfma_f32_16x16x32_bf16 v[216:219], a[152:155], a[56:59], v[216:219]
    s_add_u32 m0, s34, s4
    v_exp_f32 v209, v209
    v_mfma_f32_16x16x32_bf16 v[216:219], a[156:159], a[60:63], v[216:219]
    s_waitcnt lgkmcnt(1)
    v_mov_b32_dpp v250, v250 row_ror:2 row_mask:0xf bank_mask:0xf
    v_cvt_pk_bf16_f32 v232, v208, v209
    v_mfma_f32_16x16x32_bf16 v[220:223], a[172:175], a[60:63], v[240:243]
    s_add_u32 s8, s16, s64
    v_exp_f32 v210, v210
    v_mfma_f32_16x16x32_bf16 v[220:223], a[168:171], a[56:59], v[220:223]
    s_addc_u32 s9, s17, 0
    global_load_lds_dwordx4 v254, s[8:9] offset:0 nt
    v_mfma_f32_16x16x32_bf16 v[220:223], a[164:167], a[52:55], v[220:223]
    s_waitcnt lgkmcnt(0)
    v_exp_f32 v211, v211
    v_mfma_f32_16x16x32_bf16 v[220:223], a[160:163], a[48:51], v[220:223]
    s_add_u32 s64, s64, 16384
    v_mov_b32_dpp v251, v251 row_ror:2 row_mask:0xf bank_mask:0xf
    v_cvt_pk_bf16_f32 v233, v210, v211
    v_mfma_f32_16x16x32_bf16 v[64:67], v[224:227], a[176:179], v[64:67]
    s_cmp_gt_u32 s64, s10
    v_exp_f32 v212, v212
    v_mfma_f32_16x16x32_bf16 v[64:67], v[228:231], a[180:183], v[64:67]
    s_cselect_b32 s64, 0, s64
    ds_read_b64_tr_b16 a[180:181], v253 offset:8320
    v_mfma_f32_16x16x32_bf16 v[68:71], v[228:231], a[188:191], v[68:71]
    v_exp_f32 v213, v213
    v_mfma_f32_16x16x32_bf16 v[68:71], v[224:227], a[184:187], v[68:71]
    ds_read_b64_tr_b16 a[182:183], v253 offset:8832
    v_cvt_pk_bf16_f32 v234, v212, v213
    v_mfma_f32_16x16x32_bf16 v[72:75], v[224:227], a[192:195], v[72:75]
    v_exp_f32 v214, v214
    v_mfma_f32_16x16x32_bf16 v[72:75], v[228:231], a[196:199], v[72:75]
    s_add_u32 m0, m0, 32
    ds_read_b64_tr_b16 a[188:189], v253 offset:8336
    global_load_lds_dwordx4 v254, s[8:9] offset:1024 nt
    v_mfma_f32_16x16x32_bf16 v[76:79], v[228:231], a[204:207], v[76:79]
    s_add_u32 s31, s31, 33536
    v_exp_f32 v215, v215
    v_mfma_f32_16x16x32_bf16 v[76:79], v[224:227], a[200:203], v[76:79]
    s_cmp_eq_u32 s31, 100608
    ds_read_b64_tr_b16 a[190:191], v253 offset:8848
    v_cvt_pk_bf16_f32 v235, v214, v215
    v_mfma_f32_16x16x32_bf16 v[80:83], v[224:227], a[208:211], v[80:83]
    s_cselect_b32 s30, s71, s72
    v_exp_f32 v216, v216
    v_mfma_f32_16x16x32_bf16 v[80:83], v[228:231], a[212:215], v[80:83]
    s_cselect_b32 s31, 0, s31
    ds_read_b64_tr_b16 a[196:197], v253 offset:8352
    v_mfma_f32_16x16x32_bf16 v[84:87], v[228:231], a[220:223], v[84:87]
    v_exp_f32 v217, v217
    v_mfma_f32_16x16x32_bf16 v[84:87], v[224:227], a[216:219], v[84:87]
    ds_read_b64_tr_b16 a[198:199], v253 offset:8864
    v_cvt_pk_bf16_f32 v236, v216, v217
    v_mfma_f32_16x16x32_bf16 v[88:91], v[224:227], a[224:227], v[88:91]
    v_exp_f32 v218, v218
    v_mfma_f32_16x16x32_bf16 v[88:91], v[228:231], a[228:231], v[88:91]
    ds_read_b64_tr_b16 a[204:205], v253 offset:8368
    v_mfma_f32_16x16x32_bf16 v[92:95], v[228:231], a[236:239], v[92:95]
    v_exp_f32 v219, v219
    v_mfma_f32_16x16x32_bf16 v[92:95], v[224:227], a[232:235], v[92:95]
    ds_read_b64_tr_b16 a[206:207], v253 offset:8880
    v_cvt_pk_bf16_f32 v237, v218, v219
    v_smfmac_f32_16x16x64_bf16 v[244:247], v[248:251], v[224:231], v240
    s_add_u32 m0, m0, 32
    ds_read_b64_tr_b16 a[212:213], v253 offset:8384
    global_load_lds_dwordx4 v254, s[8:9] offset:2048 nt
    v_mfma_f32_16x16x32_bf16 v[208:211], a[112:115], a[64:67], v[240:243]
    v_exp_f32 v220, v220
    v_mfma_f32_16x16x32_bf16 v[208:211], a[116:119], a[68:71], v[208:211]
    ds_read_b64_tr_b16 a[214:215], v253 offset:8896
    v_mfma_f32_16x16x32_bf16 v[208:211], a[120:123], a[72:75], v[208:211]
    v_exp_f32 v221, v221
    v_mfma_f32_16x16x32_bf16 v[208:211], a[124:127], a[76:79], v[208:211]
    v_mov_b32_dpp v248, v248 row_ror:2 row_mask:0xf bank_mask:0xf
    v_cvt_pk_bf16_f32 v238, v220, v221
    v_mfma_f32_16x16x32_bf16 v[212:215], a[140:143], a[76:79], v[240:243]
    v_exp_f32 v222, v222
    v_mfma_f32_16x16x32_bf16 v[212:215], a[136:139], a[72:75], v[212:215]
    ds_read_b64_tr_b16 a[220:221], v253 offset:8400
    v_mfma_f32_16x16x32_bf16 v[212:215], a[132:135], a[68:71], v[212:215]
    v_exp_f32 v223, v223
    v_mfma_f32_16x16x32_bf16 v[212:215], a[128:131], a[64:67], v[212:215]
    v_mov_b32_dpp v249, v249 row_ror:2 row_mask:0xf bank_mask:0xf
    v_cvt_pk_bf16_f32 v239, v222, v223
    v_mfma_f32_16x16x32_bf16 v[216:219], a[144:147], a[64:67], v[240:243]
    v_exp_f32 v208, v208
    v_mfma_f32_16x16x32_bf16 v[216:219], a[148:151], a[68:71], v[216:219]
    s_add_u32 m0, m0, 32
    ds_read_b64_tr_b16 a[222:223], v253 offset:8912
    global_load_lds_dwordx4 v254, s[8:9] offset:3072 nt
    v_mfma_f32_16x16x32_bf16 v[216:219], a[152:155], a[72:75], v[216:219]
    v_exp_f32 v209, v209
    v_mfma_f32_16x16x32_bf16 v[216:219], a[156:159], a[76:79], v[216:219]
    v_mov_b32_dpp v250, v250 row_ror:2 row_mask:0xf bank_mask:0xf
    v_cvt_pk_bf16_f32 v224, v208, v209
    v_mfma_f32_16x16x32_bf16 v[220:223], a[172:175], a[76:79], v[240:243]
    v_exp_f32 v210, v210
    v_mfma_f32_16x16x32_bf16 v[220:223], a[168:171], a[72:75], v[220:223]
    ds_read_b64_tr_b16 a[228:229], v253 offset:8416
    v_mfma_f32_16x16x32_bf16 v[220:223], a[164:167], a[68:71], v[220:223]
    s_add_u32 m0, m0, 4128
    v_exp_f32 v211, v211
    v_mfma_f32_16x16x32_bf16 v[220:223], a[160:163], a[64:67], v[220:223]
    s_add_u32 s8, s8, s7
    v_mov_b32_dpp v251, v251 row_ror:2 row_mask:0xf bank_mask:0xf
    v_cvt_pk_bf16_f32 v225, v210, v211
    v_mfma_f32_16x16x32_bf16 v[96:99], v[232:235], a[176:179], v[96:99]
    s_waitcnt lgkmcnt(2)
    v_exp_f32 v212, v212
    v_mfma_f32_16x16x32_bf16 v[96:99], v[236:239], a[180:183], v[96:99]
    s_addc_u32 s9, s9, 0
    ds_read_b64_tr_b16 a[230:231], v253 offset:8928
    global_load_lds_dwordx4 v254, s[8:9] offset:0 nt
    v_mfma_f32_16x16x32_bf16 v[100:103], v[236:239], a[188:191], v[100:103]
    v_exp_f32 v213, v213
    v_mfma_f32_16x16x32_bf16 v[100:103], v[232:235], a[184:187], v[100:103]
    ds_read_b64_tr_b16 a[236:237], v253 offset:8432
    v_cvt_pk_bf16_f32 v226, v212, v213
    v_mfma_f32_16x16x32_bf16 v[104:107], v[232:235], a[192:195], v[104:107]
    v_exp_f32 v214, v214
    v_mfma_f32_16x16x32_bf16 v[104:107], v[236:239], a[196:199], v[104:107]
    ds_read_b64_tr_b16 a[238:239], v253 offset:8944
    v_mfma_f32_16x16x32_bf16 v[108:111], v[236:239], a[204:207], v[108:111]
    v_exp_f32 v215, v215
    v_mfma_f32_16x16x32_bf16 v[108:111], v[232:235], a[200:203], v[108:111]
    v_cvt_pk_bf16_f32 v227, v214, v215
    v_mfma_f32_16x16x32_bf16 v[112:115], v[232:235], a[208:211], v[112:115]
    s_add_u32 m0, s34, s5
    v_exp_f32 v216, v216
    v_mfma_f32_16x16x32_bf16 v[112:115], v[236:239], a[212:215], v[112:115]
    s_waitcnt lgkmcnt(3)
    v_mfma_f32_16x16x32_bf16 v[116:119], v[236:239], a[220:223], v[116:119]
    s_add_u32 s8, s20, s66
    v_exp_f32 v217, v217
    v_mfma_f32_16x16x32_bf16 v[116:119], v[232:235], a[216:219], v[116:119]
    s_addc_u32 s9, s21, 0
    v_cvt_pk_bf16_f32 v228, v216, v217
    v_mfma_f32_16x16x32_bf16 v[120:123], v[232:235], a[224:227], v[120:123]
    s_waitcnt lgkmcnt(2)
    v_exp_f32 v218, v218
    v_mfma_f32_16x16x32_bf16 v[120:123], v[236:239], a[228:231], v[120:123]
    s_waitcnt lgkmcnt(0)
    global_load_lds_dwordx4 v254, s[8:9] offset:0 nt
    v_mfma_f32_16x16x32_bf16 v[124:127], v[236:239], a[236:239], v[124:127]
    s_add_u32 s34, s34, 33536
    v_exp_f32 v219, v219
    v_mfma_f32_16x16x32_bf16 v[124:127], v[232:235], a[232:235], v[124:127]
    s_cmp_eq_u32 s34, 100608
    v_cvt_pk_bf16_f32 v229, v218, v219
    v_smfmac_f32_16x16x64_bf16 v[244:247], v[248:251], v[232:239], v240
    s_cselect_b32 s34, 0, s34
    v_mfma_f32_16x16x32_bf16 v[208:211], a[112:115], a[80:83], v[240:243]
    s_add_u32 s66, s66, 16384
    v_exp_f32 v220, v220
    v_mfma_f32_16x16x32_bf16 v[208:211], a[116:119], a[84:87], v[208:211]
    s_cmp_gt_u32 s66, s11
    v_mfma_f32_16x16x32_bf16 v[208:211], a[120:123], a[88:91], v[208:211]
    s_cselect_b32 s66, 0, s66
    v_exp_f32 v221, v221
    v_mfma_f32_16x16x32_bf16 v[208:211], a[124:127], a[92:95], v[208:211]
    v_mov_b32_dpp v248, v248 row_ror:2 row_mask:0xf bank_mask:0xf
    v_cvt_pk_bf16_f32 v230, v220, v221
    v_mfma_f32_16x16x32_bf16 v[212:215], a[140:143], a[92:95], v[240:243]
    s_add_u32 m0, m0, 16
    v_exp_f32 v222, v222
    v_mfma_f32_16x16x32_bf16 v[212:215], a[136:139], a[88:91], v[212:215]
    global_load_lds_dwordx4 v254, s[8:9] offset:1024 nt
    v_mfma_f32_16x16x32_bf16 v[212:215], a[132:135], a[84:87], v[212:215]
    v_exp_f32 v223, v223
    v_mfma_f32_16x16x32_bf16 v[212:215], a[128:131], a[80:83], v[212:215]
    v_mov_b32_dpp v249, v249 row_ror:2 row_mask:0xf bank_mask:0xf
    v_cvt_pk_bf16_f32 v231, v222, v223
    v_mfma_f32_16x16x32_bf16 v[216:219], a[144:147], a[80:83], v[240:243]
    v_exp_f32 v208, v208
    v_mfma_f32_16x16x32_bf16 v[216:219], a[148:151], a[84:87], v[216:219]
    v_mfma_f32_16x16x32_bf16 v[216:219], a[152:155], a[88:91], v[216:219]
    v_exp_f32 v209, v209
    v_mfma_f32_16x16x32_bf16 v[216:219], a[156:159], a[92:95], v[216:219]
    v_mov_b32_dpp v250, v250 row_ror:2 row_mask:0xf bank_mask:0xf
    v_cvt_pk_bf16_f32 v232, v208, v209
    v_mfma_f32_16x16x32_bf16 v[220:223], a[172:175], a[92:95], v[240:243]
    s_add_u32 m0, m0, 16
    v_exp_f32 v210, v210
    v_mfma_f32_16x16x32_bf16 v[220:223], a[168:171], a[88:91], v[220:223]
    global_load_lds_dwordx4 v254, s[8:9] offset:2048 nt
    v_mfma_f32_16x16x32_bf16 v[220:223], a[164:167], a[84:87], v[220:223]
    v_exp_f32 v211, v211
    v_mfma_f32_16x16x32_bf16 v[220:223], a[160:163], a[80:83], v[220:223]
    v_mov_b32_dpp v251, v251 row_ror:2 row_mask:0xf bank_mask:0xf
    v_cvt_pk_bf16_f32 v233, v210, v211
    v_mfma_f32_16x16x32_bf16 v[128:131], v[224:227], a[176:179], v[128:131]
    v_exp_f32 v212, v212
    v_mfma_f32_16x16x32_bf16 v[128:131], v[228:231], a[180:183], v[128:131]
    v_mfma_f32_16x16x32_bf16 v[132:135], v[228:231], a[188:191], v[132:135]
    v_exp_f32 v213, v213
    v_mfma_f32_16x16x32_bf16 v[132:135], v[224:227], a[184:187], v[132:135]
    v_cvt_pk_bf16_f32 v234, v212, v213
    v_mfma_f32_16x16x32_bf16 v[136:139], v[224:227], a[192:195], v[136:139]
    v_exp_f32 v214, v214
    v_mfma_f32_16x16x32_bf16 v[136:139], v[228:231], a[196:199], v[136:139]
    v_mfma_f32_16x16x32_bf16 v[140:143], v[228:231], a[204:207], v[140:143]
    v_exp_f32 v215, v215
    v_mfma_f32_16x16x32_bf16 v[140:143], v[224:227], a[200:203], v[140:143]
    v_cvt_pk_bf16_f32 v235, v214, v215
    v_mfma_f32_16x16x32_bf16 v[144:147], v[224:227], a[208:211], v[144:147]
    s_add_u32 m0, m0, 16
    v_exp_f32 v216, v216
    v_mfma_f32_16x16x32_bf16 v[144:147], v[228:231], a[212:215], v[144:147]
    global_load_lds_dwordx4 v254, s[8:9] offset:3072 nt
    v_mfma_f32_16x16x32_bf16 v[148:151], v[228:231], a[220:223], v[148:151]
    v_exp_f32 v217, v217
    v_mfma_f32_16x16x32_bf16 v[148:151], v[224:227], a[216:219], v[148:151]
    v_cvt_pk_bf16_f32 v236, v216, v217
    v_mfma_f32_16x16x32_bf16 v[152:155], v[224:227], a[224:227], v[152:155]
    v_exp_f32 v218, v218
    v_mfma_f32_16x16x32_bf16 v[152:155], v[228:231], a[228:231], v[152:155]
    v_mfma_f32_16x16x32_bf16 v[156:159], v[228:231], a[236:239], v[156:159]
    v_exp_f32 v219, v219
    v_mfma_f32_16x16x32_bf16 v[156:159], v[224:227], a[232:235], v[156:159]
    v_cvt_pk_bf16_f32 v237, v218, v219
    v_smfmac_f32_16x16x64_bf16 v[244:247], v[248:251], v[224:231], v240
    s_add_u32 m0, m0, 4112
    v_mfma_f32_16x16x32_bf16 v[208:211], a[112:115], a[96:99], v[240:243]
    s_add_u32 s8, s8, s7
    v_exp_f32 v220, v220
    v_mfma_f32_16x16x32_bf16 v[208:211], a[116:119], a[100:103], v[208:211]
    s_addc_u32 s9, s9, 0
    global_load_lds_dwordx4 v254, s[8:9] offset:0 nt
    v_mfma_f32_16x16x32_bf16 v[208:211], a[120:123], a[104:107], v[208:211]
    s_cmp_eq_u32 s64, 0
    v_exp_f32 v221, v221
    v_mfma_f32_16x16x32_bf16 v[208:211], a[124:127], a[108:111], v[208:211]
    s_cselect_b32 s7, 0, s7
    v_mov_b32_dpp v248, v248 row_ror:2 row_mask:0xf bank_mask:0xf
    v_cvt_pk_bf16_f32 v238, v220, v221
    v_mfma_f32_16x16x32_bf16 v[212:215], a[140:143], a[108:111], v[240:243]
    v_exp_f32 v222, v222
    v_mfma_f32_16x16x32_bf16 v[212:215], a[136:139], a[104:107], v[212:215]
    v_mfma_f32_16x16x32_bf16 v[212:215], a[132:135], a[100:103], v[212:215]
    v_exp_f32 v223, v223
    v_mfma_f32_16x16x32_bf16 v[212:215], a[128:131], a[96:99], v[212:215]
    v_mov_b32_dpp v249, v249 row_ror:2 row_mask:0xf bank_mask:0xf
    v_cvt_pk_bf16_f32 v239, v222, v223
    v_mfma_f32_16x16x32_bf16 v[216:219], a[144:147], a[96:99], v[240:243]
    v_exp_f32 v208, v208
    v_mfma_f32_16x16x32_bf16 v[216:219], a[148:151], a[100:103], v[216:219]
    v_mfma_f32_16x16x32_bf16 v[216:219], a[152:155], a[104:107], v[216:219]
    v_exp_f32 v209, v209
    v_mfma_f32_16x16x32_bf16 v[216:219], a[156:159], a[108:111], v[216:219]
    v_mov_b32_dpp v250, v250 row_ror:2 row_mask:0xf bank_mask:0xf
    v_cvt_pk_bf16_f32 v224, v208, v209
    v_mfma_f32_16x16x32_bf16 v[220:223], a[172:175], a[108:111], v[240:243]
    v_exp_f32 v210, v210
    v_mfma_f32_16x16x32_bf16 v[220:223], a[168:171], a[104:107], v[220:223]
    v_mfma_f32_16x16x32_bf16 v[220:223], a[164:167], a[100:103], v[220:223]
    v_exp_f32 v211, v211
    v_mfma_f32_16x16x32_bf16 v[220:223], a[160:163], a[96:99], v[220:223]
    v_mov_b32_dpp v251, v251 row_ror:2 row_mask:0xf bank_mask:0xf
    v_cvt_pk_bf16_f32 v225, v210, v211
    v_mfma_f32_16x16x32_bf16 v[160:163], v[232:235], a[176:179], v[160:163]
    v_exp_f32 v212, v212
    v_mfma_f32_16x16x32_bf16 v[160:163], v[236:239], a[180:183], v[160:163]
    v_mfma_f32_16x16x32_bf16 v[164:167], v[236:239], a[188:191], v[164:167]
    v_exp_f32 v213, v213
    v_mfma_f32_16x16x32_bf16 v[164:167], v[232:235], a[184:187], v[164:167]
    v_cvt_pk_bf16_f32 v226, v212, v213
    v_mfma_f32_16x16x32_bf16 v[168:171], v[232:235], a[192:195], v[168:171]
    v_exp_f32 v214, v214
    v_mfma_f32_16x16x32_bf16 v[168:171], v[236:239], a[196:199], v[168:171]
    v_mfma_f32_16x16x32_bf16 v[172:175], v[236:239], a[204:207], v[172:175]
    v_exp_f32 v215, v215
    v_mfma_f32_16x16x32_bf16 v[172:175], v[232:235], a[200:203], v[172:175]
    v_cvt_pk_bf16_f32 v227, v214, v215
    v_mfma_f32_16x16x32_bf16 v[176:179], v[232:235], a[208:211], v[176:179]
    v_exp_f32 v216, v216
    v_mfma_f32_16x16x32_bf16 v[176:179], v[236:239], a[212:215], v[176:179]
    v_mfma_f32_16x16x32_bf16 v[180:183], v[236:239], a[220:223], v[180:183]
    v_exp_f32 v217, v217
    v_mfma_f32_16x16x32_bf16 v[180:183], v[232:235], a[216:219], v[180:183]
    v_cvt_pk_bf16_f32 v228, v216, v217
    v_mfma_f32_16x16x32_bf16 v[184:187], v[232:235], a[224:227], v[184:187]
    v_exp_f32 v218, v218
    v_mfma_f32_16x16x32_bf16 v[184:187], v[236:239], a[228:231], v[184:187]
    v_add_u32 v252, s30, v252
    v_mfma_f32_16x16x32_bf16 v[188:191], v[236:239], a[236:239], v[188:191]
    v_exp_f32 v219, v219
    v_mfma_f32_16x16x32_bf16 v[188:191], v[232:235], a[232:235], v[188:191]
    s_waitcnt vmcnt(10)
    v_cvt_pk_bf16_f32 v229, v218, v219
    v_add_u32 v253, s30, v253
    v_smfmac_f32_16x16x64_bf16 v[244:247], v[248:251], v[232:239], v240
.p2align 6
L_loop_a:
    v_mfma_f32_16x16x32_bf16 v[208:211], a[144:147], a[0:3], v[240:243]
    v_exp_f32 v220, v220
    v_mfma_f32_16x16x32_bf16 v[208:211], a[148:151], a[4:7], v[208:211]
    s_barrier
    v_mfma_f32_16x16x32_bf16 v[208:211], a[152:155], a[8:11], v[208:211]
    v_exp_f32 v221, v221
    v_mfma_f32_16x16x32_bf16 v[208:211], a[156:159], a[12:15], v[208:211]
    v_mov_b32_dpp v248, v248 row_ror:2 row_mask:0xf bank_mask:0xf
    v_cvt_pk_bf16_f32 v230, v220, v221
    v_mfma_f32_16x16x32_bf16 v[212:215], a[172:175], a[12:15], v[240:243]
    v_exp_f32 v222, v222
    v_mfma_f32_16x16x32_bf16 v[212:215], a[168:171], a[8:11], v[212:215]
    ds_read_b128 a[112:115], v252 offset:0
    v_mfma_f32_16x16x32_bf16 v[212:215], a[164:167], a[4:7], v[212:215]
    v_exp_f32 v223, v223
    v_mfma_f32_16x16x32_bf16 v[212:215], a[160:163], a[0:3], v[212:215]
    s_add_u32 m0, s34, s4
    v_mov_b32_dpp v249, v249 row_ror:2 row_mask:0xf bank_mask:0xf
    v_cvt_pk_bf16_f32 v231, v222, v223
    v_mfma_f32_16x16x32_bf16 v[192:195], v[224:227], a[176:179], v[192:195]
    s_add_u32 s8, s16, s64
    v_exp_f32 v208, v208
    v_mfma_f32_16x16x32_bf16 v[192:195], v[228:231], a[180:183], v[192:195]
    s_addc_u32 s9, s17, 0
    ds_read_b128 a[116:119], v252 offset:64
    global_load_lds_dwordx4 v254, s[8:9] offset:0 nt
    v_mfma_f32_16x16x32_bf16 v[196:199], v[228:231], a[188:191], v[196:199]
    s_add_u32 s64, s64, 16384
    v_exp_f32 v209, v209
    v_mfma_f32_16x16x32_bf16 v[196:199], v[224:227], a[184:187], v[196:199]
    s_cmp_gt_u32 s64, s10
    v_mov_b32_dpp v250, v250 row_ror:2 row_mask:0xf bank_mask:0xf
    v_cvt_pk_bf16_f32 v236, v208, v209
    v_mfma_f32_16x16x32_bf16 v[200:203], v[224:227], a[192:195], v[200:203]
    s_cselect_b32 s64, 0, s64
    v_exp_f32 v210, v210
    v_mfma_f32_16x16x32_bf16 v[200:203], v[228:231], a[196:199], v[200:203]
    ds_read_b128 a[120:123], v252 offset:128
    v_mfma_f32_16x16x32_bf16 v[204:207], v[228:231], a[204:207], v[204:207]
    v_exp_f32 v211, v211
    v_mfma_f32_16x16x32_bf16 v[204:207], v[224:227], a[200:203], v[204:207]
    v_mov_b32_dpp v251, v251 row_ror:2 row_mask:0xf bank_mask:0xf
    v_cvt_pk_bf16_f32 v237, v210, v211
    v_mfma_f32_16x16x32_bf16 a[240:243], v[224:227], a[208:211], a[240:243]
    v_exp_f32 v212, v212
    v_mfma_f32_16x16x32_bf16 a[240:243], v[228:231], a[212:215], a[240:243]
    ds_read_b128 a[124:127], v252 offset:192
    v_mfma_f32_16x16x32_bf16 a[244:247], v[228:231], a[220:223], a[244:247]
    v_exp_f32 v213, v213
    v_mfma_f32_16x16x32_bf16 a[244:247], v[224:227], a[216:219], a[244:247]
    ds_read_b128 a[140:143], v252 offset:704
    v_cvt_pk_bf16_f32 v238, v212, v213
    v_mfma_f32_16x16x32_bf16 a[248:251], v[224:227], a[224:227], a[248:251]
    v_exp_f32 v214, v214
    v_mfma_f32_16x16x32_bf16 a[248:251], v[228:231], a[228:231], a[248:251]
    ds_read_b128 a[136:139], v252 offset:640
    ds_read_b128 a[132:135], v252 offset:576
    v_mfma_f32_16x16x32_bf16 a[252:255], v[228:231], a[236:239], a[252:255]
    v_exp_f32 v215, v215
    v_mfma_f32_16x16x32_bf16 a[252:255], v[224:227], a[232:235], a[252:255]
    s_add_u32 m0, m0, 32
    ds_read_b128 a[128:131], v252 offset:512
    v_cvt_pk_bf16_f32 v239, v214, v215
    v_smfmac_f32_16x16x64_bf16 v[244:247], v[248:251], v[224:231], v240
    s_waitcnt lgkmcnt(5)
    ds_read_b128 v[232:235], v254 offset:0
    v_mfma_f32_16x16x32_bf16 v[208:211], a[112:115], a[16:19], v[240:243]
    global_load_lds_dwordx4 v254, s[8:9] offset:1024 nt
    v_mfma_f32_16x16x32_bf16 v[208:211], a[116:119], a[20:23], v[208:211]
    v_mfma_f32_16x16x32_bf16 v[208:211], a[120:123], a[24:27], v[208:211]
    s_waitcnt lgkmcnt(5)
    v_mfma_f32_16x16x32_bf16 v[208:211], a[124:127], a[28:31], v[208:211]
    s_waitcnt lgkmcnt(4)
    v_mfma_f32_16x16x32_bf16 v[212:215], a[140:143], a[28:31], v[240:243]
    s_waitcnt lgkmcnt(3)
    v_mov_b32_dpp v248, v248 row_ror:4 row_mask:0xf bank_mask:0xf
    v_mfma_f32_16x16x32_bf16 v[212:215], a[136:139], a[24:27], v[212:215]
    s_waitcnt lgkmcnt(2)
    v_mov_b32_dpp v249, v249 row_ror:4 row_mask:0xf bank_mask:0xf
    v_mfma_f32_16x16x32_bf16 v[212:215], a[132:135], a[20:23], v[212:215]
    s_waitcnt lgkmcnt(1)
    v_mov_b32_dpp v250, v250 row_ror:4 row_mask:0xf bank_mask:0xf
    v_mfma_f32_16x16x32_bf16 v[212:215], a[128:131], a[16:19], v[212:215]
    v_mov_b32_dpp v251, v251 row_ror:4 row_mask:0xf bank_mask:0xf
    v_mfma_f32_16x16x32_bf16 v[216:219], a[144:147], a[16:19], v[240:243]
    v_exp_f32 v208, v208
    v_mfma_f32_16x16x32_bf16 v[216:219], a[148:151], a[20:23], v[216:219]
    v_mfma_f32_16x16x32_bf16 v[216:219], a[152:155], a[24:27], v[216:219]
    v_exp_f32 v209, v209
    v_mfma_f32_16x16x32_bf16 v[216:219], a[156:159], a[28:31], v[216:219]
    v_cvt_pk_bf16_f32 v224, v208, v209
    v_mfma_f32_16x16x32_bf16 v[220:223], a[172:175], a[28:31], v[240:243]
    s_add_u32 m0, m0, 32
    v_exp_f32 v210, v210
    v_mfma_f32_16x16x32_bf16 v[220:223], a[168:171], a[24:27], v[220:223]
    global_load_lds_dwordx4 v254, s[8:9] offset:2048 nt
    v_mfma_f32_16x16x32_bf16 v[220:223], a[164:167], a[20:23], v[220:223]
    v_exp_f32 v211, v211
    v_mfma_f32_16x16x32_bf16 v[220:223], a[160:163], a[16:19], v[220:223]
    s_waitcnt lgkmcnt(0)
    v_cvt_pk_bf16_f32 v225, v210, v211
    v_mfma_f32_16x16x32_bf16 v[0:3], v[232:235], a[176:179], v[0:3]
    v_exp_f32 v212, v212
    v_mfma_f32_16x16x32_bf16 v[0:3], v[236:239], a[180:183], v[0:3]
    ds_read_b64_tr_b16 a[176:177], v253 offset:0
    v_mfma_f32_16x16x32_bf16 v[4:7], v[236:239], a[188:191], v[4:7]
    v_exp_f32 v213, v213
    v_mfma_f32_16x16x32_bf16 v[4:7], v[232:235], a[184:187], v[4:7]
    ds_read_b64_tr_b16 a[178:179], v253 offset:512
    v_cvt_pk_bf16_f32 v226, v212, v213
    v_mfma_f32_16x16x32_bf16 v[8:11], v[232:235], a[192:195], v[8:11]
    v_exp_f32 v214, v214
    v_mfma_f32_16x16x32_bf16 v[8:11], v[236:239], a[196:199], v[8:11]
    ds_read_b64_tr_b16 a[184:185], v253 offset:16
    v_mfma_f32_16x16x32_bf16 v[12:15], v[236:239], a[204:207], v[12:15]
    v_exp_f32 v215, v215
    v_mfma_f32_16x16x32_bf16 v[12:15], v[232:235], a[200:203], v[12:15]
    ds_read_b64_tr_b16 a[186:187], v253 offset:528
    v_cvt_pk_bf16_f32 v227, v214, v215
    v_mfma_f32_16x16x32_bf16 v[16:19], v[232:235], a[208:211], v[16:19]
    v_exp_f32 v216, v216
    v_mfma_f32_16x16x32_bf16 v[16:19], v[236:239], a[212:215], v[16:19]
    ds_read_b64_tr_b16 a[192:193], v253 offset:32
    v_mfma_f32_16x16x32_bf16 v[20:23], v[236:239], a[220:223], v[20:23]
    v_exp_f32 v217, v217
    v_mfma_f32_16x16x32_bf16 v[20:23], v[232:235], a[216:219], v[20:23]
    ds_read_b64_tr_b16 a[194:195], v253 offset:544
    v_cvt_pk_bf16_f32 v228, v216, v217
    v_mfma_f32_16x16x32_bf16 v[24:27], v[232:235], a[224:227], v[24:27]
    v_exp_f32 v218, v218
    v_mfma_f32_16x16x32_bf16 v[24:27], v[236:239], a[228:231], v[24:27]
    ds_read_b64_tr_b16 a[200:201], v253 offset:48
    v_mfma_f32_16x16x32_bf16 v[28:31], v[236:239], a[236:239], v[28:31]
    v_exp_f32 v219, v219
    v_mfma_f32_16x16x32_bf16 v[28:31], v[232:235], a[232:235], v[28:31]
    ds_read_b64_tr_b16 a[202:203], v253 offset:560
    v_cvt_pk_bf16_f32 v229, v218, v219
    v_smfmac_f32_16x16x64_bf16 v[244:247], v[248:251], v[232:239], v240
    ds_read_b64_tr_b16 a[208:209], v253 offset:64
    v_mfma_f32_16x16x32_bf16 v[208:211], a[112:115], a[32:35], v[240:243]
    v_exp_f32 v220, v220
    v_mfma_f32_16x16x32_bf16 v[208:211], a[116:119], a[36:39], v[208:211]
    ds_read_b64_tr_b16 a[210:211], v253 offset:576
    v_mfma_f32_16x16x32_bf16 v[208:211], a[120:123], a[40:43], v[208:211]
    v_exp_f32 v221, v221
    v_mfma_f32_16x16x32_bf16 v[208:211], a[124:127], a[44:47], v[208:211]
    v_mov_b32_dpp v248, v248 row_ror:2 row_mask:0xf bank_mask:0xf
    v_cvt_pk_bf16_f32 v230, v220, v221
    v_mfma_f32_16x16x32_bf16 v[212:215], a[140:143], a[44:47], v[240:243]
    v_exp_f32 v222, v222
    v_mfma_f32_16x16x32_bf16 v[212:215], a[136:139], a[40:43], v[212:215]
    s_add_u32 m0, m0, 32
    ds_read_b64_tr_b16 a[216:217], v253 offset:80
    global_load_lds_dwordx4 v254, s[8:9] offset:3072 nt
    v_mfma_f32_16x16x32_bf16 v[212:215], a[132:135], a[36:39], v[212:215]
    v_exp_f32 v223, v223
    v_mfma_f32_16x16x32_bf16 v[212:215], a[128:131], a[32:35], v[212:215]
    v_mov_b32_dpp v249, v249 row_ror:2 row_mask:0xf bank_mask:0xf
    v_cvt_pk_bf16_f32 v231, v222, v223
    v_mfma_f32_16x16x32_bf16 v[216:219], a[144:147], a[32:35], v[240:243]
    v_exp_f32 v208, v208
    v_mfma_f32_16x16x32_bf16 v[216:219], a[148:151], a[36:39], v[216:219]
    ds_read_b64_tr_b16 a[218:219], v253 offset:592
    v_mfma_f32_16x16x32_bf16 v[216:219], a[152:155], a[40:43], v[216:219]
    v_exp_f32 v209, v209
    v_mfma_f32_16x16x32_bf16 v[216:219], a[156:159], a[44:47], v[216:219]
    v_mov_b32_dpp v250, v250 row_ror:2 row_mask:0xf bank_mask:0xf
    v_cvt_pk_bf16_f32 v232, v208, v209
    v_mfma_f32_16x16x32_bf16 v[220:223], a[172:175], a[44:47], v[240:243]
    v_exp_f32 v210, v210
    v_mfma_f32_16x16x32_bf16 v[220:223], a[168:171], a[40:43], v[220:223]
    ds_read_b64_tr_b16 a[224:225], v253 offset:96
    v_mfma_f32_16x16x32_bf16 v[220:223], a[164:167], a[36:39], v[220:223]
    v_exp_f32 v211, v211
    v_mfma_f32_16x16x32_bf16 v[220:223], a[160:163], a[32:35], v[220:223]
    s_waitcnt lgkmcnt(2)
    v_mov_b32_dpp v251, v251 row_ror:2 row_mask:0xf bank_mask:0xf
    v_cvt_pk_bf16_f32 v233, v210, v211
    v_mfma_f32_16x16x32_bf16 v[32:35], v[224:227], a[176:179], v[32:35]
    v_exp_f32 v212, v212
    v_mfma_f32_16x16x32_bf16 v[32:35], v[228:231], a[180:183], v[32:35]
    ds_read_b64_tr_b16 a[226:227], v253 offset:608
    v_mfma_f32_16x16x32_bf16 v[36:39], v[228:231], a[188:191], v[36:39]
    v_exp_f32 v213, v213
    v_mfma_f32_16x16x32_bf16 v[36:39], v[224:227], a[184:187], v[36:39]
    ds_read_b64_tr_b16 a[232:233], v253 offset:112
    v_cvt_pk_bf16_f32 v234, v212, v213
    v_mfma_f32_16x16x32_bf16 v[40:43], v[224:227], a[192:195], v[40:43]
    v_exp_f32 v214, v214
    v_mfma_f32_16x16x32_bf16 v[40:43], v[228:231], a[196:199], v[40:43]
    ds_read_b64_tr_b16 a[234:235], v253 offset:624
    v_mfma_f32_16x16x32_bf16 v[44:47], v[228:231], a[204:207], v[44:47]
    v_exp_f32 v215, v215
    v_mfma_f32_16x16x32_bf16 v[44:47], v[224:227], a[200:203], v[44:47]
    s_add_u32 m0, m0, 4128
    ds_read_b128 a[144:147], v252 offset:8448
    v_cvt_pk_bf16_f32 v235, v214, v215
    v_mfma_f32_16x16x32_bf16 v[48:51], v[224:227], a[208:211], v[48:51]
    s_add_u32 s8, s8, s7
    v_exp_f32 v216, v216
    v_mfma_f32_16x16x32_bf16 v[48:51], v[228:231], a[212:215], v[48:51]
    s_addc_u32 s9, s9, 0
    ds_read_b128 a[148:151], v252 offset:8512
    global_load_lds_dwordx4 v254, s[8:9] offset:0 nt
    v_mfma_f32_16x16x32_bf16 v[52:55], v[228:231], a[220:223], v[52:55]
    s_waitcnt lgkmcnt(5)
    v_exp_f32 v217, v217
    v_mfma_f32_16x16x32_bf16 v[52:55], v[224:227], a[216:219], v[52:55]
    s_waitcnt lgkmcnt(4)
    ds_read_b128 a[152:155], v252 offset:8576
    v_cvt_pk_bf16_f32 v236, v216, v217
    v_mfma_f32_16x16x32_bf16 v[56:59], v[224:227], a[224:227], v[56:59]
    v_exp_f32 v218, v218
    v_mfma_f32_16x16x32_bf16 v[56:59], v[228:231], a[228:231], v[56:59]
    ds_read_b128 a[156:159], v252 offset:8640
    v_mfma_f32_16x16x32_bf16 v[60:63], v[228:231], a[236:239], v[60:63]
    s_waitcnt lgkmcnt(4)
    v_exp_f32 v219, v219
    v_mfma_f32_16x16x32_bf16 v[60:63], v[224:227], a[232:235], v[60:63]
    ds_read_b128 a[172:175], v252 offset:9152
    v_cvt_pk_bf16_f32 v237, v218, v219
    v_smfmac_f32_16x16x64_bf16 v[244:247], v[248:251], v[224:231], v240
    ds_read_b128 a[168:171], v252 offset:9088
    v_mfma_f32_16x16x32_bf16 v[208:211], a[112:115], a[48:51], v[240:243]
    v_exp_f32 v220, v220
    v_mfma_f32_16x16x32_bf16 v[208:211], a[116:119], a[52:55], v[208:211]
    ds_read_b128 a[164:167], v252 offset:9024
    v_mfma_f32_16x16x32_bf16 v[208:211], a[120:123], a[56:59], v[208:211]
    v_exp_f32 v221, v221
    v_mfma_f32_16x16x32_bf16 v[208:211], a[124:127], a[60:63], v[208:211]
    v_mov_b32_dpp v248, v248 row_ror:2 row_mask:0xf bank_mask:0xf
    v_cvt_pk_bf16_f32 v238, v220, v221
    v_mfma_f32_16x16x32_bf16 v[212:215], a[140:143], a[60:63], v[240:243]
    v_exp_f32 v222, v222
    v_mfma_f32_16x16x32_bf16 v[212:215], a[136:139], a[56:59], v[212:215]
    ds_read_b128 a[160:163], v252 offset:8960
    v_mfma_f32_16x16x32_bf16 v[212:215], a[132:135], a[52:55], v[212:215]
    v_exp_f32 v223, v223
    v_mfma_f32_16x16x32_bf16 v[212:215], a[128:131], a[48:51], v[212:215]
    s_waitcnt lgkmcnt(4)
    v_mov_b32_dpp v249, v249 row_ror:2 row_mask:0xf bank_mask:0xf
    v_cvt_pk_bf16_f32 v239, v222, v223
    v_mfma_f32_16x16x32_bf16 v[216:219], a[144:147], a[48:51], v[240:243]
    v_exp_f32 v208, v208
    v_mfma_f32_16x16x32_bf16 v[216:219], a[148:151], a[52:55], v[216:219]
    v_mfma_f32_16x16x32_bf16 v[216:219], a[152:155], a[56:59], v[216:219]
    s_add_u32 m0, s34, s5
    v_exp_f32 v209, v209
    v_mfma_f32_16x16x32_bf16 v[216:219], a[156:159], a[60:63], v[216:219]
    s_waitcnt lgkmcnt(1)
    v_mov_b32_dpp v250, v250 row_ror:2 row_mask:0xf bank_mask:0xf
    v_cvt_pk_bf16_f32 v224, v208, v209
    v_mfma_f32_16x16x32_bf16 v[220:223], a[172:175], a[60:63], v[240:243]
    s_add_u32 s8, s20, s66
    v_exp_f32 v210, v210
    v_mfma_f32_16x16x32_bf16 v[220:223], a[168:171], a[56:59], v[220:223]
    s_addc_u32 s9, s21, 0
    global_load_lds_dwordx4 v254, s[8:9] offset:0 nt
    v_mfma_f32_16x16x32_bf16 v[220:223], a[164:167], a[52:55], v[220:223]
    s_waitcnt lgkmcnt(0)
    v_exp_f32 v211, v211
    v_mfma_f32_16x16x32_bf16 v[220:223], a[160:163], a[48:51], v[220:223]
    s_add_u32 s34, s34, 33536
    v_mov_b32_dpp v251, v251 row_ror:2 row_mask:0xf bank_mask:0xf
    v_cvt_pk_bf16_f32 v225, v210, v211
    v_mfma_f32_16x16x32_bf16 v[64:67], v[232:235], a[176:179], v[64:67]
    s_cmp_eq_u32 s34, 100608
    v_exp_f32 v212, v212
    v_mfma_f32_16x16x32_bf16 v[64:67], v[236:239], a[180:183], v[64:67]
    s_cselect_b32 s34, 0, s34
    ds_read_b64_tr_b16 a[180:181], v253 offset:8320
    v_mfma_f32_16x16x32_bf16 v[68:71], v[236:239], a[188:191], v[68:71]
    s_add_u32 s66, s66, 16384
    v_exp_f32 v213, v213
    v_mfma_f32_16x16x32_bf16 v[68:71], v[232:235], a[184:187], v[68:71]
    ds_read_b64_tr_b16 a[182:183], v253 offset:8832
    v_cvt_pk_bf16_f32 v226, v212, v213
    v_mfma_f32_16x16x32_bf16 v[72:75], v[232:235], a[192:195], v[72:75]
    s_add_u32 s31, s31, 33536
    v_exp_f32 v214, v214
    v_mfma_f32_16x16x32_bf16 v[72:75], v[236:239], a[196:199], v[72:75]
    s_cmp_eq_u32 s31, 100608
    ds_read_b64_tr_b16 a[188:189], v253 offset:8336
    v_mfma_f32_16x16x32_bf16 v[76:79], v[236:239], a[204:207], v[76:79]
    s_cselect_b32 s30, s71, s72
    v_exp_f32 v215, v215
    v_mfma_f32_16x16x32_bf16 v[76:79], v[232:235], a[200:203], v[76:79]
    s_cselect_b32 s31, 0, s31
    ds_read_b64_tr_b16 a[190:191], v253 offset:8848
    v_cvt_pk_bf16_f32 v227, v214, v215
    v_mfma_f32_16x16x32_bf16 v[80:83], v[232:235], a[208:211], v[80:83]
    s_cmp_gt_u32 s66, s11
    v_exp_f32 v216, v216
    v_mfma_f32_16x16x32_bf16 v[80:83], v[236:239], a[212:215], v[80:83]
    s_cselect_b32 s66, 0, s66
    ds_read_b64_tr_b16 a[196:197], v253 offset:8352
    v_mfma_f32_16x16x32_bf16 v[84:87], v[236:239], a[220:223], v[84:87]
    v_exp_f32 v217, v217
    v_mfma_f32_16x16x32_bf16 v[84:87], v[232:235], a[216:219], v[84:87]
    ds_read_b64_tr_b16 a[198:199], v253 offset:8864
    v_cvt_pk_bf16_f32 v228, v216, v217
    v_mfma_f32_16x16x32_bf16 v[88:91], v[232:235], a[224:227], v[88:91]
    v_exp_f32 v218, v218
    v_mfma_f32_16x16x32_bf16 v[88:91], v[236:239], a[228:231], v[88:91]
    ds_read_b64_tr_b16 a[204:205], v253 offset:8368
    v_mfma_f32_16x16x32_bf16 v[92:95], v[236:239], a[236:239], v[92:95]
    v_exp_f32 v219, v219
    v_mfma_f32_16x16x32_bf16 v[92:95], v[232:235], a[232:235], v[92:95]
    ds_read_b64_tr_b16 a[206:207], v253 offset:8880
    v_cvt_pk_bf16_f32 v229, v218, v219
    v_smfmac_f32_16x16x64_bf16 v[244:247], v[248:251], v[232:239], v240
    s_add_u32 m0, m0, 16
    ds_read_b64_tr_b16 a[212:213], v253 offset:8384
    global_load_lds_dwordx4 v254, s[8:9] offset:1024 nt
    v_mfma_f32_16x16x32_bf16 v[208:211], a[112:115], a[64:67], v[240:243]
    v_exp_f32 v220, v220
    v_mfma_f32_16x16x32_bf16 v[208:211], a[116:119], a[68:71], v[208:211]
    ds_read_b64_tr_b16 a[214:215], v253 offset:8896
    v_mfma_f32_16x16x32_bf16 v[208:211], a[120:123], a[72:75], v[208:211]
    v_exp_f32 v221, v221
    v_mfma_f32_16x16x32_bf16 v[208:211], a[124:127], a[76:79], v[208:211]
    v_mov_b32_dpp v248, v248 row_ror:2 row_mask:0xf bank_mask:0xf
    v_cvt_pk_bf16_f32 v230, v220, v221
    v_mfma_f32_16x16x32_bf16 v[212:215], a[140:143], a[76:79], v[240:243]
    v_exp_f32 v222, v222
    v_mfma_f32_16x16x32_bf16 v[212:215], a[136:139], a[72:75], v[212:215]
    ds_read_b64_tr_b16 a[220:221], v253 offset:8400
    v_mfma_f32_16x16x32_bf16 v[212:215], a[132:135], a[68:71], v[212:215]
    v_exp_f32 v223, v223
    v_mfma_f32_16x16x32_bf16 v[212:215], a[128:131], a[64:67], v[212:215]
    v_mov_b32_dpp v249, v249 row_ror:2 row_mask:0xf bank_mask:0xf
    v_cvt_pk_bf16_f32 v231, v222, v223
    v_mfma_f32_16x16x32_bf16 v[216:219], a[144:147], a[64:67], v[240:243]
    v_exp_f32 v208, v208
    v_mfma_f32_16x16x32_bf16 v[216:219], a[148:151], a[68:71], v[216:219]
    ds_read_b64_tr_b16 a[222:223], v253 offset:8912
    v_mfma_f32_16x16x32_bf16 v[216:219], a[152:155], a[72:75], v[216:219]
    v_exp_f32 v209, v209
    v_mfma_f32_16x16x32_bf16 v[216:219], a[156:159], a[76:79], v[216:219]
    v_mov_b32_dpp v250, v250 row_ror:2 row_mask:0xf bank_mask:0xf
    v_cvt_pk_bf16_f32 v232, v208, v209
    v_mfma_f32_16x16x32_bf16 v[220:223], a[172:175], a[76:79], v[240:243]
    v_exp_f32 v210, v210
    v_mfma_f32_16x16x32_bf16 v[220:223], a[168:171], a[72:75], v[220:223]
    ds_read_b64_tr_b16 a[228:229], v253 offset:8416
    v_mfma_f32_16x16x32_bf16 v[220:223], a[164:167], a[68:71], v[220:223]
    v_exp_f32 v211, v211
    v_mfma_f32_16x16x32_bf16 v[220:223], a[160:163], a[64:67], v[220:223]
    v_mov_b32_dpp v251, v251 row_ror:2 row_mask:0xf bank_mask:0xf
    v_cvt_pk_bf16_f32 v233, v210, v211
    v_mfma_f32_16x16x32_bf16 v[96:99], v[224:227], a[176:179], v[96:99]
    s_waitcnt lgkmcnt(2)
    v_exp_f32 v212, v212
    v_mfma_f32_16x16x32_bf16 v[96:99], v[228:231], a[180:183], v[96:99]
    ds_read_b64_tr_b16 a[230:231], v253 offset:8928
    v_mfma_f32_16x16x32_bf16 v[100:103], v[228:231], a[188:191], v[100:103]
    v_exp_f32 v213, v213
    v_mfma_f32_16x16x32_bf16 v[100:103], v[224:227], a[184:187], v[100:103]
    ds_read_b64_tr_b16 a[236:237], v253 offset:8432
    v_cvt_pk_bf16_f32 v234, v212, v213
    v_mfma_f32_16x16x32_bf16 v[104:107], v[224:227], a[192:195], v[104:107]
    v_exp_f32 v214, v214
    v_mfma_f32_16x16x32_bf16 v[104:107], v[228:231], a[196:199], v[104:107]
    ds_read_b64_tr_b16 a[238:239], v253 offset:8944
    v_mfma_f32_16x16x32_bf16 v[108:111], v[228:231], a[204:207], v[108:111]
    v_exp_f32 v215, v215
    v_mfma_f32_16x16x32_bf16 v[108:111], v[224:227], a[200:203], v[108:111]
    v_cvt_pk_bf16_f32 v235, v214, v215
    v_mfma_f32_16x16x32_bf16 v[112:115], v[224:227], a[208:211], v[112:115]
    s_add_u32 m0, m0, 16
    v_exp_f32 v216, v216
    v_mfma_f32_16x16x32_bf16 v[112:115], v[228:231], a[212:215], v[112:115]
    s_waitcnt lgkmcnt(3)
    global_load_lds_dwordx4 v254, s[8:9] offset:2048 nt
    v_mfma_f32_16x16x32_bf16 v[116:119], v[228:231], a[220:223], v[116:119]
    v_exp_f32 v217, v217
    v_mfma_f32_16x16x32_bf16 v[116:119], v[224:227], a[216:219], v[116:119]
    v_cvt_pk_bf16_f32 v236, v216, v217
    v_mfma_f32_16x16x32_bf16 v[120:123], v[224:227], a[224:227], v[120:123]
    s_waitcnt lgkmcnt(2)
    v_exp_f32 v218, v218
    v_mfma_f32_16x16x32_bf16 v[120:123], v[228:231], a[228:231], v[120:123]
    s_waitcnt lgkmcnt(0)
    v_mfma_f32_16x16x32_bf16 v[124:127], v[228:231], a[236:239], v[124:127]
    v_exp_f32 v219, v219
    v_mfma_f32_16x16x32_bf16 v[124:127], v[224:227], a[232:235], v[124:127]
    v_cvt_pk_bf16_f32 v237, v218, v219
    v_smfmac_f32_16x16x64_bf16 v[244:247], v[248:251], v[224:231], v240
    v_mfma_f32_16x16x32_bf16 v[208:211], a[112:115], a[80:83], v[240:243]
    v_exp_f32 v220, v220
    v_mfma_f32_16x16x32_bf16 v[208:211], a[116:119], a[84:87], v[208:211]
    v_mfma_f32_16x16x32_bf16 v[208:211], a[120:123], a[88:91], v[208:211]
    v_exp_f32 v221, v221
    v_mfma_f32_16x16x32_bf16 v[208:211], a[124:127], a[92:95], v[208:211]
    v_mov_b32_dpp v248, v248 row_ror:2 row_mask:0xf bank_mask:0xf
    v_cvt_pk_bf16_f32 v238, v220, v221
    v_mfma_f32_16x16x32_bf16 v[212:215], a[140:143], a[92:95], v[240:243]
    s_add_u32 m0, m0, 16
    v_exp_f32 v222, v222
    v_mfma_f32_16x16x32_bf16 v[212:215], a[136:139], a[88:91], v[212:215]
    global_load_lds_dwordx4 v254, s[8:9] offset:3072 nt
    v_mfma_f32_16x16x32_bf16 v[212:215], a[132:135], a[84:87], v[212:215]
    v_exp_f32 v223, v223
    v_mfma_f32_16x16x32_bf16 v[212:215], a[128:131], a[80:83], v[212:215]
    v_mov_b32_dpp v249, v249 row_ror:2 row_mask:0xf bank_mask:0xf
    v_cvt_pk_bf16_f32 v239, v222, v223
    v_mfma_f32_16x16x32_bf16 v[216:219], a[144:147], a[80:83], v[240:243]
    v_exp_f32 v208, v208
    v_mfma_f32_16x16x32_bf16 v[216:219], a[148:151], a[84:87], v[216:219]
    v_mfma_f32_16x16x32_bf16 v[216:219], a[152:155], a[88:91], v[216:219]
    v_exp_f32 v209, v209
    v_mfma_f32_16x16x32_bf16 v[216:219], a[156:159], a[92:95], v[216:219]
    v_mov_b32_dpp v250, v250 row_ror:2 row_mask:0xf bank_mask:0xf
    v_cvt_pk_bf16_f32 v224, v208, v209
    v_mfma_f32_16x16x32_bf16 v[220:223], a[172:175], a[92:95], v[240:243]
    v_exp_f32 v210, v210
    v_mfma_f32_16x16x32_bf16 v[220:223], a[168:171], a[88:91], v[220:223]
    v_mfma_f32_16x16x32_bf16 v[220:223], a[164:167], a[84:87], v[220:223]
    v_exp_f32 v211, v211
    v_mfma_f32_16x16x32_bf16 v[220:223], a[160:163], a[80:83], v[220:223]
    v_mov_b32_dpp v251, v251 row_ror:2 row_mask:0xf bank_mask:0xf
    v_cvt_pk_bf16_f32 v225, v210, v211
    v_mfma_f32_16x16x32_bf16 v[128:131], v[232:235], a[176:179], v[128:131]
    v_exp_f32 v212, v212
    v_mfma_f32_16x16x32_bf16 v[128:131], v[236:239], a[180:183], v[128:131]
    v_mfma_f32_16x16x32_bf16 v[132:135], v[236:239], a[188:191], v[132:135]
    v_exp_f32 v213, v213
    v_mfma_f32_16x16x32_bf16 v[132:135], v[232:235], a[184:187], v[132:135]
    v_cvt_pk_bf16_f32 v226, v212, v213
    v_mfma_f32_16x16x32_bf16 v[136:139], v[232:235], a[192:195], v[136:139]
    v_exp_f32 v214, v214
    v_mfma_f32_16x16x32_bf16 v[136:139], v[236:239], a[196:199], v[136:139]
    v_mfma_f32_16x16x32_bf16 v[140:143], v[236:239], a[204:207], v[140:143]
    v_exp_f32 v215, v215
    v_mfma_f32_16x16x32_bf16 v[140:143], v[232:235], a[200:203], v[140:143]
    s_add_u32 m0, m0, 4112
    v_cvt_pk_bf16_f32 v227, v214, v215
    v_mfma_f32_16x16x32_bf16 v[144:147], v[232:235], a[208:211], v[144:147]
    s_add_u32 s8, s8, s7
    v_exp_f32 v216, v216
    v_mfma_f32_16x16x32_bf16 v[144:147], v[236:239], a[212:215], v[144:147]
    s_addc_u32 s9, s9, 0
    global_load_lds_dwordx4 v254, s[8:9] offset:0 nt
    v_mfma_f32_16x16x32_bf16 v[148:151], v[236:239], a[220:223], v[148:151]
    s_cmp_eq_u32 s64, 0
    v_exp_f32 v217, v217
    v_mfma_f32_16x16x32_bf16 v[148:151], v[232:235], a[216:219], v[148:151]
    s_cselect_b32 s7, 0, s7
    v_cvt_pk_bf16_f32 v228, v216, v217
    v_mfma_f32_16x16x32_bf16 v[152:155], v[232:235], a[224:227], v[152:155]
    v_exp_f32 v218, v218
    v_mfma_f32_16x16x32_bf16 v[152:155], v[236:239], a[228:231], v[152:155]
    v_mfma_f32_16x16x32_bf16 v[156:159], v[236:239], a[236:239], v[156:159]
    v_exp_f32 v219, v219
    v_mfma_f32_16x16x32_bf16 v[156:159], v[232:235], a[232:235], v[156:159]
    v_cvt_pk_bf16_f32 v229, v218, v219
    v_smfmac_f32_16x16x64_bf16 v[244:247], v[248:251], v[232:239], v240
    v_mfma_f32_16x16x32_bf16 v[208:211], a[112:115], a[96:99], v[240:243]
    v_exp_f32 v220, v220
    v_mfma_f32_16x16x32_bf16 v[208:211], a[116:119], a[100:103], v[208:211]
    v_mfma_f32_16x16x32_bf16 v[208:211], a[120:123], a[104:107], v[208:211]
    v_exp_f32 v221, v221
    v_mfma_f32_16x16x32_bf16 v[208:211], a[124:127], a[108:111], v[208:211]
    v_mov_b32_dpp v248, v248 row_ror:2 row_mask:0xf bank_mask:0xf
    v_cvt_pk_bf16_f32 v230, v220, v221
    v_mfma_f32_16x16x32_bf16 v[212:215], a[140:143], a[108:111], v[240:243]
    v_exp_f32 v222, v222
    v_mfma_f32_16x16x32_bf16 v[212:215], a[136:139], a[104:107], v[212:215]
    v_mfma_f32_16x16x32_bf16 v[212:215], a[132:135], a[100:103], v[212:215]
    v_exp_f32 v223, v223
    v_mfma_f32_16x16x32_bf16 v[212:215], a[128:131], a[96:99], v[212:215]
    v_mov_b32_dpp v249, v249 row_ror:2 row_mask:0xf bank_mask:0xf
    v_cvt_pk_bf16_f32 v231, v222, v223
    v_mfma_f32_16x16x32_bf16 v[216:219], a[144:147], a[96:99], v[240:243]
    v_exp_f32 v208, v208
    v_mfma_f32_16x16x32_bf16 v[216:219], a[148:151], a[100:103], v[216:219]
    v_mfma_f32_16x16x32_bf16 v[216:219], a[152:155], a[104:107], v[216:219]
    v_exp_f32 v209, v209
    v_mfma_f32_16x16x32_bf16 v[216:219], a[156:159], a[108:111], v[216:219]
    v_mov_b32_dpp v250, v250 row_ror:2 row_mask:0xf bank_mask:0xf
    v_cvt_pk_bf16_f32 v232, v208, v209
    v_mfma_f32_16x16x32_bf16 v[220:223], a[172:175], a[108:111], v[240:243]
    v_exp_f32 v210, v210
    v_mfma_f32_16x16x32_bf16 v[220:223], a[168:171], a[104:107], v[220:223]
    v_mfma_f32_16x16x32_bf16 v[220:223], a[164:167], a[100:103], v[220:223]
    v_exp_f32 v211, v211
    v_mfma_f32_16x16x32_bf16 v[220:223], a[160:163], a[96:99], v[220:223]
    v_mov_b32_dpp v251, v251 row_ror:2 row_mask:0xf bank_mask:0xf
    v_cvt_pk_bf16_f32 v233, v210, v211
    v_mfma_f32_16x16x32_bf16 v[160:163], v[224:227], a[176:179], v[160:163]
    v_exp_f32 v212, v212
    v_mfma_f32_16x16x32_bf16 v[160:163], v[228:231], a[180:183], v[160:163]
    v_mfma_f32_16x16x32_bf16 v[164:167], v[228:231], a[188:191], v[164:167]
    v_exp_f32 v213, v213
    v_mfma_f32_16x16x32_bf16 v[164:167], v[224:227], a[184:187], v[164:167]
    v_cvt_pk_bf16_f32 v234, v212, v213
    v_mfma_f32_16x16x32_bf16 v[168:171], v[224:227], a[192:195], v[168:171]
    v_exp_f32 v214, v214
    v_mfma_f32_16x16x32_bf16 v[168:171], v[228:231], a[196:199], v[168:171]
    v_mfma_f32_16x16x32_bf16 v[172:175], v[228:231], a[204:207], v[172:175]
    v_exp_f32 v215, v215
    v_mfma_f32_16x16x32_bf16 v[172:175], v[224:227], a[200:203], v[172:175]
    v_cvt_pk_bf16_f32 v235, v214, v215
    v_mfma_f32_16x16x32_bf16 v[176:179], v[224:227], a[208:211], v[176:179]
    v_exp_f32 v216, v216
    v_mfma_f32_16x16x32_bf16 v[176:179], v[228:231], a[212:215], v[176:179]
    v_mfma_f32_16x16x32_bf16 v[180:183], v[228:231], a[220:223], v[180:183]
    v_exp_f32 v217, v217
    v_mfma_f32_16x16x32_bf16 v[180:183], v[224:227], a[216:219], v[180:183]
    v_cvt_pk_bf16_f32 v236, v216, v217
    v_mfma_f32_16x16x32_bf16 v[184:187], v[224:227], a[224:227], v[184:187]
    v_exp_f32 v218, v218
    v_mfma_f32_16x16x32_bf16 v[184:187], v[228:231], a[228:231], v[184:187]
    v_add_u32 v252, s30, v252
    v_mfma_f32_16x16x32_bf16 v[188:191], v[228:231], a[236:239], v[188:191]
    v_exp_f32 v219, v219
    v_mfma_f32_16x16x32_bf16 v[188:191], v[224:227], a[232:235], v[188:191]
    s_waitcnt vmcnt(10)
    v_cvt_pk_bf16_f32 v237, v218, v219
    v_add_u32 v253, s30, v253
    v_smfmac_f32_16x16x64_bf16 v[244:247], v[248:251], v[224:231], v240
    v_mfma_f32_16x16x32_bf16 v[208:211], a[144:147], a[0:3], v[240:243]
    v_exp_f32 v220, v220
    v_mfma_f32_16x16x32_bf16 v[208:211], a[148:151], a[4:7], v[208:211]
    s_barrier
    v_mfma_f32_16x16x32_bf16 v[208:211], a[152:155], a[8:11], v[208:211]
    v_exp_f32 v221, v221
    v_mfma_f32_16x16x32_bf16 v[208:211], a[156:159], a[12:15], v[208:211]
    v_mov_b32_dpp v248, v248 row_ror:2 row_mask:0xf bank_mask:0xf
    v_cvt_pk_bf16_f32 v238, v220, v221
    v_mfma_f32_16x16x32_bf16 v[212:215], a[172:175], a[12:15], v[240:243]
    v_exp_f32 v222, v222
    v_mfma_f32_16x16x32_bf16 v[212:215], a[168:171], a[8:11], v[212:215]
    ds_read_b128 a[112:115], v252 offset:0
    v_mfma_f32_16x16x32_bf16 v[212:215], a[164:167], a[4:7], v[212:215]
    v_exp_f32 v223, v223
    v_mfma_f32_16x16x32_bf16 v[212:215], a[160:163], a[0:3], v[212:215]
    s_add_u32 m0, s34, s4
    v_mov_b32_dpp v249, v249 row_ror:2 row_mask:0xf bank_mask:0xf
    v_cvt_pk_bf16_f32 v239, v222, v223
    v_mfma_f32_16x16x32_bf16 v[192:195], v[232:235], a[176:179], v[192:195]
    s_add_u32 s8, s16, s64
    v_exp_f32 v208, v208
    v_mfma_f32_16x16x32_bf16 v[192:195], v[236:239], a[180:183], v[192:195]
    s_addc_u32 s9, s17, 0
    ds_read_b128 a[116:119], v252 offset:64
    global_load_lds_dwordx4 v254, s[8:9] offset:0 nt
    v_mfma_f32_16x16x32_bf16 v[196:199], v[236:239], a[188:191], v[196:199]
    s_add_u32 s64, s64, 16384
    v_exp_f32 v209, v209
    v_mfma_f32_16x16x32_bf16 v[196:199], v[232:235], a[184:187], v[196:199]
    s_cmp_gt_u32 s64, s10
    v_mov_b32_dpp v250, v250 row_ror:2 row_mask:0xf bank_mask:0xf
    v_cvt_pk_bf16_f32 v228, v208, v209
    v_mfma_f32_16x16x32_bf16 v[200:203], v[232:235], a[192:195], v[200:203]
    s_cselect_b32 s64, 0, s64
    v_exp_f32 v210, v210
    v_mfma_f32_16x16x32_bf16 v[200:203], v[236:239], a[196:199], v[200:203]
    ds_read_b128 a[120:123], v252 offset:128
    v_mfma_f32_16x16x32_bf16 v[204:207], v[236:239], a[204:207], v[204:207]
    v_exp_f32 v211, v211
    v_mfma_f32_16x16x32_bf16 v[204:207], v[232:235], a[200:203], v[204:207]
    v_mov_b32_dpp v251, v251 row_ror:2 row_mask:0xf bank_mask:0xf
    v_cvt_pk_bf16_f32 v229, v210, v211
    v_mfma_f32_16x16x32_bf16 a[240:243], v[232:235], a[208:211], a[240:243]
    v_exp_f32 v212, v212
    v_mfma_f32_16x16x32_bf16 a[240:243], v[236:239], a[212:215], a[240:243]
    ds_read_b128 a[124:127], v252 offset:192
    v_mfma_f32_16x16x32_bf16 a[244:247], v[236:239], a[220:223], a[244:247]
    v_exp_f32 v213, v213
    v_mfma_f32_16x16x32_bf16 a[244:247], v[232:235], a[216:219], a[244:247]
    ds_read_b128 a[140:143], v252 offset:704
    v_cvt_pk_bf16_f32 v230, v212, v213
    v_mfma_f32_16x16x32_bf16 a[248:251], v[232:235], a[224:227], a[248:251]
    v_exp_f32 v214, v214
    v_mfma_f32_16x16x32_bf16 a[248:251], v[236:239], a[228:231], a[248:251]
    ds_read_b128 a[136:139], v252 offset:640
    ds_read_b128 a[132:135], v252 offset:576
    v_mfma_f32_16x16x32_bf16 a[252:255], v[236:239], a[236:239], a[252:255]
    v_exp_f32 v215, v215
    v_mfma_f32_16x16x32_bf16 a[252:255], v[232:235], a[232:235], a[252:255]
    s_add_u32 m0, m0, 32
    ds_read_b128 a[128:131], v252 offset:512
    v_cvt_pk_bf16_f32 v231, v214, v215
    v_smfmac_f32_16x16x64_bf16 v[244:247], v[248:251], v[232:239], v240
    s_waitcnt lgkmcnt(5)
    ds_read_b128 v[224:227], v254 offset:3072
    v_mfma_f32_16x16x32_bf16 v[208:211], a[112:115], a[16:19], v[240:243]
    global_load_lds_dwordx4 v254, s[8:9] offset:1024 nt
    v_mfma_f32_16x16x32_bf16 v[208:211], a[116:119], a[20:23], v[208:211]
    v_mfma_f32_16x16x32_bf16 v[208:211], a[120:123], a[24:27], v[208:211]
    s_waitcnt lgkmcnt(5)
    v_mfma_f32_16x16x32_bf16 v[208:211], a[124:127], a[28:31], v[208:211]
    s_waitcnt lgkmcnt(4)
    v_mfma_f32_16x16x32_bf16 v[212:215], a[140:143], a[28:31], v[240:243]
    s_waitcnt lgkmcnt(3)
    v_mov_b32_dpp v248, v248 row_ror:4 row_mask:0xf bank_mask:0xf
    v_mfma_f32_16x16x32_bf16 v[212:215], a[136:139], a[24:27], v[212:215]
    s_waitcnt lgkmcnt(2)
    v_mov_b32_dpp v249, v249 row_ror:4 row_mask:0xf bank_mask:0xf
    v_mfma_f32_16x16x32_bf16 v[212:215], a[132:135], a[20:23], v[212:215]
    s_waitcnt lgkmcnt(1)
    v_mov_b32_dpp v250, v250 row_ror:4 row_mask:0xf bank_mask:0xf
    v_mfma_f32_16x16x32_bf16 v[212:215], a[128:131], a[16:19], v[212:215]
    v_mov_b32_dpp v251, v251 row_ror:4 row_mask:0xf bank_mask:0xf
    v_mfma_f32_16x16x32_bf16 v[216:219], a[144:147], a[16:19], v[240:243]
    v_exp_f32 v208, v208
    v_mfma_f32_16x16x32_bf16 v[216:219], a[148:151], a[20:23], v[216:219]
    v_mfma_f32_16x16x32_bf16 v[216:219], a[152:155], a[24:27], v[216:219]
    v_exp_f32 v209, v209
    v_mfma_f32_16x16x32_bf16 v[216:219], a[156:159], a[28:31], v[216:219]
    v_cvt_pk_bf16_f32 v232, v208, v209
    v_mfma_f32_16x16x32_bf16 v[220:223], a[172:175], a[28:31], v[240:243]
    s_add_u32 m0, m0, 32
    v_exp_f32 v210, v210
    v_mfma_f32_16x16x32_bf16 v[220:223], a[168:171], a[24:27], v[220:223]
    global_load_lds_dwordx4 v254, s[8:9] offset:2048 nt
    v_mfma_f32_16x16x32_bf16 v[220:223], a[164:167], a[20:23], v[220:223]
    v_exp_f32 v211, v211
    v_mfma_f32_16x16x32_bf16 v[220:223], a[160:163], a[16:19], v[220:223]
    s_waitcnt lgkmcnt(0)
    v_cvt_pk_bf16_f32 v233, v210, v211
    v_mfma_f32_16x16x32_bf16 v[0:3], v[224:227], a[176:179], v[0:3]
    v_exp_f32 v212, v212
    v_mfma_f32_16x16x32_bf16 v[0:3], v[228:231], a[180:183], v[0:3]
    ds_read_b64_tr_b16 a[176:177], v253 offset:0
    v_mfma_f32_16x16x32_bf16 v[4:7], v[228:231], a[188:191], v[4:7]
    v_exp_f32 v213, v213
    v_mfma_f32_16x16x32_bf16 v[4:7], v[224:227], a[184:187], v[4:7]
    ds_read_b64_tr_b16 a[178:179], v253 offset:512
    v_cvt_pk_bf16_f32 v234, v212, v213
    v_mfma_f32_16x16x32_bf16 v[8:11], v[224:227], a[192:195], v[8:11]
    v_exp_f32 v214, v214
    v_mfma_f32_16x16x32_bf16 v[8:11], v[228:231], a[196:199], v[8:11]
    ds_read_b64_tr_b16 a[184:185], v253 offset:16
    v_mfma_f32_16x16x32_bf16 v[12:15], v[228:231], a[204:207], v[12:15]
    v_exp_f32 v215, v215
    v_mfma_f32_16x16x32_bf16 v[12:15], v[224:227], a[200:203], v[12:15]
    ds_read_b64_tr_b16 a[186:187], v253 offset:528
    v_cvt_pk_bf16_f32 v235, v214, v215
    v_mfma_f32_16x16x32_bf16 v[16:19], v[224:227], a[208:211], v[16:19]
    v_exp_f32 v216, v216
    v_mfma_f32_16x16x32_bf16 v[16:19], v[228:231], a[212:215], v[16:19]
    ds_read_b64_tr_b16 a[192:193], v253 offset:32
    v_mfma_f32_16x16x32_bf16 v[20:23], v[228:231], a[220:223], v[20:23]
    v_exp_f32 v217, v217
    v_mfma_f32_16x16x32_bf16 v[20:23], v[224:227], a[216:219], v[20:23]
    ds_read_b64_tr_b16 a[194:195], v253 offset:544
    v_cvt_pk_bf16_f32 v236, v216, v217
    v_mfma_f32_16x16x32_bf16 v[24:27], v[224:227], a[224:227], v[24:27]
    v_exp_f32 v218, v218
    v_mfma_f32_16x16x32_bf16 v[24:27], v[228:231], a[228:231], v[24:27]
    ds_read_b64_tr_b16 a[200:201], v253 offset:48
    v_mfma_f32_16x16x32_bf16 v[28:31], v[228:231], a[236:239], v[28:31]
    v_exp_f32 v219, v219
    v_mfma_f32_16x16x32_bf16 v[28:31], v[224:227], a[232:235], v[28:31]
    ds_read_b64_tr_b16 a[202:203], v253 offset:560
    v_cvt_pk_bf16_f32 v237, v218, v219
    v_smfmac_f32_16x16x64_bf16 v[244:247], v[248:251], v[224:231], v240
    ds_read_b64_tr_b16 a[208:209], v253 offset:64
    v_mfma_f32_16x16x32_bf16 v[208:211], a[112:115], a[32:35], v[240:243]
    v_exp_f32 v220, v220
    v_mfma_f32_16x16x32_bf16 v[208:211], a[116:119], a[36:39], v[208:211]
    ds_read_b64_tr_b16 a[210:211], v253 offset:576
    v_mfma_f32_16x16x32_bf16 v[208:211], a[120:123], a[40:43], v[208:211]
    v_exp_f32 v221, v221
    v_mfma_f32_16x16x32_bf16 v[208:211], a[124:127], a[44:47], v[208:211]
    v_mov_b32_dpp v248, v248 row_ror:2 row_mask:0xf bank_mask:0xf
    v_cvt_pk_bf16_f32 v238, v220, v221
    v_mfma_f32_16x16x32_bf16 v[212:215], a[140:143], a[44:47], v[240:243]
    v_exp_f32 v222, v222
    v_mfma_f32_16x16x32_bf16 v[212:215], a[136:139], a[40:43], v[212:215]
    s_add_u32 m0, m0, 32
    ds_read_b64_tr_b16 a[216:217], v253 offset:80
    global_load_lds_dwordx4 v254, s[8:9] offset:3072 nt
    v_mfma_f32_16x16x32_bf16 v[212:215], a[132:135], a[36:39], v[212:215]
    v_exp_f32 v223, v223
    v_mfma_f32_16x16x32_bf16 v[212:215], a[128:131], a[32:35], v[212:215]
    v_mov_b32_dpp v249, v249 row_ror:2 row_mask:0xf bank_mask:0xf
    v_cvt_pk_bf16_f32 v239, v222, v223
    v_mfma_f32_16x16x32_bf16 v[216:219], a[144:147], a[32:35], v[240:243]
    v_exp_f32 v208, v208
    v_mfma_f32_16x16x32_bf16 v[216:219], a[148:151], a[36:39], v[216:219]
    ds_read_b64_tr_b16 a[218:219], v253 offset:592
    v_mfma_f32_16x16x32_bf16 v[216:219], a[152:155], a[40:43], v[216:219]
    v_exp_f32 v209, v209
    v_mfma_f32_16x16x32_bf16 v[216:219], a[156:159], a[44:47], v[216:219]
    v_mov_b32_dpp v250, v250 row_ror:2 row_mask:0xf bank_mask:0xf
    v_cvt_pk_bf16_f32 v224, v208, v209
    v_mfma_f32_16x16x32_bf16 v[220:223], a[172:175], a[44:47], v[240:243]
    v_exp_f32 v210, v210
    v_mfma_f32_16x16x32_bf16 v[220:223], a[168:171], a[40:43], v[220:223]
    ds_read_b64_tr_b16 a[224:225], v253 offset:96
    v_mfma_f32_16x16x32_bf16 v[220:223], a[164:167], a[36:39], v[220:223]
    v_exp_f32 v211, v211
    v_mfma_f32_16x16x32_bf16 v[220:223], a[160:163], a[32:35], v[220:223]
    s_waitcnt lgkmcnt(2)
    v_mov_b32_dpp v251, v251 row_ror:2 row_mask:0xf bank_mask:0xf
    v_cvt_pk_bf16_f32 v225, v210, v211
    v_mfma_f32_16x16x32_bf16 v[32:35], v[232:235], a[176:179], v[32:35]
    v_exp_f32 v212, v212
    v_mfma_f32_16x16x32_bf16 v[32:35], v[236:239], a[180:183], v[32:35]
    ds_read_b64_tr_b16 a[226:227], v253 offset:608
    v_mfma_f32_16x16x32_bf16 v[36:39], v[236:239], a[188:191], v[36:39]
    v_exp_f32 v213, v213
    v_mfma_f32_16x16x32_bf16 v[36:39], v[232:235], a[184:187], v[36:39]
    ds_read_b64_tr_b16 a[232:233], v253 offset:112
    v_cvt_pk_bf16_f32 v226, v212, v213
    v_mfma_f32_16x16x32_bf16 v[40:43], v[232:235], a[192:195], v[40:43]
    v_exp_f32 v214, v214
    v_mfma_f32_16x16x32_bf16 v[40:43], v[236:239], a[196:199], v[40:43]
    ds_read_b64_tr_b16 a[234:235], v253 offset:624
    v_mfma_f32_16x16x32_bf16 v[44:47], v[236:239], a[204:207], v[44:47]
    v_exp_f32 v215, v215
    v_mfma_f32_16x16x32_bf16 v[44:47], v[232:235], a[200:203], v[44:47]
    s_add_u32 m0, m0, 4128
    ds_read_b128 a[144:147], v252 offset:8448
    v_cvt_pk_bf16_f32 v227, v214, v215
    v_mfma_f32_16x16x32_bf16 v[48:51], v[232:235], a[208:211], v[48:51]
    s_add_u32 s8, s8, s7
    v_exp_f32 v216, v216
    v_mfma_f32_16x16x32_bf16 v[48:51], v[236:239], a[212:215], v[48:51]
    s_addc_u32 s9, s9, 0
    ds_read_b128 a[148:151], v252 offset:8512
    global_load_lds_dwordx4 v254, s[8:9] offset:0 nt
    v_mfma_f32_16x16x32_bf16 v[52:55], v[236:239], a[220:223], v[52:55]
    s_waitcnt lgkmcnt(5)
    v_exp_f32 v217, v217
    v_mfma_f32_16x16x32_bf16 v[52:55], v[232:235], a[216:219], v[52:55]
    s_waitcnt lgkmcnt(4)
    ds_read_b128 a[152:155], v252 offset:8576
    v_cvt_pk_bf16_f32 v228, v216, v217
    v_mfma_f32_16x16x32_bf16 v[56:59], v[232:235], a[224:227], v[56:59]
    v_exp_f32 v218, v218
    v_mfma_f32_16x16x32_bf16 v[56:59], v[236:239], a[228:231], v[56:59]
    ds_read_b128 a[156:159], v252 offset:8640
    v_mfma_f32_16x16x32_bf16 v[60:63], v[236:239], a[236:239], v[60:63]
    s_waitcnt lgkmcnt(4)
    v_exp_f32 v219, v219
    v_mfma_f32_16x16x32_bf16 v[60:63], v[232:235], a[232:235], v[60:63]
    ds_read_b128 a[172:175], v252 offset:9152
    v_cvt_pk_bf16_f32 v229, v218, v219
    v_smfmac_f32_16x16x64_bf16 v[244:247], v[248:251], v[232:239], v240
    ds_read_b128 a[168:171], v252 offset:9088
    v_mfma_f32_16x16x32_bf16 v[208:211], a[112:115], a[48:51], v[240:243]
    v_exp_f32 v220, v220
    v_mfma_f32_16x16x32_bf16 v[208:211], a[116:119], a[52:55], v[208:211]
    ds_read_b128 a[164:167], v252 offset:9024
    v_mfma_f32_16x16x32_bf16 v[208:211], a[120:123], a[56:59], v[208:211]
    v_exp_f32 v221, v221
    v_mfma_f32_16x16x32_bf16 v[208:211], a[124:127], a[60:63], v[208:211]
    v_mov_b32_dpp v248, v248 row_ror:2 row_mask:0xf bank_mask:0xf
    v_cvt_pk_bf16_f32 v230, v220, v221
    v_mfma_f32_16x16x32_bf16 v[212:215], a[140:143], a[60:63], v[240:243]
    v_exp_f32 v222, v222
    v_mfma_f32_16x16x32_bf16 v[212:215], a[136:139], a[56:59], v[212:215]
    ds_read_b128 a[160:163], v252 offset:8960
    v_mfma_f32_16x16x32_bf16 v[212:215], a[132:135], a[52:55], v[212:215]
    v_exp_f32 v223, v223
    v_mfma_f32_16x16x32_bf16 v[212:215], a[128:131], a[48:51], v[212:215]
    s_waitcnt lgkmcnt(4)
    v_mov_b32_dpp v249, v249 row_ror:2 row_mask:0xf bank_mask:0xf
    v_cvt_pk_bf16_f32 v231, v222, v223
    v_mfma_f32_16x16x32_bf16 v[216:219], a[144:147], a[48:51], v[240:243]
    v_exp_f32 v208, v208
    v_mfma_f32_16x16x32_bf16 v[216:219], a[148:151], a[52:55], v[216:219]
    v_mfma_f32_16x16x32_bf16 v[216:219], a[152:155], a[56:59], v[216:219]
    s_add_u32 m0, s34, s5
    v_exp_f32 v209, v209
    v_mfma_f32_16x16x32_bf16 v[216:219], a[156:159], a[60:63], v[216:219]
    s_waitcnt lgkmcnt(1)
    v_mov_b32_dpp v250, v250 row_ror:2 row_mask:0xf bank_mask:0xf
    v_cvt_pk_bf16_f32 v232, v208, v209
    v_mfma_f32_16x16x32_bf16 v[220:223], a[172:175], a[60:63], v[240:243]
    s_add_u32 s8, s20, s66
    v_exp_f32 v210, v210
    v_mfma_f32_16x16x32_bf16 v[220:223], a[168:171], a[56:59], v[220:223]
    s_addc_u32 s9, s21, 0
    global_load_lds_dwordx4 v254, s[8:9] offset:0 nt
    v_mfma_f32_16x16x32_bf16 v[220:223], a[164:167], a[52:55], v[220:223]
    s_waitcnt lgkmcnt(0)
    v_exp_f32 v211, v211
    v_mfma_f32_16x16x32_bf16 v[220:223], a[160:163], a[48:51], v[220:223]
    s_add_u32 s34, s34, 33536
    v_mov_b32_dpp v251, v251 row_ror:2 row_mask:0xf bank_mask:0xf
    v_cvt_pk_bf16_f32 v233, v210, v211
    v_mfma_f32_16x16x32_bf16 v[64:67], v[224:227], a[176:179], v[64:67]
    s_cmp_eq_u32 s34, 100608
    v_exp_f32 v212, v212
    v_mfma_f32_16x16x32_bf16 v[64:67], v[228:231], a[180:183], v[64:67]
    s_cselect_b32 s34, 0, s34
    ds_read_b64_tr_b16 a[180:181], v253 offset:8320
    v_mfma_f32_16x16x32_bf16 v[68:71], v[228:231], a[188:191], v[68:71]
    s_add_u32 s66, s66, 16384
    v_exp_f32 v213, v213
    v_mfma_f32_16x16x32_bf16 v[68:71], v[224:227], a[184:187], v[68:71]
    ds_read_b64_tr_b16 a[182:183], v253 offset:8832
    v_cvt_pk_bf16_f32 v234, v212, v213
    v_mfma_f32_16x16x32_bf16 v[72:75], v[224:227], a[192:195], v[72:75]
    s_add_u32 s31, s31, 33536
    v_exp_f32 v214, v214
    v_mfma_f32_16x16x32_bf16 v[72:75], v[228:231], a[196:199], v[72:75]
    s_cmp_eq_u32 s31, 100608
    ds_read_b64_tr_b16 a[188:189], v253 offset:8336
    v_mfma_f32_16x16x32_bf16 v[76:79], v[228:231], a[204:207], v[76:79]
    s_cselect_b32 s30, s71, s72
    v_exp_f32 v215, v215
    v_mfma_f32_16x16x32_bf16 v[76:79], v[224:227], a[200:203], v[76:79]
    s_cselect_b32 s31, 0, s31
    ds_read_b64_tr_b16 a[190:191], v253 offset:8848
    v_cvt_pk_bf16_f32 v235, v214, v215
    v_mfma_f32_16x16x32_bf16 v[80:83], v[224:227], a[208:211], v[80:83]
    s_cmp_gt_u32 s66, s11
    v_exp_f32 v216, v216
    v_mfma_f32_16x16x32_bf16 v[80:83], v[228:231], a[212:215], v[80:83]
    s_cselect_b32 s66, 0, s66
    ds_read_b64_tr_b16 a[196:197], v253 offset:8352
    v_mfma_f32_16x16x32_bf16 v[84:87], v[228:231], a[220:223], v[84:87]
    v_exp_f32 v217, v217
    v_mfma_f32_16x16x32_bf16 v[84:87], v[224:227], a[216:219], v[84:87]
    ds_read_b64_tr_b16 a[198:199], v253 offset:8864
    v_cvt_pk_bf16_f32 v236, v216, v217
    v_mfma_f32_16x16x32_bf16 v[88:91], v[224:227], a[224:227], v[88:91]
    v_exp_f32 v218, v218
    v_mfma_f32_16x16x32_bf16 v[88:91], v[228:231], a[228:231], v[88:91]
    ds_read_b64_tr_b16 a[204:205], v253 offset:8368
    v_mfma_f32_16x16x32_bf16 v[92:95], v[228:231], a[236:239], v[92:95]
    v_exp_f32 v219, v219
    v_mfma_f32_16x16x32_bf16 v[92:95], v[224:227], a[232:235], v[92:95]
    ds_read_b64_tr_b16 a[206:207], v253 offset:8880
    v_cvt_pk_bf16_f32 v237, v218, v219
    v_smfmac_f32_16x16x64_bf16 v[244:247], v[248:251], v[224:231], v240
    s_add_u32 m0, m0, 16
    ds_read_b64_tr_b16 a[212:213], v253 offset:8384
    global_load_lds_dwordx4 v254, s[8:9] offset:1024 nt
    v_mfma_f32_16x16x32_bf16 v[208:211], a[112:115], a[64:67], v[240:243]
    v_exp_f32 v220, v220
    v_mfma_f32_16x16x32_bf16 v[208:211], a[116:119], a[68:71], v[208:211]
    ds_read_b64_tr_b16 a[214:215], v253 offset:8896
    v_mfma_f32_16x16x32_bf16 v[208:211], a[120:123], a[72:75], v[208:211]
    v_exp_f32 v221, v221
    v_mfma_f32_16x16x32_bf16 v[208:211], a[124:127], a[76:79], v[208:211]
    v_mov_b32_dpp v248, v248 row_ror:2 row_mask:0xf bank_mask:0xf
    v_cvt_pk_bf16_f32 v238, v220, v221
    v_mfma_f32_16x16x32_bf16 v[212:215], a[140:143], a[76:79], v[240:243]
    v_exp_f32 v222, v222
    v_mfma_f32_16x16x32_bf16 v[212:215], a[136:139], a[72:75], v[212:215]
    ds_read_b64_tr_b16 a[220:221], v253 offset:8400
    v_mfma_f32_16x16x32_bf16 v[212:215], a[132:135], a[68:71], v[212:215]
    v_exp_f32 v223, v223
    v_mfma_f32_16x16x32_bf16 v[212:215], a[128:131], a[64:67], v[212:215]
    v_mov_b32_dpp v249, v249 row_ror:2 row_mask:0xf bank_mask:0xf
    v_cvt_pk_bf16_f32 v239, v222, v223
    v_mfma_f32_16x16x32_bf16 v[216:219], a[144:147], a[64:67], v[240:243]
    v_exp_f32 v208, v208
    v_mfma_f32_16x16x32_bf16 v[216:219], a[148:151], a[68:71], v[216:219]
    ds_read_b64_tr_b16 a[222:223], v253 offset:8912
    v_mfma_f32_16x16x32_bf16 v[216:219], a[152:155], a[72:75], v[216:219]
    v_exp_f32 v209, v209
    v_mfma_f32_16x16x32_bf16 v[216:219], a[156:159], a[76:79], v[216:219]
    v_mov_b32_dpp v250, v250 row_ror:2 row_mask:0xf bank_mask:0xf
    v_cvt_pk_bf16_f32 v224, v208, v209
    v_mfma_f32_16x16x32_bf16 v[220:223], a[172:175], a[76:79], v[240:243]
    v_exp_f32 v210, v210
    v_mfma_f32_16x16x32_bf16 v[220:223], a[168:171], a[72:75], v[220:223]
    ds_read_b64_tr_b16 a[228:229], v253 offset:8416
    v_mfma_f32_16x16x32_bf16 v[220:223], a[164:167], a[68:71], v[220:223]
    v_exp_f32 v211, v211
    v_mfma_f32_16x16x32_bf16 v[220:223], a[160:163], a[64:67], v[220:223]
    v_mov_b32_dpp v251, v251 row_ror:2 row_mask:0xf bank_mask:0xf
    v_cvt_pk_bf16_f32 v225, v210, v211
    v_mfma_f32_16x16x32_bf16 v[96:99], v[232:235], a[176:179], v[96:99]
    s_waitcnt lgkmcnt(2)
    v_exp_f32 v212, v212
    v_mfma_f32_16x16x32_bf16 v[96:99], v[236:239], a[180:183], v[96:99]
    ds_read_b64_tr_b16 a[230:231], v253 offset:8928
    v_mfma_f32_16x16x32_bf16 v[100:103], v[236:239], a[188:191], v[100:103]
    v_exp_f32 v213, v213
    v_mfma_f32_16x16x32_bf16 v[100:103], v[232:235], a[184:187], v[100:103]
    ds_read_b64_tr_b16 a[236:237], v253 offset:8432
    v_cvt_pk_bf16_f32 v226, v212, v213
    v_mfma_f32_16x16x32_bf16 v[104:107], v[232:235], a[192:195], v[104:107]
    v_exp_f32 v214, v214
    v_mfma_f32_16x16x32_bf16 v[104:107], v[236:239], a[196:199], v[104:107]
    ds_read_b64_tr_b16 a[238:239], v253 offset:8944
    v_mfma_f32_16x16x32_bf16 v[108:111], v[236:239], a[204:207], v[108:111]
    v_exp_f32 v215, v215
    v_mfma_f32_16x16x32_bf16 v[108:111], v[232:235], a[200:203], v[108:111]
    v_cvt_pk_bf16_f32 v227, v214, v215
    v_mfma_f32_16x16x32_bf16 v[112:115], v[232:235], a[208:211], v[112:115]
    s_add_u32 m0, m0, 16
    v_exp_f32 v216, v216
    v_mfma_f32_16x16x32_bf16 v[112:115], v[236:239], a[212:215], v[112:115]
    s_waitcnt lgkmcnt(3)
    global_load_lds_dwordx4 v254, s[8:9] offset:2048 nt
    v_mfma_f32_16x16x32_bf16 v[116:119], v[236:239], a[220:223], v[116:119]
    v_exp_f32 v217, v217
    v_mfma_f32_16x16x32_bf16 v[116:119], v[232:235], a[216:219], v[116:119]
    v_cvt_pk_bf16_f32 v228, v216, v217
    v_mfma_f32_16x16x32_bf16 v[120:123], v[232:235], a[224:227], v[120:123]
    s_waitcnt lgkmcnt(2)
    v_exp_f32 v218, v218
    v_mfma_f32_16x16x32_bf16 v[120:123], v[236:239], a[228:231], v[120:123]
    s_waitcnt lgkmcnt(0)
    v_mfma_f32_16x16x32_bf16 v[124:127], v[236:239], a[236:239], v[124:127]
    v_exp_f32 v219, v219
    v_mfma_f32_16x16x32_bf16 v[124:127], v[232:235], a[232:235], v[124:127]
    v_cvt_pk_bf16_f32 v229, v218, v219
    v_smfmac_f32_16x16x64_bf16 v[244:247], v[248:251], v[232:239], v240
    v_mfma_f32_16x16x32_bf16 v[208:211], a[112:115], a[80:83], v[240:243]
    v_exp_f32 v220, v220
    v_mfma_f32_16x16x32_bf16 v[208:211], a[116:119], a[84:87], v[208:211]
    v_mfma_f32_16x16x32_bf16 v[208:211], a[120:123], a[88:91], v[208:211]
    v_exp_f32 v221, v221
    v_mfma_f32_16x16x32_bf16 v[208:211], a[124:127], a[92:95], v[208:211]
    v_mov_b32_dpp v248, v248 row_ror:2 row_mask:0xf bank_mask:0xf
    v_cvt_pk_bf16_f32 v230, v220, v221
    v_mfma_f32_16x16x32_bf16 v[212:215], a[140:143], a[92:95], v[240:243]
    s_add_u32 m0, m0, 16
    v_exp_f32 v222, v222
    v_mfma_f32_16x16x32_bf16 v[212:215], a[136:139], a[88:91], v[212:215]
    global_load_lds_dwordx4 v254, s[8:9] offset:3072 nt
    v_mfma_f32_16x16x32_bf16 v[212:215], a[132:135], a[84:87], v[212:215]
    v_exp_f32 v223, v223
    v_mfma_f32_16x16x32_bf16 v[212:215], a[128:131], a[80:83], v[212:215]
    v_mov_b32_dpp v249, v249 row_ror:2 row_mask:0xf bank_mask:0xf
    v_cvt_pk_bf16_f32 v231, v222, v223
    v_mfma_f32_16x16x32_bf16 v[216:219], a[144:147], a[80:83], v[240:243]
    v_exp_f32 v208, v208
    v_mfma_f32_16x16x32_bf16 v[216:219], a[148:151], a[84:87], v[216:219]
    v_mfma_f32_16x16x32_bf16 v[216:219], a[152:155], a[88:91], v[216:219]
    v_exp_f32 v209, v209
    v_mfma_f32_16x16x32_bf16 v[216:219], a[156:159], a[92:95], v[216:219]
    v_mov_b32_dpp v250, v250 row_ror:2 row_mask:0xf bank_mask:0xf
    v_cvt_pk_bf16_f32 v232, v208, v209
    v_mfma_f32_16x16x32_bf16 v[220:223], a[172:175], a[92:95], v[240:243]
    v_exp_f32 v210, v210
    v_mfma_f32_16x16x32_bf16 v[220:223], a[168:171], a[88:91], v[220:223]
    v_mfma_f32_16x16x32_bf16 v[220:223], a[164:167], a[84:87], v[220:223]
    v_exp_f32 v211, v211
    v_mfma_f32_16x16x32_bf16 v[220:223], a[160:163], a[80:83], v[220:223]
    v_mov_b32_dpp v251, v251 row_ror:2 row_mask:0xf bank_mask:0xf
    v_cvt_pk_bf16_f32 v233, v210, v211
    v_mfma_f32_16x16x32_bf16 v[128:131], v[224:227], a[176:179], v[128:131]
    v_exp_f32 v212, v212
    v_mfma_f32_16x16x32_bf16 v[128:131], v[228:231], a[180:183], v[128:131]
    v_mfma_f32_16x16x32_bf16 v[132:135], v[228:231], a[188:191], v[132:135]
    v_exp_f32 v213, v213
    v_mfma_f32_16x16x32_bf16 v[132:135], v[224:227], a[184:187], v[132:135]
    v_cvt_pk_bf16_f32 v234, v212, v213
    v_mfma_f32_16x16x32_bf16 v[136:139], v[224:227], a[192:195], v[136:139]
    v_exp_f32 v214, v214
    v_mfma_f32_16x16x32_bf16 v[136:139], v[228:231], a[196:199], v[136:139]
    v_mfma_f32_16x16x32_bf16 v[140:143], v[228:231], a[204:207], v[140:143]
    v_exp_f32 v215, v215
    v_mfma_f32_16x16x32_bf16 v[140:143], v[224:227], a[200:203], v[140:143]
    s_add_u32 m0, m0, 4112
    v_cvt_pk_bf16_f32 v235, v214, v215
    v_mfma_f32_16x16x32_bf16 v[144:147], v[224:227], a[208:211], v[144:147]
    s_add_u32 s8, s8, s7
    v_exp_f32 v216, v216
    v_mfma_f32_16x16x32_bf16 v[144:147], v[228:231], a[212:215], v[144:147]
    s_addc_u32 s9, s9, 0
    global_load_lds_dwordx4 v254, s[8:9] offset:0 nt
    v_mfma_f32_16x16x32_bf16 v[148:151], v[228:231], a[220:223], v[148:151]
    s_cmp_eq_u32 s64, 0
    v_exp_f32 v217, v217
    v_mfma_f32_16x16x32_bf16 v[148:151], v[224:227], a[216:219], v[148:151]
    s_cselect_b32 s7, 0, s7
    v_cvt_pk_bf16_f32 v236, v216, v217
    v_mfma_f32_16x16x32_bf16 v[152:155], v[224:227], a[224:227], v[152:155]
    s_sub_u32 s29, s29, 1
    v_exp_f32 v218, v218
    v_mfma_f32_16x16x32_bf16 v[152:155], v[228:231], a[228:231], v[152:155]
    v_mfma_f32_16x16x32_bf16 v[156:159], v[228:231], a[236:239], v[156:159]
    v_exp_f32 v219, v219
    v_mfma_f32_16x16x32_bf16 v[156:159], v[224:227], a[232:235], v[156:159]
    v_cvt_pk_bf16_f32 v237, v218, v219
    v_smfmac_f32_16x16x64_bf16 v[244:247], v[248:251], v[224:231], v240
    v_mfma_f32_16x16x32_bf16 v[208:211], a[112:115], a[96:99], v[240:243]
    v_exp_f32 v220, v220
    v_mfma_f32_16x16x32_bf16 v[208:211], a[116:119], a[100:103], v[208:211]
    v_mfma_f32_16x16x32_bf16 v[208:211], a[120:123], a[104:107], v[208:211]
    v_exp_f32 v221, v221
    v_mfma_f32_16x16x32_bf16 v[208:211], a[124:127], a[108:111], v[208:211]
    v_mov_b32_dpp v248, v248 row_ror:2 row_mask:0xf bank_mask:0xf
    v_cvt_pk_bf16_f32 v238, v220, v221
    v_mfma_f32_16x16x32_bf16 v[212:215], a[140:143], a[108:111], v[240:243]
    v_exp_f32 v222, v222
    v_mfma_f32_16x16x32_bf16 v[212:215], a[136:139], a[104:107], v[212:215]
    v_mfma_f32_16x16x32_bf16 v[212:215], a[132:135], a[100:103], v[212:215]
    v_exp_f32 v223, v223
    v_mfma_f32_16x16x32_bf16 v[212:215], a[128:131], a[96:99], v[212:215]
    v_mov_b32_dpp v249, v249 row_ror:2 row_mask:0xf bank_mask:0xf
    v_cvt_pk_bf16_f32 v239, v222, v223
    v_mfma_f32_16x16x32_bf16 v[216:219], a[144:147], a[96:99], v[240:243]
    v_exp_f32 v208, v208
    v_mfma_f32_16x16x32_bf16 v[216:219], a[148:151], a[100:103], v[216:219]
    v_mfma_f32_16x16x32_bf16 v[216:219], a[152:155], a[104:107], v[216:219]
    v_exp_f32 v209, v209
    v_mfma_f32_16x16x32_bf16 v[216:219], a[156:159], a[108:111], v[216:219]
    v_mov_b32_dpp v250, v250 row_ror:2 row_mask:0xf bank_mask:0xf
    v_cvt_pk_bf16_f32 v224, v208, v209
    v_mfma_f32_16x16x32_bf16 v[220:223], a[172:175], a[108:111], v[240:243]
    v_exp_f32 v210, v210
    v_mfma_f32_16x16x32_bf16 v[220:223], a[168:171], a[104:107], v[220:223]
    v_mfma_f32_16x16x32_bf16 v[220:223], a[164:167], a[100:103], v[220:223]
    v_exp_f32 v211, v211
    v_mfma_f32_16x16x32_bf16 v[220:223], a[160:163], a[96:99], v[220:223]
    v_mov_b32_dpp v251, v251 row_ror:2 row_mask:0xf bank_mask:0xf
    v_cvt_pk_bf16_f32 v225, v210, v211
    v_mfma_f32_16x16x32_bf16 v[160:163], v[232:235], a[176:179], v[160:163]
    v_exp_f32 v212, v212
    v_mfma_f32_16x16x32_bf16 v[160:163], v[236:239], a[180:183], v[160:163]
    v_mfma_f32_16x16x32_bf16 v[164:167], v[236:239], a[188:191], v[164:167]
    v_exp_f32 v213, v213
    v_mfma_f32_16x16x32_bf16 v[164:167], v[232:235], a[184:187], v[164:167]
    v_cvt_pk_bf16_f32 v226, v212, v213
    v_mfma_f32_16x16x32_bf16 v[168:171], v[232:235], a[192:195], v[168:171]
    v_exp_f32 v214, v214
    v_mfma_f32_16x16x32_bf16 v[168:171], v[236:239], a[196:199], v[168:171]
    v_mfma_f32_16x16x32_bf16 v[172:175], v[236:239], a[204:207], v[172:175]
    v_exp_f32 v215, v215
    v_mfma_f32_16x16x32_bf16 v[172:175], v[232:235], a[200:203], v[172:175]
    v_cvt_pk_bf16_f32 v227, v214, v215
    v_mfma_f32_16x16x32_bf16 v[176:179], v[232:235], a[208:211], v[176:179]
    v_exp_f32 v216, v216
    v_mfma_f32_16x16x32_bf16 v[176:179], v[236:239], a[212:215], v[176:179]
    v_mfma_f32_16x16x32_bf16 v[180:183], v[236:239], a[220:223], v[180:183]
    v_exp_f32 v217, v217
    v_mfma_f32_16x16x32_bf16 v[180:183], v[232:235], a[216:219], v[180:183]
    v_cvt_pk_bf16_f32 v228, v216, v217
    v_mfma_f32_16x16x32_bf16 v[184:187], v[232:235], a[224:227], v[184:187]
    v_exp_f32 v218, v218
    v_mfma_f32_16x16x32_bf16 v[184:187], v[236:239], a[228:231], v[184:187]
    v_add_u32 v252, s30, v252
    v_mfma_f32_16x16x32_bf16 v[188:191], v[236:239], a[236:239], v[188:191]
    v_exp_f32 v219, v219
    v_mfma_f32_16x16x32_bf16 v[188:191], v[232:235], a[232:235], v[188:191]
    s_waitcnt vmcnt(10)
    v_cvt_pk_bf16_f32 v229, v218, v219
    v_add_u32 v253, s30, v253
    v_smfmac_f32_16x16x64_bf16 v[244:247], v[248:251], v[232:239], v240
    s_cbranch_scc0 L_loop_a
    v_mfma_f32_16x16x32_bf16 v[208:211], a[144:147], a[0:3], v[240:243]
    s_barrier
    ds_read_b128 v[232:235], v254 offset:0
    v_subrev_u32 v252, 33536, v252
    v_mfma_f32_16x16x32_bf16 v[208:211], a[148:151], a[4:7], v[208:211]
    s_add_u32 s83, s6, 12288
    ds_read_b128 a[112:115], v252 offset:33536
    v_subrev_u32 v253, 33536, v253
    v_mfma_f32_16x16x32_bf16 v[208:211], a[152:155], a[8:11], v[208:211]
    s_add_u32 s84, s6, 16384
    ds_read_b128 a[116:119], v252 offset:33600
    v_mov_b32_dpp v248, v248 row_ror:2 row_mask:0xf bank_mask:0xf
    v_mfma_f32_16x16x32_bf16 v[208:211], a[156:159], a[12:15], v[208:211]
    s_add_u32 s85, s6, 20480
    ds_read_b128 a[120:123], v252 offset:33664
    v_mov_b32_dpp v249, v249 row_ror:2 row_mask:0xf bank_mask:0xf
    v_mfma_f32_16x16x32_bf16 v[212:215], a[172:175], a[12:15], v[240:243]
    s_add_u32 s86, s6, 24576
    ds_read_b128 a[124:127], v252 offset:33728
    v_mov_b32_dpp v250, v250 row_ror:2 row_mask:0xf bank_mask:0xf
    v_mfma_f32_16x16x32_bf16 v[212:215], a[168:171], a[8:11], v[212:215]
    s_add_u32 s80, s6, 0
    ds_read_b128 a[128:131], v252 offset:34048
    v_mov_b32_dpp v251, v251 row_ror:2 row_mask:0xf bank_mask:0xf
    v_mfma_f32_16x16x32_bf16 v[212:215], a[164:167], a[4:7], v[212:215]
    s_add_u32 s81, s6, 4096
    v_exp_f32 v220, v220
    v_mfma_f32_16x16x32_bf16 v[212:215], a[160:163], a[0:3], v[212:215]
    s_add_u32 s82, s6, 8192
    v_exp_f32 v221, v221
    v_mfma_f32_16x16x32_bf16 v[192:195], v[224:227], a[176:179], v[192:195]
    ds_read_b128 a[132:135], v252 offset:34112
    v_cvt_pk_bf16_f32 v230, v220, v221
    v_mfma_f32_16x16x32_bf16 v[200:203], v[224:227], a[192:195], v[200:203]
    v_exp_f32 v222, v222
    v_mfma_f32_16x16x32_bf16 a[240:243], v[224:227], a[208:211], a[240:243]
    v_exp_f32 v223, v223
    v_mfma_f32_16x16x32_bf16 a[248:251], v[224:227], a[224:227], a[248:251]
    s_waitcnt lgkmcnt(5)
    ds_read_b128 a[136:139], v252 offset:34176
    v_cvt_pk_bf16_f32 v231, v222, v223
    v_mfma_f32_16x16x32_bf16 v[216:219], a[112:115], a[48:51], v[240:243]
    v_exp_f32 v208, v208
    v_mfma_f32_16x16x32_bf16 v[192:195], v[228:231], a[180:183], v[192:195]
    v_exp_f32 v209, v209
    v_mfma_f32_16x16x32_bf16 v[196:199], v[228:231], a[188:191], v[196:199]
    ds_read_b128 a[140:143], v252 offset:34240
    v_cvt_pk_bf16_f32 v236, v208, v209
    v_mfma_f32_16x16x32_bf16 v[196:199], v[224:227], a[184:187], v[196:199]
    v_exp_f32 v210, v210
    v_mfma_f32_16x16x32_bf16 v[200:203], v[228:231], a[196:199], v[200:203]
    v_exp_f32 v211, v211
    v_mfma_f32_16x16x32_bf16 v[204:207], v[228:231], a[204:207], v[204:207]
    ds_read_b128 a[144:147], v252 offset:41984
    v_cvt_pk_bf16_f32 v237, v210, v211
    v_mfma_f32_16x16x32_bf16 v[204:207], v[224:227], a[200:203], v[204:207]
    v_exp_f32 v212, v212
    v_mfma_f32_16x16x32_bf16 a[240:243], v[228:231], a[212:215], a[240:243]
    v_exp_f32 v213, v213
    v_mfma_f32_16x16x32_bf16 a[244:247], v[228:231], a[220:223], a[244:247]
    ds_read_b128 a[148:151], v252 offset:42048
    v_cvt_pk_bf16_f32 v238, v212, v213
    v_mfma_f32_16x16x32_bf16 a[244:247], v[224:227], a[216:219], a[244:247]
    ds_read_b128 a[152:155], v252 offset:42112
    v_mfma_f32_16x16x32_bf16 a[248:251], v[228:231], a[228:231], a[248:251]
    ds_read_b128 a[156:159], v252 offset:42176
    v_mfma_f32_16x16x32_bf16 a[252:255], v[228:231], a[236:239], a[252:255]
    v_exp_f32 v214, v214
    v_mfma_f32_16x16x32_bf16 a[252:255], v[224:227], a[232:235], a[252:255]
    s_waitcnt lgkmcnt(10)
    v_exp_f32 v215, v215
    v_mfma_f32_16x16x32_bf16 v[216:219], a[116:119], a[52:55], v[216:219]
    s_waitcnt lgkmcnt(9)
    ds_read_b128 a[160:163], v252 offset:42496
    v_cvt_pk_bf16_f32 v239, v214, v215
    v_mfma_f32_16x16x32_bf16 v[216:219], a[120:123], a[56:59], v[216:219]
    s_waitcnt lgkmcnt(9)
    ds_read_b128 a[164:167], v252 offset:42560
    v_mfma_f32_16x16x32_bf16 v[216:219], a[124:127], a[60:63], v[216:219]
    s_waitcnt lgkmcnt(6)
    ds_read_b128 a[168:171], v252 offset:42624
    v_mfma_f32_16x16x32_bf16 v[220:223], a[140:143], a[60:63], v[240:243]
    ds_read_b128 a[172:175], v252 offset:42688
    v_mfma_f32_16x16x32_bf16 v[220:223], a[136:139], a[56:59], v[220:223]
    v_smfmac_f32_16x16x64_bf16 v[244:247], v[248:251], v[224:231], v240
    s_nop 1
    v_exp_f32 v216, v216
    v_mov_b32_dpp v248, v248 row_ror:4 row_mask:0xf bank_mask:0xf
    v_mfma_f32_16x16x32_bf16 v[220:223], a[132:135], a[52:55], v[220:223]
    v_mov_b32_dpp v249, v249 row_ror:4 row_mask:0xf bank_mask:0xf
    v_mov_b32_dpp v250, v250 row_ror:4 row_mask:0xf bank_mask:0xf
    v_mfma_f32_16x16x32_bf16 v[220:223], a[128:131], a[48:51], v[220:223]
    s_waitcnt lgkmcnt(7)
    v_exp_f32 v217, v217
    v_mfma_f32_16x16x32_bf16 v[208:211], a[144:147], a[48:51], v[240:243]
    s_waitcnt lgkmcnt(6)
    v_mov_b32_dpp v251, v251 row_ror:4 row_mask:0xf bank_mask:0xf
    v_cvt_pk_bf16_f32 v224, v216, v217
    v_mfma_f32_16x16x32_bf16 v[208:211], a[148:151], a[52:55], v[208:211]
    s_waitcnt lgkmcnt(5)
    v_exp_f32 v218, v218
    v_mfma_f32_16x16x32_bf16 v[208:211], a[152:155], a[56:59], v[208:211]
    s_waitcnt lgkmcnt(4)
    v_exp_f32 v219, v219
    v_mfma_f32_16x16x32_bf16 v[208:211], a[156:159], a[60:63], v[208:211]
    s_waitcnt lgkmcnt(0)
    v_exp_f32 v220, v220
    v_mfma_f32_16x16x32_bf16 v[212:215], a[172:175], a[60:63], v[240:243]
    v_exp_f32 v221, v221
    v_mfma_f32_16x16x32_bf16 v[212:215], a[168:171], a[56:59], v[212:215]
    v_cvt_pk_bf16_f32 v225, v218, v219
    v_cvt_pk_bf16_f32 v226, v220, v221
    v_mfma_f32_16x16x32_bf16 v[0:3], v[232:235], a[176:179], v[0:3]
    v_exp_f32 v222, v222
    v_mfma_f32_16x16x32_bf16 v[212:215], a[164:167], a[52:55], v[212:215]
    v_exp_f32 v223, v223
    v_mfma_f32_16x16x32_bf16 v[0:3], v[236:239], a[180:183], v[0:3]
    ds_read_b64_tr_b16 a[176:177], v253 offset:33536
    v_cvt_pk_bf16_f32 v227, v222, v223
    v_mfma_f32_16x16x32_bf16 v[212:215], a[160:163], a[48:51], v[212:215]
    v_exp_f32 v208, v208
    v_mfma_f32_16x16x32_bf16 v[4:7], v[236:239], a[188:191], v[4:7]
    v_exp_f32 v209, v209
    v_mfma_f32_16x16x32_bf16 v[4:7], v[232:235], a[184:187], v[4:7]
    ds_read_b64_tr_b16 a[178:179], v253 offset:34048
    v_cvt_pk_bf16_f32 v228, v208, v209
    v_mfma_f32_16x16x32_bf16 v[8:11], v[232:235], a[192:195], v[8:11]
    v_exp_f32 v210, v210
    v_mfma_f32_16x16x32_bf16 v[8:11], v[236:239], a[196:199], v[8:11]
    v_exp_f32 v211, v211
    v_mfma_f32_16x16x32_bf16 v[12:15], v[236:239], a[204:207], v[12:15]
    ds_read_b64_tr_b16 a[180:181], v253 offset:41856
    v_cvt_pk_bf16_f32 v229, v210, v211
    v_mfma_f32_16x16x32_bf16 v[12:15], v[232:235], a[200:203], v[12:15]
    v_exp_f32 v212, v212
    v_mfma_f32_16x16x32_bf16 v[16:19], v[232:235], a[208:211], v[16:19]
    v_exp_f32 v213, v213
    v_mfma_f32_16x16x32_bf16 v[16:19], v[236:239], a[212:215], v[16:19]
    ds_read_b64_tr_b16 a[182:183], v253 offset:42368
    v_cvt_pk_bf16_f32 v230, v212, v213
    v_mfma_f32_16x16x32_bf16 v[20:23], v[236:239], a[220:223], v[20:23]
    v_exp_f32 v214, v214
    v_mfma_f32_16x16x32_bf16 v[20:23], v[232:235], a[216:219], v[20:23]
    v_exp_f32 v215, v215
    v_mfma_f32_16x16x32_bf16 v[24:27], v[232:235], a[224:227], v[24:27]
    ds_read_b64_tr_b16 a[184:185], v253 offset:33552
    v_cvt_pk_bf16_f32 v231, v214, v215
    v_mfma_f32_16x16x32_bf16 v[24:27], v[236:239], a[228:231], v[24:27]
    ds_read_b64_tr_b16 a[186:187], v253 offset:34064
    v_mfma_f32_16x16x32_bf16 v[28:31], v[236:239], a[236:239], v[28:31]
    ds_read_b64_tr_b16 a[188:189], v253 offset:41872
    v_mfma_f32_16x16x32_bf16 v[28:31], v[232:235], a[232:235], v[28:31]
    s_waitcnt lgkmcnt(5)
    ds_read_b64_tr_b16 a[190:191], v253 offset:42384
    v_mfma_f32_16x16x32_bf16 v[96:99], v[224:227], a[176:179], v[96:99]
    ds_read_b64_tr_b16 a[192:193], v253 offset:33568
    v_mfma_f32_16x16x32_bf16 v[216:219], a[112:115], a[64:67], v[240:243]
    ds_read_b64_tr_b16 a[194:195], v253 offset:34080
    v_mfma_f32_16x16x32_bf16 v[216:219], a[116:119], a[68:71], v[216:219]
    s_waitcnt lgkmcnt(6)
    ds_read_b64_tr_b16 a[196:197], v253 offset:41888
    v_mfma_f32_16x16x32_bf16 v[96:99], v[228:231], a[180:183], v[96:99]
    ds_read_b64_tr_b16 a[198:199], v253 offset:42400
    v_mfma_f32_16x16x32_bf16 v[216:219], a[120:123], a[72:75], v[216:219]
    ds_read_b64_tr_b16 a[200:201], v253 offset:33584
    v_mfma_f32_16x16x32_bf16 v[216:219], a[124:127], a[76:79], v[216:219]
    ds_read_b64_tr_b16 a[202:203], v253 offset:34096
    v_mfma_f32_16x16x32_bf16 v[220:223], a[140:143], a[76:79], v[240:243]
    ds_read_b64_tr_b16 a[204:205], v253 offset:41904
    v_mfma_f32_16x16x32_bf16 v[220:223], a[136:139], a[72:75], v[220:223]
    ds_read_b64_tr_b16 a[206:207], v253 offset:42416
    v_smfmac_f32_16x16x64_bf16 v[244:247], v[248:251], v[232:239], v240
    s_waitcnt lgkmcnt(8)
    s_nop 0
    v_exp_f32 v216, v216
    v_mov_b32_dpp v248, v248 row_ror:6 row_mask:0xf bank_mask:0xf
    v_mfma_f32_16x16x32_bf16 v[100:103], v[228:231], a[188:191], v[100:103]
    ds_read_b64_tr_b16 a[208:209], v253 offset:33600
    v_mov_b32_dpp v249, v249 row_ror:6 row_mask:0xf bank_mask:0xf
    v_mfma_f32_16x16x32_bf16 v[100:103], v[224:227], a[184:187], v[100:103]
    s_waitcnt lgkmcnt(7)
    ds_read_b64_tr_b16 a[210:211], v253 offset:34112
    v_mov_b32_dpp v250, v250 row_ror:6 row_mask:0xf bank_mask:0xf
    v_mfma_f32_16x16x32_bf16 v[104:107], v[224:227], a[192:195], v[104:107]
    s_waitcnt lgkmcnt(6)
    ds_read_b64_tr_b16 a[212:213], v253 offset:41920
    v_mov_b32_dpp v251, v251 row_ror:6 row_mask:0xf bank_mask:0xf
    v_mfma_f32_16x16x32_bf16 v[104:107], v[228:231], a[196:199], v[104:107]
    ds_read_b64_tr_b16 a[214:215], v253 offset:42432
    v_smfmac_f32_16x16x64_bf16 v[244:247], v[248:251], v[224:231], v240
    v_exp_f32 v217, v217
    v_exp_f32 v218, v218
    v_mfma_f32_16x16x32_bf16 v[220:223], a[132:135], a[68:71], v[220:223]
    ds_read_b64_tr_b16 a[216:217], v253 offset:33616
    v_cvt_pk_bf16_f32 v232, v216, v217
    v_mfma_f32_16x16x32_bf16 v[220:223], a[128:131], a[64:67], v[220:223]
    s_waitcnt lgkmcnt(5)
    ds_read_b64_tr_b16 a[218:219], v253 offset:34128
    v_mov_b32_dpp v248, v248 row_ror:2 row_mask:0xf bank_mask:0xf
    v_mfma_f32_16x16x32_bf16 v[108:111], v[228:231], a[204:207], v[108:111]
    ds_read_b64_tr_b16 a[220:221], v253 offset:41936
    v_mov_b32_dpp v249, v249 row_ror:2 row_mask:0xf bank_mask:0xf
    v_mfma_f32_16x16x32_bf16 v[108:111], v[224:227], a[200:203], v[108:111]
    ds_read_b64_tr_b16 a[222:223], v253 offset:42448
    v_mov_b32_dpp v250, v250 row_ror:2 row_mask:0xf bank_mask:0xf
    v_mfma_f32_16x16x32_bf16 v[208:211], a[144:147], a[64:67], v[240:243]
    s_waitcnt lgkmcnt(6)
    ds_read_b64_tr_b16 a[224:225], v253 offset:33632
    v_mov_b32_dpp v251, v251 row_ror:2 row_mask:0xf bank_mask:0xf
    v_mfma_f32_16x16x32_bf16 v[112:115], v[224:227], a[208:211], v[112:115]
    ds_read_b64_tr_b16 a[226:227], v253 offset:34144
    v_mfma_f32_16x16x32_bf16 v[208:211], a[148:151], a[68:71], v[208:211]
    s_waitcnt lgkmcnt(6)
    ds_read_b64_tr_b16 a[228:229], v253 offset:41952
    v_mfma_f32_16x16x32_bf16 v[112:115], v[228:231], a[212:215], v[112:115]
    ds_read_b64_tr_b16 a[230:231], v253 offset:42464
    v_mfma_f32_16x16x32_bf16 v[208:211], a[152:155], a[72:75], v[208:211]
    ds_read_b64_tr_b16 a[232:233], v253 offset:33648
    v_mfma_f32_16x16x32_bf16 v[208:211], a[156:159], a[76:79], v[208:211]
    ds_read_b64_tr_b16 a[234:235], v253 offset:34160
    v_mfma_f32_16x16x32_bf16 v[212:215], a[172:175], a[76:79], v[240:243]
    ds_read_b64_tr_b16 a[236:237], v253 offset:41968
    v_mfma_f32_16x16x32_bf16 v[212:215], a[168:171], a[72:75], v[212:215]
    ds_read_b64_tr_b16 a[238:239], v253 offset:42480
    v_mfma_f32_16x16x32_bf16 v[212:215], a[164:167], a[68:71], v[212:215]
    s_waitcnt lgkmcnt(8)
    v_exp_f32 v219, v219
    v_mfma_f32_16x16x32_bf16 v[116:119], v[228:231], a[220:223], v[116:119]
    v_exp_f32 v220, v220
    v_mfma_f32_16x16x32_bf16 v[116:119], v[224:227], a[216:219], v[116:119]
    s_waitcnt lgkmcnt(6)
    v_exp_f32 v221, v221
    v_mfma_f32_16x16x32_bf16 v[120:123], v[224:227], a[224:227], v[120:123]
    v_cvt_pk_bf16_f32 v233, v218, v219
    v_cvt_pk_bf16_f32 v234, v220, v221
    v_mfma_f32_16x16x32_bf16 v[212:215], a[160:163], a[64:67], v[212:215]
    s_waitcnt lgkmcnt(4)
    v_exp_f32 v222, v222
    v_mfma_f32_16x16x32_bf16 v[120:123], v[228:231], a[228:231], v[120:123]
    v_exp_f32 v223, v223
    v_mfma_f32_16x16x32_bf16 v[216:219], a[112:115], a[80:83], v[240:243]
    v_exp_f32 v208, v208
    v_mfma_f32_16x16x32_bf16 v[216:219], a[116:119], a[84:87], v[216:219]
    v_exp_f32 v209, v209
    v_mfma_f32_16x16x32_bf16 v[216:219], a[120:123], a[88:91], v[216:219]
    s_waitcnt lgkmcnt(0)
    v_cvt_pk_bf16_f32 v235, v222, v223
    v_cvt_pk_bf16_f32 v236, v208, v209
    v_mfma_f32_16x16x32_bf16 v[124:127], v[228:231], a[236:239], v[124:127]
    v_exp_f32 v210, v210
    v_mfma_f32_16x16x32_bf16 v[124:127], v[224:227], a[232:235], v[124:127]
    v_bfe_u32 v228, v254, 8, 2
    v_lshl_add_u32 v228, v228, 4, s35
    v_mfma_f32_16x16x32_bf16 v[128:131], v[232:235], a[176:179], v[128:131]
    ds_read_b128 v[228:231], v228 offset:192
    v_add_f32 v227, v246, v247
    v_mfma_f32_16x16x32_bf16 v[136:139], v[232:235], a[192:195], v[136:139]
    v_exp_f32 v211, v211
    v_mfma_f32_16x16x32_bf16 v[216:219], a[124:127], a[92:95], v[216:219]
    v_mov_b32 v226, v227
    v_cvt_pk_bf16_f32 v237, v210, v211
    v_mfma_f32_16x16x32_bf16 v[144:147], v[232:235], a[208:211], v[144:147]
    v_permlane32_swap_b32 v227, v226
    v_mov_b32 v226, v227
    v_mfma_f32_16x16x32_bf16 v[152:155], v[232:235], a[224:227], v[152:155]
    v_exp_f32 v212, v212
    v_mfma_f32_16x16x32_bf16 v[220:223], a[140:143], a[92:95], v[240:243]
    v_exp_f32 v213, v213
    v_mfma_f32_16x16x32_bf16 v[220:223], a[136:139], a[88:91], v[220:223]
    v_permlane16_swap_b32 v227, v226
    v_cvt_pk_bf16_f32 v238, v212, v213
    v_mfma_f32_16x16x32_bf16 v[220:223], a[132:135], a[84:87], v[220:223]
    v_rcp_f32 v227, v226
    v_mfma_f32_16x16x32_bf16 v[220:223], a[128:131], a[80:83], v[220:223]
    v_exp_f32 v214, v214
    v_mfma_f32_16x16x32_bf16 v[208:211], a[144:147], a[80:83], v[240:243]
    v_exp_f32 v215, v215
    v_mfma_f32_16x16x32_bf16 v[208:211], a[148:151], a[84:87], v[208:211]
    v_mov_b32_dpp v227, v227 row_ror:12 row_mask:0x2 bank_mask:0xf
    v_cvt_pk_bf16_f32 v239, v214, v215
    v_mfma_f32_16x16x32_bf16 v[208:211], a[152:155], a[88:91], v[208:211]
    v_exp_f32 v216, v216
    v_mfma_f32_16x16x32_bf16 v[128:131], v[236:239], a[180:183], v[128:131]
    v_exp_f32 v217, v217
    v_mfma_f32_16x16x32_bf16 v[132:135], v[236:239], a[188:191], v[132:135]
    v_exp_f32 v218, v218
    v_mfma_f32_16x16x32_bf16 v[132:135], v[232:235], a[184:187], v[132:135]
    v_exp_f32 v219, v219
    v_mfma_f32_16x16x32_bf16 v[136:139], v[236:239], a[196:199], v[136:139]
    v_exp_f32 v220, v220
    v_mfma_f32_16x16x32_bf16 v[140:143], v[236:239], a[204:207], v[140:143]
    v_exp_f32 v221, v221
    v_mfma_f32_16x16x32_bf16 v[140:143], v[232:235], a[200:203], v[140:143]
    v_exp_f32 v222, v222
    v_mfma_f32_16x16x32_bf16 v[144:147], v[236:239], a[212:215], v[144:147]
    v_exp_f32 v223, v223
    v_mfma_f32_16x16x32_bf16 v[148:151], v[236:239], a[220:223], v[148:151]
    v_mov_b32_dpp v227, v227 row_ror:8 row_mask:0x4 bank_mask:0xf
    v_mfma_f32_16x16x32_bf16 v[148:151], v[232:235], a[216:219], v[148:151]
    s_nop 0
    v_mov_b32_dpp v227, v227 row_ror:4 row_mask:0x8 bank_mask:0xf
    v_mfma_f32_16x16x32_bf16 v[152:155], v[236:239], a[228:231], v[152:155]
    s_nop 0
    v_mov_b32_dpp v224, v227 row_newbcast:0 row_mask:0xf bank_mask:0xf
    v_mov_b32_dpp v225, v227 row_newbcast:1 row_mask:0xf bank_mask:0xf
    v_mfma_f32_16x16x32_bf16 v[156:159], v[236:239], a[236:239], v[156:159]
    v_mov_b32_dpp v226, v227 row_newbcast:2 row_mask:0xf bank_mask:0xf
    v_mov_b32_dpp v227, v227 row_newbcast:3 row_mask:0xf bank_mask:0xf
    v_mfma_f32_16x16x32_bf16 v[156:159], v[232:235], a[232:235], v[156:159]
    s_waitcnt lgkmcnt(0)
    v_mul_f32 v228, v228, v224
    v_mul_f32 v229, v229, v225
    v_mfma_f32_16x16x32_bf16 v[208:211], a[156:159], a[92:95], v[208:211]
    v_mul_f32 v230, v230, v226
    v_mul_f32_e64 v231, v231, v227
    v_mfma_f32_16x16x32_bf16 v[212:215], a[172:175], a[92:95], v[240:243]
    v_pk_fma_f32 v[96:97], v[96:97], v[224:225], v[228:229] neg_lo:[0,0,1] neg_hi:[0,0,1]
    v_pk_fma_f32 v[98:99], v[98:99], v[226:227], v[230:231] neg_lo:[0,0,1] neg_hi:[0,0,1]
    v_pk_fma_f32 v[100:101], v[100:101], v[224:225], v[228:229] neg_lo:[0,0,1] neg_hi:[0,0,1]
    v_pk_fma_f32 v[102:103], v[102:103], v[226:227], v[230:231] neg_lo:[0,0,1] neg_hi:[0,0,1]
    v_pk_fma_f32 v[104:105], v[104:105], v[224:225], v[228:229] neg_lo:[0,0,1] neg_hi:[0,0,1]
    v_pk_fma_f32 v[106:107], v[106:107], v[226:227], v[230:231] neg_lo:[0,0,1] neg_hi:[0,0,1]
    v_pk_fma_f32 v[108:109], v[108:109], v[224:225], v[228:229] neg_lo:[0,0,1] neg_hi:[0,0,1]
    v_pk_fma_f32 v[110:111], v[110:111], v[226:227], v[230:231] neg_lo:[0,0,1] neg_hi:[0,0,1]
    v_pk_fma_f32 v[112:113], v[112:113], v[224:225], v[228:229] neg_lo:[0,0,1] neg_hi:[0,0,1]
    v_pk_fma_f32 v[114:115], v[114:115], v[226:227], v[230:231] neg_lo:[0,0,1] neg_hi:[0,0,1]
    v_pk_fma_f32 v[116:117], v[116:117], v[224:225], v[228:229] neg_lo:[0,0,1] neg_hi:[0,0,1]
    v_pk_fma_f32 v[118:119], v[118:119], v[226:227], v[230:231] neg_lo:[0,0,1] neg_hi:[0,0,1]
    v_pk_fma_f32 v[120:121], v[120:121], v[224:225], v[228:229] neg_lo:[0,0,1] neg_hi:[0,0,1]
    v_pk_fma_f32 v[122:123], v[122:123], v[226:227], v[230:231] neg_lo:[0,0,1] neg_hi:[0,0,1]
    v_pk_fma_f32 v[124:125], v[124:125], v[224:225], v[228:229] neg_lo:[0,0,1] neg_hi:[0,0,1]
    v_pk_fma_f32 v[126:127], v[126:127], v[226:227], v[230:231] neg_lo:[0,0,1] neg_hi:[0,0,1]
    v_smfmac_f32_16x16x64_bf16 v[244:247], v[248:251], v[232:239], v240
    v_cvt_pk_bf16_f32 v224, v96, v100
    v_cvt_pk_bf16_f32 v225, v104, v108
    v_cvt_pk_bf16_f32 v226, v112, v116
    v_mfma_f32_16x16x32_bf16 v[212:215], a[168:171], a[88:91], v[212:215]
    v_cvt_pk_bf16_f32 v227, v120, v124
    v_cvt_pk_bf16_f32 v228, v97, v101
    v_mfma_f32_16x16x32_bf16 v[212:215], a[164:167], a[84:87], v[212:215]
    ds_write_b128 v255, v[224:227] offset:0
    v_mfma_f32_16x16x32_bf16 v[212:215], a[160:163], a[80:83], v[212:215]
    v_cvt_pk_bf16_f32 v229, v105, v109
    v_cvt_pk_bf16_f32 v230, v113, v117
    v_cvt_pk_bf16_f32 v231, v121, v125
    v_cvt_pk_bf16_f32 v224, v98, v102
    v_cvt_pk_bf16_f32 v225, v106, v110
    v_cvt_pk_bf16_f32 v226, v114, v118
    v_cvt_pk_bf16_f32 v227, v122, v126
    v_bfe_u32 v125, v254, 8, 2
    v_bfe_u32 v126, v254, 8, 2
    v_lshl_add_u32 v126, v126, 4, s35
    v_exp_f32 v208, v208
    v_exp_f32 v209, v209
    v_exp_f32 v210, v210
    ds_write_b128 v255, v[228:231] offset:320
    s_nop 1
    v_cvt_pk_bf16_f32 v228, v99, v103
    v_cvt_pk_bf16_f32 v229, v107, v111
    v_cvt_pk_bf16_f32 v230, v115, v119
    v_cvt_pk_bf16_f32 v231, v123, v127
    v_mul_u32_u24 v127, 0x140, v125
    v_bfe_u32 v125, v254, 6, 2
    v_lshl_add_u32 v127, v125, 4, v127
    v_bfe_u32 v125, v254, 4, 1
    v_lshl_add_u32 v127, v125, 3, v127
    v_bfe_u32 v125, v254, 5, 1
    v_lshl_add_u32 v127, v125, 7, v127
    v_add_u32 v127, s76, v127
    v_add_f32 v107, v244, v245
    ds_read_b128 v[100:103], v126 offset:320
    ds_write_b128 v255, v[224:227] offset:640
    ds_read_b128 v[108:111], v126 offset:256
    v_mov_b32 v106, v107
    v_cvt_pk_bf16_f32 v224, v216, v217
    v_cvt_pk_bf16_f32 v225, v218, v219
    v_mfma_f32_16x16x32_bf16 v[216:219], a[112:115], a[96:99], v[240:243]
    ds_write_b128 v255, v[228:231] offset:960
    v_mfma_f32_16x16x32_bf16 v[216:219], a[116:119], a[100:103], v[216:219]
    ds_read_b64_tr_b16 a[48:49], v127 offset:0
    v_permlane32_swap_b32 v107, v106
    v_mfma_f32_16x16x32_bf16 v[216:219], a[120:123], a[104:107], v[216:219]
    ds_read_b64_tr_b16 a[50:51], v127 offset:64
    v_mov_b32 v107, v106
    v_mfma_f32_16x16x32_bf16 v[216:219], a[124:127], a[108:111], v[216:219]
    ds_read_b64_tr_b16 a[52:53], v127 offset:1280
    v_permlane16_swap_b32 v106, v107
    v_rcp_f32 v107, v106
    v_cvt_pk_bf16_f32 v226, v220, v221
    v_cvt_pk_bf16_f32 v227, v222, v223
    v_mfma_f32_16x16x32_bf16 v[220:223], a[140:143], a[108:111], v[240:243]
    ds_read_b64_tr_b16 a[54:55], v127 offset:1344
    v_mov_b32_dpp v107, v107 row_ror:12 row_mask:0x2 bank_mask:0xf
    v_mfma_f32_16x16x32_bf16 v[160:163], v[224:227], a[176:179], v[160:163]
    ds_read_b64_tr_b16 a[56:57], v127 offset:2560
    v_mov_b32_dpp v107, v107 row_ror:8 row_mask:0x4 bank_mask:0xf
    v_mfma_f32_16x16x32_bf16 v[168:171], v[224:227], a[192:195], v[168:171]
    ds_read_b64_tr_b16 a[58:59], v127 offset:2624
    v_mov_b32_dpp v107, v107 row_ror:4 row_mask:0x8 bank_mask:0xf
    v_mfma_f32_16x16x32_bf16 v[176:179], v[224:227], a[208:211], v[176:179]
    ds_read_b64_tr_b16 a[60:61], v127 offset:3840
    v_mov_b32_dpp v104, v107 row_newbcast:0 row_mask:0xf bank_mask:0xf
    v_mfma_f32_16x16x32_bf16 v[184:187], v[224:227], a[224:227], v[184:187]
    ds_read_b64_tr_b16 a[62:63], v127 offset:3904
    v_mov_b32_dpp v105, v107 row_newbcast:1 row_mask:0xf bank_mask:0xf
    v_mfma_f32_16x16x32_bf16 v[220:223], a[136:139], a[104:107], v[220:223]
    v_mov_b32_dpp v106, v107 row_newbcast:2 row_mask:0xf bank_mask:0xf
    v_mov_b32_dpp v107, v107 row_newbcast:3 row_mask:0xf bank_mask:0xf
    v_mfma_f32_16x16x32_bf16 v[220:223], a[132:135], a[100:103], v[220:223]
    s_waitcnt lgkmcnt(6)
    buffer_store_dwordx4 a[48:51], v254, s[24:27], s83 offen offset:0 sc1
    v_mfma_f32_16x16x32_bf16 v[220:223], a[128:131], a[96:99], v[220:223]
    v_mul_f32 v108, v108, v104
    v_mul_f32 v109, v109, v105
    v_mul_f32 v110, v110, v106
    v_mul_f32 v111, v111, v107
    v_pk_fma_f32 v[128:129], v[128:129], v[104:105], v[108:109] neg_lo:[0,0,1] neg_hi:[0,0,1]
    v_pk_fma_f32 v[130:131], v[130:131], v[106:107], v[110:111] neg_lo:[0,0,1] neg_hi:[0,0,1]
    v_pk_fma_f32 v[132:133], v[132:133], v[104:105], v[108:109] neg_lo:[0,0,1] neg_hi:[0,0,1]
    v_pk_fma_f32 v[134:135], v[134:135], v[106:107], v[110:111] neg_lo:[0,0,1] neg_hi:[0,0,1]
    v_pk_fma_f32 v[136:137], v[136:137], v[104:105], v[108:109] neg_lo:[0,0,1] neg_hi:[0,0,1]
    v_pk_fma_f32 v[138:139], v[138:139], v[106:107], v[110:111] neg_lo:[0,0,1] neg_hi:[0,0,1]
    v_pk_fma_f32 v[140:141], v[140:141], v[104:105], v[108:109] neg_lo:[0,0,1] neg_hi:[0,0,1]
    v_pk_fma_f32 v[142:143], v[142:143], v[106:107], v[110:111] neg_lo:[0,0,1] neg_hi:[0,0,1]
    v_pk_fma_f32 v[144:145], v[144:145], v[104:105], v[108:109] neg_lo:[0,0,1] neg_hi:[0,0,1]
    v_pk_fma_f32 v[146:147], v[146:147], v[106:107], v[110:111] neg_lo:[0,0,1] neg_hi:[0,0,1]
    v_pk_fma_f32 v[148:149], v[148:149], v[104:105], v[108:109] neg_lo:[0,0,1] neg_hi:[0,0,1]
    v_pk_fma_f32 v[150:151], v[150:151], v[106:107], v[110:111] neg_lo:[0,0,1] neg_hi:[0,0,1]
    v_pk_fma_f32 v[152:153], v[152:153], v[104:105], v[108:109] neg_lo:[0,0,1] neg_hi:[0,0,1]
    v_pk_fma_f32 v[154:155], v[154:155], v[106:107], v[110:111] neg_lo:[0,0,1] neg_hi:[0,0,1]
    v_pk_fma_f32 v[156:157], v[156:157], v[104:105], v[108:109] neg_lo:[0,0,1] neg_hi:[0,0,1]
    v_pk_fma_f32 v[158:159], v[158:159], v[106:107], v[110:111] neg_lo:[0,0,1] neg_hi:[0,0,1]
    v_cvt_pk_bf16_f32 v112, v128, v132
    v_cvt_pk_bf16_f32 v113, v136, v140
    v_cvt_pk_bf16_f32 v114, v144, v148
    s_waitcnt lgkmcnt(4)
    buffer_store_dwordx4 a[52:55], v254, s[24:27], s83 offen offset:1024 sc1
    ds_read_b128 v[108:111], v126 offset:384
    v_cvt_pk_bf16_f32 v115, v152, v156
    v_cvt_pk_bf16_f32 v116, v129, v133
    v_cvt_pk_bf16_f32 v117, v137, v141
    v_cvt_pk_bf16_f32 v118, v145, v149
    v_cvt_pk_bf16_f32 v119, v153, v157
    v_cvt_pk_bf16_f32 v120, v130, v134
    v_cvt_pk_bf16_f32 v121, v138, v142
    v_cvt_pk_bf16_f32 v122, v146, v150
    v_cvt_pk_bf16_f32 v123, v154, v158
    v_cvt_pk_bf16_f32 v228, v208, v209
    v_exp_f32 v211, v211
    v_exp_f32 v212, v212
    ds_write_b128 v255, v[112:115] offset:5120
    s_waitcnt lgkmcnt(4)
    buffer_store_dwordx4 a[56:59], v254, s[24:27], s83 offen offset:2048 sc1
    v_cvt_pk_bf16_f32 v112, v131, v135
    v_cvt_pk_bf16_f32 v113, v139, v143
    v_cvt_pk_bf16_f32 v114, v147, v151
    v_cvt_pk_bf16_f32 v115, v155, v159
    v_cvt_pk_bf16_f32 v229, v210, v211
    v_mfma_f32_16x16x32_bf16 v[208:211], a[144:147], a[96:99], v[240:243]
    ds_write_b128 v255, v[116:119] offset:5440
    v_mfma_f32_16x16x32_bf16 v[208:211], a[148:151], a[100:103], v[208:211]
    s_waitcnt lgkmcnt(3)
    buffer_store_dwordx4 a[60:63], v254, s[24:27], s83 offen offset:3072 sc1
    v_mfma_f32_16x16x32_bf16 v[208:211], a[152:155], a[104:107], v[208:211]
    ds_write_b128 v255, v[120:123] offset:5760
    v_mfma_f32_16x16x32_bf16 v[208:211], a[156:159], a[108:111], v[208:211]
    v_exp_f32 v213, v213
    v_exp_f32 v214, v214
    v_cvt_pk_bf16_f32 v230, v212, v213
    v_exp_f32 v215, v215
    v_mov_b32_dpp v248, v248 row_ror:2 row_mask:0xf bank_mask:0xf
    v_cvt_pk_bf16_f32 v231, v214, v215
    v_mfma_f32_16x16x32_bf16 v[212:215], a[172:175], a[108:111], v[240:243]
    ds_write_b128 v255, v[112:115] offset:6080
    v_mfma_f32_16x16x32_bf16 v[160:163], v[228:231], a[180:183], v[160:163]
    ds_read_b64_tr_b16 a[64:65], v127 offset:5120
    v_mov_b32_dpp v249, v249 row_ror:2 row_mask:0xf bank_mask:0xf
    v_mfma_f32_16x16x32_bf16 v[164:167], v[228:231], a[188:191], v[164:167]
    ds_read_b64_tr_b16 a[66:67], v127 offset:5184
    v_mov_b32_dpp v250, v250 row_ror:2 row_mask:0xf bank_mask:0xf
    v_mfma_f32_16x16x32_bf16 v[164:167], v[224:227], a[184:187], v[164:167]
    ds_read_b64_tr_b16 a[68:69], v127 offset:6400
    v_mov_b32_dpp v251, v251 row_ror:2 row_mask:0xf bank_mask:0xf
    v_mfma_f32_16x16x32_bf16 v[168:171], v[228:231], a[196:199], v[168:171]
    v_exp_f32 v216, v216
    v_mfma_f32_16x16x32_bf16 v[172:175], v[228:231], a[204:207], v[172:175]
    v_exp_f32 v217, v217
    v_mfma_f32_16x16x32_bf16 v[172:175], v[224:227], a[200:203], v[172:175]
    ds_read_b64_tr_b16 a[70:71], v127 offset:6464
    v_cvt_pk_bf16_f32 v232, v216, v217
    v_mfma_f32_16x16x32_bf16 v[176:179], v[228:231], a[212:215], v[176:179]
    v_exp_f32 v218, v218
    v_mfma_f32_16x16x32_bf16 v[180:183], v[228:231], a[220:223], v[180:183]
    v_exp_f32 v219, v219
    v_mfma_f32_16x16x32_bf16 v[180:183], v[224:227], a[216:219], v[180:183]
    ds_read_b64_tr_b16 a[72:73], v127 offset:7680
    v_cvt_pk_bf16_f32 v233, v218, v219
    v_mfma_f32_16x16x32_bf16 v[184:187], v[228:231], a[228:231], v[184:187]
    v_exp_f32 v220, v220
    v_mfma_f32_16x16x32_bf16 v[188:191], v[228:231], a[236:239], v[188:191]
    v_exp_f32 v221, v221
    v_mfma_f32_16x16x32_bf16 v[188:191], v[224:227], a[232:235], v[188:191]
    ds_read_b64_tr_b16 a[74:75], v127 offset:7744
    s_waitcnt lgkmcnt(4)
    buffer_store_dwordx4 a[64:67], v254, s[24:27], s84 offen offset:0 sc1
    v_smfmac_f32_16x16x64_bf16 v[244:247], v[248:251], v[224:231], v240
    ds_read_b64_tr_b16 a[76:77], v127 offset:8960
    v_cvt_pk_bf16_f32 v234, v220, v221
    v_exp_f32 v222, v222
    v_mfma_f32_16x16x32_bf16 v[212:215], a[168:171], a[104:107], v[212:215]
    ds_read_b64_tr_b16 a[78:79], v127 offset:9024
    v_mov_b32_dpp v248, v248 row_ror:2 row_mask:0xf bank_mask:0xf
    v_mfma_f32_16x16x32_bf16 v[212:215], a[164:167], a[100:103], v[212:215]
    s_nop 0
    v_add_f32 v99, v246, v247
    v_mov_b32 v98, v99
    v_mfma_f32_16x16x32_bf16 v[212:215], a[160:163], a[96:99], v[212:215]
    s_waitcnt lgkmcnt(4)
    buffer_store_dwordx4 a[68:71], v254, s[24:27], s84 offen offset:1024 sc1
    v_mfma_f32_16x16x32_bf16 v[216:219], a[112:115], a[0:3], v[240:243]
    v_permlane32_swap_b32 v99, v98
    v_mov_b32 v99, v98
    v_mfma_f32_16x16x32_bf16 v[216:219], a[116:119], a[4:7], v[216:219]
    s_nop 0
    v_permlane16_swap_b32 v98, v99
    v_mov_b32_dpp v249, v249 row_ror:2 row_mask:0xf bank_mask:0xf
    v_mfma_f32_16x16x32_bf16 v[216:219], a[120:123], a[8:11], v[216:219]
    v_rcp_f32 v99, v98
    v_mfma_f32_16x16x32_bf16 v[216:219], a[124:127], a[12:15], v[216:219]
    s_waitcnt lgkmcnt(2)
    buffer_store_dwordx4 a[72:75], v254, s[24:27], s84 offen offset:2048 sc1
    v_mov_b32_dpp v99, v99 row_ror:12 row_mask:0x2 bank_mask:0xf
    v_exp_f32 v223, v223
    s_nop 0
    v_mov_b32_dpp v99, v99 row_ror:8 row_mask:0x4 bank_mask:0xf
    v_cvt_pk_bf16_f32 v235, v222, v223
    v_mfma_f32_16x16x32_bf16 v[220:223], a[140:143], a[12:15], v[240:243]
    v_mov_b32_dpp v99, v99 row_ror:4 row_mask:0x8 bank_mask:0xf
    v_mov_b32_dpp v250, v250 row_ror:2 row_mask:0xf bank_mask:0xf
    v_mfma_f32_16x16x32_bf16 v[192:195], v[232:235], a[176:179], v[192:195]
    v_mov_b32_dpp v96, v99 row_newbcast:0 row_mask:0xf bank_mask:0xf
    v_mov_b32_dpp v97, v99 row_newbcast:1 row_mask:0xf bank_mask:0xf
    v_mfma_f32_16x16x32_bf16 v[200:203], v[232:235], a[192:195], v[200:203]
    s_waitcnt lgkmcnt(0)
    buffer_store_dwordx4 a[76:79], v254, s[24:27], s84 offen offset:3072 sc1
    v_mfma_f32_16x16x32_bf16 a[240:243], v[232:235], a[208:211], a[240:243]
    v_mov_b32_dpp v98, v99 row_newbcast:2 row_mask:0xf bank_mask:0xf
    v_mov_b32_dpp v99, v99 row_newbcast:3 row_mask:0xf bank_mask:0xf
    v_mfma_f32_16x16x32_bf16 a[248:251], v[232:235], a[224:227], a[248:251]
    v_mul_f32 v100, v100, v96
    v_mul_f32 v101, v101, v97
    v_mfma_f32_16x16x32_bf16 v[220:223], a[136:139], a[8:11], v[220:223]
    v_mul_f32 v102, v102, v98
    v_mul_f32_e64 v103, v103, v99
    v_mfma_f32_16x16x32_bf16 v[220:223], a[132:135], a[4:7], v[220:223]
    v_pk_fma_f32 v[160:161], v[160:161], v[96:97], v[100:101] neg_lo:[0,0,1] neg_hi:[0,0,1]
    v_pk_fma_f32 v[162:163], v[162:163], v[98:99], v[102:103] neg_lo:[0,0,1] neg_hi:[0,0,1]
    v_pk_fma_f32 v[164:165], v[164:165], v[96:97], v[100:101] neg_lo:[0,0,1] neg_hi:[0,0,1]
    v_pk_fma_f32 v[166:167], v[166:167], v[98:99], v[102:103] neg_lo:[0,0,1] neg_hi:[0,0,1]
    v_pk_fma_f32 v[168:169], v[168:169], v[96:97], v[100:101] neg_lo:[0,0,1] neg_hi:[0,0,1]
    v_pk_fma_f32 v[170:171], v[170:171], v[98:99], v[102:103] neg_lo:[0,0,1] neg_hi:[0,0,1]
    v_pk_fma_f32 v[172:173], v[172:173], v[96:97], v[100:101] neg_lo:[0,0,1] neg_hi:[0,0,1]
    v_pk_fma_f32 v[174:175], v[174:175], v[98:99], v[102:103] neg_lo:[0,0,1] neg_hi:[0,0,1]
    v_pk_fma_f32 v[176:177], v[176:177], v[96:97], v[100:101] neg_lo:[0,0,1] neg_hi:[0,0,1]
    v_pk_fma_f32 v[178:179], v[178:179], v[98:99], v[102:103] neg_lo:[0,0,1] neg_hi:[0,0,1]
    v_pk_fma_f32 v[180:181], v[180:181], v[96:97], v[100:101] neg_lo:[0,0,1] neg_hi:[0,0,1]
    v_pk_fma_f32 v[182:183], v[182:183], v[98:99], v[102:103] neg_lo:[0,0,1] neg_hi:[0,0,1]
    v_pk_fma_f32 v[184:185], v[184:185], v[96:97], v[100:101] neg_lo:[0,0,1] neg_hi:[0,0,1]
    v_pk_fma_f32 v[186:187], v[186:187], v[98:99], v[102:103] neg_lo:[0,0,1] neg_hi:[0,0,1]
    v_pk_fma_f32 v[188:189], v[188:189], v[96:97], v[100:101] neg_lo:[0,0,1] neg_hi:[0,0,1]
    v_pk_fma_f32 v[190:191], v[190:191], v[98:99], v[102:103] neg_lo:[0,0,1] neg_hi:[0,0,1]
    v_mfma_f32_16x16x32_bf16 v[220:223], a[128:131], a[0:3], v[220:223]
    ds_read_b128 v[100:103], v126 offset:0
    v_cvt_pk_bf16_f32 v112, v160, v164
    v_cvt_pk_bf16_f32 v113, v168, v172
    v_cvt_pk_bf16_f32 v114, v176, v180
    v_cvt_pk_bf16_f32 v115, v184, v188
    v_cvt_pk_bf16_f32 v116, v161, v165
    v_cvt_pk_bf16_f32 v117, v169, v173
    v_cvt_pk_bf16_f32 v118, v177, v181
    v_cvt_pk_bf16_f32 v119, v185, v189
    v_cvt_pk_bf16_f32 v120, v162, v166
    v_cvt_pk_bf16_f32 v121, v170, v174
    v_cvt_pk_bf16_f32 v122, v178, v182
    v_cvt_pk_bf16_f32 v123, v186, v190
    v_exp_f32 v208, v208
    v_exp_f32 v209, v209
    v_exp_f32 v210, v210
    ds_write_b128 v255, v[112:115] offset:0
    s_nop 1
    v_cvt_pk_bf16_f32 v112, v163, v167
    v_cvt_pk_bf16_f32 v113, v171, v175
    v_cvt_pk_bf16_f32 v114, v179, v183
    v_cvt_pk_bf16_f32 v115, v187, v191
    v_cvt_pk_bf16_f32 v236, v208, v209
    v_exp_f32 v211, v211
    v_exp_f32 v212, v212
    v_cvt_pk_bf16_f32 v237, v210, v211
    v_mfma_f32_16x16x32_bf16 v[208:211], a[144:147], a[0:3], v[240:243]
    ds_write_b128 v255, v[116:119] offset:320
    v_mfma_f32_16x16x32_bf16 v[208:211], a[148:151], a[4:7], v[208:211]
    v_exp_f32 v213, v213
    v_mfma_f32_16x16x32_bf16 v[208:211], a[152:155], a[8:11], v[208:211]
    ds_write_b128 v255, v[120:123] offset:640
    v_mfma_f32_16x16x32_bf16 v[208:211], a[156:159], a[12:15], v[208:211]
    v_cvt_pk_bf16_f32 v238, v212, v213
    v_exp_f32 v214, v214
    v_exp_f32 v215, v215
    v_mov_b32_dpp v251, v251 row_ror:2 row_mask:0xf bank_mask:0xf
    v_cvt_pk_bf16_f32 v239, v214, v215
    v_mfma_f32_16x16x32_bf16 v[212:215], a[172:175], a[12:15], v[240:243]
    ds_write_b128 v255, v[112:115] offset:960
    v_smfmac_f32_16x16x64_bf16 v[244:247], v[248:251], v[232:239], v240
    v_exp_f32 v216, v216
    v_exp_f32 v217, v217
    v_mfma_f32_16x16x32_bf16 v[192:195], v[236:239], a[180:183], v[192:195]
    ds_read_b64_tr_b16 a[80:81], v127 offset:0
    v_cvt_pk_bf16_f32 v224, v216, v217
    v_mfma_f32_16x16x32_bf16 v[196:199], v[236:239], a[188:191], v[196:199]
    ds_read_b64_tr_b16 a[82:83], v127 offset:64
    s_nop 0
    v_add_f32 v107, v244, v245
    v_mfma_f32_16x16x32_bf16 v[196:199], v[232:235], a[184:187], v[196:199]
    ds_read_b64_tr_b16 a[84:85], v127 offset:1280
    v_mov_b32 v106, v107
    v_mfma_f32_16x16x32_bf16 v[200:203], v[236:239], a[196:199], v[200:203]
    ds_read_b64_tr_b16 a[86:87], v127 offset:1344
    v_permlane32_swap_b32 v107, v106
    v_mfma_f32_16x16x32_bf16 v[204:207], v[236:239], a[204:207], v[204:207]
    ds_read_b64_tr_b16 a[88:89], v127 offset:2560
    v_mov_b32 v107, v106
    v_mfma_f32_16x16x32_bf16 v[204:207], v[232:235], a[200:203], v[204:207]
    ds_read_b64_tr_b16 a[90:91], v127 offset:2624
    v_permlane16_swap_b32 v106, v107
    v_mfma_f32_16x16x32_bf16 a[240:243], v[236:239], a[212:215], a[240:243]
    ds_read_b64_tr_b16 a[92:93], v127 offset:3840
    v_mov_b32_dpp v248, v248 row_ror:4 row_mask:0xf bank_mask:0xf
    v_mfma_f32_16x16x32_bf16 a[244:247], v[236:239], a[220:223], a[244:247]
    ds_read_b64_tr_b16 a[94:95], v127 offset:3904
    v_mov_b32_dpp v249, v249 row_ror:4 row_mask:0xf bank_mask:0xf
    v_mfma_f32_16x16x32_bf16 a[244:247], v[232:235], a[216:219], a[244:247]
    v_rcp_f32 v107, v107
    v_mfma_f32_16x16x32_bf16 a[248:251], v[236:239], a[228:231], a[248:251]
    s_nop 0
    v_mov_b32_dpp v107, v107 row_ror:12 row_mask:0x2 bank_mask:0xf
    v_accvgpr_read_b32 v128, a240
    v_mfma_f32_16x16x32_bf16 a[252:255], v[236:239], a[236:239], a[252:255]
    s_waitcnt lgkmcnt(6)
    buffer_store_dwordx4 a[80:83], v254, s[24:27], s85 offen offset:0 sc1
    v_mfma_f32_16x16x32_bf16 a[252:255], v[232:235], a[232:235], a[252:255]
    v_mov_b32_dpp v107, v107 row_ror:8 row_mask:0x4 bank_mask:0xf
    v_accvgpr_read_b32 v129, a241
    v_mfma_f32_16x16x32_bf16 v[212:215], a[168:171], a[8:11], v[212:215]
    v_mov_b32_dpp v107, v107 row_ror:4 row_mask:0x8 bank_mask:0xf
    v_accvgpr_read_b32 v130, a242
    v_mfma_f32_16x16x32_bf16 v[212:215], a[164:167], a[4:7], v[212:215]
    v_mov_b32_dpp v104, v107 row_newbcast:0 row_mask:0xf bank_mask:0xf
    v_mov_b32_dpp v105, v107 row_newbcast:1 row_mask:0xf bank_mask:0xf
    v_mfma_f32_16x16x32_bf16 v[212:215], a[160:163], a[0:3], v[212:215]
    s_waitcnt lgkmcnt(4)
    buffer_store_dwordx4 a[84:87], v254, s[24:27], s85 offen offset:1024 sc1
    v_mov_b32_dpp v106, v107 row_newbcast:2 row_mask:0xf bank_mask:0xf
    v_mov_b32_dpp v107, v107 row_newbcast:3 row_mask:0xf bank_mask:0xf
    v_mul_f32 v108, v108, v104
    v_mul_f32 v109, v109, v105
    v_mul_f32 v110, v110, v106
    v_mul_f32_e64 v111, v111, v107
    v_accvgpr_read_b32 v131, a243
    v_accvgpr_read_b32 v132, a244
    v_accvgpr_read_b32 v133, a245
    v_accvgpr_read_b32 v134, a246
    v_accvgpr_read_b32 v135, a247
    v_accvgpr_read_b32 v136, a248
    v_accvgpr_read_b32 v137, a249
    v_accvgpr_read_b32 v138, a250
    v_accvgpr_read_b32 v139, a251
    v_accvgpr_read_b32 v140, a252
    v_accvgpr_read_b32 v141, a253
    v_accvgpr_read_b32 v142, a254
    v_accvgpr_read_b32 v143, a255
    v_pk_fma_f32 v[192:193], v[192:193], v[104:105], v[108:109] neg_lo:[0,0,1] neg_hi:[0,0,1]
    v_pk_fma_f32 v[194:195], v[194:195], v[106:107], v[110:111] neg_lo:[0,0,1] neg_hi:[0,0,1]
    v_pk_fma_f32 v[196:197], v[196:197], v[104:105], v[108:109] neg_lo:[0,0,1] neg_hi:[0,0,1]
    v_pk_fma_f32 v[198:199], v[198:199], v[106:107], v[110:111] neg_lo:[0,0,1] neg_hi:[0,0,1]
    v_pk_fma_f32 v[200:201], v[200:201], v[104:105], v[108:109] neg_lo:[0,0,1] neg_hi:[0,0,1]
    v_pk_fma_f32 v[202:203], v[202:203], v[106:107], v[110:111] neg_lo:[0,0,1] neg_hi:[0,0,1]
    v_pk_fma_f32 v[204:205], v[204:205], v[104:105], v[108:109] neg_lo:[0,0,1] neg_hi:[0,0,1]
    v_pk_fma_f32 v[206:207], v[206:207], v[106:107], v[110:111] neg_lo:[0,0,1] neg_hi:[0,0,1]
    v_pk_fma_f32 v[128:129], v[128:129], v[104:105], v[108:109] neg_lo:[0,0,1] neg_hi:[0,0,1]
    v_pk_fma_f32 v[130:131], v[130:131], v[106:107], v[110:111] neg_lo:[0,0,1] neg_hi:[0,0,1]
    v_pk_fma_f32 v[132:133], v[132:133], v[104:105], v[108:109] neg_lo:[0,0,1] neg_hi:[0,0,1]
    v_pk_fma_f32 v[134:135], v[134:135], v[106:107], v[110:111] neg_lo:[0,0,1] neg_hi:[0,0,1]
    v_pk_fma_f32 v[136:137], v[136:137], v[104:105], v[108:109] neg_lo:[0,0,1] neg_hi:[0,0,1]
    v_pk_fma_f32 v[138:139], v[138:139], v[106:107], v[110:111] neg_lo:[0,0,1] neg_hi:[0,0,1]
    v_pk_fma_f32 v[140:141], v[140:141], v[104:105], v[108:109] neg_lo:[0,0,1] neg_hi:[0,0,1]
    v_pk_fma_f32 v[142:143], v[142:143], v[106:107], v[110:111] neg_lo:[0,0,1] neg_hi:[0,0,1]
    s_waitcnt lgkmcnt(2)
    buffer_store_dwordx4 a[88:91], v254, s[24:27], s85 offen offset:2048 sc1
    ds_read_b128 v[108:111], v126 offset:64
    v_cvt_pk_bf16_f32 v112, v192, v196
    v_cvt_pk_bf16_f32 v113, v200, v204
    v_cvt_pk_bf16_f32 v114, v128, v132
    v_cvt_pk_bf16_f32 v115, v136, v140
    v_cvt_pk_bf16_f32 v116, v193, v197
    v_cvt_pk_bf16_f32 v117, v201, v205
    v_cvt_pk_bf16_f32 v118, v129, v133
    v_cvt_pk_bf16_f32 v119, v137, v141
    v_cvt_pk_bf16_f32 v120, v194, v198
    v_cvt_pk_bf16_f32 v121, v202, v206
    v_cvt_pk_bf16_f32 v122, v130, v134
    v_cvt_pk_bf16_f32 v123, v138, v142
    v_exp_f32 v218, v218
    v_exp_f32 v219, v219
    v_exp_f32_e64 v220, v220
    ds_write_b128 v255, v[112:115] offset:5120
    s_waitcnt lgkmcnt(2)
    buffer_store_dwordx4 a[92:95], v254, s[24:27], s85 offen offset:3072 sc1
    v_cvt_pk_bf16_f32 v112, v195, v199
    v_cvt_pk_bf16_f32 v113, v203, v207
    v_cvt_pk_bf16_f32 v114, v131, v135
    v_cvt_pk_bf16_f32 v115, v139, v143
    v_cvt_pk_bf16_f32 v225, v218, v219
    v_mfma_f32_16x16x32_bf16 v[216:219], a[144:147], a[16:19], v[240:243]
    ds_write_b128 v255, v[116:119] offset:5440
    v_mfma_f32_16x16x32_bf16 v[216:219], a[148:151], a[20:23], v[216:219]
    v_exp_f32 v221, v221
    v_mfma_f32_16x16x32_bf16 v[216:219], a[152:155], a[24:27], v[216:219]
    ds_write_b128 v255, v[120:123] offset:5760
    v_mfma_f32_16x16x32_bf16 v[216:219], a[156:159], a[28:31], v[216:219]
    v_cvt_pk_bf16_f32 v226, v220, v221
    v_exp_f32 v222, v222
    v_exp_f32 v223, v223
    v_exp_f32 v208, v208
    v_cvt_pk_bf16_f32 v227, v222, v223
    v_mfma_f32_16x16x32_bf16 v[220:223], a[172:175], a[28:31], v[240:243]
    ds_write_b128 v255, v[112:115] offset:6080
    v_mfma_f32_16x16x32_bf16 v[0:3], v[224:227], a[176:179], v[0:3]
    ds_read_b64_tr_b16 a[96:97], v127 offset:5120
    v_mov_b32_dpp v250, v250 row_ror:4 row_mask:0xf bank_mask:0xf
    v_mfma_f32_16x16x32_bf16 v[8:11], v[224:227], a[192:195], v[8:11]
    ds_read_b64_tr_b16 a[98:99], v127 offset:5184
    v_mov_b32_dpp v251, v251 row_ror:4 row_mask:0xf bank_mask:0xf
    v_mfma_f32_16x16x32_bf16 v[16:19], v[224:227], a[208:211], v[16:19]
    ds_read_b64_tr_b16 a[100:101], v127 offset:6400
    v_mov_b32 v232, 0
    v_mfma_f32_16x16x32_bf16 v[24:27], v[224:227], a[224:227], v[24:27]
    ds_read_b64_tr_b16 a[102:103], v127 offset:6464
    v_mov_b32 v233, 0
    v_mfma_f32_16x16x32_bf16 v[220:223], a[168:171], a[24:27], v[220:223]
    ds_read_b64_tr_b16 a[104:105], v127 offset:7680
    v_mov_b32 v234, 0
    v_mfma_f32_16x16x32_bf16 v[220:223], a[164:167], a[20:23], v[220:223]
    ds_read_b64_tr_b16 a[106:107], v127 offset:7744
    v_mov_b32 v235, 0
    v_mfma_f32_16x16x32_bf16 v[220:223], a[160:163], a[16:19], v[220:223]
    v_exp_f32 v209, v209
    v_exp_f32 v210, v210
    v_cvt_pk_bf16_f32 v228, v208, v209
    v_exp_f32 v211, v211
    v_exp_f32 v212, v212
    v_cvt_pk_bf16_f32 v229, v210, v211
    v_mfma_f32_16x16x32_bf16 v[208:211], a[144:147], a[32:35], v[240:243]
    v_exp_f32 v213, v213
    v_mfma_f32_16x16x32_bf16 v[208:211], a[148:151], a[36:39], v[208:211]
    ds_read_b64_tr_b16 a[108:109], v127 offset:8960
    s_waitcnt lgkmcnt(5)
    buffer_store_dwordx4 a[96:99], v254, s[24:27], s86 offen offset:0 sc1
    v_mfma_f32_16x16x32_bf16 v[208:211], a[152:155], a[40:43], v[208:211]
    ds_read_b64_tr_b16 a[110:111], v127 offset:9024
    v_cvt_pk_bf16_f32 v230, v212, v213
    v_mfma_f32_16x16x32_bf16 v[208:211], a[156:159], a[44:47], v[208:211]
    v_exp_f32 v214, v214
    v_exp_f32 v215, v215
    v_exp_f32 v216, v216
    v_cvt_pk_bf16_f32 v231, v214, v215
    v_mfma_f32_16x16x32_bf16 v[212:215], a[172:175], a[44:47], v[240:243]
    s_waitcnt lgkmcnt(4)
    buffer_store_dwordx4 a[100:103], v254, s[24:27], s86 offen offset:1024 sc1
    v_smfmac_f32_16x16x64_bf16 v[244:247], v[248:251], v[224:231], v240
    v_exp_f32 v217, v217
    ds_read_b128 a[144:147], v252 offset:8448
    v_mfma_f32_16x16x32_bf16 v[0:3], v[228:231], a[180:183], v[0:3]
    ds_read_b128 a[148:151], v252 offset:8512
    v_cvt_pk_bf16_f32 v236, v216, v217
    v_mfma_f32_16x16x32_bf16 v[4:7], v[228:231], a[188:191], v[4:7]
    s_waitcnt lgkmcnt(4)
    buffer_store_dwordx4 a[104:107], v254, s[24:27], s86 offen offset:2048 sc1
    v_mfma_f32_16x16x32_bf16 v[4:7], v[224:227], a[184:187], v[4:7]
    ds_read_b128 a[152:155], v252 offset:8576
    v_add_f32 v99, v244, v245
    v_mfma_f32_16x16x32_bf16 v[8:11], v[228:231], a[196:199], v[8:11]
    ds_read_b128 a[156:159], v252 offset:8640
    v_mov_b32 v98, v99
    v_mfma_f32_16x16x32_bf16 v[12:15], v[228:231], a[204:207], v[12:15]
    ds_read_b128 a[172:175], v252 offset:9152
    v_permlane32_swap_b32 v99, v98
    v_mfma_f32_16x16x32_bf16 v[12:15], v[224:227], a[200:203], v[12:15]
    s_waitcnt lgkmcnt(5)
    buffer_store_dwordx4 a[108:111], v254, s[24:27], s86 offen offset:3072 sc1
    v_mfma_f32_16x16x32_bf16 v[16:19], v[228:231], a[212:215], v[16:19]
    v_mov_b32 v98, v99
    v_mov_b32_dpp v248, v248 row_ror:2 row_mask:0xf bank_mask:0xf
    v_mfma_f32_16x16x32_bf16 v[20:23], v[228:231], a[220:223], v[20:23]
    v_permlane16_swap_b32 v99, v98
    v_mov_b32_dpp v249, v249 row_ror:2 row_mask:0xf bank_mask:0xf
    v_mfma_f32_16x16x32_bf16 v[20:23], v[224:227], a[216:219], v[20:23]
    v_rcp_f32 v99, v99
    v_mfma_f32_16x16x32_bf16 v[24:27], v[228:231], a[228:231], v[24:27]
    s_nop 0
    v_mov_b32_dpp v99, v99 row_ror:12 row_mask:0x2 bank_mask:0xf
    v_mov_b32_dpp v250, v250 row_ror:2 row_mask:0xf bank_mask:0xf
    v_mfma_f32_16x16x32_bf16 v[28:31], v[228:231], a[236:239], v[28:31]
    v_mov_b32_dpp v99, v99 row_ror:8 row_mask:0x4 bank_mask:0xf
    v_mov_b32_dpp v251, v251 row_ror:2 row_mask:0xf bank_mask:0xf
    v_mfma_f32_16x16x32_bf16 v[28:31], v[224:227], a[232:235], v[28:31]
    v_exp_f32_e64 v218, v218
    v_mfma_f32_16x16x32_bf16 v[212:215], a[168:171], a[40:43], v[212:215]
    ds_read_b128 a[168:171], v252 offset:9088
    v_mov_b32_dpp v99, v99 row_ror:4 row_mask:0x8 bank_mask:0xf
    v_mfma_f32_16x16x32_bf16 v[212:215], a[164:167], a[36:39], v[212:215]
    ds_read_b128 a[164:167], v252 offset:9024
    v_mov_b32_dpp v96, v99 row_newbcast:0 row_mask:0xf bank_mask:0xf
    v_mfma_f32_16x16x32_bf16 v[212:215], a[160:163], a[32:35], v[212:215]
    ds_read_b128 a[160:163], v252 offset:8960
    v_mov_b32_dpp v97, v99 row_newbcast:1 row_mask:0xf bank_mask:0xf
    v_mov_b32_dpp v98, v99 row_newbcast:2 row_mask:0xf bank_mask:0xf
    v_mov_b32_dpp v99, v99 row_newbcast:3 row_mask:0xf bank_mask:0xf
    v_mul_f32 v100, v100, v96
    v_mul_f32 v101, v101, v97
    v_mul_f32 v102, v102, v98
    v_mul_f32 v103, v103, v99
    v_pk_fma_f32 v[0:1], v[0:1], v[96:97], v[100:101] neg_lo:[0,0,1] neg_hi:[0,0,1]
    v_pk_fma_f32 v[2:3], v[2:3], v[98:99], v[102:103] neg_lo:[0,0,1] neg_hi:[0,0,1]
    v_pk_fma_f32 v[4:5], v[4:5], v[96:97], v[100:101] neg_lo:[0,0,1] neg_hi:[0,0,1]
    v_pk_fma_f32 v[6:7], v[6:7], v[98:99], v[102:103] neg_lo:[0,0,1] neg_hi:[0,0,1]
    v_pk_fma_f32 v[8:9], v[8:9], v[96:97], v[100:101] neg_lo:[0,0,1] neg_hi:[0,0,1]
    v_pk_fma_f32 v[10:11], v[10:11], v[98:99], v[102:103] neg_lo:[0,0,1] neg_hi:[0,0,1]
    v_pk_fma_f32 v[12:13], v[12:13], v[96:97], v[100:101] neg_lo:[0,0,1] neg_hi:[0,0,1]
    v_pk_fma_f32 v[14:15], v[14:15], v[98:99], v[102:103] neg_lo:[0,0,1] neg_hi:[0,0,1]
    v_pk_fma_f32 v[16:17], v[16:17], v[96:97], v[100:101] neg_lo:[0,0,1] neg_hi:[0,0,1]
    v_pk_fma_f32 v[18:19], v[18:19], v[98:99], v[102:103] neg_lo:[0,0,1] neg_hi:[0,0,1]
    v_pk_fma_f32 v[20:21], v[20:21], v[96:97], v[100:101] neg_lo:[0,0,1] neg_hi:[0,0,1]
    v_pk_fma_f32 v[22:23], v[22:23], v[98:99], v[102:103] neg_lo:[0,0,1] neg_hi:[0,0,1]
    v_pk_fma_f32 v[24:25], v[24:25], v[96:97], v[100:101] neg_lo:[0,0,1] neg_hi:[0,0,1]
    v_pk_fma_f32 v[26:27], v[26:27], v[98:99], v[102:103] neg_lo:[0,0,1] neg_hi:[0,0,1]
    v_pk_fma_f32 v[28:29], v[28:29], v[96:97], v[100:101] neg_lo:[0,0,1] neg_hi:[0,0,1]
    v_pk_fma_f32 v[30:31], v[30:31], v[98:99], v[102:103] neg_lo:[0,0,1] neg_hi:[0,0,1]
    v_cvt_pk_bf16_f32 v112, v0, v4
    v_cvt_pk_bf16_f32 v113, v8, v12
    v_cvt_pk_bf16_f32 v114, v16, v20
    v_cvt_pk_bf16_f32 v115, v24, v28
    v_cvt_pk_bf16_f32 v116, v1, v5
    v_cvt_pk_bf16_f32 v117, v9, v13
    v_cvt_pk_bf16_f32 v118, v17, v21
    v_cvt_pk_bf16_f32 v119, v25, v29
    v_cvt_pk_bf16_f32 v120, v2, v6
    v_cvt_pk_bf16_f32 v121, v10, v14
    v_cvt_pk_bf16_f32 v122, v18, v22
    v_cvt_pk_bf16_f32 v123, v26, v30
    ds_read_b128 v[100:103], v126 offset:128
    ds_write_b128 v255, v[112:115] offset:0
    s_nop 1
    v_cvt_pk_bf16_f32 v112, v3, v7
    v_cvt_pk_bf16_f32 v113, v11, v15
    v_cvt_pk_bf16_f32 v114, v19, v23
    v_cvt_pk_bf16_f32 v115, v27, v31
    v_exp_f32 v219, v219
    v_exp_f32 v220, v220
    v_cvt_pk_bf16_f32 v237, v218, v219
    v_mfma_f32_16x16x32_bf16 v[216:219], a[112:115], a[16:19], v[240:243]
    ds_write_b128 v255, v[116:119] offset:320
    v_mfma_f32_16x16x32_bf16 v[216:219], a[116:119], a[20:23], v[216:219]
    v_exp_f32 v221, v221
    v_mfma_f32_16x16x32_bf16 v[216:219], a[120:123], a[24:27], v[216:219]
    ds_write_b128 v255, v[120:123] offset:640
    v_mfma_f32_16x16x32_bf16 v[216:219], a[124:127], a[28:31], v[216:219]
    v_cvt_pk_bf16_f32 v238, v220, v221
    v_exp_f32 v222, v222
    v_exp_f32 v223, v223
    v_exp_f32 v208, v208
    v_cvt_pk_bf16_f32 v239, v222, v223
    v_mfma_f32_16x16x32_bf16 v[220:223], a[140:143], a[28:31], v[240:243]
    ds_write_b128 v255, v[112:115] offset:960
    v_smfmac_f32_16x16x64_bf16 v[244:247], v[248:251], v[232:239], v240
    ds_read_b64_tr_b16 a[0:1], v127 offset:0
    v_mov_b32 v224, 0
    v_exp_f32 v209, v209
    v_mfma_f32_16x16x32_bf16 v[32:35], v[236:239], a[180:183], v[32:35]
    ds_read_b64_tr_b16 a[2:3], v127 offset:64
    v_cvt_pk_bf16_f32 v228, v208, v209
    v_mfma_f32_16x16x32_bf16 v[220:223], a[136:139], a[24:27], v[220:223]
    ds_read_b64_tr_b16 a[4:5], v127 offset:1280
    v_mov_b32_dpp v248, v248 row_ror:2 row_mask:0xf bank_mask:0xf
    v_mfma_f32_16x16x32_bf16 v[36:39], v[236:239], a[188:191], v[36:39]
    ds_read_b64_tr_b16 a[6:7], v127 offset:1344
    v_mov_b32_dpp v249, v249 row_ror:2 row_mask:0xf bank_mask:0xf
    v_mfma_f32_16x16x32_bf16 v[220:223], a[132:135], a[20:23], v[220:223]
    ds_read_b64_tr_b16 a[8:9], v127 offset:2560
    v_mov_b32_dpp v250, v250 row_ror:2 row_mask:0xf bank_mask:0xf
    v_mfma_f32_16x16x32_bf16 v[40:43], v[236:239], a[196:199], v[40:43]
    ds_read_b64_tr_b16 a[10:11], v127 offset:2624
    v_mov_b32_dpp v251, v251 row_ror:2 row_mask:0xf bank_mask:0xf
    v_mfma_f32_16x16x32_bf16 v[220:223], a[128:131], a[16:19], v[220:223]
    ds_read_b64_tr_b16 a[12:13], v127 offset:3840
    v_mov_b32 v225, 0
    v_mfma_f32_16x16x32_bf16 v[44:47], v[236:239], a[204:207], v[44:47]
    ds_read_b64_tr_b16 a[14:15], v127 offset:3904
    v_mov_b32 v226, 0
    v_mfma_f32_16x16x32_bf16 v[48:51], v[236:239], a[212:215], v[48:51]
    v_exp_f32 v210, v210
    v_mfma_f32_16x16x32_bf16 v[52:55], v[236:239], a[220:223], v[52:55]
    v_exp_f32 v211, v211
    v_mfma_f32_16x16x32_bf16 v[56:59], v[236:239], a[228:231], v[56:59]
    s_waitcnt lgkmcnt(6)
    buffer_store_dwordx4 a[0:3], v254, s[24:27], s80 offen offset:0 sc1
    v_mfma_f32_16x16x32_bf16 v[60:63], v[236:239], a[236:239], v[60:63]
    v_cvt_pk_bf16_f32 v229, v210, v211
    v_mov_b32 v227, 0
    v_mfma_f32_16x16x32_bf16 v[208:211], a[144:147], a[16:19], v[240:243]
    v_exp_f32 v212, v212
    v_mfma_f32_16x16x32_bf16 v[208:211], a[148:151], a[20:23], v[208:211]
    v_exp_f32 v213, v213
    v_mfma_f32_16x16x32_bf16 v[208:211], a[152:155], a[24:27], v[208:211]
    s_waitcnt lgkmcnt(4)
    buffer_store_dwordx4 a[4:7], v254, s[24:27], s80 offen offset:1024 sc1
    v_mfma_f32_16x16x32_bf16 v[208:211], a[156:159], a[28:31], v[208:211]
    v_cvt_pk_bf16_f32 v230, v212, v213
    v_exp_f32 v214, v214
    v_exp_f32 v215, v215
    v_exp_f32 v216, v216
    v_cvt_pk_bf16_f32 v231, v214, v215
    v_mfma_f32_16x16x32_bf16 v[212:215], a[172:175], a[28:31], v[240:243]
    v_exp_f32 v217, v217
    v_mfma_f32_16x16x32_bf16 v[212:215], a[168:171], a[24:27], v[212:215]
    s_waitcnt lgkmcnt(2)
    buffer_store_dwordx4 a[8:11], v254, s[24:27], s80 offen offset:2048 sc1
    v_mfma_f32_16x16x32_bf16 v[212:215], a[164:167], a[20:23], v[212:215]
    v_exp_f32 v218, v218
    v_mfma_f32_16x16x32_bf16 v[212:215], a[160:163], a[16:19], v[212:215]
    v_exp_f32 v219, v219
    v_mfma_f32_16x16x32_bf16 v[64:67], v[228:231], a[180:183], v[64:67]
    ds_read_b64_tr_b16 a[180:181], v253 offset:8320
    v_cvt_pk_bf16_f32 v232, v216, v217
    v_mfma_f32_16x16x32_bf16 v[68:71], v[228:231], a[188:191], v[68:71]
    s_waitcnt lgkmcnt(1)
    buffer_store_dwordx4 a[12:15], v254, s[24:27], s80 offen offset:3072 sc1
    v_smfmac_f32_16x16x64_bf16 v[244:247], v[248:251], v[224:231], v240
    ds_read_b64_tr_b16 a[182:183], v253 offset:8832
    v_cvt_pk_bf16_f32 v233, v218, v219
    v_exp_f32 v220, v220
    v_mfma_f32_16x16x32_bf16 v[72:75], v[228:231], a[196:199], v[72:75]
    ds_read_b64_tr_b16 a[188:189], v253 offset:8336
    v_mov_b32_dpp v248, v248 row_ror:14 row_mask:0xf bank_mask:0xf
    v_mfma_f32_16x16x32_bf16 v[76:79], v[228:231], a[204:207], v[76:79]
    ds_read_b64_tr_b16 a[190:191], v253 offset:8848
    v_mov_b32_dpp v249, v249 row_ror:14 row_mask:0xf bank_mask:0xf
    v_mfma_f32_16x16x32_bf16 v[80:83], v[228:231], a[212:215], v[80:83]
    ds_read_b64_tr_b16 a[196:197], v253 offset:8352
    v_mov_b32_dpp v250, v250 row_ror:14 row_mask:0xf bank_mask:0xf
    v_mfma_f32_16x16x32_bf16 v[84:87], v[228:231], a[220:223], v[84:87]
    ds_read_b64_tr_b16 a[198:199], v253 offset:8864
    v_mov_b32_dpp v251, v251 row_ror:14 row_mask:0xf bank_mask:0xf
    v_mfma_f32_16x16x32_bf16 v[88:91], v[228:231], a[228:231], v[88:91]
    v_exp_f32 v221, v221
    v_mfma_f32_16x16x32_bf16 v[92:95], v[228:231], a[236:239], v[92:95]
    ds_read_b64_tr_b16 a[204:205], v253 offset:8368
    v_cvt_pk_bf16_f32 v234, v220, v221
    v_mfma_f32_16x16x32_bf16 v[216:219], a[112:115], a[32:35], v[240:243]
    v_exp_f32 v222, v222
    v_mfma_f32_16x16x32_bf16 v[216:219], a[116:119], a[36:39], v[216:219]
    v_exp_f32 v223, v223
    v_mfma_f32_16x16x32_bf16 v[216:219], a[120:123], a[40:43], v[216:219]
    ds_read_b64_tr_b16 a[206:207], v253 offset:8880
    v_cvt_pk_bf16_f32 v235, v222, v223
    v_mfma_f32_16x16x32_bf16 v[216:219], a[124:127], a[44:47], v[216:219]
    v_exp_f32 v208, v208
    v_mfma_f32_16x16x32_bf16 v[32:35], v[232:235], a[176:179], v[32:35]
    v_exp_f32 v209, v209
    v_mfma_f32_16x16x32_bf16 v[40:43], v[232:235], a[192:195], v[40:43]
    ds_read_b64_tr_b16 a[212:213], v253 offset:8384
    v_cvt_pk_bf16_f32 v236, v208, v209
    v_mfma_f32_16x16x32_bf16 v[48:51], v[232:235], a[208:211], v[48:51]
    v_exp_f32 v210, v210
    v_mfma_f32_16x16x32_bf16 v[56:59], v[232:235], a[224:227], v[56:59]
    v_exp_f32 v211, v211
    v_mfma_f32_16x16x32_bf16 v[220:223], a[140:143], a[44:47], v[240:243]
    ds_read_b64_tr_b16 a[214:215], v253 offset:8896
    v_cvt_pk_bf16_f32 v237, v210, v211
    v_mfma_f32_16x16x32_bf16 v[220:223], a[136:139], a[40:43], v[220:223]
    v_exp_f32 v212, v212
    v_mfma_f32_16x16x32_bf16 v[220:223], a[132:135], a[36:39], v[220:223]
    v_exp_f32 v213, v213
    v_mfma_f32_16x16x32_bf16 v[220:223], a[128:131], a[32:35], v[220:223]
    ds_read_b64_tr_b16 a[220:221], v253 offset:8400
    v_cvt_pk_bf16_f32 v238, v212, v213
    v_mfma_f32_16x16x32_bf16 v[208:211], a[144:147], a[32:35], v[240:243]
    v_exp_f32 v214, v214
    v_mfma_f32_16x16x32_bf16 v[208:211], a[148:151], a[36:39], v[208:211]
    v_exp_f32 v215, v215
    v_mfma_f32_16x16x32_bf16 v[208:211], a[152:155], a[40:43], v[208:211]
    ds_read_b64_tr_b16 a[222:223], v253 offset:8912
    v_cvt_pk_bf16_f32 v239, v214, v215
    v_mfma_f32_16x16x32_bf16 v[208:211], a[156:159], a[44:47], v[208:211]
    s_waitcnt lgkmcnt(10)
    v_exp_f32 v216, v216
    v_mfma_f32_16x16x32_bf16 v[32:35], v[236:239], a[180:183], v[32:35]
    s_waitcnt lgkmcnt(8)
    v_exp_f32 v217, v217
    v_mfma_f32_16x16x32_bf16 v[36:39], v[236:239], a[188:191], v[36:39]
    ds_read_b64_tr_b16 a[228:229], v253 offset:8416
    v_cvt_pk_bf16_f32 v224, v216, v217
    v_mfma_f32_16x16x32_bf16 v[36:39], v[232:235], a[184:187], v[36:39]
    ds_read_b64_tr_b16 a[230:231], v253 offset:8928
    v_smfmac_f32_16x16x64_bf16 v[244:247], v[248:251], v[232:239], v240
    s_waitcnt lgkmcnt(8)
    ds_read_b64_tr_b16 a[236:237], v253 offset:8432
    v_mfma_f32_16x16x32_bf16 v[40:43], v[236:239], a[196:199], v[40:43]
    s_waitcnt lgkmcnt(7)
    ds_read_b64_tr_b16 a[238:239], v253 offset:8944
    v_mov_b32_dpp v248, v248 row_ror:2 row_mask:0xf bank_mask:0xf
    v_mfma_f32_16x16x32_bf16 v[44:47], v[236:239], a[204:207], v[44:47]
    v_exp_f32 v218, v218
    v_mfma_f32_16x16x32_bf16 v[44:47], v[232:235], a[200:203], v[44:47]
    s_waitcnt lgkmcnt(6)
    v_add_f32 v107, v246, v247
    v_mov_b32 v106, v107
    v_mfma_f32_16x16x32_bf16 v[48:51], v[236:239], a[212:215], v[48:51]
    s_waitcnt lgkmcnt(4)
    v_permlane32_swap_b32 v107, v106
    v_mov_b32 v106, v107
    v_mfma_f32_16x16x32_bf16 v[52:55], v[236:239], a[220:223], v[52:55]
    s_nop 0
    v_permlane16_swap_b32 v107, v106
    v_mov_b32_dpp v249, v249 row_ror:2 row_mask:0xf bank_mask:0xf
    v_mfma_f32_16x16x32_bf16 v[52:55], v[232:235], a[216:219], v[52:55]
    v_rcp_f32 v107, v107
    v_mfma_f32_16x16x32_bf16 v[212:215], a[172:175], a[44:47], v[240:243]
    s_nop 0
    v_mov_b32_dpp v107, v107 row_ror:12 row_mask:0x2 bank_mask:0xf
    v_mov_b32_dpp v250, v250 row_ror:2 row_mask:0xf bank_mask:0xf
    v_mfma_f32_16x16x32_bf16 v[212:215], a[168:171], a[40:43], v[212:215]
    s_waitcnt lgkmcnt(2)
    v_mov_b32_dpp v107, v107 row_ror:8 row_mask:0x4 bank_mask:0xf
    v_mov_b32_dpp v251, v251 row_ror:2 row_mask:0xf bank_mask:0xf
    v_mfma_f32_16x16x32_bf16 v[56:59], v[236:239], a[228:231], v[56:59]
    v_exp_f32 v219, v219
    v_mfma_f32_16x16x32_bf16 v[212:215], a[164:167], a[36:39], v[212:215]
    s_waitcnt lgkmcnt(0)
    v_mov_b32_dpp v107, v107 row_ror:4 row_mask:0x8 bank_mask:0xf
    v_cvt_pk_bf16_f32 v225, v218, v219
    v_mfma_f32_16x16x32_bf16 v[60:63], v[236:239], a[236:239], v[60:63]
    v_mov_b32_dpp v104, v107 row_newbcast:0 row_mask:0xf bank_mask:0xf
    v_mov_b32_dpp v105, v107 row_newbcast:1 row_mask:0xf bank_mask:0xf
    v_mfma_f32_16x16x32_bf16 v[60:63], v[232:235], a[232:235], v[60:63]
    v_mov_b32_dpp v106, v107 row_newbcast:2 row_mask:0xf bank_mask:0xf
    v_mov_b32_dpp v107, v107 row_newbcast:3 row_mask:0xf bank_mask:0xf
    v_mfma_f32_16x16x32_bf16 v[212:215], a[160:163], a[32:35], v[212:215]
    v_mul_f32 v108, v108, v104
    v_mul_f32 v109, v109, v105
    v_mul_f32 v110, v110, v106
    v_mul_f32 v111, v111, v107
    v_pk_fma_f32 v[32:33], v[32:33], v[104:105], v[108:109] neg_lo:[0,0,1] neg_hi:[0,0,1]
    v_pk_fma_f32 v[34:35], v[34:35], v[106:107], v[110:111] neg_lo:[0,0,1] neg_hi:[0,0,1]
    v_pk_fma_f32 v[36:37], v[36:37], v[104:105], v[108:109] neg_lo:[0,0,1] neg_hi:[0,0,1]
    v_pk_fma_f32 v[38:39], v[38:39], v[106:107], v[110:111] neg_lo:[0,0,1] neg_hi:[0,0,1]
    v_pk_fma_f32 v[40:41], v[40:41], v[104:105], v[108:109] neg_lo:[0,0,1] neg_hi:[0,0,1]
    v_pk_fma_f32 v[42:43], v[42:43], v[106:107], v[110:111] neg_lo:[0,0,1] neg_hi:[0,0,1]
    v_pk_fma_f32 v[44:45], v[44:45], v[104:105], v[108:109] neg_lo:[0,0,1] neg_hi:[0,0,1]
    v_pk_fma_f32 v[46:47], v[46:47], v[106:107], v[110:111] neg_lo:[0,0,1] neg_hi:[0,0,1]
    v_pk_fma_f32 v[48:49], v[48:49], v[104:105], v[108:109] neg_lo:[0,0,1] neg_hi:[0,0,1]
    v_pk_fma_f32 v[50:51], v[50:51], v[106:107], v[110:111] neg_lo:[0,0,1] neg_hi:[0,0,1]
    v_pk_fma_f32 v[52:53], v[52:53], v[104:105], v[108:109] neg_lo:[0,0,1] neg_hi:[0,0,1]
    v_pk_fma_f32 v[54:55], v[54:55], v[106:107], v[110:111] neg_lo:[0,0,1] neg_hi:[0,0,1]
    v_pk_fma_f32 v[56:57], v[56:57], v[104:105], v[108:109] neg_lo:[0,0,1] neg_hi:[0,0,1]
    v_pk_fma_f32 v[58:59], v[58:59], v[106:107], v[110:111] neg_lo:[0,0,1] neg_hi:[0,0,1]
    v_pk_fma_f32 v[60:61], v[60:61], v[104:105], v[108:109] neg_lo:[0,0,1] neg_hi:[0,0,1]
    v_pk_fma_f32 v[62:63], v[62:63], v[106:107], v[110:111] neg_lo:[0,0,1] neg_hi:[0,0,1]
    v_cvt_pk_bf16_f32 v112, v32, v36
    v_cvt_pk_bf16_f32 v113, v40, v44
    v_cvt_pk_bf16_f32 v114, v48, v52
    v_cvt_pk_bf16_f32 v115, v56, v60
    v_cvt_pk_bf16_f32 v116, v33, v37
    v_cvt_pk_bf16_f32 v117, v41, v45
    v_cvt_pk_bf16_f32 v118, v49, v53
    v_cvt_pk_bf16_f32 v119, v57, v61
    v_cvt_pk_bf16_f32 v120, v34, v38
    v_cvt_pk_bf16_f32 v121, v42, v46
    v_cvt_pk_bf16_f32 v122, v50, v54
    v_cvt_pk_bf16_f32 v123, v58, v62
    v_exp_f32 v220, v220
    v_exp_f32 v221, v221
    v_exp_f32 v222, v222
    ds_write_b128 v255, v[112:115] offset:5120
    s_nop 1
    v_cvt_pk_bf16_f32 v112, v35, v39
    v_cvt_pk_bf16_f32 v113, v43, v47
    v_cvt_pk_bf16_f32 v114, v51, v55
    v_cvt_pk_bf16_f32 v115, v59, v63
    v_cvt_pk_bf16_f32 v226, v220, v221
    v_exp_f32 v223, v223
    v_exp_f32 v208, v208
    v_cvt_pk_bf16_f32 v227, v222, v223
    v_exp_f32 v209, v209
    s_nop 0
    v_mfma_f32_16x16x32_bf16 v[64:67], v[224:227], a[176:179], v[64:67]
    ds_write_b128 v255, v[116:119] offset:5440
    v_mfma_f32_16x16x32_bf16 v[72:75], v[224:227], a[192:195], v[72:75]
    v_exp_f32 v210, v210
    v_mfma_f32_16x16x32_bf16 v[80:83], v[224:227], a[208:211], v[80:83]
    ds_write_b128 v255, v[120:123] offset:5760
    v_mfma_f32_16x16x32_bf16 v[88:91], v[224:227], a[224:227], v[88:91]
    v_cvt_pk_bf16_f32 v228, v208, v209
    v_exp_f32 v211, v211
    v_exp_f32 v212, v212
    v_cvt_pk_bf16_f32 v229, v210, v211
    v_exp_f32 v213, v213
    v_exp_f32 v214, v214
    v_cvt_pk_bf16_f32 v230, v212, v213
    v_exp_f32 v215, v215
    s_nop 0
    v_cvt_pk_bf16_f32 v231, v214, v215
    s_nop 1
    v_smfmac_f32_16x16x64_bf16 v[244:247], v[248:251], v[224:231], v240
    ds_write_b128 v255, v[112:115] offset:6080
    v_mfma_f32_16x16x32_bf16 v[64:67], v[228:231], a[180:183], v[64:67]
    ds_read_b64_tr_b16 a[16:17], v127 offset:5120
    s_nop 4
    v_add_f32 v99, v244, v245
    v_mfma_f32_16x16x32_bf16 v[68:71], v[228:231], a[188:191], v[68:71]
    ds_read_b64_tr_b16 a[18:19], v127 offset:5184
    v_mov_b32 v98, v99
    v_mfma_f32_16x16x32_bf16 v[68:71], v[224:227], a[184:187], v[68:71]
    ds_read_b64_tr_b16 a[20:21], v127 offset:6400
    v_permlane32_swap_b32 v99, v98
    v_mfma_f32_16x16x32_bf16 v[72:75], v[228:231], a[196:199], v[72:75]
    ds_read_b64_tr_b16 a[22:23], v127 offset:6464
    v_mov_b32 v98, v99
    v_mfma_f32_16x16x32_bf16 v[76:79], v[228:231], a[204:207], v[76:79]
    ds_read_b64_tr_b16 a[24:25], v127 offset:7680
    v_permlane16_swap_b32 v99, v98
    v_mfma_f32_16x16x32_bf16 v[76:79], v[224:227], a[200:203], v[76:79]
    ds_read_b64_tr_b16 a[26:27], v127 offset:7744
    v_add_f32 v248, v244, v245
    v_mfma_f32_16x16x32_bf16 v[80:83], v[228:231], a[212:215], v[80:83]
    ds_read_b64_tr_b16 a[28:29], v127 offset:8960
    v_add_f32 v249, v246, v247
    v_mfma_f32_16x16x32_bf16 v[84:87], v[228:231], a[220:223], v[84:87]
    ds_read_b64_tr_b16 a[30:31], v127 offset:9024
    v_max_u32 v250, v248, v249
    v_mfma_f32_16x16x32_bf16 v[84:87], v[224:227], a[216:219], v[84:87]
    v_rcp_f32_e64 v99, v98
    v_mfma_f32_16x16x32_bf16 v[88:91], v[228:231], a[228:231], v[88:91]
    s_nop 0
    v_mov_b32_dpp v99, v99 row_ror:12 row_mask:0x2 bank_mask:0xf
    v_min_u32 v251, v248, v249
    v_mfma_f32_16x16x32_bf16 v[92:95], v[228:231], a[236:239], v[92:95]
    s_waitcnt lgkmcnt(6)
    buffer_store_dwordx4 a[16:19], v254, s[24:27], s81 offen offset:0 sc1
    v_mfma_f32_16x16x32_bf16 v[92:95], v[224:227], a[232:235], v[92:95]
    v_mov_b32_dpp v99, v99 row_ror:8 row_mask:0x4 bank_mask:0xf
    s_nop 1
    v_mov_b32_dpp v99, v99 row_ror:4 row_mask:0x8 bank_mask:0xf
    s_nop 1
    v_mov_b32_dpp v96, v99 row_newbcast:0 row_mask:0xf bank_mask:0xf
    v_mov_b32_dpp v97, v99 row_newbcast:1 row_mask:0xf bank_mask:0xf
    v_mov_b32_dpp v98, v99 row_newbcast:2 row_mask:0xf bank_mask:0xf
    v_mov_b32_dpp v99, v99 row_newbcast:3 row_mask:0xf bank_mask:0xf
    v_mul_f32 v100, v100, v96
    v_mul_f32 v101, v101, v97
    v_mul_f32 v102, v102, v98
    v_mul_f32 v103, v103, v99
    v_pk_fma_f32 v[64:65], v[64:65], v[96:97], v[100:101] neg_lo:[0,0,1] neg_hi:[0,0,1]
    v_pk_fma_f32 v[66:67], v[66:67], v[98:99], v[102:103] neg_lo:[0,0,1] neg_hi:[0,0,1]
    v_pk_fma_f32 v[68:69], v[68:69], v[96:97], v[100:101] neg_lo:[0,0,1] neg_hi:[0,0,1]
    v_pk_fma_f32 v[70:71], v[70:71], v[98:99], v[102:103] neg_lo:[0,0,1] neg_hi:[0,0,1]
    v_pk_fma_f32 v[72:73], v[72:73], v[96:97], v[100:101] neg_lo:[0,0,1] neg_hi:[0,0,1]
    v_pk_fma_f32 v[74:75], v[74:75], v[98:99], v[102:103] neg_lo:[0,0,1] neg_hi:[0,0,1]
    v_pk_fma_f32 v[76:77], v[76:77], v[96:97], v[100:101] neg_lo:[0,0,1] neg_hi:[0,0,1]
    v_pk_fma_f32 v[78:79], v[78:79], v[98:99], v[102:103] neg_lo:[0,0,1] neg_hi:[0,0,1]
    v_pk_fma_f32 v[80:81], v[80:81], v[96:97], v[100:101] neg_lo:[0,0,1] neg_hi:[0,0,1]
    v_pk_fma_f32 v[82:83], v[82:83], v[98:99], v[102:103] neg_lo:[0,0,1] neg_hi:[0,0,1]
    v_pk_fma_f32 v[84:85], v[84:85], v[96:97], v[100:101] neg_lo:[0,0,1] neg_hi:[0,0,1]
    v_pk_fma_f32 v[86:87], v[86:87], v[98:99], v[102:103] neg_lo:[0,0,1] neg_hi:[0,0,1]
    v_pk_fma_f32 v[88:89], v[88:89], v[96:97], v[100:101] neg_lo:[0,0,1] neg_hi:[0,0,1]
    v_pk_fma_f32 v[90:91], v[90:91], v[98:99], v[102:103] neg_lo:[0,0,1] neg_hi:[0,0,1]
    v_pk_fma_f32 v[92:93], v[92:93], v[96:97], v[100:101] neg_lo:[0,0,1] neg_hi:[0,0,1]
    v_pk_fma_f32 v[94:95], v[94:95], v[98:99], v[102:103] neg_lo:[0,0,1] neg_hi:[0,0,1]
    s_waitcnt lgkmcnt(4)
    buffer_store_dwordx4 a[20:23], v254, s[24:27], s81 offen offset:1024 sc1
    v_cvt_pk_bf16_f32 v112, v64, v68
    v_cvt_pk_bf16_f32 v113, v72, v76
    v_cvt_pk_bf16_f32 v114, v80, v84
    v_cvt_pk_bf16_f32 v115, v88, v92
    v_cvt_pk_bf16_f32 v116, v65, v69
    v_cvt_pk_bf16_f32 v117, v73, v77
    v_cvt_pk_bf16_f32 v118, v81, v85
    v_cvt_pk_bf16_f32 v119, v89, v93
    v_cvt_pk_bf16_f32 v120, v66, v70
    v_cvt_pk_bf16_f32 v121, v74, v78
    v_cvt_pk_bf16_f32 v122, v82, v86
    v_cvt_pk_bf16_f32 v123, v90, v94
    s_waitcnt lgkmcnt(2)
    buffer_store_dwordx4 a[24:27], v254, s[24:27], s81 offen offset:2048 sc1
    ds_write_b128 v255, v[112:115] offset:0
    s_nop 1
    v_cvt_pk_bf16_f32 v112, v67, v71
    v_cvt_pk_bf16_f32 v113, v75, v79
    v_cvt_pk_bf16_f32 v114, v83, v87
    v_cvt_pk_bf16_f32 v115, v91, v95
    ds_write_b128 v255, v[116:119] offset:320
    s_waitcnt lgkmcnt(2)
    buffer_store_dwordx4 a[28:31], v254, s[24:27], s81 offen offset:3072 sc1
    ds_write_b128 v255, v[120:123] offset:640
    ds_write_b128 v255, v[112:115] offset:960
    ds_read_b64_tr_b16 a[32:33], v127 offset:0
    ds_read_b64_tr_b16 a[34:35], v127 offset:64
    ds_read_b64_tr_b16 a[36:37], v127 offset:1280
    ds_read_b64_tr_b16 a[38:39], v127 offset:1344
    ds_read_b64_tr_b16 a[40:41], v127 offset:2560
    ds_read_b64_tr_b16 a[42:43], v127 offset:2624
    ds_read_b64_tr_b16 a[44:45], v127 offset:3840
    ds_read_b64_tr_b16 a[46:47], v127 offset:3904
    s_waitcnt lgkmcnt(6)
    buffer_store_dwordx4 a[32:35], v254, s[24:27], s82 offen offset:0 sc1
    s_waitcnt lgkmcnt(4)
    buffer_store_dwordx4 a[36:39], v254, s[24:27], s82 offen offset:1024 sc1
    s_waitcnt lgkmcnt(2)
    buffer_store_dwordx4 a[40:43], v254, s[24:27], s82 offen offset:2048 sc1
    s_waitcnt lgkmcnt(0)
    buffer_store_dwordx4 a[44:47], v254, s[24:27], s82 offen offset:3072 sc1
    v_cmp_le_u32 vcc, 0x4e800000, v250
    s_nop 3
    s_mov_b64 s[36:37], vcc
    v_cmp_ge_u32 vcc, 0x30800000, v251
    s_nop 3
    s_or_b64 s[36:37], s[36:37], vcc
    s_mov_b32 s73, 7
    s_cbranch_scc1 L_slow
    s_endpgm
L_wave_b:
    v_mov_b32 v244, 0
    v_mov_b32 v245, 0
    v_mov_b32 v246, 0
    v_mov_b32 v247, 0
    v_mov_b32 v248, 1.0
    s_nop 1
    v_mov_b32_dpp v244, v248 quad_perm:[0,1,2,3] row_mask:0x8 bank_mask:0xf
    v_mov_b32_dpp v246, v248 quad_perm:[0,1,2,3] row_mask:0x8 bank_mask:0xf
    v_bfe_u32 v248, v254, 5, 3
    v_cmp_eq_u32 vcc, 0, v248
    v_mov_b32 v251, 0x3f803f80
    s_nop 0
    v_cndmask_b32 v248, 0, v251, vcc
    v_cndmask_b32 v249, 0, v251, vcc
    v_cndmask_b32 v250, 0, v251, vcc
    v_cndmask_b32 v251, 0, v251, vcc
    s_waitcnt vmcnt(10)
    ds_read_b128 v[160:163], v62 offset:0
    ds_read_b128 v[164:167], v62 offset:64
    ds_read_b128 v[168:171], v62 offset:128
    ds_read_b128 v[172:175], v62 offset:192
    v_mov_b32_dpp v248, v248 row_ror:10 row_mask:0xf bank_mask:0xf
    v_mov_b32_dpp v249, v249 row_ror:10 row_mask:0xf bank_mask:0xf
    v_mov_b32_dpp v250, v250 row_ror:10 row_mask:0xf bank_mask:0xf
    v_mov_b32_dpp v251, v251 row_ror:10 row_mask:0xf bank_mask:0xf
    s_add_u32 m0, s77, 34816
    s_sub_u32 s36, s78, 20480
    s_waitcnt lgkmcnt(3)
    v_lshlrev_b32 v176, 16, v160
    v_and_b32 v177, s3, v160
    v_lshlrev_b32 v178, 16, v161
    v_and_b32 v179, s3, v161
    v_lshlrev_b32 v180, 16, v162
    v_and_b32 v181, s3, v162
    v_lshlrev_b32 v182, 16, v163
    v_and_b32_e64 v183, s3, v163
    v_pk_mul_f32 v[176:177], v[176:177], s[100:101]
    v_pk_mul_f32 v[178:179], v[178:179], s[100:101]
    v_pk_mul_f32 v[180:181], v[180:181], s[100:101]
    v_pk_mul_f32 v[182:183], v[182:183], s[100:101]
    v_cvt_pk_bf16_f32 v160, v176, v177
    v_accvgpr_write_b32 a80, v160
    v_cvt_pk_bf16_f32 v161, v178, v179
    v_accvgpr_write_b32 a81, v161
    v_cvt_pk_bf16_f32 v162, v180, v181
    v_accvgpr_write_b32 a82, v162
    v_cvt_pk_bf16_f32 v163, v182, v183
    v_accvgpr_write_b32 a83, v163
    s_waitcnt lgkmcnt(2)
    v_lshlrev_b32 v176, 16, v164
    v_and_b32 v177, s3, v164
    v_lshlrev_b32 v178, 16, v165
    v_and_b32 v179, s3, v165
    v_lshlrev_b32 v180, 16, v166
    v_and_b32 v181, s3, v166
    v_lshlrev_b32 v182, 16, v167
    v_and_b32_e64 v183, s3, v167
    v_pk_mul_f32 v[176:177], v[176:177], s[100:101]
    v_pk_mul_f32 v[178:179], v[178:179], s[100:101]
    v_pk_mul_f32 v[180:181], v[180:181], s[100:101]
    v_pk_mul_f32 v[182:183], v[182:183], s[100:101]
    v_cvt_pk_bf16_f32 v164, v176, v177
    v_accvgpr_write_b32 a84, v164
    v_cvt_pk_bf16_f32 v165, v178, v179
    v_accvgpr_write_b32 a85, v165
    v_cvt_pk_bf16_f32 v166, v180, v181
    v_accvgpr_write_b32 a86, v166
    v_cvt_pk_bf16_f32 v167, v182, v183
    v_accvgpr_write_b32 a87, v167
    s_waitcnt lgkmcnt(1)
    v_lshlrev_b32 v176, 16, v168
    v_and_b32 v177, s3, v168
    v_lshlrev_b32 v178, 16, v169
    v_and_b32 v179, s3, v169
    v_lshlrev_b32 v180, 16, v170
    v_and_b32 v181, s3, v170
    v_lshlrev_b32 v182, 16, v171
    v_and_b32_e64 v183, s3, v171
    v_pk_mul_f32 v[176:177], v[176:177], s[100:101]
    v_pk_mul_f32 v[178:179], v[178:179], s[100:101]
    v_pk_mul_f32 v[180:181], v[180:181], s[100:101]
    v_pk_mul_f32 v[182:183], v[182:183], s[100:101]
    v_cvt_pk_bf16_f32 v168, v176, v177
    v_accvgpr_write_b32 a88, v168
    v_cvt_pk_bf16_f32 v169, v178, v179
    v_accvgpr_write_b32 a89, v169
    v_cvt_pk_bf16_f32 v170, v180, v181
    v_accvgpr_write_b32 a90, v170
    v_cvt_pk_bf16_f32 v171, v182, v183
    v_accvgpr_write_b32 a91, v171
    s_waitcnt lgkmcnt(0)
    v_lshlrev_b32 v176, 16, v172
    v_and_b32 v177, s3, v172
    v_lshlrev_b32 v178, 16, v173
    v_and_b32 v179, s3, v173
    v_lshlrev_b32 v180, 16, v174
    v_and_b32 v181, s3, v174
    v_lshlrev_b32 v182, 16, v175
    v_and_b32_e64 v183, s3, v175
    v_pk_mul_f32 v[176:177], v[176:177], s[100:101]
    v_pk_mul_f32 v[178:179], v[178:179], s[100:101]
    v_pk_mul_f32 v[180:181], v[180:181], s[100:101]
    v_pk_mul_f32 v[182:183], v[182:183], s[100:101]
    v_cvt_pk_bf16_f32 v172, v176, v177
    v_accvgpr_write_b32 a92, v172
    v_cvt_pk_bf16_f32 v173, v178, v179
    v_accvgpr_write_b32 a93, v173
    v_cvt_pk_bf16_f32 v174, v180, v181
    v_accvgpr_write_b32 a94, v174
    v_cvt_pk_bf16_f32 v175, v182, v183
    v_accvgpr_write_b32 a95, v175
    s_waitcnt vmcnt(8)
    s_barrier
    ds_read_b128 a[112:115], v252 offset:0
    ds_read_b128 a[116:119], v252 offset:64
    ds_read_b128 a[120:123], v252 offset:128
    ds_read_b128 a[124:127], v252 offset:192
    ds_read_b128 a[128:131], v252 offset:512
    ds_read_b128 a[132:135], v252 offset:576
    ds_read_b128 a[136:139], v252 offset:640
    ds_read_b128 a[140:143], v252 offset:704
    ds_read_b128 a[144:147], v252 offset:8448
    ds_read_b128 a[148:151], v252 offset:8512
    ds_read_b128 a[152:155], v252 offset:8576
    ds_read_b128 a[156:159], v252 offset:8640
    ds_read_b128 a[160:163], v252 offset:8960
    ds_read_b128 a[164:167], v252 offset:9024
    ds_read_b128 a[168:171], v252 offset:9088
    ds_read_b128 a[172:175], v252 offset:9152
    s_waitcnt lgkmcnt(15)
    v_mfma_f32_16x16x32_bf16 v[208:211], a[112:115], a[80:83], 0
    s_waitcnt lgkmcnt(14)
    v_mfma_f32_16x16x32_bf16 v[208:211], a[116:119], a[84:87], v[208:211]
    s_waitcnt lgkmcnt(13)
    v_mfma_f32_16x16x32_bf16 v[208:211], a[120:123], a[88:91], v[208:211]
    s_waitcnt lgkmcnt(12)
    v_mfma_f32_16x16x32_bf16 v[208:211], a[124:127], a[92:95], v[208:211]
    s_waitcnt lgkmcnt(8)
    v_mfma_f32_16x16x32_bf16 v[212:215], a[140:143], a[92:95], 0
    v_mfma_f32_16x16x32_bf16 v[212:215], a[136:139], a[88:91], v[212:215]
    s_nop 4
    v_max3_f32 v58, v208, v209, v210
    v_mfma_f32_16x16x32_bf16 v[212:215], a[132:135], a[84:87], v[212:215]
    v_mfma_f32_16x16x32_bf16 v[212:215], a[128:131], a[80:83], v[212:215]
    s_waitcnt lgkmcnt(7)
    v_mfma_f32_16x16x32_bf16 v[216:219], a[144:147], a[80:83], 0
    s_waitcnt lgkmcnt(6)
    v_mfma_f32_16x16x32_bf16 v[216:219], a[148:151], a[84:87], v[216:219]
    s_waitcnt lgkmcnt(0)
    s_nop 2
    v_max3_f32 v58, v58, v211, v212
    v_mfma_f32_16x16x32_bf16 v[216:219], a[152:155], a[88:91], v[216:219]
    v_max3_f32 v58, v58, v213, v214
    v_max_f32 v58, v58, v215
    v_mfma_f32_16x16x32_bf16 v[216:219], a[156:159], a[92:95], v[216:219]
    v_mov_b32 v61, v58
    v_mfma_f32_16x16x32_bf16 v[220:223], a[172:175], a[92:95], 0
    s_nop 0
    v_permlane32_swap_b32 v58, v61
    v_max_f32 v58, v58, v61
    v_mfma_f32_16x16x32_bf16 v[220:223], a[168:171], a[88:91], v[220:223]
    v_mov_b32 v61, v58
    v_mfma_f32_16x16x32_bf16 v[220:223], a[164:167], a[84:87], v[220:223]
    s_nop 0
    v_permlane16_swap_b32 v58, v61
    v_max_f32 v58, v58, v61
    v_mfma_f32_16x16x32_bf16 v[220:223], a[160:163], a[80:83], v[220:223]
    s_nop 0
    v_max_f32_dpp v58, v58, v58 row_ror:8 row_mask:0xf bank_mask:0xf
    v_bfe_u32 v61, v254, 4, 1
    v_mul_u32_u24 v61, 0xaaaa, v61
    v_max_f32_dpp v58, v58, v58 row_ror:4 row_mask:0xf bank_mask:0xf
    v_add_u32 v61, 0x4444, v61
    s_nop 0
    v_max_f32_dpp v58, v58, v58 row_ror:2 row_mask:0xf bank_mask:0xf
    s_nop 1
    v_max_f32_dpp v58, v58, v58 row_ror:1 row_mask:0xf bank_mask:0xf
    ds_write_b32 v56, v58
    s_waitcnt lgkmcnt(0)
    s_barrier
    v_mov_b32 v56, 6144
    ds_read_b128 v[240:243], v56
    s_waitcnt lgkmcnt(0)
    v_max3_f32 v58, v240, v241, v242
    v_max_f32 v58, v58, v243
    v_sub_f32_e64 v58, 0xc0000000, v58
    v_and_or_b32 v240, v58, s3, v61
    v_and_or_b32 v241, v58, s3, v61
    v_and_or_b32 v242, v58, s3, v61
    v_and_or_b32 v243, v58, s3, v61
    v_add_f32 v208, v208, v240
    v_add_f32 v209, v209, v240
    v_add_f32 v210, v210, v240
    v_add_f32 v211, v211, v240
    v_exp_f32 v208, v208
    v_exp_f32 v209, v209
    v_exp_f32 v210, v210
    v_cvt_pk_bf16_f32 v232, v208, v209
    v_exp_f32 v211, v211
    v_add_f32 v212, v212, v240
    v_cvt_pk_bf16_f32 v233, v210, v211
    v_add_f32 v213, v213, v240
    v_add_f32 v214, v214, v240
    v_add_f32 v215, v215, v240
    v_exp_f32 v212, v212
    v_exp_f32 v213, v213
    v_exp_f32 v214, v214
    v_cvt_pk_bf16_f32 v234, v212, v213
    v_exp_f32 v215, v215
    v_add_f32 v216, v216, v240
    v_cvt_pk_bf16_f32 v235, v214, v215
    v_add_f32 v217, v217, v240
    v_add_f32 v218, v218, v240
    v_add_f32 v219, v219, v240
    v_exp_f32 v216, v216
    v_exp_f32 v217, v217
    v_exp_f32 v218, v218
    v_cvt_pk_bf16_f32 v236, v216, v217
    v_exp_f32 v219, v219
    v_add_f32 v220, v220, v240
    v_cvt_pk_bf16_f32 v237, v218, v219
    v_mov_b32 v58, 0
    v_add_f32 v221, v221, v240
    v_add_f32 v222, v222, v240
    v_add_f32 v223, v223, v240
    v_exp_f32 v220, v220
    v_exp_f32 v221, v221
    v_exp_f32 v222, v222
    v_cvt_pk_bf16_f32 v238, v220, v221
    v_exp_f32_e64 v223, v223
    s_waitcnt vmcnt(4)
    v_cvt_pk_bf16_f32 v239, v222, v223
    s_nop 1
    v_smfmac_f32_16x16x64_bf16 v[244:247], v[248:251], v[232:239], v240
    ds_read_b128 v[128:131], v62 offset:17408
    ds_read_b128 v[132:135], v62 offset:17472
    ds_read_b128 v[136:139], v62 offset:17536
    ds_read_b128 v[140:143], v62 offset:17600
    v_mov_b32_dpp v248, v248 row_ror:14 row_mask:0xf bank_mask:0xf
    v_mov_b32_dpp v249, v249 row_ror:14 row_mask:0xf bank_mask:0xf
    v_mov_b32_dpp v250, v250 row_ror:14 row_mask:0xf bank_mask:0xf
    v_mov_b32_dpp v251, v251 row_ror:14 row_mask:0xf bank_mask:0xf
    v_add_f32_dpp v58, v246, v247 quad_perm:[0,1,2,3] row_mask:0x4 bank_mask:0xf
    s_waitcnt lgkmcnt(3)
    v_lshlrev_b32 v144, 16, v128
    v_and_b32 v145, s3, v128
    v_lshlrev_b32 v146, 16, v129
    v_and_b32 v147, s3, v129
    v_lshlrev_b32 v148, 16, v130
    v_and_b32 v149, s3, v130
    v_lshlrev_b32 v150, 16, v131
    v_and_b32_e64 v151, s3, v131
    v_pk_mul_f32 v[144:145], v[144:145], s[100:101]
    v_pk_mul_f32 v[146:147], v[146:147], s[100:101]
    v_pk_mul_f32 v[148:149], v[148:149], s[100:101]
    v_pk_mul_f32 v[150:151], v[150:151], s[100:101]
    v_cvt_pk_bf16_f32 v128, v144, v145
    v_accvgpr_write_b32 a64, v128
    buffer_load_dwordx4 v57, s[12:15], s36 offen offset:0 nt lds
    s_add_u32 m0, m0, 64
    s_nop 0
    buffer_load_dwordx4 v57, s[12:15], s36 offen offset:1024 nt lds
    v_cvt_pk_bf16_f32 v129, v146, v147
    v_accvgpr_write_b32 a65, v129
    v_cvt_pk_bf16_f32 v130, v148, v149
    v_accvgpr_write_b32 a66, v130
    s_add_u32 m0, m0, 64
    v_cvt_pk_bf16_f32 v131, v150, v151
    v_accvgpr_write_b32 a67, v131
    s_waitcnt lgkmcnt(2)
    v_lshlrev_b32 v144, 16, v132
    v_and_b32 v145, s3, v132
    v_mfma_f32_16x16x32_bf16 v[208:211], a[112:115], a[64:67], v[240:243]
    buffer_load_dwordx4 v57, s[12:15], s36 offen offset:2048 nt lds
    v_lshlrev_b32 v146, 16, v133
    v_mfma_f32_16x16x32_bf16 v[212:215], a[128:131], a[64:67], v[240:243]
    s_add_u32 m0, m0, 64
    v_and_b32 v147, s3, v133
    v_lshlrev_b32 v148, 16, v134
    v_mfma_f32_16x16x32_bf16 v[216:219], a[144:147], a[64:67], v[240:243]
    v_and_b32 v149, s3, v134
    v_lshlrev_b32 v150, 16, v135
    v_mfma_f32_16x16x32_bf16 v[220:223], a[160:163], a[64:67], v[240:243]
    v_and_b32_e64 v151, s3, v135
    v_pk_mul_f32 v[144:145], v[144:145], s[100:101]
    v_pk_mul_f32 v[146:147], v[146:147], s[100:101]
    v_pk_mul_f32 v[148:149], v[148:149], s[100:101]
    v_pk_mul_f32 v[150:151], v[150:151], s[100:101]
    v_cvt_pk_bf16_f32 v132, v144, v145
    v_accvgpr_write_b32 a68, v132
    v_cvt_pk_bf16_f32 v133, v146, v147
    v_accvgpr_write_b32 a69, v133
    v_cvt_pk_bf16_f32 v134, v148, v149
    v_accvgpr_write_b32 a70, v134
    v_cvt_pk_bf16_f32 v135, v150, v151
    v_accvgpr_write_b32 a71, v135
    buffer_load_dwordx4 v57, s[12:15], s36 offen offset:3072 nt lds
    s_nop 0
    v_mfma_f32_16x16x32_bf16 v[208:211], a[116:119], a[68:71], v[208:211]
    s_add_u32 m0, s76, 0
    s_waitcnt lgkmcnt(1)
    v_lshlrev_b32 v144, 16, v136
    v_and_b32 v145, s3, v136
    v_mfma_f32_16x16x32_bf16 v[212:215], a[132:135], a[68:71], v[212:215]
    s_sub_u32 s36, s78, 8192
    v_lshlrev_b32 v146, 16, v137
    v_and_b32 v147, s3, v137
    v_mfma_f32_16x16x32_bf16 v[216:219], a[148:151], a[68:71], v[216:219]
    v_lshlrev_b32 v148, 16, v138
    v_and_b32 v149, s3, v138
    v_mfma_f32_16x16x32_bf16 v[220:223], a[164:167], a[68:71], v[220:223]
    v_lshlrev_b32 v150, 16, v139
    v_and_b32_e64 v151, s3, v139
    v_pk_mul_f32 v[144:145], v[144:145], s[100:101]
    v_pk_mul_f32 v[146:147], v[146:147], s[100:101]
    v_pk_mul_f32 v[148:149], v[148:149], s[100:101]
    v_pk_mul_f32 v[150:151], v[150:151], s[100:101]
    v_cvt_pk_bf16_f32 v136, v144, v145
    v_accvgpr_write_b32 a72, v136
    v_cvt_pk_bf16_f32 v137, v146, v147
    v_accvgpr_write_b32 a73, v137
    v_cvt_pk_bf16_f32 v138, v148, v149
    v_accvgpr_write_b32 a74, v138
    v_cvt_pk_bf16_f32 v139, v150, v151
    v_accvgpr_write_b32 a75, v139
    s_waitcnt lgkmcnt(0)
    v_lshlrev_b32 v144, 16, v140
    v_and_b32 v145, s3, v140
    v_mfma_f32_16x16x32_bf16 v[208:211], a[120:123], a[72:75], v[208:211]
    s_waitcnt vmcnt(4)
    v_lshlrev_b32 v146, 16, v141
    v_and_b32_e64 v147, s3, v141
    v_mfma_f32_16x16x32_bf16 v[212:215], a[136:139], a[72:75], v[212:215]
    s_barrier
    ds_read_b64_tr_b16 a[176:177], v253 offset:0
    ds_read_b64_tr_b16 a[178:179], v253 offset:512
    v_mfma_f32_16x16x32_bf16 v[216:219], a[152:155], a[72:75], v[216:219]
    ds_read_b64_tr_b16 a[180:181], v253 offset:8320
    ds_read_b64_tr_b16 a[182:183], v253 offset:8832
    v_mfma_f32_16x16x32_bf16 v[220:223], a[168:171], a[72:75], v[220:223]
    ds_read_b64_tr_b16 a[184:185], v253 offset:16
    ds_read_b64_tr_b16 a[186:187], v253 offset:528
    ds_read_b64_tr_b16 a[188:189], v253 offset:8336
    ds_read_b64_tr_b16 a[190:191], v253 offset:8848
    ds_read_b64_tr_b16 a[192:193], v253 offset:32
    ds_read_b64_tr_b16 a[194:195], v253 offset:544
    ds_read_b64_tr_b16 a[196:197], v253 offset:8352
    ds_read_b64_tr_b16 a[198:199], v253 offset:8864
    ds_read_b64_tr_b16 a[200:201], v253 offset:48
    ds_read_b64_tr_b16 a[202:203], v253 offset:560
    ds_read_b64_tr_b16 a[204:205], v253 offset:8368
    ds_read_b64_tr_b16 a[206:207], v253 offset:8880
    ds_read_b64_tr_b16 a[208:209], v253 offset:64
    ds_read_b64_tr_b16 a[210:211], v253 offset:576
    ds_read_b64_tr_b16 a[212:213], v253 offset:8384
    ds_read_b64_tr_b16 a[214:215], v253 offset:8896
    ds_read_b64_tr_b16 a[216:217], v253 offset:80
    ds_read_b64_tr_b16 a[218:219], v253 offset:592
    ds_read_b64_tr_b16 a[220:221], v253 offset:8400
    ds_read_b64_tr_b16 a[222:223], v253 offset:8912
    ds_read_b64_tr_b16 a[224:225], v253 offset:96
    ds_read_b64_tr_b16 a[226:227], v253 offset:608
    ds_read_b64_tr_b16 a[228:229], v253 offset:8416
    ds_read_b64_tr_b16 a[230:231], v253 offset:8928
    ds_read_b64_tr_b16 a[232:233], v253 offset:112
    ds_read_b64_tr_b16 a[234:235], v253 offset:624
    ds_read_b64_tr_b16 a[236:237], v253 offset:8432
    ds_read_b64_tr_b16 a[238:239], v253 offset:8944
    v_lshlrev_b32 v148, 16, v142
    v_and_b32 v149, s3, v142
    v_lshlrev_b32 v150, 16, v143
    v_and_b32 v151, s3, v143
    v_pk_mul_f32 v[144:145], v[144:145], s[100:101]
    v_pk_mul_f32 v[146:147], v[146:147], s[100:101]
    v_pk_mul_f32 v[148:149], v[148:149], s[100:101]
    v_pk_mul_f32 v[150:151], v[150:151], s[100:101]
    v_cvt_pk_bf16_f32 v140, v144, v145
    v_accvgpr_write_b32 a76, v140
    v_cvt_pk_bf16_f32 v141, v146, v147
    v_accvgpr_write_b32 a77, v141
    v_cvt_pk_bf16_f32 v142, v148, v149
    v_accvgpr_write_b32 a78, v142
    v_cvt_pk_bf16_f32 v143, v150, v151
    v_accvgpr_write_b32 a79, v143
    s_waitcnt lgkmcnt(15)
    v_accvgpr_read_b32 v32, a176
    v_accvgpr_read_b32 v33, a178
    v_mfma_f32_16x16x32_bf16 v[208:211], a[124:127], a[76:79], v[208:211]
    buffer_load_dwordx4 v57, s[12:15], s36 offen offset:0 nt lds
    s_add_u32 m0, m0, 64
    v_mfma_f32_16x16x32_bf16 v[212:215], a[140:143], a[76:79], v[212:215]
    buffer_load_dwordx4 v57, s[12:15], s36 offen offset:1024 nt lds
    v_accvgpr_read_b32 v34, a181
    v_mfma_f32_16x16x32_bf16 v[216:219], a[156:159], a[76:79], v[216:219]
    s_add_u32 m0, m0, 64
    v_max3_f32 v48, |v32|, |v33|, |v34|
    v_accvgpr_read_b32 v35, a184
    v_mfma_f32_16x16x32_bf16 v[220:223], a[172:175], a[76:79], v[220:223]
    v_accvgpr_read_b32 v36, a186
    v_accvgpr_read_b32 v37, a189
    v_max3_f32 v49, |v35|, |v36|, |v37|
    v_accvgpr_read_b32 v38, a192
    v_accvgpr_read_b32 v39, a194
    v_accvgpr_read_b32 v40, a197
    v_max3_f32 v50, |v38|, |v39|, |v40|
    v_accvgpr_read_b32 v41, a200
    v_accvgpr_read_b32 v42, a202
    v_accvgpr_read_b32 v43, a205
    v_max3_f32 v51, |v41|, |v42|, |v43|
    v_accvgpr_read_b32 v32, a208
    s_waitcnt lgkmcnt(14)
    v_accvgpr_read_b32 v33, a210
    s_waitcnt lgkmcnt(13)
    v_accvgpr_read_b32 v34, a213
    v_max3_f32 v52, |v32|, |v33|, |v34|
    s_waitcnt lgkmcnt(11)
    v_accvgpr_read_b32 v35, a216
    s_waitcnt lgkmcnt(10)
    v_accvgpr_read_b32 v36, a218
    s_waitcnt lgkmcnt(9)
    v_accvgpr_read_b32 v37, a221
    v_max3_f32 v53, |v35|, |v36|, |v37|
    s_waitcnt lgkmcnt(7)
    v_accvgpr_read_b32 v38, a224
    s_waitcnt lgkmcnt(6)
    v_accvgpr_read_b32 v39, a226
    s_waitcnt lgkmcnt(5)
    v_accvgpr_read_b32 v40, a229
    v_max3_f32 v54, |v38|, |v39|, |v40|
    buffer_load_dwordx4 v57, s[12:15], s36 offen offset:2048 nt lds
    s_waitcnt lgkmcnt(3)
    v_accvgpr_read_b32 v41, a232
    s_waitcnt lgkmcnt(2)
    v_accvgpr_read_b32 v42, a234
    s_waitcnt lgkmcnt(1)
    v_accvgpr_read_b32 v43, a237
    v_max3_f32 v55, |v41|, |v42|, |v43|
    v_min3_f32 v61, v48, v49, v50
    v_min3_f32 v61, v61, v51, v52
    v_min3_f32 v61, v61, v53, v54
    v_min_f32 v61, v61, v55
    v_mov_b32 v48, v61
    s_add_u32 m0, m0, 64
    v_exp_f32 v208, v208
    v_permlane32_swap_b32 v61, v48
    v_min_f32 v61, v61, v48
    v_mov_b32 v48, v61
    v_exp_f32 v209, v209
    s_nop 0
    v_permlane16_swap_b32 v61, v48
    v_min_f32 v61, v61, v48
    v_cvt_pk_bf16_f32 v224, v208, v209
    v_exp_f32 v210, v210
    v_min_f32_dpp v61, v61, v61 row_ror:8 row_mask:0xf bank_mask:0xf
    v_exp_f32 v211, v211
    s_nop 0
    v_min_f32_dpp v61, v61, v61 row_ror:4 row_mask:0xf bank_mask:0xf
    buffer_load_dwordx4 v57, s[12:15], s36 offen offset:3072 nt lds
    s_nop 0
    v_min_f32_dpp v61, v61, v61 row_ror:2 row_mask:0xf bank_mask:0xf
    v_cvt_pk_bf16_f32 v225, v210, v211
    v_exp_f32 v212, v212
    v_min_f32_dpp v61, v61, v61 row_ror:1 row_mask:0xf bank_mask:0xf
    v_min_f32 v61, 0x5b800000, v61
    v_mul_f32 v61, 0x41800000, v61
    v_exp_f32_e64 v213, v213
    s_nop 0
    v_mfma_f32_16x16x4_f32 v[172:175], v58, v61, 0
    s_waitcnt vmcnt(4)
    s_add_u32 m0, s76, 4352
    s_sub_u32 s36, s78, 12288
    ds_read_b128 v[0:3], v62 offset:34816
    ds_read_b128 v[4:7], v62 offset:34880
    ds_read_b128 v[8:11], v62 offset:34944
    ds_read_b128 v[12:15], v62 offset:35008
    s_nop 2
    v_and_or_b32 v172, v172, s79, v60
    v_and_or_b32 v173, v173, s79, v60
    v_and_or_b32 v174, v174, s79, v60
    v_and_or_b32 v175, v175, s79, v60
    v_mov_b32 v58, 0
    v_cvt_pk_bf16_f32 v226, v212, v213
    v_mfma_f32_16x16x32_bf16 v[160:163], v[232:235], a[176:179], v[172:175]
    ds_write_b128 v59, v[172:175] offset:320
    v_mfma_f32_16x16x32_bf16 v[160:163], v[236:239], a[180:183], v[160:163]
    v_exp_f32 v214, v214
    v_mfma_f32_16x16x32_bf16 v[164:167], v[236:239], a[188:191], v[172:175]
    v_exp_f32 v215, v215
    v_mfma_f32_16x16x32_bf16 v[164:167], v[232:235], a[184:187], v[164:167]
    v_exp_f32 v216, v216
    v_mfma_f32_16x16x32_bf16 v[168:171], v[232:235], a[192:195], v[172:175]
    v_exp_f32 v217, v217
    v_mfma_f32_16x16x32_bf16 v[168:171], v[236:239], a[196:199], v[168:171]
    v_cvt_pk_bf16_f32 v227, v214, v215
    v_cvt_pk_bf16_f32 v228, v216, v217
    v_mfma_f32_16x16x32_bf16 v[176:179], v[236:239], a[212:215], v[172:175]
    v_exp_f32 v218, v218
    v_mfma_f32_16x16x32_bf16 v[176:179], v[232:235], a[208:211], v[176:179]
    v_exp_f32 v219, v219
    v_mfma_f32_16x16x32_bf16 v[180:183], v[232:235], a[216:219], v[172:175]
    v_cvt_pk_bf16_f32 v229, v218, v219
    s_waitcnt lgkmcnt(4)
    v_lshlrev_b32 v16, 16, v0
    v_mfma_f32_16x16x32_bf16 v[180:183], v[236:239], a[220:223], v[180:183]
    buffer_load_dwordx4 v57, s[12:15], s36 offen offset:0 nt lds
    v_and_b32 v17, s3, v0
    v_mfma_f32_16x16x32_bf16 v[184:187], v[236:239], a[228:231], v[172:175]
    s_add_u32 m0, m0, 64
    v_exp_f32 v220, v220
    v_mfma_f32_16x16x32_bf16 v[184:187], v[232:235], a[224:227], v[184:187]
    v_exp_f32 v221, v221
    v_mfma_f32_16x16x32_bf16 v[188:191], v[232:235], a[232:235], v[172:175]
    v_cvt_pk_bf16_f32 v230, v220, v221
    v_lshlrev_b32 v18, 16, v1
    v_mfma_f32_16x16x32_bf16 v[188:191], v[236:239], a[236:239], v[188:191]
    v_exp_f32 v222, v222
    v_mfma_f32_16x16x32_bf16 v[172:175], v[236:239], a[204:207], v[172:175]
    v_exp_f32 v223, v223
    v_mfma_f32_16x16x32_bf16 v[172:175], v[232:235], a[200:203], v[172:175]
    v_cvt_pk_bf16_f32 v231, v222, v223
    v_and_b32 v19, s3, v1
    v_lshlrev_b32 v20, 16, v2
    v_smfmac_f32_16x16x64_bf16 v[244:247], v[248:251], v[224:231], v240
    v_and_b32 v21, s3, v2
    v_lshlrev_b32 v22, 16, v3
    v_and_b32 v23, s3, v3
    v_pk_mul_f32 v[16:17], v[16:17], s[100:101]
    v_pk_mul_f32 v[18:19], v[18:19], s[100:101]
    v_pk_mul_f32 v[20:21], v[20:21], s[100:101]
    v_pk_mul_f32 v[22:23], v[22:23], s[100:101]
    v_cvt_pk_bf16_f32 v0, v16, v17
    v_accvgpr_write_b32 a0, v0
    v_add_f32_dpp v58, v244, v245 quad_perm:[0,1,2,3] row_mask:0x4 bank_mask:0xf
    v_cvt_pk_bf16_f32 v1, v18, v19
    v_accvgpr_write_b32 a1, v1
    v_mfma_f32_16x16x4_f32 v[140:143], v58, v61, 0
    v_cvt_pk_bf16_f32 v2, v20, v21
    v_accvgpr_write_b32 a2, v2
    s_nop 7
    v_and_or_b32 v140, v140, s79, v60
    v_and_or_b32 v141, v141, s79, v60
    v_and_or_b32 v142, v142, s79, v60
    v_and_or_b32 v143, v143, s79, v60
    v_cvt_pk_bf16_f32 v3, v22, v23
    v_accvgpr_write_b32 a3, v3
    v_mfma_f32_16x16x32_bf16 v[128:131], v[224:227], a[176:179], v[140:143]
    ds_write_b128 v59, v[140:143] offset:256
    v_mfma_f32_16x16x32_bf16 v[208:211], a[112:115], a[0:3], v[240:243]
    buffer_load_dwordx4 v57, s[12:15], s36 offen offset:1024 nt lds
    s_waitcnt lgkmcnt(1)
    v_lshlrev_b32 v16, 16, v4
    v_mfma_f32_16x16x32_bf16 v[212:215], a[128:131], a[0:3], v[240:243]
    s_add_u32 m0, m0, 64
    v_and_b32 v17, s3, v4
    v_lshlrev_b32 v18, 16, v5
    v_mfma_f32_16x16x32_bf16 v[216:219], a[144:147], a[0:3], v[240:243]
    v_and_b32 v19, s3, v5
    v_lshlrev_b32 v20, 16, v6
    v_mfma_f32_16x16x32_bf16 v[220:223], a[160:163], a[0:3], v[240:243]
    v_and_b32 v21, s3, v6
    v_lshlrev_b32 v22, 16, v7
    v_mfma_f32_16x16x32_bf16 v[128:131], v[228:231], a[180:183], v[128:131]
    v_and_b32_e64 v23, s3, v7
    v_pk_mul_f32 v[16:17], v[16:17], s[100:101]
    v_pk_mul_f32 v[18:19], v[18:19], s[100:101]
    v_pk_mul_f32 v[20:21], v[20:21], s[100:101]
    v_pk_mul_f32 v[22:23], v[22:23], s[100:101]
    v_mfma_f32_16x16x32_bf16 v[132:135], v[228:231], a[188:191], v[140:143]
    v_cvt_pk_bf16_f32 v4, v16, v17
    v_accvgpr_write_b32 a4, v4
    v_mfma_f32_16x16x32_bf16 v[132:135], v[224:227], a[184:187], v[132:135]
    v_cvt_pk_bf16_f32 v5, v18, v19
    v_accvgpr_write_b32 a5, v5
    v_mfma_f32_16x16x32_bf16 v[136:139], v[224:227], a[192:195], v[140:143]
    v_cvt_pk_bf16_f32 v6, v20, v21
    v_accvgpr_write_b32 a6, v6
    v_mfma_f32_16x16x32_bf16 v[136:139], v[228:231], a[196:199], v[136:139]
    v_cvt_pk_bf16_f32 v7, v22, v23
    v_accvgpr_write_b32 a7, v7
    v_mfma_f32_16x16x32_bf16 v[144:147], v[228:231], a[212:215], v[140:143]
    v_lshlrev_b32 v16, 16, v8
    v_and_b32 v17, s3, v8
    v_mfma_f32_16x16x32_bf16 v[208:211], a[116:119], a[4:7], v[208:211]
    v_lshlrev_b32 v18, 16, v9
    v_and_b32 v19, s3, v9
    v_mfma_f32_16x16x32_bf16 v[212:215], a[132:135], a[4:7], v[212:215]
    buffer_load_dwordx4 v57, s[12:15], s36 offen offset:2048 nt lds
    v_lshlrev_b32 v20, 16, v10
    v_mfma_f32_16x16x32_bf16 v[216:219], a[148:151], a[4:7], v[216:219]
    s_add_u32 m0, m0, 64
    v_and_b32 v21, s3, v10
    v_mov_b32_dpp v248, v248 row_ror:8 row_mask:0xf bank_mask:0xf
    v_mfma_f32_16x16x32_bf16 v[220:223], a[164:167], a[4:7], v[220:223]
    v_lshlrev_b32 v22, 16, v11
    v_mov_b32_dpp v249, v249 row_ror:8 row_mask:0xf bank_mask:0xf
    v_mfma_f32_16x16x32_bf16 v[144:147], v[224:227], a[208:211], v[144:147]
    v_and_b32_e64 v23, s3, v11
    v_mov_b32_dpp v250, v250 row_ror:8 row_mask:0xf bank_mask:0xf
    v_mfma_f32_16x16x32_bf16 v[148:151], v[224:227], a[216:219], v[140:143]
    v_pk_mul_f32 v[16:17], v[16:17], s[100:101]
    v_pk_mul_f32 v[18:19], v[18:19], s[100:101]
    v_pk_mul_f32 v[20:21], v[20:21], s[100:101]
    v_pk_mul_f32 v[22:23], v[22:23], s[100:101]
    v_mfma_f32_16x16x32_bf16 v[148:151], v[228:231], a[220:223], v[148:151]
    v_mov_b32_dpp v251, v251 row_ror:8 row_mask:0xf bank_mask:0xf
    v_mov_b32 v58, 0
    v_mfma_f32_16x16x32_bf16 v[152:155], v[228:231], a[228:231], v[140:143]
    v_cvt_pk_bf16_f32 v8, v16, v17
    v_accvgpr_write_b32 a8, v8
    v_mfma_f32_16x16x32_bf16 v[152:155], v[224:227], a[224:227], v[152:155]
    v_cvt_pk_bf16_f32 v9, v18, v19
    v_accvgpr_write_b32 a9, v9
    v_mfma_f32_16x16x32_bf16 v[156:159], v[224:227], a[232:235], v[140:143]
    v_cvt_pk_bf16_f32 v10, v20, v21
    v_accvgpr_write_b32 a10, v10
    v_mfma_f32_16x16x32_bf16 v[156:159], v[228:231], a[236:239], v[156:159]
    v_cvt_pk_bf16_f32 v11, v22, v23
    v_accvgpr_write_b32 a11, v11
    v_mfma_f32_16x16x32_bf16 v[140:143], v[228:231], a[204:207], v[140:143]
    v_lshlrev_b32 v16, 16, v12
    v_and_b32 v17, s3, v12
    v_mfma_f32_16x16x32_bf16 v[208:211], a[120:123], a[8:11], v[208:211]
    v_lshlrev_b32 v18, 16, v13
    v_and_b32 v19, s3, v13
    v_mfma_f32_16x16x32_bf16 v[212:215], a[136:139], a[8:11], v[212:215]
    v_lshlrev_b32 v20, 16, v14
    v_and_b32 v21, s3, v14
    v_mfma_f32_16x16x32_bf16 v[216:219], a[152:155], a[8:11], v[216:219]
    v_lshlrev_b32 v22, 16, v15
    v_and_b32_e64 v23, s3, v15
    v_mfma_f32_16x16x32_bf16 v[220:223], a[168:171], a[8:11], v[220:223]
    buffer_load_dwordx4 v57, s[12:15], s36 offen offset:3072 nt lds
    v_pk_mul_f32 v[16:17], v[16:17], s[100:101]
    v_pk_mul_f32 v[18:19], v[18:19], s[100:101]
    v_pk_mul_f32 v[20:21], v[20:21], s[100:101]
    v_pk_mul_f32 v[22:23], v[22:23], s[100:101]
    v_mfma_f32_16x16x32_bf16 v[140:143], v[224:227], a[200:203], v[140:143]
    s_add_u32 m0, s76, 8704
    v_cvt_pk_bf16_f32 v12, v16, v17
    v_accvgpr_write_b32 a12, v12
    v_cvt_pk_bf16_f32 v13, v18, v19
    v_accvgpr_write_b32 a13, v13
    v_cvt_pk_bf16_f32 v14, v20, v21
    v_accvgpr_write_b32 a14, v14
    v_cvt_pk_bf16_f32 v15, v22, v23
    v_accvgpr_write_b32 a15, v15
    s_sub_u32 s36, s78, 16384
    s_nop 0
    v_mfma_f32_16x16x32_bf16 v[208:211], a[124:127], a[12:15], v[208:211]
    v_mfma_f32_16x16x32_bf16 v[212:215], a[140:143], a[12:15], v[212:215]
    v_mfma_f32_16x16x32_bf16 v[216:219], a[156:159], a[12:15], v[216:219]
    v_mfma_f32_16x16x32_bf16 v[220:223], a[172:175], a[12:15], v[220:223]
    s_nop 4
    v_exp_f32 v208, v208
    v_exp_f32 v209, v209
    v_exp_f32 v210, v210
    v_cvt_pk_bf16_f32 v232, v208, v209
    v_exp_f32 v211, v211
    v_exp_f32 v212, v212
    v_cvt_pk_bf16_f32 v233, v210, v211
    v_exp_f32 v213, v213
    v_exp_f32 v214, v214
    v_cvt_pk_bf16_f32 v234, v212, v213
    v_exp_f32 v215, v215
    v_exp_f32 v216, v216
    v_cvt_pk_bf16_f32 v235, v214, v215
    v_exp_f32 v217, v217
    v_exp_f32 v218, v218
    v_cvt_pk_bf16_f32 v236, v216, v217
    v_exp_f32 v219, v219
    v_exp_f32 v220, v220
    v_cvt_pk_bf16_f32 v237, v218, v219
    v_exp_f32 v221, v221
    v_exp_f32 v222, v222
    v_cvt_pk_bf16_f32 v238, v220, v221
    v_exp_f32 v223, v223
    s_waitcnt vmcnt(4)
    v_cvt_pk_bf16_f32 v239, v222, v223
    s_nop 1
    v_smfmac_f32_16x16x64_bf16 v[244:247], v[248:251], v[232:239], v240
    ds_read_b128 v[96:99], v63 offset:0
    ds_read_b128 v[100:103], v63 offset:64
    ds_read_b128 v[104:107], v63 offset:128
    ds_read_b128 v[108:111], v63 offset:192
    v_mov_b32_dpp v248, v248 row_ror:6 row_mask:0xf bank_mask:0xf
    v_mov_b32_dpp v249, v249 row_ror:6 row_mask:0xf bank_mask:0xf
    v_mov_b32_dpp v250, v250 row_ror:6 row_mask:0xf bank_mask:0xf
    v_mov_b32_dpp v251, v251 row_ror:6 row_mask:0xf bank_mask:0xf
    v_add_f32_dpp v58, v244, v245 quad_perm:[0,1,2,3] row_mask:0x1 bank_mask:0xf
    s_nop 1
    v_mfma_f32_16x16x4_f32 v[12:15], v58, v61, 0
    v_mov_b32_e64 v58, 0
    s_nop 8
    v_and_or_b32 v12, v12, s79, v60
    v_and_or_b32 v13, v13, s79, v60
    v_and_or_b32 v14, v14, s79, v60
    v_and_or_b32 v15, v15, s79, v60
    s_nop 1
    v_mfma_f32_16x16x32_bf16 v[0:3], v[232:235], a[176:179], v[12:15]
    ds_write_b128 v59, v[12:15] offset:0
    v_mfma_f32_16x16x32_bf16 v[0:3], v[236:239], a[180:183], v[0:3]
    s_waitcnt lgkmcnt(4)
    v_lshlrev_b32 v112, 16, v96
    v_and_b32 v113, s3, v96
    v_mfma_f32_16x16x32_bf16 v[4:7], v[236:239], a[188:191], v[12:15]
    buffer_load_dwordx4 v57, s[12:15], s36 offen offset:0 nt lds
    v_lshlrev_b32 v114, 16, v97
    v_mfma_f32_16x16x32_bf16 v[4:7], v[232:235], a[184:187], v[4:7]
    s_add_u32 m0, m0, 64
    v_and_b32 v115, s3, v97
    v_lshlrev_b32 v116, 16, v98
    v_mfma_f32_16x16x32_bf16 v[8:11], v[232:235], a[192:195], v[12:15]
    v_and_b32 v117, s3, v98
    v_lshlrev_b32 v118, 16, v99
    v_mfma_f32_16x16x32_bf16 v[8:11], v[236:239], a[196:199], v[8:11]
    v_and_b32_e64 v119, s3, v99
    v_pk_mul_f32 v[112:113], v[112:113], s[100:101]
    v_pk_mul_f32 v[114:115], v[114:115], s[100:101]
    v_pk_mul_f32 v[116:117], v[116:117], s[100:101]
    v_pk_mul_f32 v[118:119], v[118:119], s[100:101]
    v_mfma_f32_16x16x32_bf16 v[16:19], v[236:239], a[212:215], v[12:15]
    v_cvt_pk_bf16_f32 v96, v112, v113
    v_accvgpr_write_b32 a48, v96
    v_mfma_f32_16x16x32_bf16 v[16:19], v[232:235], a[208:211], v[16:19]
    v_cvt_pk_bf16_f32 v97, v114, v115
    v_accvgpr_write_b32 a49, v97
    v_mfma_f32_16x16x32_bf16 v[20:23], v[232:235], a[216:219], v[12:15]
    v_cvt_pk_bf16_f32 v98, v116, v117
    v_accvgpr_write_b32 a50, v98
    v_mfma_f32_16x16x32_bf16 v[20:23], v[236:239], a[220:223], v[20:23]
    v_cvt_pk_bf16_f32 v99, v118, v119
    v_accvgpr_write_b32 a51, v99
    v_mfma_f32_16x16x32_bf16 v[24:27], v[236:239], a[228:231], v[12:15]
    buffer_load_dwordx4 v57, s[12:15], s36 offen offset:1024 nt lds
    s_waitcnt lgkmcnt(0)
    v_lshlrev_b32 v112, 16, v100
    v_mfma_f32_16x16x32_bf16 v[208:211], a[112:115], a[48:51], v[240:243]
    s_add_u32 m0, m0, 64
    v_and_b32 v113, s3, v100
    v_lshlrev_b32 v114, 16, v101
    v_mfma_f32_16x16x32_bf16 v[212:215], a[128:131], a[48:51], v[240:243]
    v_and_b32 v115, s3, v101
    v_lshlrev_b32 v116, 16, v102
    v_mfma_f32_16x16x32_bf16 v[216:219], a[144:147], a[48:51], v[240:243]
    v_and_b32 v117, s3, v102
    v_lshlrev_b32 v118, 16, v103
    v_mfma_f32_16x16x32_bf16 v[220:223], a[160:163], a[48:51], v[240:243]
    v_and_b32 v119, s3, v103
    v_pk_mul_f32 v[112:113], v[112:113], s[100:101]
    v_pk_mul_f32 v[114:115], v[114:115], s[100:101]
    v_pk_mul_f32 v[116:117], v[116:117], s[100:101]
    v_pk_mul_f32 v[118:119], v[118:119], s[100:101]
    v_mfma_f32_16x16x32_bf16 v[24:27], v[232:235], a[224:227], v[24:27]
    v_cvt_pk_bf16_f32 v100, v112, v113
    v_accvgpr_write_b32 a52, v100
    v_mfma_f32_16x16x32_bf16 v[28:31], v[232:235], a[232:235], v[12:15]
    v_cvt_pk_bf16_f32 v101, v114, v115
    v_accvgpr_write_b32 a53, v101
    v_mfma_f32_16x16x32_bf16 v[28:31], v[236:239], a[236:239], v[28:31]
    v_cvt_pk_bf16_f32 v102, v116, v117
    v_accvgpr_write_b32 a54, v102
    v_mfma_f32_16x16x32_bf16 v[12:15], v[236:239], a[204:207], v[12:15]
    v_cvt_pk_bf16_f32 v103, v118, v119
    v_accvgpr_write_b32 a55, v103
    v_mfma_f32_16x16x32_bf16 v[12:15], v[232:235], a[200:203], v[12:15]
    v_lshlrev_b32 v112, 16, v104
    v_and_b32 v113, s3, v104
    v_mfma_f32_16x16x32_bf16 v[208:211], a[116:119], a[52:55], v[208:211]
    v_lshlrev_b32 v114, 16, v105
    v_and_b32 v115, s3, v105
    v_mfma_f32_16x16x32_bf16 v[212:215], a[132:135], a[52:55], v[212:215]
    buffer_load_dwordx4 v57, s[12:15], s36 offen offset:2048 nt lds
    v_lshlrev_b32 v116, 16, v106
    v_mfma_f32_16x16x32_bf16 v[216:219], a[148:151], a[52:55], v[216:219]
    s_add_u32 m0, m0, 64
    v_and_b32 v117, s3, v106
    v_lshlrev_b32 v118, 16, v107
    v_mfma_f32_16x16x32_bf16 v[220:223], a[164:167], a[52:55], v[220:223]
    v_and_b32_e64 v119, s3, v107
    v_pk_mul_f32 v[112:113], v[112:113], s[100:101]
    v_pk_mul_f32 v[114:115], v[114:115], s[100:101]
    v_pk_mul_f32 v[116:117], v[116:117], s[100:101]
    v_pk_mul_f32 v[118:119], v[118:119], s[100:101]
    v_cvt_pk_bf16_f32 v104, v112, v113
    v_accvgpr_write_b32 a56, v104
    v_cvt_pk_bf16_f32 v105, v114, v115
    v_accvgpr_write_b32 a57, v105
    v_cvt_pk_bf16_f32 v106, v116, v117
    v_accvgpr_write_b32 a58, v106
    v_cvt_pk_bf16_f32 v107, v118, v119
    v_accvgpr_write_b32 a59, v107
    v_lshlrev_b32 v112, 16, v108
    v_and_b32 v113, s3, v108
    v_mfma_f32_16x16x32_bf16 v[208:211], a[120:123], a[56:59], v[208:211]
    v_lshlrev_b32 v114, 16, v109
    v_and_b32 v115, s3, v109
    v_mfma_f32_16x16x32_bf16 v[212:215], a[136:139], a[56:59], v[212:215]
    v_lshlrev_b32 v116, 16, v110
    v_and_b32 v117, s3, v110
    v_mfma_f32_16x16x32_bf16 v[216:219], a[152:155], a[56:59], v[216:219]
    v_lshlrev_b32 v118, 16, v111
    v_and_b32 v119, s3, v111
    v_mfma_f32_16x16x32_bf16 v[220:223], a[168:171], a[56:59], v[220:223]
    buffer_load_dwordx4 v57, s[12:15], s36 offen offset:3072 nt lds
    v_pk_mul_f32 v[112:113], v[112:113], s[100:101]
    v_pk_mul_f32 v[114:115], v[114:115], s[100:101]
    v_pk_mul_f32 v[116:117], v[116:117], s[100:101]
    v_pk_mul_f32 v[118:119], v[118:119], s[100:101]
    v_cvt_pk_bf16_f32 v108, v112, v113
    v_accvgpr_write_b32 a60, v108
    v_cvt_pk_bf16_f32 v109, v114, v115
    v_accvgpr_write_b32 a61, v109
    v_cvt_pk_bf16_f32 v110, v116, v117
    v_accvgpr_write_b32 a62, v110
    v_cvt_pk_bf16_f32 v111, v118, v119
    v_accvgpr_write_b32 a63, v111
    s_add_u32 m0, s68, 39936
    s_add_u32 s8, s0, 16384
    v_mfma_f32_16x16x32_bf16 v[208:211], a[124:127], a[60:63], v[208:211]
    s_addc_u32 s9, s1, 0
    v_mfma_f32_16x16x32_bf16 v[212:215], a[140:143], a[60:63], v[212:215]
    v_mfma_f32_16x16x32_bf16 v[216:219], a[156:159], a[60:63], v[216:219]
    v_mfma_f32_16x16x32_bf16 v[220:223], a[172:175], a[60:63], v[220:223]
    s_nop 3
    v_exp_f32 v208, v208
    v_exp_f32 v209, v209
    v_exp_f32 v210, v210
    v_cvt_pk_bf16_f32 v224, v208, v209
    v_exp_f32 v211, v211
    v_exp_f32 v212, v212
    v_cvt_pk_bf16_f32 v225, v210, v211
    v_exp_f32 v213, v213
    v_exp_f32 v214, v214
    v_cvt_pk_bf16_f32 v226, v212, v213
    v_exp_f32 v215, v215
    v_exp_f32 v216, v216
    v_cvt_pk_bf16_f32 v227, v214, v215
    v_exp_f32 v217, v217
    v_exp_f32 v218, v218
    v_cvt_pk_bf16_f32 v228, v216, v217
    v_exp_f32 v219, v219
    v_exp_f32 v220, v220
    v_cvt_pk_bf16_f32 v229, v218, v219
    v_exp_f32 v221, v221
    v_exp_f32 v222, v222
    v_cvt_pk_bf16_f32 v230, v220, v221
    v_exp_f32 v223, v223
    s_waitcnt vmcnt(4)
    v_cvt_pk_bf16_f32 v231, v222, v223
    s_nop 1
    v_smfmac_f32_16x16x64_bf16 v[244:247], v[248:251], v[224:231], v240
    ds_read_b128 v[64:67], v63 offset:4352
    ds_read_b128 v[68:71], v63 offset:4416
    ds_read_b128 v[72:75], v63 offset:4480
    ds_read_b128 v[76:79], v63 offset:4544
    v_mov_b32_dpp v248, v248 row_ror:14 row_mask:0xf bank_mask:0xf
    v_mov_b32_dpp v249, v249 row_ror:14 row_mask:0xf bank_mask:0xf
    v_mov_b32_dpp v250, v250 row_ror:14 row_mask:0xf bank_mask:0xf
    v_mov_b32_dpp v251, v251 row_ror:14 row_mask:0xf bank_mask:0xf
    v_add_f32_dpp v58, v246, v247 quad_perm:[0,1,2,3] row_mask:0x2 bank_mask:0xf
    s_nop 1
    v_mfma_f32_16x16x4_f32 v[108:111], v58, v61, 0
    v_mov_b32_e64 v58, 0
    s_nop 8
    v_and_or_b32 v108, v108, s79, v60
    v_and_or_b32 v109, v109, s79, v60
    v_and_or_b32 v110, v110, s79, v60
    v_and_or_b32 v111, v111, s79, v60
    s_nop 1
    v_mfma_f32_16x16x32_bf16 v[96:99], v[224:227], a[176:179], v[108:111]
    ds_write_b128 v59, v[108:111] offset:192
    v_mfma_f32_16x16x32_bf16 v[96:99], v[228:231], a[180:183], v[96:99]
    s_waitcnt lgkmcnt(4)
    v_lshlrev_b32 v80, 16, v64
    v_and_b32 v81, s3, v64
    v_mfma_f32_16x16x32_bf16 v[100:103], v[228:231], a[188:191], v[108:111]
    global_load_lds_dwordx4 v254, s[8:9] offset:0 nt
    v_lshlrev_b32 v82, 16, v65
    v_mfma_f32_16x16x32_bf16 v[100:103], v[224:227], a[184:187], v[100:103]
    s_add_u32 m0, m0, 32
    v_and_b32 v83, s3, v65
    v_lshlrev_b32 v84, 16, v66
    v_mfma_f32_16x16x32_bf16 v[104:107], v[224:227], a[192:195], v[108:111]
    v_and_b32 v85, s3, v66
    v_lshlrev_b32 v86, 16, v67
    v_mfma_f32_16x16x32_bf16 v[104:107], v[228:231], a[196:199], v[104:107]
    v_and_b32_e64 v87, s3, v67
    v_pk_mul_f32 v[80:81], v[80:81], s[100:101]
    v_pk_mul_f32 v[82:83], v[82:83], s[100:101]
    v_pk_mul_f32 v[84:85], v[84:85], s[100:101]
    v_pk_mul_f32 v[86:87], v[86:87], s[100:101]
    v_mfma_f32_16x16x32_bf16 v[112:115], v[228:231], a[212:215], v[108:111]
    v_cvt_pk_bf16_f32 v64, v80, v81
    v_accvgpr_write_b32 a32, v64
    v_mfma_f32_16x16x32_bf16 v[112:115], v[224:227], a[208:211], v[112:115]
    v_cvt_pk_bf16_f32 v65, v82, v83
    v_accvgpr_write_b32 a33, v65
    v_mfma_f32_16x16x32_bf16 v[116:119], v[224:227], a[216:219], v[108:111]
    v_cvt_pk_bf16_f32 v66, v84, v85
    v_accvgpr_write_b32 a34, v66
    v_mfma_f32_16x16x32_bf16 v[116:119], v[228:231], a[220:223], v[116:119]
    v_cvt_pk_bf16_f32 v67, v86, v87
    v_accvgpr_write_b32 a35, v67
    v_mfma_f32_16x16x32_bf16 v[120:123], v[228:231], a[228:231], v[108:111]
    global_load_lds_dwordx4 v254, s[8:9] offset:1024 nt
    s_waitcnt lgkmcnt(0)
    v_lshlrev_b32 v80, 16, v68
    v_mfma_f32_16x16x32_bf16 v[208:211], a[112:115], a[32:35], v[240:243]
    s_add_u32 m0, s69, 56832
    v_and_b32 v81, s3, v68
    v_lshlrev_b32 v82, 16, v69
    v_mfma_f32_16x16x32_bf16 v[212:215], a[128:131], a[32:35], v[240:243]
    s_add_u32 s8, s38, 16384
    v_and_b32 v83, s3, v69
    v_lshlrev_b32 v84, 16, v70
    v_mfma_f32_16x16x32_bf16 v[216:219], a[144:147], a[32:35], v[240:243]
    s_addc_u32 s9, s39, 0
    v_and_b32 v85, s3, v70
    v_lshlrev_b32 v86, 16, v71
    v_mfma_f32_16x16x32_bf16 v[220:223], a[160:163], a[32:35], v[240:243]
    v_and_b32 v87, s3, v71
    v_pk_mul_f32 v[80:81], v[80:81], s[100:101]
    v_pk_mul_f32 v[82:83], v[82:83], s[100:101]
    v_pk_mul_f32 v[84:85], v[84:85], s[100:101]
    v_pk_mul_f32 v[86:87], v[86:87], s[100:101]
    v_mfma_f32_16x16x32_bf16 v[120:123], v[224:227], a[224:227], v[120:123]
    v_cvt_pk_bf16_f32 v68, v80, v81
    v_accvgpr_write_b32 a36, v68
    v_mfma_f32_16x16x32_bf16 v[124:127], v[224:227], a[232:235], v[108:111]
    v_cvt_pk_bf16_f32 v69, v82, v83
    v_accvgpr_write_b32 a37, v69
    v_mfma_f32_16x16x32_bf16 v[124:127], v[228:231], a[236:239], v[124:127]
    v_cvt_pk_bf16_f32 v70, v84, v85
    v_accvgpr_write_b32 a38, v70
    v_mfma_f32_16x16x32_bf16 v[108:111], v[228:231], a[204:207], v[108:111]
    v_cvt_pk_bf16_f32 v71, v86, v87
    v_accvgpr_write_b32 a39, v71
    v_mfma_f32_16x16x32_bf16 v[108:111], v[224:227], a[200:203], v[108:111]
    v_lshlrev_b32 v80, 16, v72
    v_and_b32 v81, s3, v72
    v_mfma_f32_16x16x32_bf16 v[208:211], a[116:119], a[36:39], v[208:211]
    v_lshlrev_b32 v82, 16, v73
    v_and_b32 v83, s3, v73
    v_mfma_f32_16x16x32_bf16 v[212:215], a[132:135], a[36:39], v[212:215]
    global_load_lds_dwordx4 v254, s[8:9] offset:0 nt
    v_lshlrev_b32 v84, 16, v74
    v_mfma_f32_16x16x32_bf16 v[216:219], a[148:151], a[36:39], v[216:219]
    s_add_u32 m0, m0, 16
    v_and_b32 v85, s3, v74
    v_lshlrev_b32 v86, 16, v75
    v_mfma_f32_16x16x32_bf16 v[220:223], a[164:167], a[36:39], v[220:223]
    v_and_b32_e64 v87, s3, v75
    v_pk_mul_f32 v[80:81], v[80:81], s[100:101]
    v_pk_mul_f32 v[82:83], v[82:83], s[100:101]
    v_pk_mul_f32 v[84:85], v[84:85], s[100:101]
    v_pk_mul_f32 v[86:87], v[86:87], s[100:101]
    v_cvt_pk_bf16_f32 v72, v80, v81
    v_accvgpr_write_b32 a40, v72
    v_cvt_pk_bf16_f32 v73, v82, v83
    v_accvgpr_write_b32 a41, v73
    v_cvt_pk_bf16_f32 v74, v84, v85
    v_accvgpr_write_b32 a42, v74
    v_cvt_pk_bf16_f32 v75, v86, v87
    v_accvgpr_write_b32 a43, v75
    v_lshlrev_b32 v80, 16, v76
    v_and_b32 v81, s3, v76
    v_mfma_f32_16x16x32_bf16 v[208:211], a[120:123], a[40:43], v[208:211]
    v_lshlrev_b32 v82, 16, v77
    v_and_b32 v83, s3, v77
    v_mfma_f32_16x16x32_bf16 v[212:215], a[136:139], a[40:43], v[212:215]
    v_lshlrev_b32 v84, 16, v78
    v_and_b32 v85, s3, v78
    v_mfma_f32_16x16x32_bf16 v[216:219], a[152:155], a[40:43], v[216:219]
    v_lshlrev_b32 v86, 16, v79
    v_and_b32 v87, s3, v79
    v_mfma_f32_16x16x32_bf16 v[220:223], a[168:171], a[40:43], v[220:223]
    global_load_lds_dwordx4 v254, s[8:9] offset:1024 nt
    v_pk_mul_f32 v[80:81], v[80:81], s[100:101]
    v_pk_mul_f32 v[82:83], v[82:83], s[100:101]
    v_pk_mul_f32 v[84:85], v[84:85], s[100:101]
    v_pk_mul_f32 v[86:87], v[86:87], s[100:101]
    v_cvt_pk_bf16_f32 v76, v80, v81
    v_accvgpr_write_b32 a44, v76
    v_cvt_pk_bf16_f32 v77, v82, v83
    v_accvgpr_write_b32 a45, v77
    v_cvt_pk_bf16_f32 v78, v84, v85
    v_accvgpr_write_b32 a46, v78
    v_cvt_pk_bf16_f32 v79, v86, v87
    v_accvgpr_write_b32 a47, v79
    s_add_u32 m0, s68, 48384
    s_add_u32 s8, s0, 24576
    v_mfma_f32_16x16x32_bf16 v[208:211], a[124:127], a[44:47], v[208:211]
    s_addc_u32 s9, s1, 0
    v_mfma_f32_16x16x32_bf16 v[212:215], a[140:143], a[44:47], v[212:215]
    v_mfma_f32_16x16x32_bf16 v[216:219], a[156:159], a[44:47], v[216:219]
    v_mfma_f32_16x16x32_bf16 v[220:223], a[172:175], a[44:47], v[220:223]
    s_nop 3
    v_exp_f32 v208, v208
    v_exp_f32 v209, v209
    v_exp_f32 v210, v210
    v_cvt_pk_bf16_f32 v232, v208, v209
    v_exp_f32 v211, v211
    v_exp_f32 v212, v212
    v_cvt_pk_bf16_f32 v233, v210, v211
    v_exp_f32 v213, v213
    v_exp_f32 v214, v214
    v_cvt_pk_bf16_f32 v234, v212, v213
    v_exp_f32 v215, v215
    v_exp_f32 v216, v216
    v_cvt_pk_bf16_f32 v235, v214, v215
    v_exp_f32 v217, v217
    v_exp_f32 v218, v218
    v_cvt_pk_bf16_f32 v236, v216, v217
    v_exp_f32 v219, v219
    v_exp_f32 v220, v220
    v_cvt_pk_bf16_f32 v237, v218, v219
    v_exp_f32 v221, v221
    v_exp_f32 v222, v222
    v_cvt_pk_bf16_f32 v238, v220, v221
    v_exp_f32 v223, v223
    s_waitcnt vmcnt(4)
    v_cvt_pk_bf16_f32 v239, v222, v223
    s_nop 1
    v_smfmac_f32_16x16x64_bf16 v[244:247], v[248:251], v[232:239], v240
    ds_read_b128 v[32:35], v63 offset:8704
    ds_read_b128 v[36:39], v63 offset:8768
    ds_read_b128 v[40:43], v63 offset:8832
    ds_read_b128 v[44:47], v63 offset:8896
    v_mov_b32_dpp v248, v248 row_ror:14 row_mask:0xf bank_mask:0xf
    v_mov_b32_dpp v249, v249 row_ror:14 row_mask:0xf bank_mask:0xf
    v_mov_b32_dpp v250, v250 row_ror:14 row_mask:0xf bank_mask:0xf
    v_mov_b32_dpp v251, v251 row_ror:14 row_mask:0xf bank_mask:0xf
    v_add_f32_dpp v58, v244, v245 quad_perm:[0,1,2,3] row_mask:0x2 bank_mask:0xf
    s_nop 1
    v_mfma_f32_16x16x4_f32 v[76:79], v58, v61, 0
    v_mov_b32_e64 v58, 0
    s_nop 8
    v_and_or_b32 v76, v76, s79, v60
    v_and_or_b32 v77, v77, s79, v60
    v_and_or_b32 v78, v78, s79, v60
    v_and_or_b32 v79, v79, s79, v60
    s_nop 1
    v_mfma_f32_16x16x32_bf16 v[64:67], v[232:235], a[176:179], v[76:79]
    ds_write_b128 v59, v[76:79] offset:128
    v_mfma_f32_16x16x32_bf16 v[64:67], v[236:239], a[180:183], v[64:67]
    s_waitcnt lgkmcnt(4)
    v_lshlrev_b32 v48, 16, v32
    v_and_b32 v49, s3, v32
    v_mfma_f32_16x16x32_bf16 v[68:71], v[236:239], a[188:191], v[76:79]
    global_load_lds_dwordx4 v254, s[8:9] offset:0 nt
    v_lshlrev_b32 v50, 16, v33
    v_mfma_f32_16x16x32_bf16 v[68:71], v[232:235], a[184:187], v[68:71]
    s_add_u32 m0, m0, 32
    v_and_b32 v51, s3, v33
    v_lshlrev_b32 v52, 16, v34
    v_mfma_f32_16x16x32_bf16 v[72:75], v[232:235], a[192:195], v[76:79]
    v_and_b32 v53, s3, v34
    v_lshlrev_b32 v54, 16, v35
    v_mfma_f32_16x16x32_bf16 v[72:75], v[236:239], a[196:199], v[72:75]
    v_and_b32_e64 v55, s3, v35
    v_pk_mul_f32 v[48:49], v[48:49], s[100:101]
    v_pk_mul_f32 v[50:51], v[50:51], s[100:101]
    v_pk_mul_f32 v[52:53], v[52:53], s[100:101]
    v_pk_mul_f32 v[54:55], v[54:55], s[100:101]
    v_mfma_f32_16x16x32_bf16 v[80:83], v[236:239], a[212:215], v[76:79]
    v_cvt_pk_bf16_f32 v32, v48, v49
    v_accvgpr_write_b32 a16, v32
    v_mfma_f32_16x16x32_bf16 v[80:83], v[232:235], a[208:211], v[80:83]
    v_cvt_pk_bf16_f32 v33, v50, v51
    v_accvgpr_write_b32 a17, v33
    v_mfma_f32_16x16x32_bf16 v[84:87], v[232:235], a[216:219], v[76:79]
    v_cvt_pk_bf16_f32 v34, v52, v53
    v_accvgpr_write_b32 a18, v34
    v_mfma_f32_16x16x32_bf16 v[84:87], v[236:239], a[220:223], v[84:87]
    global_load_lds_dwordx4 v254, s[8:9] offset:1024 nt
    v_cvt_pk_bf16_f32 v35, v54, v55
    v_mfma_f32_16x16x32_bf16 v[88:91], v[236:239], a[228:231], v[76:79]
    s_add_u32 m0, s69, 65152
    v_accvgpr_write_b32 a19, v35
    s_waitcnt lgkmcnt(0)
    v_lshlrev_b32 v48, 16, v36
    v_mfma_f32_16x16x32_bf16 v[88:91], v[232:235], a[224:227], v[88:91]
    s_add_u32 s8, s38, 24576
    v_and_b32 v49, s3, v36
    v_lshlrev_b32 v50, 16, v37
    v_mfma_f32_16x16x32_bf16 v[208:211], a[112:115], a[16:19], v[240:243]
    s_addc_u32 s9, s39, 0
    v_and_b32 v51, s3, v37
    v_lshlrev_b32 v52, 16, v38
    v_mfma_f32_16x16x32_bf16 v[212:215], a[128:131], a[16:19], v[240:243]
    v_and_b32 v53, s3, v38
    v_lshlrev_b32 v54, 16, v39
    v_mfma_f32_16x16x32_bf16 v[216:219], a[144:147], a[16:19], v[240:243]
    v_and_b32 v55, s3, v39
    v_pk_mul_f32 v[48:49], v[48:49], s[100:101]
    v_pk_mul_f32 v[50:51], v[50:51], s[100:101]
    v_pk_mul_f32 v[52:53], v[52:53], s[100:101]
    v_pk_mul_f32 v[54:55], v[54:55], s[100:101]
    v_mfma_f32_16x16x32_bf16 v[220:223], a[160:163], a[16:19], v[240:243]
    v_cvt_pk_bf16_f32 v36, v48, v49
    v_accvgpr_write_b32 a20, v36
    v_mfma_f32_16x16x32_bf16 v[92:95], v[232:235], a[232:235], v[76:79]
    v_cvt_pk_bf16_f32 v37, v50, v51
    v_accvgpr_write_b32 a21, v37
    v_mfma_f32_16x16x32_bf16 v[92:95], v[236:239], a[236:239], v[92:95]
    v_cvt_pk_bf16_f32 v38, v52, v53
    v_accvgpr_write_b32 a22, v38
    v_mfma_f32_16x16x32_bf16 v[76:79], v[236:239], a[204:207], v[76:79]
    v_cvt_pk_bf16_f32 v39, v54, v55
    v_accvgpr_write_b32 a23, v39
    v_mfma_f32_16x16x32_bf16 v[76:79], v[232:235], a[200:203], v[76:79]
    global_load_lds_dwordx4 v254, s[8:9] offset:0 nt
    v_lshlrev_b32 v48, 16, v40
    v_mfma_f32_16x16x32_bf16 v[208:211], a[116:119], a[20:23], v[208:211]
    s_add_u32 m0, m0, 16
    v_and_b32 v49, s3, v40
    v_lshlrev_b32 v50, 16, v41
    v_mfma_f32_16x16x32_bf16 v[212:215], a[132:135], a[20:23], v[212:215]
    v_and_b32 v51, s3, v41
    v_lshlrev_b32 v52, 16, v42
    v_mfma_f32_16x16x32_bf16 v[216:219], a[148:151], a[20:23], v[216:219]
    v_and_b32 v53, s3, v42
    v_lshlrev_b32 v54, 16, v43
    v_mfma_f32_16x16x32_bf16 v[220:223], a[164:167], a[20:23], v[220:223]
    v_and_b32_e64 v55, s3, v43
    v_pk_mul_f32 v[48:49], v[48:49], s[100:101]
    v_pk_mul_f32 v[50:51], v[50:51], s[100:101]
    v_pk_mul_f32 v[52:53], v[52:53], s[100:101]
    v_pk_mul_f32 v[54:55], v[54:55], s[100:101]
    v_cvt_pk_bf16_f32 v40, v48, v49
    v_accvgpr_write_b32 a24, v40
    v_cvt_pk_bf16_f32 v41, v50, v51
    v_accvgpr_write_b32 a25, v41
    v_cvt_pk_bf16_f32 v42, v52, v53
    v_accvgpr_write_b32 a26, v42
    v_cvt_pk_bf16_f32 v43, v54, v55
    v_accvgpr_write_b32 a27, v43
    v_lshlrev_b32 v48, 16, v44
    v_and_b32 v49, s3, v44
    v_mfma_f32_16x16x32_bf16 v[208:211], a[120:123], a[24:27], v[208:211]
    global_load_lds_dwordx4 v254, s[8:9] offset:1024 nt
    v_lshlrev_b32 v50, 16, v45
    v_mfma_f32_16x16x32_bf16 v[212:215], a[136:139], a[24:27], v[212:215]
    s_add_u32 m0, s68, 73472
    v_and_b32 v51, s3, v45
    v_lshlrev_b32 v52, 16, v46
    v_mfma_f32_16x16x32_bf16 v[216:219], a[152:155], a[24:27], v[216:219]
    s_add_u32 s8, s0, 32768
    v_and_b32 v53, s3, v46
    v_lshlrev_b32 v54, 16, v47
    v_mfma_f32_16x16x32_bf16 v[220:223], a[168:171], a[24:27], v[220:223]
    s_addc_u32 s9, s1, 0
    v_and_b32_e64 v55, s3, v47
    v_pk_mul_f32 v[48:49], v[48:49], s[100:101]
    v_pk_mul_f32 v[50:51], v[50:51], s[100:101]
    v_pk_mul_f32 v[52:53], v[52:53], s[100:101]
    v_pk_mul_f32 v[54:55], v[54:55], s[100:101]
    v_cvt_pk_bf16_f32 v44, v48, v49
    v_accvgpr_write_b32 a28, v44
    v_cvt_pk_bf16_f32 v45, v50, v51
    v_accvgpr_write_b32 a29, v45
    v_cvt_pk_bf16_f32 v46, v52, v53
    v_accvgpr_write_b32 a30, v46
    v_cvt_pk_bf16_f32 v47, v54, v55
    v_accvgpr_write_b32 a31, v47
    v_mov_b32 v236, 0
    v_mov_b32 v237, 0
    v_mfma_f32_16x16x32_bf16 v[208:211], a[124:127], a[28:31], v[208:211]
    v_mov_b32 v238, 0
    v_mov_b32_e64 v239, 0
    v_mfma_f32_16x16x32_bf16 v[212:215], a[140:143], a[28:31], v[212:215]
    v_mfma_f32_16x16x32_bf16 v[216:219], a[156:159], a[28:31], v[216:219]
    s_nop 3
    s_waitcnt vmcnt(6)
    v_mfma_f32_16x16x32_bf16 v[220:223], a[172:175], a[28:31], v[220:223]
    s_barrier
    ds_read_b128 a[112:115], v252 offset:33536
    ds_read_b128 a[116:119], v252 offset:33600
    ds_read_b128 a[120:123], v252 offset:33664
    ds_read_b128 a[124:127], v252 offset:33728
    ds_read_b128 a[96:99], v62 offset:21760
    ds_read_b128 a[100:103], v62 offset:21824
    ds_read_b128 a[104:107], v62 offset:21888
    ds_read_b128 a[108:111], v62 offset:21952
    ds_read_b128 a[240:243], v62 offset:26112
    ds_read_b128 a[244:247], v62 offset:26176
    ds_read_b128 a[248:251], v62 offset:26240
    ds_read_b128 a[252:255], v62 offset:26304
    ds_read_b128 v[192:195], v62 offset:30464
    ds_read_b128 v[196:199], v62 offset:30528
    ds_read_b128 v[200:203], v62 offset:30592
    ds_read_b128 v[204:207], v62 offset:30656
    ds_read_b128 a[128:131], v252 offset:34048
    ds_read_b128 a[132:135], v252 offset:34112
    ds_read_b128 a[136:139], v252 offset:34176
    ds_read_b128 a[140:143], v252 offset:34240
    v_exp_f32 v208, v208
    v_exp_f32 v209, v209
    v_exp_f32 v210, v210
    v_cvt_pk_bf16_f32 v224, v208, v209
    v_exp_f32 v211, v211
    v_exp_f32 v212, v212
    v_cvt_pk_bf16_f32 v225, v210, v211
    v_exp_f32 v213, v213
    v_exp_f32 v214, v214
    v_cvt_pk_bf16_f32 v226, v212, v213
    v_exp_f32 v215, v215
    s_waitcnt lgkmcnt(15)
    v_mfma_f32_16x16x32_bf16 v[208:211], a[112:115], a[96:99], v[240:243]
    s_waitcnt lgkmcnt(14)
    v_exp_f32 v216, v216
    v_mfma_f32_16x16x32_bf16 v[208:211], a[116:119], a[100:103], v[208:211]
    s_waitcnt lgkmcnt(13)
    v_exp_f32 v217, v217
    v_mfma_f32_16x16x32_bf16 v[208:211], a[120:123], a[104:107], v[208:211]
    s_waitcnt lgkmcnt(12)
    v_cvt_pk_bf16_f32 v227, v214, v215
    v_cvt_pk_bf16_f32 v228, v216, v217
    v_mfma_f32_16x16x32_bf16 v[208:211], a[124:127], a[108:111], v[208:211]
    v_exp_f32 v218, v218
    v_mfma_f32_16x16x32_bf16 v[212:215], a[112:115], a[16:19], v[240:243]
    v_exp_f32 v219, v219
    v_mfma_f32_16x16x32_bf16 v[212:215], a[116:119], a[20:23], v[212:215]
    v_exp_f32 v220, v220
    v_mfma_f32_16x16x32_bf16 v[212:215], a[120:123], a[24:27], v[212:215]
    v_exp_f32 v221, v221
    v_mfma_f32_16x16x32_bf16 v[212:215], a[124:127], a[28:31], v[212:215]
    s_waitcnt lgkmcnt(0)
    v_cvt_pk_bf16_f32 v229, v218, v219
    v_cvt_pk_bf16_f32 v230, v220, v221
    v_mfma_f32_16x16x32_bf16 v[216:219], a[140:143], a[28:31], v[240:243]
    v_exp_f32 v222, v222
    v_mfma_f32_16x16x32_bf16 v[216:219], a[136:139], a[24:27], v[216:219]
    v_exp_f32 v223, v223
    v_mfma_f32_16x16x32_bf16 v[216:219], a[132:135], a[20:23], v[216:219]
    v_exp_f32 v208, v208
    v_mfma_f32_16x16x32_bf16 v[216:219], a[128:131], a[16:19], v[216:219]
    v_cvt_pk_bf16_f32 v231, v222, v223
    v_mfma_f32_16x16x32_bf16 v[220:223], a[112:115], a[240:243], v[240:243]
    v_exp_f32 v209, v209
    v_mfma_f32_16x16x32_bf16 v[220:223], a[116:119], a[244:247], v[220:223]
    v_exp_f32 v210, v210
    v_mfma_f32_16x16x32_bf16 v[220:223], a[120:123], a[248:251], v[220:223]
    v_exp_f32 v211, v211
    v_mfma_f32_16x16x32_bf16 v[220:223], a[124:127], a[252:255], v[220:223]
    v_cvt_pk_bf16_f32 v208, v208, v209
    v_cvt_pk_bf16_f32 v209, v210, v211
    v_exp_f32 v212, v212
    v_smfmac_f32_16x16x64_bf16 v[244:247], v[248:251], v[224:231], v240
    ds_write_b64 v254, v[208:209] offset:3072
    v_mfma_f32_16x16x32_bf16 v[208:211], a[112:115], a[32:35], v[240:243]
    v_exp_f32 v213, v213
    v_mfma_f32_16x16x32_bf16 v[208:211], a[116:119], a[36:39], v[208:211]
    s_nop 3
    v_add_f32_dpp v58, v246, v247 quad_perm:[0,1,2,3] row_mask:0x1 bank_mask:0xf
    v_cvt_pk_bf16_f32 v232, v212, v213
    v_mfma_f32_16x16x32_bf16 v[208:211], a[120:123], a[40:43], v[208:211]
    v_exp_f32 v214, v214
    v_mfma_f32_16x16x32_bf16 v[208:211], a[124:127], a[44:47], v[208:211]
    v_exp_f32 v215, v215
    v_exp_f32 v216, v216
    v_mfma_f32_16x16x4_f32 v[44:47], v58, v61, 0
    v_cvt_pk_bf16_f32 v233, v214, v215
    v_mfma_f32_16x16x32_bf16 v[212:215], a[140:143], a[44:47], v[240:243]
    s_nop 7
    v_and_or_b32 v44, v44, s79, v60
    v_and_or_b32 v45, v45, s79, v60
    v_mfma_f32_16x16x32_bf16 v[212:215], a[136:139], a[40:43], v[212:215]
    v_and_or_b32 v46, v46, s79, v60
    v_and_or_b32 v47, v47, s79, v60
    v_mfma_f32_16x16x32_bf16 v[212:215], a[132:135], a[36:39], v[212:215]
    ds_write_b128 v59, v[44:47] offset:64
    v_mfma_f32_16x16x32_bf16 v[32:35], v[224:227], a[176:179], v[44:47]
    v_exp_f32 v217, v217
    v_mfma_f32_16x16x32_bf16 v[32:35], v[228:231], a[180:183], v[32:35]
    v_exp_f32 v218, v218
    v_mfma_f32_16x16x32_bf16 v[36:39], v[228:231], a[188:191], v[44:47]
    v_exp_f32 v219, v219
    v_mfma_f32_16x16x32_bf16 v[36:39], v[224:227], a[184:187], v[36:39]
    v_cvt_pk_bf16_f32 v234, v216, v217
    s_nop 2
    s_waitcnt vmcnt(4)
    v_mfma_f32_16x16x32_bf16 v[40:43], v[224:227], a[192:195], v[44:47]
    s_waitcnt lgkmcnt(0)
    s_barrier
    ds_read_b64_tr_b16 a[176:177], v253 offset:33536
    ds_read_b64_tr_b16 a[178:179], v253 offset:34048
    v_mfma_f32_16x16x32_bf16 v[40:43], v[228:231], a[196:199], v[40:43]
    ds_read_b64_tr_b16 a[184:185], v253 offset:33552
    ds_read_b64_tr_b16 a[186:187], v253 offset:34064
    v_mfma_f32_16x16x32_bf16 v[48:51], v[228:231], a[212:215], v[44:47]
    ds_read_b64_tr_b16 a[192:193], v253 offset:33568
    ds_read_b64_tr_b16 a[194:195], v253 offset:34080
    v_mfma_f32_16x16x32_bf16 v[48:51], v[224:227], a[208:211], v[48:51]
    ds_read_b64_tr_b16 a[208:209], v253 offset:33600
    ds_read_b64_tr_b16 a[210:211], v253 offset:34112
    v_mfma_f32_16x16x32_bf16 v[52:55], v[224:227], a[216:219], v[44:47]
    ds_read_b64_tr_b16 a[216:217], v253 offset:33616
    ds_read_b64_tr_b16 a[218:219], v253 offset:34128
    v_mfma_f32_16x16x32_bf16 v[52:55], v[228:231], a[220:223], v[52:55]
    global_load_lds_dwordx4 v254, s[8:9] offset:0 nt
    s_add_u32 m0, m0, 32
    v_mfma_f32_16x16x32_bf16 v[56:59], v[228:231], a[228:231], v[44:47]
    global_load_lds_dwordx4 v254, s[8:9] offset:1024 nt
    v_cvt_pk_bf16_f32 v235, v218, v219
    v_mfma_f32_16x16x32_bf16 v[56:59], v[224:227], a[224:227], v[56:59]
    s_waitcnt vmcnt(2)
    ds_read_b64_tr_b16 a[224:225], v253 offset:33632
    ds_read_b64_tr_b16 a[226:227], v253 offset:34144
    v_mfma_f32_16x16x32_bf16 v[60:63], v[224:227], a[232:235], v[44:47]
    s_barrier
    ds_read_b64_tr_b16 a[232:233], v253 offset:33648
    ds_read_b64_tr_b16 a[234:235], v253 offset:34160
    v_mfma_f32_16x16x32_bf16 v[60:63], v[228:231], a[236:239], v[60:63]
    s_add_u32 m0, s69, 90368
    ds_read_b128 a[144:147], v252 offset:41984
    ds_read_b128 a[148:151], v252 offset:42048
    v_mfma_f32_16x16x32_bf16 v[44:47], v[228:231], a[204:207], v[44:47]
    s_add_u32 s8, s38, 32768
    ds_read_b128 a[152:155], v252 offset:42112
    ds_read_b128 a[156:159], v252 offset:42176
    v_mfma_f32_16x16x32_bf16 v[44:47], v[224:227], a[200:203], v[44:47]
    s_addc_u32 s9, s39, 0
    ds_read_b64_tr_b16 a[200:201], v253 offset:33584
    ds_read_b64_tr_b16 a[202:203], v253 offset:34096
    v_mfma_f32_16x16x32_bf16 v[212:215], a[128:131], a[32:35], v[212:215]
    ds_read_b128 a[160:163], v252 offset:42496
    ds_read_b128 a[164:167], v252 offset:42560
    v_mfma_f32_16x16x32_bf16 v[216:219], a[112:115], v[192:195], v[240:243]
    ds_read_b128 a[168:171], v252 offset:42624
    ds_read_b128 a[172:175], v252 offset:42688
    v_mfma_f32_16x16x32_bf16 v[216:219], a[116:119], v[196:199], v[216:219]
    ds_read_b64_tr_b16 a[180:181], v253 offset:41856
    ds_read_b64_tr_b16 a[182:183], v253 offset:42368
    v_mfma_f32_16x16x32_bf16 v[216:219], a[120:123], v[200:203], v[216:219]
    ds_read_b64_tr_b16 a[188:189], v253 offset:41872
    ds_read_b64_tr_b16 a[190:191], v253 offset:42384
    v_mfma_f32_16x16x32_bf16 v[216:219], a[124:127], v[204:207], v[216:219]
    s_waitcnt lgkmcnt(15)
    ds_read_b64_tr_b16 a[196:197], v253 offset:41888
    ds_read_b64_tr_b16 a[198:199], v253 offset:42400
    v_mfma_f32_16x16x32_bf16 v[32:35], v[232:235], a[176:179], v[32:35]
    s_waitcnt lgkmcnt(15)
    ds_read_b64_tr_b16 a[204:205], v253 offset:41904
    ds_read_b64_tr_b16 a[206:207], v253 offset:42416
    v_mfma_f32_16x16x32_bf16 v[36:39], v[232:235], a[184:187], v[36:39]
    s_waitcnt lgkmcnt(15)
    ds_read_b64_tr_b16 a[212:213], v253 offset:41920
    ds_read_b64_tr_b16 a[214:215], v253 offset:42432
    v_mfma_f32_16x16x32_bf16 v[40:43], v[232:235], a[192:195], v[40:43]
    s_waitcnt lgkmcnt(15)
    ds_read_b64_tr_b16 a[220:221], v253 offset:41936
    ds_read_b64_tr_b16 a[222:223], v253 offset:42448
    v_mfma_f32_16x16x32_bf16 v[48:51], v[232:235], a[208:211], v[48:51]
    s_waitcnt lgkmcnt(15)
    ds_read_b64_tr_b16 a[228:229], v253 offset:41952
    ds_read_b64_tr_b16 a[230:231], v253 offset:42464
    v_mfma_f32_16x16x32_bf16 v[44:47], v[232:235], a[200:203], v[44:47]
    ds_read_b64_tr_b16 a[236:237], v253 offset:41968
    ds_read_b64_tr_b16 a[238:239], v253 offset:42480
    v_mfma_f32_16x16x32_bf16 v[52:55], v[232:235], a[216:219], v[52:55]
    v_add_u32 v252, 67072, v252
    v_add_u32 v253, 67072, v253
    v_mfma_f32_16x16x32_bf16 v[56:59], v[232:235], a[224:227], v[56:59]
    global_load_lds_dwordx4 v254, s[8:9] offset:0 nt
    s_add_u32 m0, m0, 16
    v_mfma_f32_16x16x32_bf16 v[60:63], v[232:235], a[232:235], v[60:63]
    global_load_lds_dwordx4 v254, s[8:9] offset:1024 nt
    v_mov_b32 v228, 0
    v_exp_f32 v220, v220
    v_smfmac_f32_16x16x64_bf16 v[244:247], v[248:251], v[232:239], v240
    s_add_u32 m0, s68, 81920
    v_exp_f32 v221, v221
    v_exp_f32 v222, v222
    v_cvt_pk_bf16_f32 v220, v220, v221
    v_exp_f32 v223, v223
    v_exp_f32 v208, v208
    v_cvt_pk_bf16_f32 v221, v222, v223
    s_add_u32 s8, s0, 40960
    s_addc_u32 s9, s1, 0
    ds_write_b64 v254, v[220:221] offset:4096
    v_mfma_f32_16x16x32_bf16 v[220:223], a[112:115], a[48:51], v[240:243]
    global_load_lds_dwordx4 v254, s[8:9] offset:0 nt
    v_mov_b32_dpp v248, v248 row_ror:2 row_mask:0xf bank_mask:0xf
    v_mfma_f32_16x16x32_bf16 v[220:223], a[116:119], a[52:55], v[220:223]
    s_add_u32 m0, m0, 32
    s_nop 0
    global_load_lds_dwordx4 v254, s[8:9] offset:1024 nt
    v_mov_b32_dpp v249, v249 row_ror:2 row_mask:0xf bank_mask:0xf
    v_mfma_f32_16x16x32_bf16 v[220:223], a[120:123], a[56:59], v[220:223]
    s_add_u32 m0, s69, 98688
    v_exp_f32 v209, v209
    v_mfma_f32_16x16x32_bf16 v[220:223], a[124:127], a[60:63], v[220:223]
    s_add_u32 s8, s38, 40960
    v_cvt_pk_bf16_f32 v224, v208, v209
    v_exp_f32 v210, v210
    v_exp_f32 v211, v211
    v_exp_f32 v212, v212
    v_cvt_pk_bf16_f32 v225, v210, v211
    v_mfma_f32_16x16x32_bf16 v[208:211], a[140:143], a[60:63], v[240:243]
    s_addc_u32 s9, s39, 0
    v_exp_f32 v213, v213
    v_mfma_f32_16x16x32_bf16 v[208:211], a[136:139], a[56:59], v[208:211]
    v_cvt_pk_bf16_f32 v226, v212, v213
    v_mov_b32_dpp v250, v250 row_ror:2 row_mask:0xf bank_mask:0xf
    v_mfma_f32_16x16x32_bf16 v[208:211], a[132:135], a[52:55], v[208:211]
    v_exp_f32 v214, v214
    v_mfma_f32_16x16x32_bf16 v[208:211], a[128:131], a[48:51], v[208:211]
    v_exp_f32 v215, v215
    v_mov_b32_dpp v251, v251 row_ror:2 row_mask:0xf bank_mask:0xf
    v_cvt_pk_bf16_f32 v227, v214, v215
    v_mfma_f32_16x16x32_bf16 v[212:215], a[140:143], a[108:111], v[240:243]
    v_mov_b32 v229, 0
    v_mov_b32 v230, 0
    v_mfma_f32_16x16x32_bf16 v[212:215], a[136:139], a[104:107], v[212:215]
    v_exp_f32 v216, v216
    v_mfma_f32_16x16x32_bf16 v[212:215], a[132:135], a[100:103], v[212:215]
    v_exp_f32 v217, v217
    v_mfma_f32_16x16x32_bf16 v[212:215], a[128:131], a[96:99], v[212:215]
    v_mov_b32 v231, 0
    v_cvt_pk_bf16_f32 v216, v216, v217
    v_mfma_f32_16x16x32_bf16 v[64:67], v[224:227], a[176:179], v[64:67]
    global_load_lds_dwordx4 v254, s[8:9] offset:0 nt
    v_mfma_f32_16x16x32_bf16 v[68:71], v[224:227], a[184:187], v[68:71]
    s_add_u32 m0, m0, 16
    v_exp_f32 v218, v218
    v_mfma_f32_16x16x32_bf16 v[72:75], v[224:227], a[192:195], v[72:75]
    v_exp_f32 v219, v219
    v_mfma_f32_16x16x32_bf16 v[76:79], v[224:227], a[200:203], v[76:79]
    v_exp_f32 v220, v220
    v_mfma_f32_16x16x32_bf16 v[80:83], v[224:227], a[208:211], v[80:83]
    v_exp_f32 v221, v221
    v_mfma_f32_16x16x32_bf16 v[84:87], v[224:227], a[216:219], v[84:87]
    v_cvt_pk_bf16_f32 v217, v218, v219
    v_cvt_pk_bf16_f32 v232, v220, v221
    v_mfma_f32_16x16x32_bf16 v[88:91], v[224:227], a[224:227], v[88:91]
    ds_write_b64 v254, v[216:217] offset:5120
    v_mfma_f32_16x16x32_bf16 v[216:219], a[112:115], a[64:67], v[240:243]
    v_exp_f32 v222, v222
    v_mfma_f32_16x16x32_bf16 v[216:219], a[116:119], a[68:71], v[216:219]
    v_exp_f32 v223, v223
    v_mfma_f32_16x16x32_bf16 v[216:219], a[120:123], a[72:75], v[216:219]
    v_exp_f32 v208, v208
    v_mfma_f32_16x16x32_bf16 v[216:219], a[124:127], a[76:79], v[216:219]
    v_exp_f32 v209, v209
    v_mfma_f32_16x16x32_bf16 v[92:95], v[224:227], a[232:235], v[92:95]
    v_cvt_pk_bf16_f32 v233, v222, v223
    v_cvt_pk_bf16_f32 v234, v208, v209
    v_mfma_f32_16x16x32_bf16 v[220:223], a[140:143], a[76:79], v[240:243]
    global_load_lds_dwordx4 v254, s[8:9] offset:1024 nt
    v_mfma_f32_16x16x32_bf16 v[220:223], a[136:139], a[72:75], v[220:223]
    v_exp_f32 v210, v210
    v_mfma_f32_16x16x32_bf16 v[220:223], a[132:135], a[68:71], v[220:223]
    v_exp_f32 v211, v211
    v_mfma_f32_16x16x32_bf16 v[220:223], a[128:131], a[64:67], v[220:223]
    v_exp_f32 v212, v212
    v_cvt_pk_bf16_f32 v235, v210, v211
    v_smfmac_f32_16x16x64_bf16 v[244:247], v[248:251], v[224:231], v240
    v_exp_f32 v213, v213
    v_mov_b32_dpp v248, v248 row_ror:2 row_mask:0xf bank_mask:0xf
    v_mfma_f32_16x16x32_bf16 v[208:211], a[144:147], a[64:67], v[240:243]
    v_mov_b32_dpp v249, v249 row_ror:2 row_mask:0xf bank_mask:0xf
    v_mov_b32_dpp v250, v250 row_ror:2 row_mask:0xf bank_mask:0xf
    v_mfma_f32_16x16x32_bf16 v[208:211], a[148:151], a[68:71], v[208:211]
    v_mov_b32_dpp v251, v251 row_ror:2 row_mask:0xf bank_mask:0xf
    v_cvt_pk_bf16_f32 v212, v212, v213
    v_mfma_f32_16x16x32_bf16 v[208:211], a[152:155], a[72:75], v[208:211]
    v_exp_f32 v214, v214
    v_mfma_f32_16x16x32_bf16 v[208:211], a[156:159], a[76:79], v[208:211]
    v_exp_f32 v215, v215
    v_mfma_f32_16x16x32_bf16 v[96:99], v[232:235], a[176:179], v[96:99]
    v_exp_f32 v216, v216
    v_mfma_f32_16x16x32_bf16 v[100:103], v[232:235], a[184:187], v[100:103]
    v_exp_f32 v217, v217
    v_mfma_f32_16x16x32_bf16 v[104:107], v[232:235], a[192:195], v[104:107]
    v_cvt_pk_bf16_f32 v213, v214, v215
    v_cvt_pk_bf16_f32 v224, v216, v217
    v_mfma_f32_16x16x32_bf16 v[108:111], v[232:235], a[200:203], v[108:111]
    s_waitcnt lgkmcnt(0)
    ds_write_b64 v254, v[212:213] offset:3080
    v_mfma_f32_16x16x32_bf16 v[212:215], a[172:175], a[76:79], v[240:243]
    v_exp_f32 v218, v218
    v_mfma_f32_16x16x32_bf16 v[212:215], a[168:171], a[72:75], v[212:215]
    v_exp_f32 v219, v219
    v_mfma_f32_16x16x32_bf16 v[212:215], a[164:167], a[68:71], v[212:215]
    v_exp_f32 v220, v220
    v_mfma_f32_16x16x32_bf16 v[212:215], a[160:163], a[64:67], v[212:215]
    v_exp_f32 v221, v221
    v_mfma_f32_16x16x32_bf16 v[112:115], v[232:235], a[208:211], v[112:115]
    v_cvt_pk_bf16_f32 v225, v218, v219
    v_cvt_pk_bf16_f32 v226, v220, v221
    v_mfma_f32_16x16x32_bf16 v[116:119], v[232:235], a[216:219], v[116:119]
    v_exp_f32 v222, v222
    v_mfma_f32_16x16x32_bf16 v[216:219], a[140:143], a[252:255], v[240:243]
    v_exp_f32 v223, v223
    v_mfma_f32_16x16x32_bf16 v[120:123], v[232:235], a[224:227], v[120:123]
    v_exp_f32 v208, v208
    v_mfma_f32_16x16x32_bf16 v[216:219], a[136:139], a[248:251], v[216:219]
    v_exp_f32 v209, v209
    v_mfma_f32_16x16x32_bf16 v[124:127], v[232:235], a[232:235], v[124:127]
    v_cvt_pk_bf16_f32 v227, v222, v223
    v_cvt_pk_bf16_f32 v228, v208, v209
    v_mfma_f32_16x16x32_bf16 v[216:219], a[132:135], a[244:247], v[216:219]
    v_exp_f32 v210, v210
    v_mfma_f32_16x16x32_bf16 v[216:219], a[128:131], a[240:243], v[216:219]
    v_exp_f32 v211, v211
    v_mfma_f32_16x16x32_bf16 v[220:223], a[172:175], a[92:95], v[240:243]
    v_exp_f32 v212, v212
    v_mfma_f32_16x16x32_bf16 v[220:223], a[168:171], a[88:91], v[220:223]
    v_exp_f32 v213, v213
    v_mfma_f32_16x16x32_bf16 v[220:223], a[164:167], a[84:87], v[220:223]
    v_cvt_pk_bf16_f32 v229, v210, v211
    v_cvt_pk_bf16_f32 v230, v212, v213
    v_mfma_f32_16x16x32_bf16 v[208:211], a[112:115], a[80:83], v[240:243]
    v_exp_f32 v214, v214
    v_mfma_f32_16x16x32_bf16 v[208:211], a[116:119], a[84:87], v[208:211]
    v_exp_f32 v215, v215
    v_mfma_f32_16x16x32_bf16 v[208:211], a[120:123], a[88:91], v[208:211]
    v_exp_f32 v216, v216
    v_mfma_f32_16x16x32_bf16 v[208:211], a[124:127], a[92:95], v[208:211]
    v_exp_f32 v217, v217
    v_mfma_f32_16x16x32_bf16 v[220:223], a[160:163], a[80:83], v[220:223]
    v_cvt_pk_bf16_f32 v231, v214, v215
    v_cvt_pk_bf16_f32 v216, v216, v217
    v_mfma_f32_16x16x32_bf16 v[212:215], a[140:143], a[92:95], v[240:243]
    v_exp_f32 v218, v218
    v_mfma_f32_16x16x32_bf16 v[212:215], a[136:139], a[88:91], v[212:215]
    v_exp_f32 v219, v219
    v_mfma_f32_16x16x32_bf16 v[212:215], a[132:135], a[84:87], v[212:215]
    v_exp_f32 v208, v208
    v_mfma_f32_16x16x32_bf16 v[212:215], a[128:131], a[80:83], v[212:215]
    v_exp_f32 v209, v209
    v_mfma_f32_16x16x32_bf16 v[128:131], v[224:227], a[176:179], v[128:131]
    v_exp_f32 v210, v210
    v_mfma_f32_16x16x32_bf16 v[128:131], v[228:231], a[180:183], v[128:131]
    v_exp_f32 v211, v211
    v_mfma_f32_16x16x32_bf16 v[132:135], v[228:231], a[188:191], v[132:135]
    s_nop 1
    v_exp_f32 v212, v212
    v_mfma_f32_16x16x32_bf16 v[132:135], v[224:227], a[184:187], v[132:135]
    v_exp_f32 v213, v213
    v_mfma_f32_16x16x32_bf16 v[136:139], v[224:227], a[192:195], v[136:139]
    v_exp_f32 v214, v214
    v_mfma_f32_16x16x32_bf16 v[136:139], v[228:231], a[196:199], v[136:139]
    v_exp_f32 v215, v215
    v_mfma_f32_16x16x32_bf16 v[140:143], v[228:231], a[204:207], v[140:143]
    v_cvt_pk_bf16_f32 v217, v218, v219
    v_mfma_f32_16x16x32_bf16 v[140:143], v[224:227], a[200:203], v[140:143]
    ds_write_b64 v254, v[216:217] offset:4104
    v_smfmac_f32_16x16x64_bf16 v[244:247], v[248:251], v[232:239], v240
    v_mov_b32_dpp v248, v248 row_ror:2 row_mask:0xf bank_mask:0xf
    v_mfma_f32_16x16x32_bf16 v[216:219], a[144:147], a[80:83], v[240:243]
    v_mov_b32_dpp v249, v249 row_ror:2 row_mask:0xf bank_mask:0xf
    v_mov_b32_dpp v250, v250 row_ror:2 row_mask:0xf bank_mask:0xf
    v_mfma_f32_16x16x32_bf16 v[216:219], a[148:151], a[84:87], v[216:219]
    v_mov_b32_dpp v251, v251 row_ror:2 row_mask:0xf bank_mask:0xf
    v_cvt_pk_bf16_f32 v232, v208, v209
    v_mfma_f32_16x16x32_bf16 v[216:219], a[152:155], a[88:91], v[216:219]
    v_cvt_pk_bf16_f32 v233, v210, v211
    v_cvt_pk_bf16_f32 v234, v212, v213
    v_mfma_f32_16x16x32_bf16 v[216:219], a[156:159], a[92:95], v[216:219]
    v_cvt_pk_bf16_f32 v235, v214, v215
    v_mfma_f32_16x16x32_bf16 v[144:147], v[224:227], a[208:211], v[144:147]
    v_mfma_f32_16x16x32_bf16 v[144:147], v[228:231], a[212:215], v[144:147]
    v_mfma_f32_16x16x32_bf16 v[148:151], v[228:231], a[220:223], v[148:151]
    s_nop 3
    v_exp_f32 v216, v216
    v_mfma_f32_16x16x32_bf16 v[148:151], v[224:227], a[216:219], v[148:151]
    v_exp_f32 v217, v217
    v_mfma_f32_16x16x32_bf16 v[152:155], v[224:227], a[224:227], v[152:155]
    v_exp_f32 v218, v218
    v_mfma_f32_16x16x32_bf16 v[152:155], v[228:231], a[228:231], v[152:155]
    v_exp_f32 v219, v219
    v_mfma_f32_16x16x32_bf16 v[156:159], v[228:231], a[236:239], v[156:159]
    v_cvt_pk_bf16_f32 v236, v216, v217
    v_cvt_pk_bf16_f32 v237, v218, v219
    v_mfma_f32_16x16x32_bf16 v[156:159], v[224:227], a[232:235], v[156:159]
    v_smfmac_f32_16x16x64_bf16 v[244:247], v[248:251], v[224:231], v240
    v_mfma_f32_16x16x32_bf16 v[208:211], a[140:143], v[204:207], v[240:243]
    v_exp_f32 v220, v220
    v_mfma_f32_16x16x32_bf16 v[208:211], a[136:139], v[200:203], v[208:211]
    v_exp_f32 v221, v221
    v_mfma_f32_16x16x32_bf16 v[208:211], a[132:135], v[196:199], v[208:211]
    v_mov_b32_dpp v248, v248 row_ror:2 row_mask:0xf bank_mask:0xf
    v_cvt_pk_bf16_f32 v238, v220, v221
    v_mfma_f32_16x16x32_bf16 v[208:211], a[128:131], v[192:195], v[208:211]
    v_exp_f32 v222, v222
    v_mfma_f32_16x16x32_bf16 v[212:215], a[112:115], a[0:3], v[240:243]
    v_mov_b32_dpp v250, v250 row_ror:2 row_mask:0xf bank_mask:0xf
    v_mov_b32_dpp v249, v249 row_ror:2 row_mask:0xf bank_mask:0xf
    v_mfma_f32_16x16x32_bf16 v[212:215], a[116:119], a[4:7], v[212:215]
    v_exp_f32 v223, v223
    v_mfma_f32_16x16x32_bf16 v[212:215], a[120:123], a[8:11], v[212:215]
    v_mov_b32_dpp v251, v251 row_ror:2 row_mask:0xf bank_mask:0xf
    v_cvt_pk_bf16_f32 v239, v222, v223
    v_mfma_f32_16x16x32_bf16 v[212:215], a[124:127], a[12:15], v[212:215]
    v_exp_f32 v208, v208
    v_mfma_f32_16x16x32_bf16 v[216:219], a[140:143], a[12:15], v[240:243]
    v_exp_f32 v209, v209
    v_mfma_f32_16x16x32_bf16 v[216:219], a[136:139], a[8:11], v[216:219]
    v_cvt_pk_bf16_f32 v208, v208, v209
    v_mfma_f32_16x16x32_bf16 v[216:219], a[132:135], a[4:7], v[216:219]
    v_exp_f32 v210, v210
    v_mfma_f32_16x16x32_bf16 v[216:219], a[128:131], a[0:3], v[216:219]
    ds_write_b32 v254, v208 offset:5128
    v_mfma_f32_16x16x32_bf16 v[220:223], a[144:147], a[0:3], v[240:243]
    v_exp_f32 v211, v211
    v_mfma_f32_16x16x32_bf16 v[220:223], a[148:151], a[4:7], v[220:223]
    v_cvt_pk_bf16_f32 v209, v210, v211
    v_mfma_f32_16x16x32_bf16 v[220:223], a[152:155], a[8:11], v[220:223]
    ds_write_b32 v254, v209 offset:5132
    v_mfma_f32_16x16x32_bf16 v[220:223], a[156:159], a[12:15], v[220:223]
    v_exp_f32 v212, v212
    v_mfma_f32_16x16x32_bf16 v[208:211], a[172:175], a[12:15], v[240:243]
    v_exp_f32 v213, v213
    v_mfma_f32_16x16x32_bf16 v[208:211], a[168:171], a[8:11], v[208:211]
    v_cvt_pk_bf16_f32 v224, v212, v213
    v_mfma_f32_16x16x32_bf16 v[208:211], a[164:167], a[4:7], v[208:211]
    v_exp_f32 v214, v214
    v_mfma_f32_16x16x32_bf16 v[208:211], a[160:163], a[0:3], v[208:211]
    s_waitcnt vmcnt(6)
    v_mfma_f32_16x16x32_bf16 v[160:163], v[232:235], a[176:179], v[160:163]
    s_waitcnt lgkmcnt(0)
    v_exp_f32 v215, v215
    v_mfma_f32_16x16x32_bf16 v[160:163], v[236:239], a[180:183], v[160:163]
    s_barrier
    v_cvt_pk_bf16_f32 v225, v214, v215
    v_mfma_f32_16x16x32_bf16 v[164:167], v[236:239], a[188:191], v[164:167]
    v_exp_f32 v216, v216
    v_mfma_f32_16x16x32_bf16 v[164:167], v[232:235], a[184:187], v[164:167]
    v_exp_f32 v217, v217
    v_mfma_f32_16x16x32_bf16 v[168:171], v[232:235], a[192:195], v[168:171]
    s_add_u32 m0, s68, 6400
    ds_read_b128 a[124:127], v252 offset:192
    v_cvt_pk_bf16_f32 v226, v216, v217
    v_mfma_f32_16x16x32_bf16 v[168:171], v[236:239], a[196:199], v[168:171]
    s_add_u32 s8, s0, 49152
    v_exp_f32 v218, v218
    v_mfma_f32_16x16x32_bf16 v[172:175], v[236:239], a[204:207], v[172:175]
    s_addc_u32 s9, s1, 0
    ds_read_b128 a[120:123], v252 offset:128
    global_load_lds_dwordx4 v254, s[8:9] offset:0 nt
    v_mfma_f32_16x16x32_bf16 v[172:175], v[232:235], a[200:203], v[172:175]
    v_exp_f32 v219, v219
    v_mfma_f32_16x16x32_bf16 v[176:179], v[232:235], a[208:211], v[176:179]
    ds_read_b128 a[116:119], v252 offset:64
    v_cvt_pk_bf16_f32 v227, v218, v219
    v_mfma_f32_16x16x32_bf16 v[176:179], v[236:239], a[212:215], v[176:179]
    v_exp_f32 v220, v220
    v_mfma_f32_16x16x32_bf16 v[180:183], v[236:239], a[220:223], v[180:183]
    v_exp_f32 v221, v221
    v_mfma_f32_16x16x32_bf16 v[180:183], v[232:235], a[216:219], v[180:183]
    ds_read_b128 a[112:115], v252 offset:0
    v_cvt_pk_bf16_f32 v228, v220, v221
    v_mfma_f32_16x16x32_bf16 v[184:187], v[232:235], a[224:227], v[184:187]
    v_exp_f32 v222, v222
    v_mfma_f32_16x16x32_bf16 v[184:187], v[236:239], a[228:231], v[184:187]
    s_add_u32 m0, m0, 32
    ds_read_b128 a[140:143], v252 offset:704
    global_load_lds_dwordx4 v254, s[8:9] offset:1024 nt
    v_mfma_f32_16x16x32_bf16 v[188:191], v[236:239], a[236:239], v[188:191]
    v_exp_f32 v223, v223
    v_mfma_f32_16x16x32_bf16 v[188:191], v[232:235], a[232:235], v[188:191]
    ds_read_b128 a[136:139], v252 offset:640
    v_cvt_pk_bf16_f32 v229, v222, v223
    v_smfmac_f32_16x16x64_bf16 v[244:247], v[248:251], v[232:239], v240
    s_waitcnt lgkmcnt(4)
    ds_read_b128 a[132:135], v252 offset:576
    ds_read_b128 a[128:131], v252 offset:512
    v_mfma_f32_16x16x32_bf16 v[212:215], a[124:127], a[108:111], v[240:243]
    v_exp_f32 v208, v208
    v_mfma_f32_16x16x32_bf16 v[212:215], a[120:123], a[104:107], v[212:215]
    s_waitcnt lgkmcnt(5)
    v_exp_f32 v209, v209
    v_mfma_f32_16x16x32_bf16 v[212:215], a[116:119], a[100:103], v[212:215]
    s_waitcnt lgkmcnt(4)
    v_mov_b32_dpp v248, v248 row_ror:6 row_mask:0xf bank_mask:0xf
    v_cvt_pk_bf16_f32 v230, v208, v209
    v_mfma_f32_16x16x32_bf16 v[212:215], a[112:115], a[96:99], v[212:215]
    v_exp_f32 v210, v210
    v_mfma_f32_16x16x32_bf16 v[216:219], a[112:115], a[16:19], v[240:243]
    s_add_u32 m0, s69, 23296
    v_mov_b32_dpp v250, v250 row_ror:6 row_mask:0xf bank_mask:0xf
    v_mov_b32_dpp v249, v249 row_ror:6 row_mask:0xf bank_mask:0xf
    v_mfma_f32_16x16x32_bf16 v[216:219], a[116:119], a[20:23], v[216:219]
    s_add_u32 s8, s38, 49152
    v_exp_f32 v211, v211
    v_mfma_f32_16x16x32_bf16 v[216:219], a[120:123], a[24:27], v[216:219]
    s_addc_u32 s9, s39, 0
    v_mov_b32_dpp v251, v251 row_ror:6 row_mask:0xf bank_mask:0xf
    v_cvt_pk_bf16_f32 v231, v210, v211
    v_mfma_f32_16x16x32_bf16 v[216:219], a[124:127], a[28:31], v[216:219]
    s_waitcnt lgkmcnt(3)
    v_exp_f32 v212, v212
    v_mfma_f32_16x16x32_bf16 v[220:223], a[140:143], a[28:31], v[240:243]
    s_waitcnt lgkmcnt(2)
    v_exp_f32 v213, v213
    v_mfma_f32_16x16x32_bf16 v[220:223], a[136:139], a[24:27], v[220:223]
    s_waitcnt lgkmcnt(0)
    global_load_lds_dwordx4 v254, s[8:9] offset:0 nt
    v_cvt_pk_bf16_f32 v212, v212, v213
    v_mfma_f32_16x16x32_bf16 v[220:223], a[132:135], a[20:23], v[220:223]
    v_exp_f32 v214, v214
    v_mfma_f32_16x16x32_bf16 v[220:223], a[128:131], a[16:19], v[220:223]
    ds_write_b32 v254, v212 offset:0
    v_mfma_f32_16x16x32_bf16 v[208:211], a[144:147], a[16:19], v[240:243]
    s_add_u32 m0, m0, 16
    v_exp_f32 v215, v215
    v_mfma_f32_16x16x32_bf16 v[208:211], a[148:151], a[20:23], v[208:211]
    global_load_lds_dwordx4 v254, s[8:9] offset:1024 nt
    v_cvt_pk_bf16_f32 v213, v214, v215
    v_mfma_f32_16x16x32_bf16 v[208:211], a[152:155], a[24:27], v[208:211]
    ds_write_b32 v254, v213 offset:4
    v_mfma_f32_16x16x32_bf16 v[208:211], a[156:159], a[28:31], v[208:211]
    s_add_u32 m0, s68, 14848
    v_exp_f32 v216, v216
    v_mfma_f32_16x16x32_bf16 v[212:215], a[172:175], a[28:31], v[240:243]
    s_waitcnt vmcnt(4)
    v_exp_f32 v217, v217
    v_mfma_f32_16x16x32_bf16 v[212:215], a[168:171], a[24:27], v[212:215]
    s_barrier
    v_cvt_pk_bf16_f32 v232, v216, v217
    v_mfma_f32_16x16x32_bf16 v[212:215], a[164:167], a[20:23], v[212:215]
    s_add_u32 s8, s0, 57344
    v_exp_f32 v218, v218
    v_mfma_f32_16x16x32_bf16 v[212:215], a[160:163], a[16:19], v[212:215]
    s_addc_u32 s9, s1, 0
    global_load_lds_dwordx4 v254, s[8:9] offset:0 nt
    v_mfma_f32_16x16x32_bf16 v[0:3], v[224:227], a[176:179], v[0:3]
    v_exp_f32 v219, v219
    v_mfma_f32_16x16x32_bf16 v[0:3], v[228:231], a[180:183], v[0:3]
    ds_read_b64_tr_b16 a[176:177], v253 offset:0
    v_cvt_pk_bf16_f32 v233, v218, v219
    v_mfma_f32_16x16x32_bf16 v[4:7], v[228:231], a[188:191], v[4:7]
    v_exp_f32 v220, v220
    v_mfma_f32_16x16x32_bf16 v[4:7], v[224:227], a[184:187], v[4:7]
    v_exp_f32 v221, v221
    v_mfma_f32_16x16x32_bf16 v[8:11], v[224:227], a[192:195], v[8:11]
    ds_read_b64_tr_b16 a[178:179], v253 offset:512
    v_cvt_pk_bf16_f32 v234, v220, v221
    v_mfma_f32_16x16x32_bf16 v[8:11], v[228:231], a[196:199], v[8:11]
    v_exp_f32 v222, v222
    v_mfma_f32_16x16x32_bf16 v[12:15], v[228:231], a[204:207], v[12:15]
    s_add_u32 m0, m0, 32
    ds_read_b64_tr_b16 a[184:185], v253 offset:16
    global_load_lds_dwordx4 v254, s[8:9] offset:1024 nt
    v_mfma_f32_16x16x32_bf16 v[12:15], v[224:227], a[200:203], v[12:15]
    v_exp_f32 v223, v223
    v_mfma_f32_16x16x32_bf16 v[16:19], v[224:227], a[208:211], v[16:19]
    ds_read_b64_tr_b16 a[186:187], v253 offset:528
    v_cvt_pk_bf16_f32 v235, v222, v223
    v_mfma_f32_16x16x32_bf16 v[16:19], v[228:231], a[212:215], v[16:19]
    v_exp_f32 v208, v208
    v_mfma_f32_16x16x32_bf16 v[20:23], v[228:231], a[220:223], v[20:23]
    v_exp_f32 v209, v209
    v_mfma_f32_16x16x32_bf16 v[20:23], v[224:227], a[216:219], v[20:23]
    s_add_u32 m0, s69, 31616
    ds_read_b64_tr_b16 a[192:193], v253 offset:32
    v_cvt_pk_bf16_f32 v236, v208, v209
    v_mfma_f32_16x16x32_bf16 v[24:27], v[224:227], a[224:227], v[24:27]
    s_add_u32 s8, s38, 57344
    v_exp_f32 v210, v210
    v_mfma_f32_16x16x32_bf16 v[24:27], v[228:231], a[228:231], v[24:27]
    s_addc_u32 s9, s39, 0
    ds_read_b64_tr_b16 a[194:195], v253 offset:544
    global_load_lds_dwordx4 v254, s[8:9] offset:0 nt
    v_mfma_f32_16x16x32_bf16 v[28:31], v[228:231], a[236:239], v[28:31]
    v_exp_f32 v211, v211
    v_mfma_f32_16x16x32_bf16 v[28:31], v[224:227], a[232:235], v[28:31]
    ds_read_b64_tr_b16 a[200:201], v253 offset:48
    v_cvt_pk_bf16_f32 v237, v210, v211
    v_smfmac_f32_16x16x64_bf16 v[244:247], v[248:251], v[224:231], v240
    s_add_u32 m0, m0, 16
    ds_read_b64_tr_b16 a[202:203], v253 offset:560
    global_load_lds_dwordx4 v254, s[8:9] offset:1024 nt
    v_mfma_f32_16x16x32_bf16 v[216:219], a[124:127], a[252:255], v[240:243]
    v_exp_f32 v212, v212
    v_mfma_f32_16x16x32_bf16 v[216:219], a[120:123], a[248:251], v[216:219]
    v_exp_f32 v213, v213
    v_mfma_f32_16x16x32_bf16 v[216:219], a[116:119], a[244:247], v[216:219]
    v_mov_b32_dpp v248, v248 row_ror:2 row_mask:0xf bank_mask:0xf
    v_cvt_pk_bf16_f32 v238, v212, v213
    v_mfma_f32_16x16x32_bf16 v[216:219], a[112:115], a[240:243], v[216:219]
    v_exp_f32 v214, v214
    v_mfma_f32_16x16x32_bf16 v[220:223], a[112:115], a[32:35], v[240:243]
    v_mov_b32_dpp v250, v250 row_ror:2 row_mask:0xf bank_mask:0xf
    v_mov_b32_dpp v249, v249 row_ror:2 row_mask:0xf bank_mask:0xf
    v_mfma_f32_16x16x32_bf16 v[220:223], a[116:119], a[36:39], v[220:223]
    v_exp_f32 v215, v215
    v_mfma_f32_16x16x32_bf16 v[220:223], a[120:123], a[40:43], v[220:223]
    v_mov_b32_dpp v251, v251 row_ror:2 row_mask:0xf bank_mask:0xf
    v_cvt_pk_bf16_f32 v239, v214, v215
    v_mfma_f32_16x16x32_bf16 v[220:223], a[124:127], a[44:47], v[220:223]
    v_exp_f32 v216, v216
    v_mfma_f32_16x16x32_bf16 v[208:211], a[140:143], a[44:47], v[240:243]
    v_exp_f32 v217, v217
    v_mfma_f32_16x16x32_bf16 v[208:211], a[136:139], a[40:43], v[208:211]
    ds_read_b64_tr_b16 a[208:209], v253 offset:64
    v_cvt_pk_bf16_f32 v216, v216, v217
    v_mfma_f32_16x16x32_bf16 v[208:211], a[132:135], a[36:39], v[208:211]
    v_exp_f32 v218, v218
    v_mfma_f32_16x16x32_bf16 v[208:211], a[128:131], a[32:35], v[208:211]
    ds_write_b32 v254, v216 offset:1024
    v_mfma_f32_16x16x32_bf16 v[212:215], a[144:147], a[32:35], v[240:243]
    v_exp_f32 v219, v219
    v_mfma_f32_16x16x32_bf16 v[212:215], a[148:151], a[36:39], v[212:215]
    ds_read_b64_tr_b16 a[210:211], v253 offset:576
    v_cvt_pk_bf16_f32 v217, v218, v219
    v_mfma_f32_16x16x32_bf16 v[212:215], a[152:155], a[40:43], v[212:215]
    ds_write_b32 v254, v217 offset:1028
    v_mfma_f32_16x16x32_bf16 v[212:215], a[156:159], a[44:47], v[212:215]
    v_exp_f32 v220, v220
    v_mfma_f32_16x16x32_bf16 v[216:219], a[172:175], a[44:47], v[240:243]
    v_exp_f32 v221, v221
    v_mfma_f32_16x16x32_bf16 v[216:219], a[168:171], a[40:43], v[216:219]
    ds_read_b64_tr_b16 a[216:217], v253 offset:80
    v_cvt_pk_bf16_f32 v224, v220, v221
    v_mfma_f32_16x16x32_bf16 v[216:219], a[164:167], a[36:39], v[216:219]
    v_exp_f32 v222, v222
    v_mfma_f32_16x16x32_bf16 v[216:219], a[160:163], a[32:35], v[216:219]
    s_waitcnt lgkmcnt(4)
    ds_read_b64_tr_b16 a[218:219], v253 offset:592
    ds_read_b64_tr_b16 a[224:225], v253 offset:96
    v_mfma_f32_16x16x32_bf16 v[32:35], v[232:235], a[176:179], v[32:35]
    v_exp_f32 v223, v223
    v_mfma_f32_16x16x32_bf16 v[32:35], v[236:239], a[180:183], v[32:35]
    ds_read_b64_tr_b16 a[226:227], v253 offset:608
    v_cvt_pk_bf16_f32 v225, v222, v223
    v_mfma_f32_16x16x32_bf16 v[36:39], v[236:239], a[188:191], v[36:39]
    v_exp_f32 v208, v208
    v_mfma_f32_16x16x32_bf16 v[36:39], v[232:235], a[184:187], v[36:39]
    v_exp_f32 v209, v209
    v_mfma_f32_16x16x32_bf16 v[40:43], v[232:235], a[192:195], v[40:43]
    ds_read_b64_tr_b16 a[232:233], v253 offset:112
    v_cvt_pk_bf16_f32 v226, v208, v209
    v_mfma_f32_16x16x32_bf16 v[40:43], v[236:239], a[196:199], v[40:43]
    s_add_u32 m0, s34, s4
    v_exp_f32 v210, v210
    v_mfma_f32_16x16x32_bf16 v[44:47], v[236:239], a[204:207], v[44:47]
    s_add_u32 s8, s16, s64
    ds_read_b64_tr_b16 a[234:235], v253 offset:624
    v_mfma_f32_16x16x32_bf16 v[44:47], v[232:235], a[200:203], v[44:47]
    s_waitcnt lgkmcnt(5)
    v_exp_f32 v211, v211
    v_mfma_f32_16x16x32_bf16 v[48:51], v[232:235], a[208:211], v[48:51]
    s_addc_u32 s9, s17, 0
    global_load_lds_dwordx4 v254, s[8:9] offset:0 nt
    v_cvt_pk_bf16_f32 v227, v210, v211
    v_mfma_f32_16x16x32_bf16 v[48:51], v[236:239], a[212:215], v[48:51]
    s_add_u32 s64, s64, 16384
    v_exp_f32 v212, v212
    v_mfma_f32_16x16x32_bf16 v[52:55], v[236:239], a[220:223], v[52:55]
    s_waitcnt lgkmcnt(3)
    v_exp_f32 v213, v213
    v_mfma_f32_16x16x32_bf16 v[52:55], v[232:235], a[216:219], v[52:55]
    s_waitcnt lgkmcnt(2)
    v_cvt_pk_bf16_f32 v228, v212, v213
    v_mfma_f32_16x16x32_bf16 v[56:59], v[232:235], a[224:227], v[56:59]
    s_cmp_gt_u32 s64, s10
    v_exp_f32 v214, v214
    v_mfma_f32_16x16x32_bf16 v[56:59], v[236:239], a[228:231], v[56:59]
    s_cselect_b32 s64, 0, s64
    v_mfma_f32_16x16x32_bf16 v[60:63], v[236:239], a[236:239], v[60:63]
    s_waitcnt lgkmcnt(0)
    v_exp_f32 v215, v215
    v_mfma_f32_16x16x32_bf16 v[60:63], v[232:235], a[232:235], v[60:63]
    v_cvt_pk_bf16_f32 v229, v214, v215
    v_smfmac_f32_16x16x64_bf16 v[244:247], v[248:251], v[232:239], v240
    v_mfma_f32_16x16x32_bf16 v[220:223], a[124:127], v[204:207], v[240:243]
    s_add_u32 s31, s31, 33536
    v_exp_f32 v216, v216
    v_mfma_f32_16x16x32_bf16 v[220:223], a[120:123], v[200:203], v[220:223]
    s_cmp_eq_u32 s31, 100608
    v_exp_f32 v217, v217
    v_mfma_f32_16x16x32_bf16 v[220:223], a[116:119], v[196:199], v[220:223]
    s_cselect_b32 s30, s71, s72
    v_mov_b32_dpp v248, v248 row_ror:2 row_mask:0xf bank_mask:0xf
    v_cvt_pk_bf16_f32 v230, v216, v217
    v_mfma_f32_16x16x32_bf16 v[220:223], a[112:115], v[192:195], v[220:223]
    s_cselect_b32 s31, 0, s31
    v_exp_f32 v218, v218
    v_mfma_f32_16x16x32_bf16 v[208:211], a[112:115], a[48:51], v[240:243]
    v_mov_b32_dpp v250, v250 row_ror:2 row_mask:0xf bank_mask:0xf
    v_mov_b32_dpp v249, v249 row_ror:2 row_mask:0xf bank_mask:0xf
    v_mfma_f32_16x16x32_bf16 v[208:211], a[116:119], a[52:55], v[208:211]
    v_exp_f32 v219, v219
    v_mfma_f32_16x16x32_bf16 v[208:211], a[120:123], a[56:59], v[208:211]
    v_mov_b32_dpp v251, v251 row_ror:2 row_mask:0xf bank_mask:0xf
    v_cvt_pk_bf16_f32 v231, v218, v219
    v_mfma_f32_16x16x32_bf16 v[208:211], a[124:127], a[60:63], v[208:211]
    v_exp_f32 v220, v220
    v_mfma_f32_16x16x32_bf16 v[212:215], a[140:143], a[60:63], v[240:243]
    v_exp_f32 v221, v221
    v_mfma_f32_16x16x32_bf16 v[212:215], a[136:139], a[56:59], v[212:215]
    v_cvt_pk_bf16_f32 v220, v220, v221
    v_mfma_f32_16x16x32_bf16 v[212:215], a[132:135], a[52:55], v[212:215]
    v_exp_f32 v222, v222
    v_mfma_f32_16x16x32_bf16 v[212:215], a[128:131], a[48:51], v[212:215]
    ds_write_b32 v254, v220 offset:2048
    v_mfma_f32_16x16x32_bf16 v[216:219], a[144:147], a[48:51], v[240:243]
    v_exp_f32 v223, v223
    v_mfma_f32_16x16x32_bf16 v[216:219], a[148:151], a[52:55], v[216:219]
    ds_read_b128 a[144:147], v252 offset:8448
    v_cvt_pk_bf16_f32 v221, v222, v223
    v_mfma_f32_16x16x32_bf16 v[216:219], a[152:155], a[56:59], v[216:219]
    ds_write_b32 v254, v221 offset:2052
    v_mfma_f32_16x16x32_bf16 v[216:219], a[156:159], a[60:63], v[216:219]
    v_exp_f32 v208, v208
    v_mfma_f32_16x16x32_bf16 v[220:223], a[172:175], a[60:63], v[240:243]
    v_exp_f32 v209, v209
    v_mfma_f32_16x16x32_bf16 v[220:223], a[168:171], a[56:59], v[220:223]
    ds_read_b128 a[148:151], v252 offset:8512
    v_cvt_pk_bf16_f32 v232, v208, v209
    v_mfma_f32_16x16x32_bf16 v[220:223], a[164:167], a[52:55], v[220:223]
    v_exp_f32 v210, v210
    v_mfma_f32_16x16x32_bf16 v[220:223], a[160:163], a[48:51], v[220:223]
    ds_read_b128 a[152:155], v252 offset:8576
    v_mfma_f32_16x16x32_bf16 v[64:67], v[224:227], a[176:179], v[64:67]
    v_exp_f32 v211, v211
    v_mfma_f32_16x16x32_bf16 v[64:67], v[228:231], a[180:183], v[64:67]
    ds_read_b128 a[156:159], v252 offset:8640
    v_cvt_pk_bf16_f32 v233, v210, v211
    v_mfma_f32_16x16x32_bf16 v[68:71], v[228:231], a[188:191], v[68:71]
    v_exp_f32 v212, v212
    v_mfma_f32_16x16x32_bf16 v[68:71], v[224:227], a[184:187], v[68:71]
    v_exp_f32 v213, v213
    v_mfma_f32_16x16x32_bf16 v[72:75], v[224:227], a[192:195], v[72:75]
    ds_read_b128 a[172:175], v252 offset:9152
    v_cvt_pk_bf16_f32 v234, v212, v213
    v_mfma_f32_16x16x32_bf16 v[72:75], v[228:231], a[196:199], v[72:75]
    v_exp_f32 v214, v214
    v_mfma_f32_16x16x32_bf16 v[76:79], v[228:231], a[204:207], v[76:79]
    ds_read_b128 a[168:171], v252 offset:9088
    v_mfma_f32_16x16x32_bf16 v[76:79], v[224:227], a[200:203], v[76:79]
    v_exp_f32 v215, v215
    v_mfma_f32_16x16x32_bf16 v[80:83], v[224:227], a[208:211], v[80:83]
    ds_read_b128 a[164:167], v252 offset:9024
    v_cvt_pk_bf16_f32 v235, v214, v215
    v_mfma_f32_16x16x32_bf16 v[80:83], v[228:231], a[212:215], v[80:83]
    v_exp_f32 v216, v216
    v_mfma_f32_16x16x32_bf16 v[84:87], v[228:231], a[220:223], v[84:87]
    v_exp_f32 v217, v217
    v_mfma_f32_16x16x32_bf16 v[84:87], v[224:227], a[216:219], v[84:87]
    ds_read_b128 a[160:163], v252 offset:8960
    v_cvt_pk_bf16_f32 v236, v216, v217
    v_mfma_f32_16x16x32_bf16 v[88:91], v[224:227], a[224:227], v[88:91]
    v_exp_f32 v218, v218
    v_mfma_f32_16x16x32_bf16 v[88:91], v[228:231], a[228:231], v[88:91]
    v_mfma_f32_16x16x32_bf16 v[92:95], v[228:231], a[236:239], v[92:95]
    s_add_u32 m0, s34, s5
    v_exp_f32 v219, v219
    v_mfma_f32_16x16x32_bf16 v[92:95], v[224:227], a[232:235], v[92:95]
    s_add_u32 s8, s20, s66
    v_cvt_pk_bf16_f32 v237, v218, v219
    v_smfmac_f32_16x16x64_bf16 v[244:247], v[248:251], v[224:231], v240
    s_addc_u32 s9, s21, 0
    global_load_lds_dwordx4 v254, s[8:9] offset:0 nt
    v_mfma_f32_16x16x32_bf16 v[208:211], a[140:143], a[108:111], v[240:243]
    s_add_u32 s34, s34, 33536
    v_exp_f32 v220, v220
    v_mfma_f32_16x16x32_bf16 v[208:211], a[136:139], a[104:107], v[208:211]
    s_cmp_eq_u32 s34, 100608
    v_exp_f32 v221, v221
    v_mfma_f32_16x16x32_bf16 v[208:211], a[132:135], a[100:103], v[208:211]
    s_cselect_b32 s34, 0, s34
    v_mov_b32_dpp v248, v248 row_ror:2 row_mask:0xf bank_mask:0xf
    v_cvt_pk_bf16_f32 v238, v220, v221
    v_mfma_f32_16x16x32_bf16 v[208:211], a[128:131], a[96:99], v[208:211]
    s_add_u32 s66, s66, 16384
    v_exp_f32 v222, v222
    v_mfma_f32_16x16x32_bf16 v[212:215], a[112:115], a[64:67], v[240:243]
    s_cmp_gt_u32 s66, s11
    v_mov_b32_dpp v250, v250 row_ror:2 row_mask:0xf bank_mask:0xf
    v_mov_b32_dpp v249, v249 row_ror:2 row_mask:0xf bank_mask:0xf
    v_mfma_f32_16x16x32_bf16 v[212:215], a[116:119], a[68:71], v[212:215]
    s_cselect_b32 s66, 0, s66
    v_exp_f32 v223, v223
    v_mfma_f32_16x16x32_bf16 v[212:215], a[120:123], a[72:75], v[212:215]
    v_mov_b32_dpp v251, v251 row_ror:2 row_mask:0xf bank_mask:0xf
    v_cvt_pk_bf16_f32 v239, v222, v223
    v_mfma_f32_16x16x32_bf16 v[212:215], a[124:127], a[76:79], v[212:215]
    v_exp_f32 v208, v208
    v_mfma_f32_16x16x32_bf16 v[216:219], a[140:143], a[76:79], v[240:243]
    v_exp_f32 v209, v209
    v_mfma_f32_16x16x32_bf16 v[216:219], a[136:139], a[72:75], v[216:219]
    v_cvt_pk_bf16_f32 v208, v208, v209
    v_mfma_f32_16x16x32_bf16 v[216:219], a[132:135], a[68:71], v[216:219]
    v_exp_f32 v210, v210
    v_mfma_f32_16x16x32_bf16 v[216:219], a[128:131], a[64:67], v[216:219]
    s_waitcnt lgkmcnt(0)
    ds_write_b32 v254, v208 offset:8
    v_mfma_f32_16x16x32_bf16 v[220:223], a[144:147], a[64:67], v[240:243]
    v_exp_f32 v211, v211
    v_mfma_f32_16x16x32_bf16 v[220:223], a[148:151], a[68:71], v[220:223]
    v_cvt_pk_bf16_f32 v209, v210, v211
    v_mfma_f32_16x16x32_bf16 v[220:223], a[152:155], a[72:75], v[220:223]
    ds_write_b32 v254, v209 offset:12
    v_mfma_f32_16x16x32_bf16 v[220:223], a[156:159], a[76:79], v[220:223]
    v_exp_f32 v212, v212
    v_mfma_f32_16x16x32_bf16 v[208:211], a[172:175], a[76:79], v[240:243]
    v_exp_f32 v213, v213
    v_mfma_f32_16x16x32_bf16 v[208:211], a[168:171], a[72:75], v[208:211]
    v_cvt_pk_bf16_f32 v224, v212, v213
    v_mfma_f32_16x16x32_bf16 v[208:211], a[164:167], a[68:71], v[208:211]
    v_exp_f32 v214, v214
    v_mfma_f32_16x16x32_bf16 v[208:211], a[160:163], a[64:67], v[208:211]
    v_mfma_f32_16x16x32_bf16 v[96:99], v[232:235], a[176:179], v[96:99]
    v_exp_f32 v215, v215
    v_mfma_f32_16x16x32_bf16 v[96:99], v[236:239], a[180:183], v[96:99]
    ds_read_b64_tr_b16 a[180:181], v253 offset:8320
    v_cvt_pk_bf16_f32 v225, v214, v215
    v_mfma_f32_16x16x32_bf16 v[100:103], v[236:239], a[188:191], v[100:103]
    v_exp_f32 v216, v216
    v_mfma_f32_16x16x32_bf16 v[100:103], v[232:235], a[184:187], v[100:103]
    v_exp_f32 v217, v217
    v_mfma_f32_16x16x32_bf16 v[104:107], v[232:235], a[192:195], v[104:107]
    ds_read_b64_tr_b16 a[182:183], v253 offset:8832
    v_cvt_pk_bf16_f32 v226, v216, v217
    v_mfma_f32_16x16x32_bf16 v[104:107], v[236:239], a[196:199], v[104:107]
    v_exp_f32 v218, v218
    v_mfma_f32_16x16x32_bf16 v[108:111], v[236:239], a[204:207], v[108:111]
    ds_read_b64_tr_b16 a[188:189], v253 offset:8336
    v_mfma_f32_16x16x32_bf16 v[108:111], v[232:235], a[200:203], v[108:111]
    v_exp_f32 v219, v219
    v_mfma_f32_16x16x32_bf16 v[112:115], v[232:235], a[208:211], v[112:115]
    ds_read_b64_tr_b16 a[190:191], v253 offset:8848
    v_cvt_pk_bf16_f32 v227, v218, v219
    v_mfma_f32_16x16x32_bf16 v[112:115], v[236:239], a[212:215], v[112:115]
    v_exp_f32 v220, v220
    v_mfma_f32_16x16x32_bf16 v[116:119], v[236:239], a[220:223], v[116:119]
    v_exp_f32 v221, v221
    v_mfma_f32_16x16x32_bf16 v[116:119], v[232:235], a[216:219], v[116:119]
    ds_read_b64_tr_b16 a[196:197], v253 offset:8352
    v_cvt_pk_bf16_f32 v228, v220, v221
    v_mfma_f32_16x16x32_bf16 v[120:123], v[232:235], a[224:227], v[120:123]
    v_exp_f32 v222, v222
    v_mfma_f32_16x16x32_bf16 v[120:123], v[236:239], a[228:231], v[120:123]
    ds_read_b64_tr_b16 a[198:199], v253 offset:8864
    v_mfma_f32_16x16x32_bf16 v[124:127], v[236:239], a[236:239], v[124:127]
    v_exp_f32 v223, v223
    v_mfma_f32_16x16x32_bf16 v[124:127], v[232:235], a[232:235], v[124:127]
    ds_read_b64_tr_b16 a[204:205], v253 offset:8368
    v_cvt_pk_bf16_f32 v229, v222, v223
    v_smfmac_f32_16x16x64_bf16 v[244:247], v[248:251], v[232:239], v240
    ds_read_b64_tr_b16 a[206:207], v253 offset:8880
    ds_read_b64_tr_b16 a[212:213], v253 offset:8384
    v_mfma_f32_16x16x32_bf16 v[212:215], a[140:143], a[252:255], v[240:243]
    v_exp_f32 v208, v208
    v_mfma_f32_16x16x32_bf16 v[212:215], a[136:139], a[248:251], v[212:215]
    v_exp_f32 v209, v209
    v_mfma_f32_16x16x32_bf16 v[212:215], a[132:135], a[244:247], v[212:215]
    v_mov_b32_dpp v248, v248 row_ror:2 row_mask:0xf bank_mask:0xf
    v_cvt_pk_bf16_f32 v230, v208, v209
    v_mfma_f32_16x16x32_bf16 v[212:215], a[128:131], a[240:243], v[212:215]
    v_exp_f32 v210, v210
    v_mfma_f32_16x16x32_bf16 v[216:219], a[112:115], a[80:83], v[240:243]
    v_mov_b32_dpp v250, v250 row_ror:2 row_mask:0xf bank_mask:0xf
    v_mov_b32_dpp v249, v249 row_ror:2 row_mask:0xf bank_mask:0xf
    v_mfma_f32_16x16x32_bf16 v[216:219], a[116:119], a[84:87], v[216:219]
    v_exp_f32 v211, v211
    v_mfma_f32_16x16x32_bf16 v[216:219], a[120:123], a[88:91], v[216:219]
    v_mov_b32_dpp v251, v251 row_ror:2 row_mask:0xf bank_mask:0xf
    v_cvt_pk_bf16_f32 v231, v210, v211
    v_mfma_f32_16x16x32_bf16 v[216:219], a[124:127], a[92:95], v[216:219]
    v_exp_f32 v212, v212
    v_mfma_f32_16x16x32_bf16 v[220:223], a[140:143], a[92:95], v[240:243]
    v_exp_f32 v213, v213
    v_mfma_f32_16x16x32_bf16 v[220:223], a[136:139], a[88:91], v[220:223]
    ds_read_b64_tr_b16 a[214:215], v253 offset:8896
    v_cvt_pk_bf16_f32 v212, v212, v213
    v_mfma_f32_16x16x32_bf16 v[220:223], a[132:135], a[84:87], v[220:223]
    v_exp_f32 v214, v214
    v_mfma_f32_16x16x32_bf16 v[220:223], a[128:131], a[80:83], v[220:223]
    ds_write_b32 v254, v212 offset:1032
    v_mfma_f32_16x16x32_bf16 v[208:211], a[144:147], a[80:83], v[240:243]
    v_exp_f32 v215, v215
    v_mfma_f32_16x16x32_bf16 v[208:211], a[148:151], a[84:87], v[208:211]
    ds_read_b64_tr_b16 a[220:221], v253 offset:8400
    v_cvt_pk_bf16_f32 v213, v214, v215
    v_mfma_f32_16x16x32_bf16 v[208:211], a[152:155], a[88:91], v[208:211]
    ds_write_b32 v254, v213 offset:1036
    v_mfma_f32_16x16x32_bf16 v[208:211], a[156:159], a[92:95], v[208:211]
    v_exp_f32 v216, v216
    v_mfma_f32_16x16x32_bf16 v[212:215], a[172:175], a[92:95], v[240:243]
    v_exp_f32 v217, v217
    v_mfma_f32_16x16x32_bf16 v[212:215], a[168:171], a[88:91], v[212:215]
    ds_read_b64_tr_b16 a[222:223], v253 offset:8912
    v_cvt_pk_bf16_f32 v232, v216, v217
    v_mfma_f32_16x16x32_bf16 v[212:215], a[164:167], a[84:87], v[212:215]
    v_exp_f32 v218, v218
    v_mfma_f32_16x16x32_bf16 v[212:215], a[160:163], a[80:83], v[212:215]
    ds_read_b64_tr_b16 a[228:229], v253 offset:8416
    ds_read_b64_tr_b16 a[230:231], v253 offset:8928
    v_mfma_f32_16x16x32_bf16 v[128:131], v[224:227], a[176:179], v[128:131]
    s_waitcnt lgkmcnt(6)
    v_exp_f32 v219, v219
    v_mfma_f32_16x16x32_bf16 v[128:131], v[228:231], a[180:183], v[128:131]
    ds_read_b64_tr_b16 a[236:237], v253 offset:8432
    v_cvt_pk_bf16_f32 v233, v218, v219
    v_mfma_f32_16x16x32_bf16 v[132:135], v[228:231], a[188:191], v[132:135]
    v_exp_f32 v220, v220
    v_mfma_f32_16x16x32_bf16 v[132:135], v[224:227], a[184:187], v[132:135]
    v_exp_f32 v221, v221
    v_mfma_f32_16x16x32_bf16 v[136:139], v[224:227], a[192:195], v[136:139]
    ds_read_b64_tr_b16 a[238:239], v253 offset:8944
    v_cvt_pk_bf16_f32 v234, v220, v221
    v_mfma_f32_16x16x32_bf16 v[136:139], v[228:231], a[196:199], v[136:139]
    v_exp_f32 v222, v222
    v_mfma_f32_16x16x32_bf16 v[140:143], v[228:231], a[204:207], v[140:143]
    v_mfma_f32_16x16x32_bf16 v[140:143], v[224:227], a[200:203], v[140:143]
    v_exp_f32 v223, v223
    v_mfma_f32_16x16x32_bf16 v[144:147], v[224:227], a[208:211], v[144:147]
    v_cvt_pk_bf16_f32 v235, v222, v223
    v_mfma_f32_16x16x32_bf16 v[144:147], v[228:231], a[212:215], v[144:147]
    s_waitcnt lgkmcnt(2)
    v_exp_f32 v208, v208
    v_mfma_f32_16x16x32_bf16 v[148:151], v[228:231], a[220:223], v[148:151]
    v_exp_f32 v209, v209
    v_mfma_f32_16x16x32_bf16 v[148:151], v[224:227], a[216:219], v[148:151]
    v_cvt_pk_bf16_f32 v236, v208, v209
    v_mfma_f32_16x16x32_bf16 v[152:155], v[224:227], a[224:227], v[152:155]
    v_exp_f32 v210, v210
    v_mfma_f32_16x16x32_bf16 v[152:155], v[228:231], a[228:231], v[152:155]
    s_waitcnt lgkmcnt(0)
    v_add_u32 v252, s30, v252
    v_mfma_f32_16x16x32_bf16 v[156:159], v[228:231], a[236:239], v[156:159]
    v_exp_f32 v211, v211
    v_mfma_f32_16x16x32_bf16 v[156:159], v[224:227], a[232:235], v[156:159]
    s_waitcnt vmcnt(2)
    v_cvt_pk_bf16_f32 v237, v210, v211
    v_add_u32 v253, s30, v253
    v_smfmac_f32_16x16x64_bf16 v[244:247], v[248:251], v[224:231], v240
.p2align 6
L_loop_b:
    v_mfma_f32_16x16x32_bf16 v[216:219], a[140:143], v[204:207], v[240:243]
    v_exp_f32 v212, v212
    v_mfma_f32_16x16x32_bf16 v[216:219], a[136:139], v[200:203], v[216:219]
    v_exp_f32 v213, v213
    v_mfma_f32_16x16x32_bf16 v[216:219], a[132:135], v[196:199], v[216:219]
    v_mov_b32_dpp v248, v248 row_ror:2 row_mask:0xf bank_mask:0xf
    v_cvt_pk_bf16_f32 v238, v212, v213
    v_mfma_f32_16x16x32_bf16 v[216:219], a[128:131], v[192:195], v[216:219]
    v_exp_f32 v214, v214
    v_mfma_f32_16x16x32_bf16 v[220:223], a[112:115], a[0:3], v[240:243]
    v_mov_b32_dpp v250, v250 row_ror:2 row_mask:0xf bank_mask:0xf
    v_mov_b32_dpp v249, v249 row_ror:2 row_mask:0xf bank_mask:0xf
    v_mfma_f32_16x16x32_bf16 v[220:223], a[116:119], a[4:7], v[220:223]
    v_exp_f32 v215, v215
    v_mfma_f32_16x16x32_bf16 v[220:223], a[120:123], a[8:11], v[220:223]
    v_mov_b32_dpp v251, v251 row_ror:2 row_mask:0xf bank_mask:0xf
    v_cvt_pk_bf16_f32 v239, v214, v215
    v_mfma_f32_16x16x32_bf16 v[220:223], a[124:127], a[12:15], v[220:223]
    v_exp_f32 v216, v216
    v_mfma_f32_16x16x32_bf16 v[208:211], a[140:143], a[12:15], v[240:243]
    v_exp_f32 v217, v217
    v_mfma_f32_16x16x32_bf16 v[208:211], a[136:139], a[8:11], v[208:211]
    v_cvt_pk_bf16_f32 v216, v216, v217
    v_mfma_f32_16x16x32_bf16 v[208:211], a[132:135], a[4:7], v[208:211]
    v_exp_f32 v218, v218
    v_mfma_f32_16x16x32_bf16 v[208:211], a[128:131], a[0:3], v[208:211]
    ds_write_b32 v254, v216 offset:2056
    v_mfma_f32_16x16x32_bf16 v[212:215], a[144:147], a[0:3], v[240:243]
    v_exp_f32 v219, v219
    v_mfma_f32_16x16x32_bf16 v[212:215], a[148:151], a[4:7], v[212:215]
    v_cvt_pk_bf16_f32 v217, v218, v219
    v_mfma_f32_16x16x32_bf16 v[212:215], a[152:155], a[8:11], v[212:215]
    ds_write_b32 v254, v217 offset:2060
    v_mfma_f32_16x16x32_bf16 v[212:215], a[156:159], a[12:15], v[212:215]
    v_exp_f32 v220, v220
    v_mfma_f32_16x16x32_bf16 v[216:219], a[172:175], a[12:15], v[240:243]
    v_exp_f32 v221, v221
    v_mfma_f32_16x16x32_bf16 v[216:219], a[168:171], a[8:11], v[216:219]
    v_cvt_pk_bf16_f32 v224, v220, v221
    v_mfma_f32_16x16x32_bf16 v[216:219], a[164:167], a[4:7], v[216:219]
    v_exp_f32 v222, v222
    v_mfma_f32_16x16x32_bf16 v[216:219], a[160:163], a[0:3], v[216:219]
    v_mfma_f32_16x16x32_bf16 v[160:163], v[232:235], a[176:179], v[160:163]
    s_waitcnt lgkmcnt(0)
    v_exp_f32 v223, v223
    v_mfma_f32_16x16x32_bf16 v[160:163], v[236:239], a[180:183], v[160:163]
    s_barrier
    v_cvt_pk_bf16_f32 v225, v222, v223
    v_mfma_f32_16x16x32_bf16 v[164:167], v[236:239], a[188:191], v[164:167]
    v_exp_f32 v208, v208
    v_mfma_f32_16x16x32_bf16 v[164:167], v[232:235], a[184:187], v[164:167]
    v_exp_f32 v209, v209
    v_mfma_f32_16x16x32_bf16 v[168:171], v[232:235], a[192:195], v[168:171]
    s_add_u32 m0, s34, s4
    ds_read_b128 a[124:127], v252 offset:192
    v_cvt_pk_bf16_f32 v226, v208, v209
    v_mfma_f32_16x16x32_bf16 v[168:171], v[236:239], a[196:199], v[168:171]
    s_add_u32 s8, s16, s64
    v_exp_f32 v210, v210
    v_mfma_f32_16x16x32_bf16 v[172:175], v[236:239], a[204:207], v[172:175]
    s_addc_u32 s9, s17, 0
    ds_read_b128 a[120:123], v252 offset:128
    global_load_lds_dwordx4 v254, s[8:9] offset:0 nt
    v_mfma_f32_16x16x32_bf16 v[172:175], v[232:235], a[200:203], v[172:175]
    s_add_u32 s64, s64, 16384
    v_exp_f32 v211, v211
    v_mfma_f32_16x16x32_bf16 v[176:179], v[232:235], a[208:211], v[176:179]
    s_cmp_gt_u32 s64, s10
    ds_read_b128 a[116:119], v252 offset:64
    v_cvt_pk_bf16_f32 v227, v210, v211
    v_mfma_f32_16x16x32_bf16 v[176:179], v[236:239], a[212:215], v[176:179]
    s_cselect_b32 s64, 0, s64
    v_exp_f32 v212, v212
    v_mfma_f32_16x16x32_bf16 v[180:183], v[236:239], a[220:223], v[180:183]
    v_exp_f32 v213, v213
    v_mfma_f32_16x16x32_bf16 v[180:183], v[232:235], a[216:219], v[180:183]
    ds_read_b128 a[112:115], v252 offset:0
    v_cvt_pk_bf16_f32 v228, v212, v213
    v_mfma_f32_16x16x32_bf16 v[184:187], v[232:235], a[224:227], v[184:187]
    v_exp_f32 v214, v214
    v_mfma_f32_16x16x32_bf16 v[184:187], v[236:239], a[228:231], v[184:187]
    ds_read_b128 a[140:143], v252 offset:704
    v_mfma_f32_16x16x32_bf16 v[188:191], v[236:239], a[236:239], v[188:191]
    v_exp_f32 v215, v215
    v_mfma_f32_16x16x32_bf16 v[188:191], v[232:235], a[232:235], v[188:191]
    ds_read_b128 a[136:139], v252 offset:640
    v_cvt_pk_bf16_f32 v229, v214, v215
    v_smfmac_f32_16x16x64_bf16 v[244:247], v[248:251], v[232:239], v240
    s_waitcnt lgkmcnt(4)
    ds_read_b128 a[132:135], v252 offset:576
    ds_read_b128 a[128:131], v252 offset:512
    v_mfma_f32_16x16x32_bf16 v[220:223], a[124:127], a[108:111], v[240:243]
    v_exp_f32 v216, v216
    v_mfma_f32_16x16x32_bf16 v[220:223], a[120:123], a[104:107], v[220:223]
    s_waitcnt lgkmcnt(5)
    v_exp_f32 v217, v217
    v_mfma_f32_16x16x32_bf16 v[220:223], a[116:119], a[100:103], v[220:223]
    s_waitcnt lgkmcnt(4)
    v_mov_b32_dpp v248, v248 row_ror:6 row_mask:0xf bank_mask:0xf
    v_cvt_pk_bf16_f32 v230, v216, v217
    v_mfma_f32_16x16x32_bf16 v[220:223], a[112:115], a[96:99], v[220:223]
    v_exp_f32 v218, v218
    v_mfma_f32_16x16x32_bf16 v[208:211], a[112:115], a[16:19], v[240:243]
    v_mov_b32_dpp v250, v250 row_ror:6 row_mask:0xf bank_mask:0xf
    v_mov_b32_dpp v249, v249 row_ror:6 row_mask:0xf bank_mask:0xf
    v_mfma_f32_16x16x32_bf16 v[208:211], a[116:119], a[20:23], v[208:211]
    v_exp_f32 v219, v219
    v_mfma_f32_16x16x32_bf16 v[208:211], a[120:123], a[24:27], v[208:211]
    v_mov_b32_dpp v251, v251 row_ror:6 row_mask:0xf bank_mask:0xf
    v_cvt_pk_bf16_f32 v231, v218, v219
    v_mfma_f32_16x16x32_bf16 v[208:211], a[124:127], a[28:31], v[208:211]
    s_waitcnt lgkmcnt(3)
    v_exp_f32 v220, v220
    v_mfma_f32_16x16x32_bf16 v[212:215], a[140:143], a[28:31], v[240:243]
    s_waitcnt lgkmcnt(2)
    v_exp_f32 v221, v221
    v_mfma_f32_16x16x32_bf16 v[212:215], a[136:139], a[24:27], v[212:215]
    s_waitcnt lgkmcnt(0)
    v_cvt_pk_bf16_f32 v220, v220, v221
    v_mfma_f32_16x16x32_bf16 v[212:215], a[132:135], a[20:23], v[212:215]
    v_exp_f32 v222, v222
    v_mfma_f32_16x16x32_bf16 v[212:215], a[128:131], a[16:19], v[212:215]
    ds_write_b32 v254, v220 offset:3072
    v_mfma_f32_16x16x32_bf16 v[216:219], a[144:147], a[16:19], v[240:243]
    v_exp_f32 v223, v223
    v_mfma_f32_16x16x32_bf16 v[216:219], a[148:151], a[20:23], v[216:219]
    v_cvt_pk_bf16_f32 v221, v222, v223
    v_mfma_f32_16x16x32_bf16 v[216:219], a[152:155], a[24:27], v[216:219]
    ds_write_b32 v254, v221 offset:3076
    v_mfma_f32_16x16x32_bf16 v[216:219], a[156:159], a[28:31], v[216:219]
    v_exp_f32 v208, v208
    v_mfma_f32_16x16x32_bf16 v[220:223], a[172:175], a[28:31], v[240:243]
    v_exp_f32 v209, v209
    v_mfma_f32_16x16x32_bf16 v[220:223], a[168:171], a[24:27], v[220:223]
    v_cvt_pk_bf16_f32 v232, v208, v209
    v_mfma_f32_16x16x32_bf16 v[220:223], a[164:167], a[20:23], v[220:223]
    v_exp_f32 v210, v210
    v_mfma_f32_16x16x32_bf16 v[220:223], a[160:163], a[16:19], v[220:223]
    v_mfma_f32_16x16x32_bf16 v[0:3], v[224:227], a[176:179], v[0:3]
    v_exp_f32 v211, v211
    v_mfma_f32_16x16x32_bf16 v[0:3], v[228:231], a[180:183], v[0:3]
    ds_read_b64_tr_b16 a[176:177], v253 offset:0
    v_cvt_pk_bf16_f32 v233, v210, v211
    v_mfma_f32_16x16x32_bf16 v[4:7], v[228:231], a[188:191], v[4:7]
    v_exp_f32 v212, v212
    v_mfma_f32_16x16x32_bf16 v[4:7], v[224:227], a[184:187], v[4:7]
    v_exp_f32 v213, v213
    v_mfma_f32_16x16x32_bf16 v[8:11], v[224:227], a[192:195], v[8:11]
    ds_read_b64_tr_b16 a[178:179], v253 offset:512
    v_cvt_pk_bf16_f32 v234, v212, v213
    v_mfma_f32_16x16x32_bf16 v[8:11], v[228:231], a[196:199], v[8:11]
    v_exp_f32 v214, v214
    v_mfma_f32_16x16x32_bf16 v[12:15], v[228:231], a[204:207], v[12:15]
    ds_read_b64_tr_b16 a[184:185], v253 offset:16
    v_mfma_f32_16x16x32_bf16 v[12:15], v[224:227], a[200:203], v[12:15]
    v_exp_f32 v215, v215
    v_mfma_f32_16x16x32_bf16 v[16:19], v[224:227], a[208:211], v[16:19]
    ds_read_b64_tr_b16 a[186:187], v253 offset:528
    v_cvt_pk_bf16_f32 v235, v214, v215
    v_mfma_f32_16x16x32_bf16 v[16:19], v[228:231], a[212:215], v[16:19]
    v_exp_f32 v216, v216
    v_mfma_f32_16x16x32_bf16 v[20:23], v[228:231], a[220:223], v[20:23]
    v_exp_f32 v217, v217
    v_mfma_f32_16x16x32_bf16 v[20:23], v[224:227], a[216:219], v[20:23]
    ds_read_b64_tr_b16 a[192:193], v253 offset:32
    v_cvt_pk_bf16_f32 v236, v216, v217
    v_mfma_f32_16x16x32_bf16 v[24:27], v[224:227], a[224:227], v[24:27]
    v_exp_f32 v218, v218
    v_mfma_f32_16x16x32_bf16 v[24:27], v[228:231], a[228:231], v[24:27]
    ds_read_b64_tr_b16 a[194:195], v253 offset:544
    v_mfma_f32_16x16x32_bf16 v[28:31], v[228:231], a[236:239], v[28:31]
    v_exp_f32 v219, v219
    v_mfma_f32_16x16x32_bf16 v[28:31], v[224:227], a[232:235], v[28:31]
    ds_read_b64_tr_b16 a[200:201], v253 offset:48
    v_cvt_pk_bf16_f32 v237, v218, v219
    v_smfmac_f32_16x16x64_bf16 v[244:247], v[248:251], v[224:231], v240
    ds_read_b64_tr_b16 a[202:203], v253 offset:560
    v_mfma_f32_16x16x32_bf16 v[208:211], a[124:127], a[252:255], v[240:243]
    v_exp_f32 v220, v220
    v_mfma_f32_16x16x32_bf16 v[208:211], a[120:123], a[248:251], v[208:211]
    v_exp_f32 v221, v221
    v_mfma_f32_16x16x32_bf16 v[208:211], a[116:119], a[244:247], v[208:211]
    v_mov_b32_dpp v248, v248 row_ror:2 row_mask:0xf bank_mask:0xf
    v_cvt_pk_bf16_f32 v238, v220, v221
    v_mfma_f32_16x16x32_bf16 v[208:211], a[112:115], a[240:243], v[208:211]
    v_exp_f32 v222, v222
    v_mfma_f32_16x16x32_bf16 v[212:215], a[112:115], a[32:35], v[240:243]
    v_mov_b32_dpp v250, v250 row_ror:2 row_mask:0xf bank_mask:0xf
    v_mov_b32_dpp v249, v249 row_ror:2 row_mask:0xf bank_mask:0xf
    v_mfma_f32_16x16x32_bf16 v[212:215], a[116:119], a[36:39], v[212:215]
    v_exp_f32 v223, v223
    v_mfma_f32_16x16x32_bf16 v[212:215], a[120:123], a[40:43], v[212:215]
    v_mov_b32_dpp v251, v251 row_ror:2 row_mask:0xf bank_mask:0xf
    v_cvt_pk_bf16_f32 v239, v222, v223
    v_mfma_f32_16x16x32_bf16 v[212:215], a[124:127], a[44:47], v[212:215]
    v_exp_f32 v208, v208
    v_mfma_f32_16x16x32_bf16 v[216:219], a[140:143], a[44:47], v[240:243]
    v_exp_f32 v209, v209
    v_mfma_f32_16x16x32_bf16 v[216:219], a[136:139], a[40:43], v[216:219]
    ds_read_b64_tr_b16 a[208:209], v253 offset:64
    v_cvt_pk_bf16_f32 v208, v208, v209
    v_mfma_f32_16x16x32_bf16 v[216:219], a[132:135], a[36:39], v[216:219]
    v_exp_f32 v210, v210
    v_mfma_f32_16x16x32_bf16 v[216:219], a[128:131], a[32:35], v[216:219]
    ds_write_b32 v254, v208 offset:4096
    v_mfma_f32_16x16x32_bf16 v[220:223], a[144:147], a[32:35], v[240:243]
    v_exp_f32 v211, v211
    v_mfma_f32_16x16x32_bf16 v[220:223], a[148:151], a[36:39], v[220:223]
    ds_read_b64_tr_b16 a[210:211], v253 offset:576
    v_cvt_pk_bf16_f32 v209, v210, v211
    v_mfma_f32_16x16x32_bf16 v[220:223], a[152:155], a[40:43], v[220:223]
    ds_write_b32 v254, v209 offset:4100
    v_mfma_f32_16x16x32_bf16 v[220:223], a[156:159], a[44:47], v[220:223]
    v_exp_f32 v212, v212
    v_mfma_f32_16x16x32_bf16 v[208:211], a[172:175], a[44:47], v[240:243]
    v_exp_f32 v213, v213
    v_mfma_f32_16x16x32_bf16 v[208:211], a[168:171], a[40:43], v[208:211]
    ds_read_b64_tr_b16 a[216:217], v253 offset:80
    v_cvt_pk_bf16_f32 v224, v212, v213
    v_mfma_f32_16x16x32_bf16 v[208:211], a[164:167], a[36:39], v[208:211]
    v_exp_f32 v214, v214
    v_mfma_f32_16x16x32_bf16 v[208:211], a[160:163], a[32:35], v[208:211]
    s_waitcnt lgkmcnt(4)
    ds_read_b64_tr_b16 a[218:219], v253 offset:592
    ds_read_b64_tr_b16 a[224:225], v253 offset:96
    v_mfma_f32_16x16x32_bf16 v[32:35], v[232:235], a[176:179], v[32:35]
    v_exp_f32 v215, v215
    v_mfma_f32_16x16x32_bf16 v[32:35], v[236:239], a[180:183], v[32:35]
    ds_read_b64_tr_b16 a[226:227], v253 offset:608
    v_cvt_pk_bf16_f32 v225, v214, v215
    v_mfma_f32_16x16x32_bf16 v[36:39], v[236:239], a[188:191], v[36:39]
    v_exp_f32 v216, v216
    v_mfma_f32_16x16x32_bf16 v[36:39], v[232:235], a[184:187], v[36:39]
    v_exp_f32 v217, v217
    v_mfma_f32_16x16x32_bf16 v[40:43], v[232:235], a[192:195], v[40:43]
    ds_read_b64_tr_b16 a[232:233], v253 offset:112
    v_cvt_pk_bf16_f32 v226, v216, v217
    v_mfma_f32_16x16x32_bf16 v[40:43], v[236:239], a[196:199], v[40:43]
    v_exp_f32 v218, v218
    v_mfma_f32_16x16x32_bf16 v[44:47], v[236:239], a[204:207], v[44:47]
    ds_read_b64_tr_b16 a[234:235], v253 offset:624
    v_mfma_f32_16x16x32_bf16 v[44:47], v[232:235], a[200:203], v[44:47]
    s_waitcnt lgkmcnt(5)
    v_exp_f32 v219, v219
    v_mfma_f32_16x16x32_bf16 v[48:51], v[232:235], a[208:211], v[48:51]
    v_cvt_pk_bf16_f32 v227, v218, v219
    v_mfma_f32_16x16x32_bf16 v[48:51], v[236:239], a[212:215], v[48:51]
    v_exp_f32 v220, v220
    v_mfma_f32_16x16x32_bf16 v[52:55], v[236:239], a[220:223], v[52:55]
    s_waitcnt lgkmcnt(3)
    v_exp_f32 v221, v221
    v_mfma_f32_16x16x32_bf16 v[52:55], v[232:235], a[216:219], v[52:55]
    s_waitcnt lgkmcnt(2)
    v_cvt_pk_bf16_f32 v228, v220, v221
    v_mfma_f32_16x16x32_bf16 v[56:59], v[232:235], a[224:227], v[56:59]
    v_exp_f32 v222, v222
    v_mfma_f32_16x16x32_bf16 v[56:59], v[236:239], a[228:231], v[56:59]
    s_add_u32 m0, s34, s5
    v_mfma_f32_16x16x32_bf16 v[60:63], v[236:239], a[236:239], v[60:63]
    s_waitcnt lgkmcnt(0)
    v_exp_f32 v223, v223
    v_mfma_f32_16x16x32_bf16 v[60:63], v[232:235], a[232:235], v[60:63]
    s_add_u32 s8, s20, s66
    v_cvt_pk_bf16_f32 v229, v222, v223
    v_smfmac_f32_16x16x64_bf16 v[244:247], v[248:251], v[232:239], v240
    s_addc_u32 s9, s21, 0
    global_load_lds_dwordx4 v254, s[8:9] offset:0 nt
    v_mfma_f32_16x16x32_bf16 v[212:215], a[124:127], v[204:207], v[240:243]
    s_add_u32 s31, s31, 33536
    v_exp_f32 v208, v208
    v_mfma_f32_16x16x32_bf16 v[212:215], a[120:123], v[200:203], v[212:215]
    s_cmp_eq_u32 s31, 100608
    v_exp_f32 v209, v209
    v_mfma_f32_16x16x32_bf16 v[212:215], a[116:119], v[196:199], v[212:215]
    s_cselect_b32 s30, s71, s72
    v_mov_b32_dpp v248, v248 row_ror:2 row_mask:0xf bank_mask:0xf
    v_cvt_pk_bf16_f32 v230, v208, v209
    v_mfma_f32_16x16x32_bf16 v[212:215], a[112:115], v[192:195], v[212:215]
    s_cselect_b32 s31, 0, s31
    v_exp_f32 v210, v210
    v_mfma_f32_16x16x32_bf16 v[216:219], a[112:115], a[48:51], v[240:243]
    s_add_u32 s34, s34, 33536
    v_mov_b32_dpp v250, v250 row_ror:2 row_mask:0xf bank_mask:0xf
    v_mov_b32_dpp v249, v249 row_ror:2 row_mask:0xf bank_mask:0xf
    v_mfma_f32_16x16x32_bf16 v[216:219], a[116:119], a[52:55], v[216:219]
    s_cmp_eq_u32 s34, 100608
    v_exp_f32 v211, v211
    v_mfma_f32_16x16x32_bf16 v[216:219], a[120:123], a[56:59], v[216:219]
    s_cselect_b32 s34, 0, s34
    v_mov_b32_dpp v251, v251 row_ror:2 row_mask:0xf bank_mask:0xf
    v_cvt_pk_bf16_f32 v231, v210, v211
    v_mfma_f32_16x16x32_bf16 v[216:219], a[124:127], a[60:63], v[216:219]
    s_add_u32 s66, s66, 16384
    v_exp_f32 v212, v212
    v_mfma_f32_16x16x32_bf16 v[220:223], a[140:143], a[60:63], v[240:243]
    s_cmp_gt_u32 s66, s11
    v_exp_f32 v213, v213
    v_mfma_f32_16x16x32_bf16 v[220:223], a[136:139], a[56:59], v[220:223]
    s_cselect_b32 s66, 0, s66
    v_cvt_pk_bf16_f32 v212, v212, v213
    v_mfma_f32_16x16x32_bf16 v[220:223], a[132:135], a[52:55], v[220:223]
    v_exp_f32 v214, v214
    v_mfma_f32_16x16x32_bf16 v[220:223], a[128:131], a[48:51], v[220:223]
    ds_write_b32 v254, v212 offset:5120
    v_mfma_f32_16x16x32_bf16 v[208:211], a[144:147], a[48:51], v[240:243]
    v_exp_f32 v215, v215
    v_mfma_f32_16x16x32_bf16 v[208:211], a[148:151], a[52:55], v[208:211]
    ds_read_b128 a[144:147], v252 offset:8448
    v_cvt_pk_bf16_f32 v213, v214, v215
    v_mfma_f32_16x16x32_bf16 v[208:211], a[152:155], a[56:59], v[208:211]
    ds_write_b32 v254, v213 offset:5124
    v_mfma_f32_16x16x32_bf16 v[208:211], a[156:159], a[60:63], v[208:211]
    v_exp_f32 v216, v216
    v_mfma_f32_16x16x32_bf16 v[212:215], a[172:175], a[60:63], v[240:243]
    v_exp_f32 v217, v217
    v_mfma_f32_16x16x32_bf16 v[212:215], a[168:171], a[56:59], v[212:215]
    ds_read_b128 a[148:151], v252 offset:8512
    v_cvt_pk_bf16_f32 v232, v216, v217
    v_mfma_f32_16x16x32_bf16 v[212:215], a[164:167], a[52:55], v[212:215]
    v_exp_f32 v218, v218
    v_mfma_f32_16x16x32_bf16 v[212:215], a[160:163], a[48:51], v[212:215]
    ds_read_b128 a[152:155], v252 offset:8576
    v_mfma_f32_16x16x32_bf16 v[64:67], v[224:227], a[176:179], v[64:67]
    v_exp_f32 v219, v219
    v_mfma_f32_16x16x32_bf16 v[64:67], v[228:231], a[180:183], v[64:67]
    ds_read_b128 a[156:159], v252 offset:8640
    v_cvt_pk_bf16_f32 v233, v218, v219
    v_mfma_f32_16x16x32_bf16 v[68:71], v[228:231], a[188:191], v[68:71]
    v_exp_f32 v220, v220
    v_mfma_f32_16x16x32_bf16 v[68:71], v[224:227], a[184:187], v[68:71]
    v_exp_f32 v221, v221
    v_mfma_f32_16x16x32_bf16 v[72:75], v[224:227], a[192:195], v[72:75]
    ds_read_b128 a[172:175], v252 offset:9152
    v_cvt_pk_bf16_f32 v234, v220, v221
    v_mfma_f32_16x16x32_bf16 v[72:75], v[228:231], a[196:199], v[72:75]
    v_exp_f32 v222, v222
    v_mfma_f32_16x16x32_bf16 v[76:79], v[228:231], a[204:207], v[76:79]
    ds_read_b128 a[168:171], v252 offset:9088
    v_mfma_f32_16x16x32_bf16 v[76:79], v[224:227], a[200:203], v[76:79]
    v_exp_f32 v223, v223
    v_mfma_f32_16x16x32_bf16 v[80:83], v[224:227], a[208:211], v[80:83]
    ds_read_b128 a[164:167], v252 offset:9024
    v_cvt_pk_bf16_f32 v235, v222, v223
    v_mfma_f32_16x16x32_bf16 v[80:83], v[228:231], a[212:215], v[80:83]
    v_exp_f32 v208, v208
    v_mfma_f32_16x16x32_bf16 v[84:87], v[228:231], a[220:223], v[84:87]
    v_exp_f32 v209, v209
    v_mfma_f32_16x16x32_bf16 v[84:87], v[224:227], a[216:219], v[84:87]
    ds_read_b128 a[160:163], v252 offset:8960
    v_cvt_pk_bf16_f32 v236, v208, v209
    v_mfma_f32_16x16x32_bf16 v[88:91], v[224:227], a[224:227], v[88:91]
    v_exp_f32 v210, v210
    v_mfma_f32_16x16x32_bf16 v[88:91], v[228:231], a[228:231], v[88:91]
    v_mfma_f32_16x16x32_bf16 v[92:95], v[228:231], a[236:239], v[92:95]
    v_exp_f32 v211, v211
    v_mfma_f32_16x16x32_bf16 v[92:95], v[224:227], a[232:235], v[92:95]
    v_cvt_pk_bf16_f32 v237, v210, v211
    v_smfmac_f32_16x16x64_bf16 v[244:247], v[248:251], v[224:231], v240
    v_mfma_f32_16x16x32_bf16 v[216:219], a[140:143], a[108:111], v[240:243]
    v_exp_f32 v212, v212
    v_mfma_f32_16x16x32_bf16 v[216:219], a[136:139], a[104:107], v[216:219]
    v_exp_f32 v213, v213
    v_mfma_f32_16x16x32_bf16 v[216:219], a[132:135], a[100:103], v[216:219]
    v_mov_b32_dpp v248, v248 row_ror:2 row_mask:0xf bank_mask:0xf
    v_cvt_pk_bf16_f32 v238, v212, v213
    v_mfma_f32_16x16x32_bf16 v[216:219], a[128:131], a[96:99], v[216:219]
    v_exp_f32 v214, v214
    v_mfma_f32_16x16x32_bf16 v[220:223], a[112:115], a[64:67], v[240:243]
    v_mov_b32_dpp v250, v250 row_ror:2 row_mask:0xf bank_mask:0xf
    v_mov_b32_dpp v249, v249 row_ror:2 row_mask:0xf bank_mask:0xf
    v_mfma_f32_16x16x32_bf16 v[220:223], a[116:119], a[68:71], v[220:223]
    v_exp_f32 v215, v215
    v_mfma_f32_16x16x32_bf16 v[220:223], a[120:123], a[72:75], v[220:223]
    v_mov_b32_dpp v251, v251 row_ror:2 row_mask:0xf bank_mask:0xf
    v_cvt_pk_bf16_f32 v239, v214, v215
    v_mfma_f32_16x16x32_bf16 v[220:223], a[124:127], a[76:79], v[220:223]
    v_exp_f32 v216, v216
    v_mfma_f32_16x16x32_bf16 v[208:211], a[140:143], a[76:79], v[240:243]
    v_exp_f32 v217, v217
    v_mfma_f32_16x16x32_bf16 v[208:211], a[136:139], a[72:75], v[208:211]
    v_cvt_pk_bf16_f32 v216, v216, v217
    v_mfma_f32_16x16x32_bf16 v[208:211], a[132:135], a[68:71], v[208:211]
    v_exp_f32 v218, v218
    v_mfma_f32_16x16x32_bf16 v[208:211], a[128:131], a[64:67], v[208:211]
    s_waitcnt lgkmcnt(0)
    ds_write_b32 v254, v216 offset:3080
    v_mfma_f32_16x16x32_bf16 v[212:215], a[144:147], a[64:67], v[240:243]
    v_exp_f32 v219, v219
    v_mfma_f32_16x16x32_bf16 v[212:215], a[148:151], a[68:71], v[212:215]
    v_cvt_pk_bf16_f32 v217, v218, v219
    v_mfma_f32_16x16x32_bf16 v[212:215], a[152:155], a[72:75], v[212:215]
    ds_write_b32 v254, v217 offset:3084
    v_mfma_f32_16x16x32_bf16 v[212:215], a[156:159], a[76:79], v[212:215]
    v_exp_f32 v220, v220
    v_mfma_f32_16x16x32_bf16 v[216:219], a[172:175], a[76:79], v[240:243]
    v_exp_f32 v221, v221
    v_mfma_f32_16x16x32_bf16 v[216:219], a[168:171], a[72:75], v[216:219]
    v_cvt_pk_bf16_f32 v224, v220, v221
    v_mfma_f32_16x16x32_bf16 v[216:219], a[164:167], a[68:71], v[216:219]
    v_exp_f32 v222, v222
    v_mfma_f32_16x16x32_bf16 v[216:219], a[160:163], a[64:67], v[216:219]
    v_mfma_f32_16x16x32_bf16 v[96:99], v[232:235], a[176:179], v[96:99]
    v_exp_f32 v223, v223
    v_mfma_f32_16x16x32_bf16 v[96:99], v[236:239], a[180:183], v[96:99]
    ds_read_b64_tr_b16 a[180:181], v253 offset:8320
    v_cvt_pk_bf16_f32 v225, v222, v223
    v_mfma_f32_16x16x32_bf16 v[100:103], v[236:239], a[188:191], v[100:103]
    v_exp_f32 v208, v208
    v_mfma_f32_16x16x32_bf16 v[100:103], v[232:235], a[184:187], v[100:103]
    v_exp_f32 v209, v209
    v_mfma_f32_16x16x32_bf16 v[104:107], v[232:235], a[192:195], v[104:107]
    ds_read_b64_tr_b16 a[182:183], v253 offset:8832
    v_cvt_pk_bf16_f32 v226, v208, v209
    v_mfma_f32_16x16x32_bf16 v[104:107], v[236:239], a[196:199], v[104:107]
    v_exp_f32 v210, v210
    v_mfma_f32_16x16x32_bf16 v[108:111], v[236:239], a[204:207], v[108:111]
    ds_read_b64_tr_b16 a[188:189], v253 offset:8336
    v_mfma_f32_16x16x32_bf16 v[108:111], v[232:235], a[200:203], v[108:111]
    v_exp_f32 v211, v211
    v_mfma_f32_16x16x32_bf16 v[112:115], v[232:235], a[208:211], v[112:115]
    ds_read_b64_tr_b16 a[190:191], v253 offset:8848
    v_cvt_pk_bf16_f32 v227, v210, v211
    v_mfma_f32_16x16x32_bf16 v[112:115], v[236:239], a[212:215], v[112:115]
    v_exp_f32 v212, v212
    v_mfma_f32_16x16x32_bf16 v[116:119], v[236:239], a[220:223], v[116:119]
    v_exp_f32 v213, v213
    v_mfma_f32_16x16x32_bf16 v[116:119], v[232:235], a[216:219], v[116:119]
    ds_read_b64_tr_b16 a[196:197], v253 offset:8352
    v_cvt_pk_bf16_f32 v228, v212, v213
    v_mfma_f32_16x16x32_bf16 v[120:123], v[232:235], a[224:227], v[120:123]
    v_exp_f32 v214, v214
    v_mfma_f32_16x16x32_bf16 v[120:123], v[236:239], a[228:231], v[120:123]
    ds_read_b64_tr_b16 a[198:199], v253 offset:8864
    v_mfma_f32_16x16x32_bf16 v[124:127], v[236:239], a[236:239], v[124:127]
    v_exp_f32 v215, v215
    v_mfma_f32_16x16x32_bf16 v[124:127], v[232:235], a[232:235], v[124:127]
    ds_read_b64_tr_b16 a[204:205], v253 offset:8368
    v_cvt_pk_bf16_f32 v229, v214, v215
    v_smfmac_f32_16x16x64_bf16 v[244:247], v[248:251], v[232:239], v240
    ds_read_b64_tr_b16 a[206:207], v253 offset:8880
    ds_read_b64_tr_b16 a[212:213], v253 offset:8384
    v_mfma_f32_16x16x32_bf16 v[220:223], a[140:143], a[252:255], v[240:243]
    v_exp_f32 v216, v216
    v_mfma_f32_16x16x32_bf16 v[220:223], a[136:139], a[248:251], v[220:223]
    v_exp_f32 v217, v217
    v_mfma_f32_16x16x32_bf16 v[220:223], a[132:135], a[244:247], v[220:223]
    v_mov_b32_dpp v248, v248 row_ror:2 row_mask:0xf bank_mask:0xf
    v_cvt_pk_bf16_f32 v230, v216, v217
    v_mfma_f32_16x16x32_bf16 v[220:223], a[128:131], a[240:243], v[220:223]
    v_exp_f32 v218, v218
    v_mfma_f32_16x16x32_bf16 v[208:211], a[112:115], a[80:83], v[240:243]
    v_mov_b32_dpp v250, v250 row_ror:2 row_mask:0xf bank_mask:0xf
    v_mov_b32_dpp v249, v249 row_ror:2 row_mask:0xf bank_mask:0xf
    v_mfma_f32_16x16x32_bf16 v[208:211], a[116:119], a[84:87], v[208:211]
    v_exp_f32 v219, v219
    v_mfma_f32_16x16x32_bf16 v[208:211], a[120:123], a[88:91], v[208:211]
    v_mov_b32_dpp v251, v251 row_ror:2 row_mask:0xf bank_mask:0xf
    v_cvt_pk_bf16_f32 v231, v218, v219
    v_mfma_f32_16x16x32_bf16 v[208:211], a[124:127], a[92:95], v[208:211]
    v_exp_f32 v220, v220
    v_mfma_f32_16x16x32_bf16 v[212:215], a[140:143], a[92:95], v[240:243]
    v_exp_f32 v221, v221
    v_mfma_f32_16x16x32_bf16 v[212:215], a[136:139], a[88:91], v[212:215]
    ds_read_b64_tr_b16 a[214:215], v253 offset:8896
    v_cvt_pk_bf16_f32 v220, v220, v221
    v_mfma_f32_16x16x32_bf16 v[212:215], a[132:135], a[84:87], v[212:215]
    v_exp_f32 v222, v222
    v_mfma_f32_16x16x32_bf16 v[212:215], a[128:131], a[80:83], v[212:215]
    ds_write_b32 v254, v220 offset:4104
    v_mfma_f32_16x16x32_bf16 v[216:219], a[144:147], a[80:83], v[240:243]
    v_exp_f32 v223, v223
    v_mfma_f32_16x16x32_bf16 v[216:219], a[148:151], a[84:87], v[216:219]
    ds_read_b64_tr_b16 a[220:221], v253 offset:8400
    v_cvt_pk_bf16_f32 v221, v222, v223
    v_mfma_f32_16x16x32_bf16 v[216:219], a[152:155], a[88:91], v[216:219]
    ds_write_b32 v254, v221 offset:4108
    v_mfma_f32_16x16x32_bf16 v[216:219], a[156:159], a[92:95], v[216:219]
    v_exp_f32 v208, v208
    v_mfma_f32_16x16x32_bf16 v[220:223], a[172:175], a[92:95], v[240:243]
    v_exp_f32 v209, v209
    v_mfma_f32_16x16x32_bf16 v[220:223], a[168:171], a[88:91], v[220:223]
    ds_read_b64_tr_b16 a[222:223], v253 offset:8912
    v_cvt_pk_bf16_f32 v232, v208, v209
    v_mfma_f32_16x16x32_bf16 v[220:223], a[164:167], a[84:87], v[220:223]
    v_exp_f32 v210, v210
    v_mfma_f32_16x16x32_bf16 v[220:223], a[160:163], a[80:83], v[220:223]
    ds_read_b64_tr_b16 a[228:229], v253 offset:8416
    ds_read_b64_tr_b16 a[230:231], v253 offset:8928
    v_mfma_f32_16x16x32_bf16 v[128:131], v[224:227], a[176:179], v[128:131]
    s_waitcnt lgkmcnt(6)
    v_exp_f32 v211, v211
    v_mfma_f32_16x16x32_bf16 v[128:131], v[228:231], a[180:183], v[128:131]
    ds_read_b64_tr_b16 a[236:237], v253 offset:8432
    v_cvt_pk_bf16_f32 v233, v210, v211
    v_mfma_f32_16x16x32_bf16 v[132:135], v[228:231], a[188:191], v[132:135]
    v_exp_f32 v212, v212
    v_mfma_f32_16x16x32_bf16 v[132:135], v[224:227], a[184:187], v[132:135]
    v_exp_f32 v213, v213
    v_mfma_f32_16x16x32_bf16 v[136:139], v[224:227], a[192:195], v[136:139]
    ds_read_b64_tr_b16 a[238:239], v253 offset:8944
    v_cvt_pk_bf16_f32 v234, v212, v213
    v_mfma_f32_16x16x32_bf16 v[136:139], v[228:231], a[196:199], v[136:139]
    v_exp_f32 v214, v214
    v_mfma_f32_16x16x32_bf16 v[140:143], v[228:231], a[204:207], v[140:143]
    v_mfma_f32_16x16x32_bf16 v[140:143], v[224:227], a[200:203], v[140:143]
    v_exp_f32 v215, v215
    v_mfma_f32_16x16x32_bf16 v[144:147], v[224:227], a[208:211], v[144:147]
    v_cvt_pk_bf16_f32 v235, v214, v215
    v_mfma_f32_16x16x32_bf16 v[144:147], v[228:231], a[212:215], v[144:147]
    s_waitcnt lgkmcnt(2)
    v_exp_f32 v216, v216
    v_mfma_f32_16x16x32_bf16 v[148:151], v[228:231], a[220:223], v[148:151]
    v_exp_f32 v217, v217
    v_mfma_f32_16x16x32_bf16 v[148:151], v[224:227], a[216:219], v[148:151]
    v_cvt_pk_bf16_f32 v236, v216, v217
    v_mfma_f32_16x16x32_bf16 v[152:155], v[224:227], a[224:227], v[152:155]
    v_exp_f32 v218, v218
    v_mfma_f32_16x16x32_bf16 v[152:155], v[228:231], a[228:231], v[152:155]
    s_waitcnt lgkmcnt(0)
    v_add_u32 v252, s30, v252
    v_mfma_f32_16x16x32_bf16 v[156:159], v[228:231], a[236:239], v[156:159]
    v_exp_f32 v219, v219
    v_mfma_f32_16x16x32_bf16 v[156:159], v[224:227], a[232:235], v[156:159]
    s_waitcnt vmcnt(2)
    v_cvt_pk_bf16_f32 v237, v218, v219
    v_add_u32 v253, s30, v253
    v_smfmac_f32_16x16x64_bf16 v[244:247], v[248:251], v[224:231], v240
    v_mfma_f32_16x16x32_bf16 v[208:211], a[140:143], v[204:207], v[240:243]
    v_exp_f32 v220, v220
    v_mfma_f32_16x16x32_bf16 v[208:211], a[136:139], v[200:203], v[208:211]
    v_exp_f32 v221, v221
    v_mfma_f32_16x16x32_bf16 v[208:211], a[132:135], v[196:199], v[208:211]
    v_mov_b32_dpp v248, v248 row_ror:2 row_mask:0xf bank_mask:0xf
    v_cvt_pk_bf16_f32 v238, v220, v221
    v_mfma_f32_16x16x32_bf16 v[208:211], a[128:131], v[192:195], v[208:211]
    v_exp_f32 v222, v222
    v_mfma_f32_16x16x32_bf16 v[212:215], a[112:115], a[0:3], v[240:243]
    v_mov_b32_dpp v250, v250 row_ror:2 row_mask:0xf bank_mask:0xf
    v_mov_b32_dpp v249, v249 row_ror:2 row_mask:0xf bank_mask:0xf
    v_mfma_f32_16x16x32_bf16 v[212:215], a[116:119], a[4:7], v[212:215]
    v_exp_f32 v223, v223
    v_mfma_f32_16x16x32_bf16 v[212:215], a[120:123], a[8:11], v[212:215]
    v_mov_b32_dpp v251, v251 row_ror:2 row_mask:0xf bank_mask:0xf
    v_cvt_pk_bf16_f32 v239, v222, v223
    v_mfma_f32_16x16x32_bf16 v[212:215], a[124:127], a[12:15], v[212:215]
    v_exp_f32 v208, v208
    v_mfma_f32_16x16x32_bf16 v[216:219], a[140:143], a[12:15], v[240:243]
    v_exp_f32 v209, v209
    v_mfma_f32_16x16x32_bf16 v[216:219], a[136:139], a[8:11], v[216:219]
    v_cvt_pk_bf16_f32 v208, v208, v209
    v_mfma_f32_16x16x32_bf16 v[216:219], a[132:135], a[4:7], v[216:219]
    v_exp_f32 v210, v210
    v_mfma_f32_16x16x32_bf16 v[216:219], a[128:131], a[0:3], v[216:219]
    ds_write_b32 v254, v208 offset:5128
    v_mfma_f32_16x16x32_bf16 v[220:223], a[144:147], a[0:3], v[240:243]
    v_exp_f32 v211, v211
    v_mfma_f32_16x16x32_bf16 v[220:223], a[148:151], a[4:7], v[220:223]
    v_cvt_pk_bf16_f32 v209, v210, v211
    v_mfma_f32_16x16x32_bf16 v[220:223], a[152:155], a[8:11], v[220:223]
    ds_write_b32 v254, v209 offset:5132
    v_mfma_f32_16x16x32_bf16 v[220:223], a[156:159], a[12:15], v[220:223]
    v_exp_f32 v212, v212
    v_mfma_f32_16x16x32_bf16 v[208:211], a[172:175], a[12:15], v[240:243]
    v_exp_f32 v213, v213
    v_mfma_f32_16x16x32_bf16 v[208:211], a[168:171], a[8:11], v[208:211]
    v_cvt_pk_bf16_f32 v224, v212, v213
    v_mfma_f32_16x16x32_bf16 v[208:211], a[164:167], a[4:7], v[208:211]
    v_exp_f32 v214, v214
    v_mfma_f32_16x16x32_bf16 v[208:211], a[160:163], a[0:3], v[208:211]
    v_mfma_f32_16x16x32_bf16 v[160:163], v[232:235], a[176:179], v[160:163]
    s_waitcnt lgkmcnt(0)
    v_exp_f32 v215, v215
    v_mfma_f32_16x16x32_bf16 v[160:163], v[236:239], a[180:183], v[160:163]
    s_barrier
    v_cvt_pk_bf16_f32 v225, v214, v215
    v_mfma_f32_16x16x32_bf16 v[164:167], v[236:239], a[188:191], v[164:167]
    v_exp_f32 v216, v216
    v_mfma_f32_16x16x32_bf16 v[164:167], v[232:235], a[184:187], v[164:167]
    v_exp_f32 v217, v217
    v_mfma_f32_16x16x32_bf16 v[168:171], v[232:235], a[192:195], v[168:171]
    s_add_u32 m0, s34, s4
    ds_read_b128 a[124:127], v252 offset:192
    v_cvt_pk_bf16_f32 v226, v216, v217
    v_mfma_f32_16x16x32_bf16 v[168:171], v[236:239], a[196:199], v[168:171]
    s_add_u32 s8, s16, s64
    v_exp_f32 v218, v218
    v_mfma_f32_16x16x32_bf16 v[172:175], v[236:239], a[204:207], v[172:175]
    s_addc_u32 s9, s17, 0
    ds_read_b128 a[120:123], v252 offset:128
    global_load_lds_dwordx4 v254, s[8:9] offset:0 nt
    v_mfma_f32_16x16x32_bf16 v[172:175], v[232:235], a[200:203], v[172:175]
    s_add_u32 s64, s64, 16384
    v_exp_f32 v219, v219
    v_mfma_f32_16x16x32_bf16 v[176:179], v[232:235], a[208:211], v[176:179]
    s_cmp_gt_u32 s64, s10
    ds_read_b128 a[116:119], v252 offset:64
    v_cvt_pk_bf16_f32 v227, v218, v219
    v_mfma_f32_16x16x32_bf16 v[176:179], v[236:239], a[212:215], v[176:179]
    s_cselect_b32 s64, 0, s64
    v_exp_f32 v220, v220
    v_mfma_f32_16x16x32_bf16 v[180:183], v[236:239], a[220:223], v[180:183]
    v_exp_f32 v221, v221
    v_mfma_f32_16x16x32_bf16 v[180:183], v[232:235], a[216:219], v[180:183]
    ds_read_b128 a[112:115], v252 offset:0
    v_cvt_pk_bf16_f32 v228, v220, v221
    v_mfma_f32_16x16x32_bf16 v[184:187], v[232:235], a[224:227], v[184:187]
    v_exp_f32 v222, v222
    v_mfma_f32_16x16x32_bf16 v[184:187], v[236:239], a[228:231], v[184:187]
    ds_read_b128 a[140:143], v252 offset:704
    v_mfma_f32_16x16x32_bf16 v[188:191], v[236:239], a[236:239], v[188:191]
    v_exp_f32 v223, v223
    v_mfma_f32_16x16x32_bf16 v[188:191], v[232:235], a[232:235], v[188:191]
    ds_read_b128 a[136:139], v252 offset:640
    v_cvt_pk_bf16_f32 v229, v222, v223
    v_smfmac_f32_16x16x64_bf16 v[244:247], v[248:251], v[232:239], v240
    s_waitcnt lgkmcnt(4)
    ds_read_b128 a[132:135], v252 offset:576
    ds_read_b128 a[128:131], v252 offset:512
    v_mfma_f32_16x16x32_bf16 v[212:215], a[124:127], a[108:111], v[240:243]
    v_exp_f32 v208, v208
    v_mfma_f32_16x16x32_bf16 v[212:215], a[120:123], a[104:107], v[212:215]
    s_waitcnt lgkmcnt(5)
    v_exp_f32 v209, v209
    v_mfma_f32_16x16x32_bf16 v[212:215], a[116:119], a[100:103], v[212:215]
    s_waitcnt lgkmcnt(4)
    v_mov_b32_dpp v248, v248 row_ror:6 row_mask:0xf bank_mask:0xf
    v_cvt_pk_bf16_f32 v230, v208, v209
    v_mfma_f32_16x16x32_bf16 v[212:215], a[112:115], a[96:99], v[212:215]
    v_exp_f32 v210, v210
    v_mfma_f32_16x16x32_bf16 v[216:219], a[112:115], a[16:19], v[240:243]
    v_mov_b32_dpp v250, v250 row_ror:6 row_mask:0xf bank_mask:0xf
    v_mov_b32_dpp v249, v249 row_ror:6 row_mask:0xf bank_mask:0xf
    v_mfma_f32_16x16x32_bf16 v[216:219], a[116:119], a[20:23], v[216:219]
    v_exp_f32 v211, v211
    v_mfma_f32_16x16x32_bf16 v[216:219], a[120:123], a[24:27], v[216:219]
    v_mov_b32_dpp v251, v251 row_ror:6 row_mask:0xf bank_mask:0xf
    v_cvt_pk_bf16_f32 v231, v210, v211
    v_mfma_f32_16x16x32_bf16 v[216:219], a[124:127], a[28:31], v[216:219]
    s_waitcnt lgkmcnt(3)
    v_exp_f32 v212, v212
    v_mfma_f32_16x16x32_bf16 v[220:223], a[140:143], a[28:31], v[240:243]
    s_waitcnt lgkmcnt(2)
    v_exp_f32 v213, v213
    v_mfma_f32_16x16x32_bf16 v[220:223], a[136:139], a[24:27], v[220:223]
    s_waitcnt lgkmcnt(0)
    v_cvt_pk_bf16_f32 v212, v212, v213
    v_mfma_f32_16x16x32_bf16 v[220:223], a[132:135], a[20:23], v[220:223]
    v_exp_f32 v214, v214
    v_mfma_f32_16x16x32_bf16 v[220:223], a[128:131], a[16:19], v[220:223]
    ds_write_b32 v254, v212 offset:0
    v_mfma_f32_16x16x32_bf16 v[208:211], a[144:147], a[16:19], v[240:243]
    v_exp_f32 v215, v215
    v_mfma_f32_16x16x32_bf16 v[208:211], a[148:151], a[20:23], v[208:211]
    v_cvt_pk_bf16_f32 v213, v214, v215
    v_mfma_f32_16x16x32_bf16 v[208:211], a[152:155], a[24:27], v[208:211]
    ds_write_b32 v254, v213 offset:4
    v_mfma_f32_16x16x32_bf16 v[208:211], a[156:159], a[28:31], v[208:211]
    v_exp_f32 v216, v216
    v_mfma_f32_16x16x32_bf16 v[212:215], a[172:175], a[28:31], v[240:243]
    v_exp_f32 v217, v217
    v_mfma_f32_16x16x32_bf16 v[212:215], a[168:171], a[24:27], v[212:215]
    v_cvt_pk_bf16_f32 v232, v216, v217
    v_mfma_f32_16x16x32_bf16 v[212:215], a[164:167], a[20:23], v[212:215]
    v_exp_f32 v218, v218
    v_mfma_f32_16x16x32_bf16 v[212:215], a[160:163], a[16:19], v[212:215]
    v_mfma_f32_16x16x32_bf16 v[0:3], v[224:227], a[176:179], v[0:3]
    v_exp_f32 v219, v219
    v_mfma_f32_16x16x32_bf16 v[0:3], v[228:231], a[180:183], v[0:3]
    ds_read_b64_tr_b16 a[176:177], v253 offset:0
    v_cvt_pk_bf16_f32 v233, v218, v219
    v_mfma_f32_16x16x32_bf16 v[4:7], v[228:231], a[188:191], v[4:7]
    v_exp_f32 v220, v220
    v_mfma_f32_16x16x32_bf16 v[4:7], v[224:227], a[184:187], v[4:7]
    v_exp_f32 v221, v221
    v_mfma_f32_16x16x32_bf16 v[8:11], v[224:227], a[192:195], v[8:11]
    ds_read_b64_tr_b16 a[178:179], v253 offset:512
    v_cvt_pk_bf16_f32 v234, v220, v221
    v_mfma_f32_16x16x32_bf16 v[8:11], v[228:231], a[196:199], v[8:11]
    v_exp_f32 v222, v222
    v_mfma_f32_16x16x32_bf16 v[12:15], v[228:231], a[204:207], v[12:15]
    ds_read_b64_tr_b16 a[184:185], v253 offset:16
    v_mfma_f32_16x16x32_bf16 v[12:15], v[224:227], a[200:203], v[12:15]
    v_exp_f32 v223, v223
    v_mfma_f32_16x16x32_bf16 v[16:19], v[224:227], a[208:211], v[16:19]
    ds_read_b64_tr_b16 a[186:187], v253 offset:528
    v_cvt_pk_bf16_f32 v235, v222, v223
    v_mfma_f32_16x16x32_bf16 v[16:19], v[228:231], a[212:215], v[16:19]
    v_exp_f32 v208, v208
    v_mfma_f32_16x16x32_bf16 v[20:23], v[228:231], a[220:223], v[20:23]
    v_exp_f32 v209, v209
    v_mfma_f32_16x16x32_bf16 v[20:23], v[224:227], a[216:219], v[20:23]
    ds_read_b64_tr_b16 a[192:193], v253 offset:32
    v_cvt_pk_bf16_f32 v236, v208, v209
    v_mfma_f32_16x16x32_bf16 v[24:27], v[224:227], a[224:227], v[24:27]
    v_exp_f32 v210, v210
    v_mfma_f32_16x16x32_bf16 v[24:27], v[228:231], a[228:231], v[24:27]
    ds_read_b64_tr_b16 a[194:195], v253 offset:544
    v_mfma_f32_16x16x32_bf16 v[28:31], v[228:231], a[236:239], v[28:31]
    v_exp_f32 v211, v211
    v_mfma_f32_16x16x32_bf16 v[28:31], v[224:227], a[232:235], v[28:31]
    ds_read_b64_tr_b16 a[200:201], v253 offset:48
    v_cvt_pk_bf16_f32 v237, v210, v211
    v_smfmac_f32_16x16x64_bf16 v[244:247], v[248:251], v[224:231], v240
    ds_read_b64_tr_b16 a[202:203], v253 offset:560
    v_mfma_f32_16x16x32_bf16 v[216:219], a[124:127], a[252:255], v[240:243]
    v_exp_f32 v212, v212
    v_mfma_f32_16x16x32_bf16 v[216:219], a[120:123], a[248:251], v[216:219]
    v_exp_f32 v213, v213
    v_mfma_f32_16x16x32_bf16 v[216:219], a[116:119], a[244:247], v[216:219]
    v_mov_b32_dpp v248, v248 row_ror:2 row_mask:0xf bank_mask:0xf
    v_cvt_pk_bf16_f32 v238, v212, v213
    v_mfma_f32_16x16x32_bf16 v[216:219], a[112:115], a[240:243], v[216:219]
    v_exp_f32 v214, v214
    v_mfma_f32_16x16x32_bf16 v[220:223], a[112:115], a[32:35], v[240:243]
    v_mov_b32_dpp v250, v250 row_ror:2 row_mask:0xf bank_mask:0xf
    v_mov_b32_dpp v249, v249 row_ror:2 row_mask:0xf bank_mask:0xf
    v_mfma_f32_16x16x32_bf16 v[220:223], a[116:119], a[36:39], v[220:223]
    v_exp_f32 v215, v215
    v_mfma_f32_16x16x32_bf16 v[220:223], a[120:123], a[40:43], v[220:223]
    v_mov_b32_dpp v251, v251 row_ror:2 row_mask:0xf bank_mask:0xf
    v_cvt_pk_bf16_f32 v239, v214, v215
    v_mfma_f32_16x16x32_bf16 v[220:223], a[124:127], a[44:47], v[220:223]
    v_exp_f32 v216, v216
    v_mfma_f32_16x16x32_bf16 v[208:211], a[140:143], a[44:47], v[240:243]
    v_exp_f32 v217, v217
    v_mfma_f32_16x16x32_bf16 v[208:211], a[136:139], a[40:43], v[208:211]
    ds_read_b64_tr_b16 a[208:209], v253 offset:64
    v_cvt_pk_bf16_f32 v216, v216, v217
    v_mfma_f32_16x16x32_bf16 v[208:211], a[132:135], a[36:39], v[208:211]
    v_exp_f32 v218, v218
    v_mfma_f32_16x16x32_bf16 v[208:211], a[128:131], a[32:35], v[208:211]
    ds_write_b32 v254, v216 offset:1024
    v_mfma_f32_16x16x32_bf16 v[212:215], a[144:147], a[32:35], v[240:243]
    v_exp_f32 v219, v219
    v_mfma_f32_16x16x32_bf16 v[212:215], a[148:151], a[36:39], v[212:215]
    ds_read_b64_tr_b16 a[210:211], v253 offset:576
    v_cvt_pk_bf16_f32 v217, v218, v219
    v_mfma_f32_16x16x32_bf16 v[212:215], a[152:155], a[40:43], v[212:215]
    ds_write_b32 v254, v217 offset:1028
    v_mfma_f32_16x16x32_bf16 v[212:215], a[156:159], a[44:47], v[212:215]
    v_exp_f32 v220, v220
    v_mfma_f32_16x16x32_bf16 v[216:219], a[172:175], a[44:47], v[240:243]
    v_exp_f32 v221, v221
    v_mfma_f32_16x16x32_bf16 v[216:219], a[168:171], a[40:43], v[216:219]
    ds_read_b64_tr_b16 a[216:217], v253 offset:80
    v_cvt_pk_bf16_f32 v224, v220, v221
    v_mfma_f32_16x16x32_bf16 v[216:219], a[164:167], a[36:39], v[216:219]
    v_exp_f32 v222, v222
    v_mfma_f32_16x16x32_bf16 v[216:219], a[160:163], a[32:35], v[216:219]
    s_waitcnt lgkmcnt(4)
    ds_read_b64_tr_b16 a[218:219], v253 offset:592
    ds_read_b64_tr_b16 a[224:225], v253 offset:96
    v_mfma_f32_16x16x32_bf16 v[32:35], v[232:235], a[176:179], v[32:35]
    v_exp_f32 v223, v223
    v_mfma_f32_16x16x32_bf16 v[32:35], v[236:239], a[180:183], v[32:35]
    ds_read_b64_tr_b16 a[226:227], v253 offset:608
    v_cvt_pk_bf16_f32 v225, v222, v223
    v_mfma_f32_16x16x32_bf16 v[36:39], v[236:239], a[188:191], v[36:39]
    v_exp_f32 v208, v208
    v_mfma_f32_16x16x32_bf16 v[36:39], v[232:235], a[184:187], v[36:39]
    v_exp_f32 v209, v209
    v_mfma_f32_16x16x32_bf16 v[40:43], v[232:235], a[192:195], v[40:43]
    ds_read_b64_tr_b16 a[232:233], v253 offset:112
    v_cvt_pk_bf16_f32 v226, v208, v209
    v_mfma_f32_16x16x32_bf16 v[40:43], v[236:239], a[196:199], v[40:43]
    v_exp_f32 v210, v210
    v_mfma_f32_16x16x32_bf16 v[44:47], v[236:239], a[204:207], v[44:47]
    ds_read_b64_tr_b16 a[234:235], v253 offset:624
    v_mfma_f32_16x16x32_bf16 v[44:47], v[232:235], a[200:203], v[44:47]
    s_waitcnt lgkmcnt(5)
    v_exp_f32 v211, v211
    v_mfma_f32_16x16x32_bf16 v[48:51], v[232:235], a[208:211], v[48:51]
    v_cvt_pk_bf16_f32 v227, v210, v211
    v_mfma_f32_16x16x32_bf16 v[48:51], v[236:239], a[212:215], v[48:51]
    v_exp_f32 v212, v212
    v_mfma_f32_16x16x32_bf16 v[52:55], v[236:239], a[220:223], v[52:55]
    s_waitcnt lgkmcnt(3)
    v_exp_f32 v213, v213
    v_mfma_f32_16x16x32_bf16 v[52:55], v[232:235], a[216:219], v[52:55]
    s_waitcnt lgkmcnt(2)
    v_cvt_pk_bf16_f32 v228, v212, v213
    v_mfma_f32_16x16x32_bf16 v[56:59], v[232:235], a[224:227], v[56:59]
    v_exp_f32 v214, v214
    v_mfma_f32_16x16x32_bf16 v[56:59], v[236:239], a[228:231], v[56:59]
    s_add_u32 m0, s34, s5
    v_mfma_f32_16x16x32_bf16 v[60:63], v[236:239], a[236:239], v[60:63]
    s_waitcnt lgkmcnt(0)
    v_exp_f32 v215, v215
    v_mfma_f32_16x16x32_bf16 v[60:63], v[232:235], a[232:235], v[60:63]
    s_add_u32 s8, s20, s66
    v_cvt_pk_bf16_f32 v229, v214, v215
    v_smfmac_f32_16x16x64_bf16 v[244:247], v[248:251], v[232:239], v240
    s_addc_u32 s9, s21, 0
    global_load_lds_dwordx4 v254, s[8:9] offset:0 nt
    v_mfma_f32_16x16x32_bf16 v[220:223], a[124:127], v[204:207], v[240:243]
    s_add_u32 s31, s31, 33536
    v_exp_f32 v216, v216
    v_mfma_f32_16x16x32_bf16 v[220:223], a[120:123], v[200:203], v[220:223]
    s_cmp_eq_u32 s31, 100608
    v_exp_f32 v217, v217
    v_mfma_f32_16x16x32_bf16 v[220:223], a[116:119], v[196:199], v[220:223]
    s_cselect_b32 s30, s71, s72
    v_mov_b32_dpp v248, v248 row_ror:2 row_mask:0xf bank_mask:0xf
    v_cvt_pk_bf16_f32 v230, v216, v217
    v_mfma_f32_16x16x32_bf16 v[220:223], a[112:115], v[192:195], v[220:223]
    s_cselect_b32 s31, 0, s31
    v_exp_f32 v218, v218
    v_mfma_f32_16x16x32_bf16 v[208:211], a[112:115], a[48:51], v[240:243]
    s_add_u32 s34, s34, 33536
    v_mov_b32_dpp v250, v250 row_ror:2 row_mask:0xf bank_mask:0xf
    v_mov_b32_dpp v249, v249 row_ror:2 row_mask:0xf bank_mask:0xf
    v_mfma_f32_16x16x32_bf16 v[208:211], a[116:119], a[52:55], v[208:211]
    s_cmp_eq_u32 s34, 100608
    v_exp_f32 v219, v219
    v_mfma_f32_16x16x32_bf16 v[208:211], a[120:123], a[56:59], v[208:211]
    s_cselect_b32 s34, 0, s34
    v_mov_b32_dpp v251, v251 row_ror:2 row_mask:0xf bank_mask:0xf
    v_cvt_pk_bf16_f32 v231, v218, v219
    v_mfma_f32_16x16x32_bf16 v[208:211], a[124:127], a[60:63], v[208:211]
    s_add_u32 s66, s66, 16384
    v_exp_f32 v220, v220
    v_mfma_f32_16x16x32_bf16 v[212:215], a[140:143], a[60:63], v[240:243]
    s_cmp_gt_u32 s66, s11
    v_exp_f32 v221, v221
    v_mfma_f32_16x16x32_bf16 v[212:215], a[136:139], a[56:59], v[212:215]
    s_cselect_b32 s66, 0, s66
    v_cvt_pk_bf16_f32 v220, v220, v221
    v_mfma_f32_16x16x32_bf16 v[212:215], a[132:135], a[52:55], v[212:215]
    s_sub_u32 s29, s29, 1
    v_exp_f32 v222, v222
    v_mfma_f32_16x16x32_bf16 v[212:215], a[128:131], a[48:51], v[212:215]
    ds_write_b32 v254, v220 offset:2048
    v_mfma_f32_16x16x32_bf16 v[216:219], a[144:147], a[48:51], v[240:243]
    v_exp_f32 v223, v223
    v_mfma_f32_16x16x32_bf16 v[216:219], a[148:151], a[52:55], v[216:219]
    ds_read_b128 a[144:147], v252 offset:8448
    v_cvt_pk_bf16_f32 v221, v222, v223
    v_mfma_f32_16x16x32_bf16 v[216:219], a[152:155], a[56:59], v[216:219]
    ds_write_b32 v254, v221 offset:2052
    v_mfma_f32_16x16x32_bf16 v[216:219], a[156:159], a[60:63], v[216:219]
    v_exp_f32 v208, v208
    v_mfma_f32_16x16x32_bf16 v[220:223], a[172:175], a[60:63], v[240:243]
    v_exp_f32 v209, v209
    v_mfma_f32_16x16x32_bf16 v[220:223], a[168:171], a[56:59], v[220:223]
    ds_read_b128 a[148:151], v252 offset:8512
    v_cvt_pk_bf16_f32 v232, v208, v209
    v_mfma_f32_16x16x32_bf16 v[220:223], a[164:167], a[52:55], v[220:223]
    v_exp_f32 v210, v210
    v_mfma_f32_16x16x32_bf16 v[220:223], a[160:163], a[48:51], v[220:223]
    ds_read_b128 a[152:155], v252 offset:8576
    v_mfma_f32_16x16x32_bf16 v[64:67], v[224:227], a[176:179], v[64:67]
    v_exp_f32 v211, v211
    v_mfma_f32_16x16x32_bf16 v[64:67], v[228:231], a[180:183], v[64:67]
    ds_read_b128 a[156:159], v252 offset:8640
    v_cvt_pk_bf16_f32 v233, v210, v211
    v_mfma_f32_16x16x32_bf16 v[68:71], v[228:231], a[188:191], v[68:71]
    v_exp_f32 v212, v212
    v_mfma_f32_16x16x32_bf16 v[68:71], v[224:227], a[184:187], v[68:71]
    v_exp_f32 v213, v213
    v_mfma_f32_16x16x32_bf16 v[72:75], v[224:227], a[192:195], v[72:75]
    ds_read_b128 a[172:175], v252 offset:9152
    v_cvt_pk_bf16_f32 v234, v212, v213
    v_mfma_f32_16x16x32_bf16 v[72:75], v[228:231], a[196:199], v[72:75]
    v_exp_f32 v214, v214
    v_mfma_f32_16x16x32_bf16 v[76:79], v[228:231], a[204:207], v[76:79]
    ds_read_b128 a[168:171], v252 offset:9088
    v_mfma_f32_16x16x32_bf16 v[76:79], v[224:227], a[200:203], v[76:79]
    v_exp_f32 v215, v215
    v_mfma_f32_16x16x32_bf16 v[80:83], v[224:227], a[208:211], v[80:83]
    ds_read_b128 a[164:167], v252 offset:9024
    v_cvt_pk_bf16_f32 v235, v214, v215
    v_mfma_f32_16x16x32_bf16 v[80:83], v[228:231], a[212:215], v[80:83]
    v_exp_f32 v216, v216
    v_mfma_f32_16x16x32_bf16 v[84:87], v[228:231], a[220:223], v[84:87]
    v_exp_f32 v217, v217
    v_mfma_f32_16x16x32_bf16 v[84:87], v[224:227], a[216:219], v[84:87]
    ds_read_b128 a[160:163], v252 offset:8960
    v_cvt_pk_bf16_f32 v236, v216, v217
    v_mfma_f32_16x16x32_bf16 v[88:91], v[224:227], a[224:227], v[88:91]
    v_exp_f32 v218, v218
    v_mfma_f32_16x16x32_bf16 v[88:91], v[228:231], a[228:231], v[88:91]
    v_mfma_f32_16x16x32_bf16 v[92:95], v[228:231], a[236:239], v[92:95]
    v_exp_f32 v219, v219
    v_mfma_f32_16x16x32_bf16 v[92:95], v[224:227], a[232:235], v[92:95]
    v_cvt_pk_bf16_f32 v237, v218, v219
    v_smfmac_f32_16x16x64_bf16 v[244:247], v[248:251], v[224:231], v240
    v_mfma_f32_16x16x32_bf16 v[208:211], a[140:143], a[108:111], v[240:243]
    v_exp_f32 v220, v220
    v_mfma_f32_16x16x32_bf16 v[208:211], a[136:139], a[104:107], v[208:211]
    v_exp_f32 v221, v221
    v_mfma_f32_16x16x32_bf16 v[208:211], a[132:135], a[100:103], v[208:211]
    v_mov_b32_dpp v248, v248 row_ror:2 row_mask:0xf bank_mask:0xf
    v_cvt_pk_bf16_f32 v238, v220, v221
    v_mfma_f32_16x16x32_bf16 v[208:211], a[128:131], a[96:99], v[208:211]
    v_exp_f32 v222, v222
    v_mfma_f32_16x16x32_bf16 v[212:215], a[112:115], a[64:67], v[240:243]
    v_mov_b32_dpp v250, v250 row_ror:2 row_mask:0xf bank_mask:0xf
    v_mov_b32_dpp v249, v249 row_ror:2 row_mask:0xf bank_mask:0xf
    v_mfma_f32_16x16x32_bf16 v[212:215], a[116:119], a[68:71], v[212:215]
    v_exp_f32 v223, v223
    v_mfma_f32_16x16x32_bf16 v[212:215], a[120:123], a[72:75], v[212:215]
    v_mov_b32_dpp v251, v251 row_ror:2 row_mask:0xf bank_mask:0xf
    v_cvt_pk_bf16_f32 v239, v222, v223
    v_mfma_f32_16x16x32_bf16 v[212:215], a[124:127], a[76:79], v[212:215]
    v_exp_f32 v208, v208
    v_mfma_f32_16x16x32_bf16 v[216:219], a[140:143], a[76:79], v[240:243]
    v_exp_f32 v209, v209
    v_mfma_f32_16x16x32_bf16 v[216:219], a[136:139], a[72:75], v[216:219]
    v_cvt_pk_bf16_f32 v208, v208, v209
    v_mfma_f32_16x16x32_bf16 v[216:219], a[132:135], a[68:71], v[216:219]
    v_exp_f32 v210, v210
    v_mfma_f32_16x16x32_bf16 v[216:219], a[128:131], a[64:67], v[216:219]
    s_waitcnt lgkmcnt(0)
    ds_write_b32 v254, v208 offset:8
    v_mfma_f32_16x16x32_bf16 v[220:223], a[144:147], a[64:67], v[240:243]
    v_exp_f32 v211, v211
    v_mfma_f32_16x16x32_bf16 v[220:223], a[148:151], a[68:71], v[220:223]
    v_cvt_pk_bf16_f32 v209, v210, v211
    v_mfma_f32_16x16x32_bf16 v[220:223], a[152:155], a[72:75], v[220:223]
    ds_write_b32 v254, v209 offset:12
    v_mfma_f32_16x16x32_bf16 v[220:223], a[156:159], a[76:79], v[220:223]
    v_exp_f32 v212, v212
    v_mfma_f32_16x16x32_bf16 v[208:211], a[172:175], a[76:79], v[240:243]
    v_exp_f32 v213, v213
    v_mfma_f32_16x16x32_bf16 v[208:211], a[168:171], a[72:75], v[208:211]
    v_cvt_pk_bf16_f32 v224, v212, v213
    v_mfma_f32_16x16x32_bf16 v[208:211], a[164:167], a[68:71], v[208:211]
    v_exp_f32 v214, v214
    v_mfma_f32_16x16x32_bf16 v[208:211], a[160:163], a[64:67], v[208:211]
    v_mfma_f32_16x16x32_bf16 v[96:99], v[232:235], a[176:179], v[96:99]
    v_exp_f32 v215, v215
    v_mfma_f32_16x16x32_bf16 v[96:99], v[236:239], a[180:183], v[96:99]
    ds_read_b64_tr_b16 a[180:181], v253 offset:8320
    v_cvt_pk_bf16_f32 v225, v214, v215
    v_mfma_f32_16x16x32_bf16 v[100:103], v[236:239], a[188:191], v[100:103]
    v_exp_f32 v216, v216
    v_mfma_f32_16x16x32_bf16 v[100:103], v[232:235], a[184:187], v[100:103]
    v_exp_f32 v217, v217
    v_mfma_f32_16x16x32_bf16 v[104:107], v[232:235], a[192:195], v[104:107]
    ds_read_b64_tr_b16 a[182:183], v253 offset:8832
    v_cvt_pk_bf16_f32 v226, v216, v217
    v_mfma_f32_16x16x32_bf16 v[104:107], v[236:239], a[196:199], v[104:107]
    v_exp_f32 v218, v218
    v_mfma_f32_16x16x32_bf16 v[108:111], v[236:239], a[204:207], v[108:111]
    ds_read_b64_tr_b16 a[188:189], v253 offset:8336
    v_mfma_f32_16x16x32_bf16 v[108:111], v[232:235], a[200:203], v[108:111]
    v_exp_f32 v219, v219
    v_mfma_f32_16x16x32_bf16 v[112:115], v[232:235], a[208:211], v[112:115]
    ds_read_b64_tr_b16 a[190:191], v253 offset:8848
    v_cvt_pk_bf16_f32 v227, v218, v219
    v_mfma_f32_16x16x32_bf16 v[112:115], v[236:239], a[212:215], v[112:115]
    v_exp_f32 v220, v220
    v_mfma_f32_16x16x32_bf16 v[116:119], v[236:239], a[220:223], v[116:119]
    v_exp_f32 v221, v221
    v_mfma_f32_16x16x32_bf16 v[116:119], v[232:235], a[216:219], v[116:119]
    ds_read_b64_tr_b16 a[196:197], v253 offset:8352
    v_cvt_pk_bf16_f32 v228, v220, v221
    v_mfma_f32_16x16x32_bf16 v[120:123], v[232:235], a[224:227], v[120:123]
    v_exp_f32 v222, v222
    v_mfma_f32_16x16x32_bf16 v[120:123], v[236:239], a[228:231], v[120:123]
    ds_read_b64_tr_b16 a[198:199], v253 offset:8864
    v_mfma_f32_16x16x32_bf16 v[124:127], v[236:239], a[236:239], v[124:127]
    v_exp_f32 v223, v223
    v_mfma_f32_16x16x32_bf16 v[124:127], v[232:235], a[232:235], v[124:127]
    ds_read_b64_tr_b16 a[204:205], v253 offset:8368
    v_cvt_pk_bf16_f32 v229, v222, v223
    v_smfmac_f32_16x16x64_bf16 v[244:247], v[248:251], v[232:239], v240
    ds_read_b64_tr_b16 a[206:207], v253 offset:8880
    ds_read_b64_tr_b16 a[212:213], v253 offset:8384
    v_mfma_f32_16x16x32_bf16 v[212:215], a[140:143], a[252:255], v[240:243]
    v_exp_f32 v208, v208
    v_mfma_f32_16x16x32_bf16 v[212:215], a[136:139], a[248:251], v[212:215]
    v_exp_f32 v209, v209
    v_mfma_f32_16x16x32_bf16 v[212:215], a[132:135], a[244:247], v[212:215]
    v_mov_b32_dpp v248, v248 row_ror:2 row_mask:0xf bank_mask:0xf
    v_cvt_pk_bf16_f32 v230, v208, v209
    v_mfma_f32_16x16x32_bf16 v[212:215], a[128:131], a[240:243], v[212:215]
    v_exp_f32 v210, v210
    v_mfma_f32_16x16x32_bf16 v[216:219], a[112:115], a[80:83], v[240:243]
    v_mov_b32_dpp v250, v250 row_ror:2 row_mask:0xf bank_mask:0xf
    v_mov_b32_dpp v249, v249 row_ror:2 row_mask:0xf bank_mask:0xf
    v_mfma_f32_16x16x32_bf16 v[216:219], a[116:119], a[84:87], v[216:219]
    v_exp_f32 v211, v211
    v_mfma_f32_16x16x32_bf16 v[216:219], a[120:123], a[88:91], v[216:219]
    v_mov_b32_dpp v251, v251 row_ror:2 row_mask:0xf bank_mask:0xf
    v_cvt_pk_bf16_f32 v231, v210, v211
    v_mfma_f32_16x16x32_bf16 v[216:219], a[124:127], a[92:95], v[216:219]
    v_exp_f32 v212, v212
    v_mfma_f32_16x16x32_bf16 v[220:223], a[140:143], a[92:95], v[240:243]
    v_exp_f32 v213, v213
    v_mfma_f32_16x16x32_bf16 v[220:223], a[136:139], a[88:91], v[220:223]
    ds_read_b64_tr_b16 a[214:215], v253 offset:8896
    v_cvt_pk_bf16_f32 v212, v212, v213
    v_mfma_f32_16x16x32_bf16 v[220:223], a[132:135], a[84:87], v[220:223]
    v_exp_f32 v214, v214
    v_mfma_f32_16x16x32_bf16 v[220:223], a[128:131], a[80:83], v[220:223]
    ds_write_b32 v254, v212 offset:1032
    v_mfma_f32_16x16x32_bf16 v[208:211], a[144:147], a[80:83], v[240:243]
    v_exp_f32 v215, v215
    v_mfma_f32_16x16x32_bf16 v[208:211], a[148:151], a[84:87], v[208:211]
    ds_read_b64_tr_b16 a[220:221], v253 offset:8400
    v_cvt_pk_bf16_f32 v213, v214, v215
    v_mfma_f32_16x16x32_bf16 v[208:211], a[152:155], a[88:91], v[208:211]
    ds_write_b32 v254, v213 offset:1036
    v_mfma_f32_16x16x32_bf16 v[208:211], a[156:159], a[92:95], v[208:211]
    v_exp_f32 v216, v216
    v_mfma_f32_16x16x32_bf16 v[212:215], a[172:175], a[92:95], v[240:243]
    v_exp_f32 v217, v217
    v_mfma_f32_16x16x32_bf16 v[212:215], a[168:171], a[88:91], v[212:215]
    ds_read_b64_tr_b16 a[222:223], v253 offset:8912
    v_cvt_pk_bf16_f32 v232, v216, v217
    v_mfma_f32_16x16x32_bf16 v[212:215], a[164:167], a[84:87], v[212:215]
    v_exp_f32 v218, v218
    v_mfma_f32_16x16x32_bf16 v[212:215], a[160:163], a[80:83], v[212:215]
    ds_read_b64_tr_b16 a[228:229], v253 offset:8416
    ds_read_b64_tr_b16 a[230:231], v253 offset:8928
    v_mfma_f32_16x16x32_bf16 v[128:131], v[224:227], a[176:179], v[128:131]
    s_waitcnt lgkmcnt(6)
    v_exp_f32 v219, v219
    v_mfma_f32_16x16x32_bf16 v[128:131], v[228:231], a[180:183], v[128:131]
    ds_read_b64_tr_b16 a[236:237], v253 offset:8432
    v_cvt_pk_bf16_f32 v233, v218, v219
    v_mfma_f32_16x16x32_bf16 v[132:135], v[228:231], a[188:191], v[132:135]
    v_exp_f32 v220, v220
    v_mfma_f32_16x16x32_bf16 v[132:135], v[224:227], a[184:187], v[132:135]
    v_exp_f32 v221, v221
    v_mfma_f32_16x16x32_bf16 v[136:139], v[224:227], a[192:195], v[136:139]
    ds_read_b64_tr_b16 a[238:239], v253 offset:8944
    v_cvt_pk_bf16_f32 v234, v220, v221
    v_mfma_f32_16x16x32_bf16 v[136:139], v[228:231], a[196:199], v[136:139]
    v_exp_f32 v222, v222
    v_mfma_f32_16x16x32_bf16 v[140:143], v[228:231], a[204:207], v[140:143]
    v_mfma_f32_16x16x32_bf16 v[140:143], v[224:227], a[200:203], v[140:143]
    v_exp_f32 v223, v223
    v_mfma_f32_16x16x32_bf16 v[144:147], v[224:227], a[208:211], v[144:147]
    v_cvt_pk_bf16_f32 v235, v222, v223
    v_mfma_f32_16x16x32_bf16 v[144:147], v[228:231], a[212:215], v[144:147]
    s_waitcnt lgkmcnt(2)
    v_exp_f32 v208, v208
    v_mfma_f32_16x16x32_bf16 v[148:151], v[228:231], a[220:223], v[148:151]
    v_exp_f32 v209, v209
    v_mfma_f32_16x16x32_bf16 v[148:151], v[224:227], a[216:219], v[148:151]
    v_cvt_pk_bf16_f32 v236, v208, v209
    v_mfma_f32_16x16x32_bf16 v[152:155], v[224:227], a[224:227], v[152:155]
    v_exp_f32 v210, v210
    v_mfma_f32_16x16x32_bf16 v[152:155], v[228:231], a[228:231], v[152:155]
    s_waitcnt lgkmcnt(0)
    v_add_u32 v252, s30, v252
    v_mfma_f32_16x16x32_bf16 v[156:159], v[228:231], a[236:239], v[156:159]
    v_exp_f32 v211, v211
    v_mfma_f32_16x16x32_bf16 v[156:159], v[224:227], a[232:235], v[156:159]
    s_waitcnt vmcnt(2)
    v_cvt_pk_bf16_f32 v237, v210, v211
    v_add_u32 v253, s30, v253
    v_smfmac_f32_16x16x64_bf16 v[244:247], v[248:251], v[224:231], v240
    s_cbranch_scc0 L_loop_b
    v_mfma_f32_16x16x32_bf16 v[216:219], a[140:143], v[204:207], v[240:243]
    s_add_u32 s84, s6, 16384
    v_exp_f32 v212, v212
    v_mfma_f32_16x16x32_bf16 v[216:219], a[136:139], v[200:203], v[216:219]
    s_add_u32 s85, s6, 20480
    v_exp_f32 v213, v213
    v_mfma_f32_16x16x32_bf16 v[216:219], a[132:135], v[196:199], v[216:219]
    s_add_u32 s81, s6, 4096
    v_cvt_pk_bf16_f32 v238, v212, v213
    v_subrev_u32 v252, 33536, v252
    v_mfma_f32_16x16x32_bf16 v[216:219], a[128:131], v[192:195], v[216:219]
    s_add_u32 s82, s6, 8192
    v_exp_f32 v214, v214
    v_mfma_f32_16x16x32_bf16 v[160:163], v[232:235], a[176:179], v[160:163]
    s_add_u32 s83, s6, 12288
    v_exp_f32 v215, v215
    v_mfma_f32_16x16x32_bf16 v[168:171], v[232:235], a[192:195], v[168:171]
    s_add_u32 s80, s6, 0
    v_cvt_pk_bf16_f32 v239, v214, v215
    v_subrev_u32 v253, 33536, v253
    v_mfma_f32_16x16x32_bf16 v[176:179], v[232:235], a[208:211], v[176:179]
    v_exp_f32 v216, v216
    v_mfma_f32_16x16x32_bf16 v[160:163], v[236:239], a[180:183], v[160:163]
    v_exp_f32 v217, v217
    v_mfma_f32_16x16x32_bf16 v[164:167], v[236:239], a[188:191], v[164:167]
    v_cvt_pk_bf16_f32 v216, v216, v217
    v_mov_b32_dpp v248, v248 row_ror:2 row_mask:0xf bank_mask:0xf
    v_mfma_f32_16x16x32_bf16 v[164:167], v[232:235], a[184:187], v[164:167]
    v_exp_f32 v218, v218
    v_mfma_f32_16x16x32_bf16 v[168:171], v[236:239], a[196:199], v[168:171]
    v_exp_f32 v219, v219
    v_mfma_f32_16x16x32_bf16 v[172:175], v[236:239], a[204:207], v[172:175]
    v_cvt_pk_bf16_f32 v217, v218, v219
    v_mov_b32_dpp v249, v249 row_ror:2 row_mask:0xf bank_mask:0xf
    v_mfma_f32_16x16x32_bf16 v[172:175], v[232:235], a[200:203], v[172:175]
    ds_write_b64 v254, v[216:217] offset:2056
    s_waitcnt lgkmcnt(0)
    s_barrier
    v_mfma_f32_16x16x32_bf16 v[176:179], v[236:239], a[212:215], v[176:179]
    ds_read_b128 a[112:115], v252 offset:33536
    v_mov_b32_dpp v250, v250 row_ror:2 row_mask:0xf bank_mask:0xf
    v_mfma_f32_16x16x32_bf16 v[180:183], v[236:239], a[220:223], v[180:183]
    ds_read_b128 a[116:119], v252 offset:33600
    v_mov_b32_dpp v251, v251 row_ror:2 row_mask:0xf bank_mask:0xf
    v_mfma_f32_16x16x32_bf16 v[180:183], v[232:235], a[216:219], v[180:183]
    ds_read_b128 a[120:123], v252 offset:33664
    v_mfma_f32_16x16x32_bf16 v[184:187], v[232:235], a[224:227], v[184:187]
    ds_read_b128 a[124:127], v252 offset:33728
    v_mfma_f32_16x16x32_bf16 v[184:187], v[236:239], a[228:231], v[184:187]
    ds_read_b128 a[128:131], v252 offset:34048
    v_mfma_f32_16x16x32_bf16 v[188:191], v[236:239], a[236:239], v[188:191]
    ds_read_b128 a[132:135], v252 offset:34112
    v_mfma_f32_16x16x32_bf16 v[188:191], v[232:235], a[232:235], v[188:191]
    ds_read_b128 a[136:139], v252 offset:34176
    v_smfmac_f32_16x16x64_bf16 v[244:247], v[248:251], v[232:239], v240
    s_waitcnt lgkmcnt(6)
    ds_read_b128 a[140:143], v252 offset:34240
    v_mov_b32_dpp v248, v248 row_ror:14 row_mask:0xf bank_mask:0xf
    v_mov_b32_dpp v249, v249 row_ror:14 row_mask:0xf bank_mask:0xf
    v_mov_b32_dpp v250, v250 row_ror:14 row_mask:0xf bank_mask:0xf
    v_mov_b32_dpp v251, v251 row_ror:14 row_mask:0xf bank_mask:0xf
    v_mfma_f32_16x16x32_bf16 v[220:223], a[112:115], a[64:67], v[240:243]
    s_waitcnt lgkmcnt(6)
    ds_read_b128 a[144:147], v252 offset:41984
    v_mfma_f32_16x16x32_bf16 v[220:223], a[116:119], a[68:71], v[220:223]
    s_waitcnt lgkmcnt(6)
    ds_read_b128 a[148:151], v252 offset:42048
    v_mfma_f32_16x16x32_bf16 v[220:223], a[120:123], a[72:75], v[220:223]
    s_waitcnt lgkmcnt(6)
    ds_read_b128 a[152:155], v252 offset:42112
    v_mfma_f32_16x16x32_bf16 v[220:223], a[124:127], a[76:79], v[220:223]
    s_waitcnt lgkmcnt(3)
    ds_read_b128 a[156:159], v252 offset:42176
    ds_read_b128 a[160:163], v252 offset:42496
    ds_read_b128 a[164:167], v252 offset:42560
    s_nop 3
    v_exp_f32 v220, v220
    v_exp_f32 v221, v221
    v_exp_f32 v222, v222
    v_mfma_f32_16x16x32_bf16 v[208:211], a[140:143], a[76:79], v[240:243]
    ds_read_b128 a[168:171], v252 offset:42624
    v_cvt_pk_bf16_f32 v224, v220, v221
    v_mfma_f32_16x16x32_bf16 v[208:211], a[136:139], a[72:75], v[208:211]
    ds_read_b128 a[172:175], v252 offset:42688
    v_mfma_f32_16x16x32_bf16 v[208:211], a[132:135], a[68:71], v[208:211]
    ds_read_b64_tr_b16 a[176:177], v253 offset:33536
    v_mfma_f32_16x16x32_bf16 v[208:211], a[128:131], a[64:67], v[208:211]
    s_waitcnt lgkmcnt(8)
    ds_read_b64_tr_b16 a[178:179], v253 offset:34048
    v_mfma_f32_16x16x32_bf16 v[212:215], a[144:147], a[64:67], v[240:243]
    s_waitcnt lgkmcnt(8)
    ds_read_b64_tr_b16 a[180:181], v253 offset:41856
    v_mfma_f32_16x16x32_bf16 v[212:215], a[148:151], a[68:71], v[212:215]
    s_waitcnt lgkmcnt(8)
    ds_read_b64_tr_b16 a[182:183], v253 offset:42368
    v_mfma_f32_16x16x32_bf16 v[212:215], a[152:155], a[72:75], v[212:215]
    s_waitcnt lgkmcnt(8)
    ds_read_b64_tr_b16 a[184:185], v253 offset:33552
    v_mfma_f32_16x16x32_bf16 v[212:215], a[156:159], a[76:79], v[212:215]
    ds_read_b64_tr_b16 a[186:187], v253 offset:34064
    v_exp_f32 v223, v223
    v_exp_f32 v208, v208
    v_cvt_pk_bf16_f32 v225, v222, v223
    v_mfma_f32_16x16x32_bf16 v[220:223], a[112:115], a[80:83], v[240:243]
    ds_read_b64_tr_b16 a[188:189], v253 offset:41872
    v_mfma_f32_16x16x32_bf16 v[220:223], a[116:119], a[84:87], v[220:223]
    s_waitcnt lgkmcnt(7)
    ds_read_b64_tr_b16 a[190:191], v253 offset:42384
    v_mfma_f32_16x16x32_bf16 v[216:219], a[172:175], a[76:79], v[240:243]
    ds_read_b64_tr_b16 a[192:193], v253 offset:33568
    v_mfma_f32_16x16x32_bf16 v[216:219], a[168:171], a[72:75], v[216:219]
    ds_read_b64_tr_b16 a[194:195], v253 offset:34080
    v_mfma_f32_16x16x32_bf16 v[216:219], a[164:167], a[68:71], v[216:219]
    ds_read_b64_tr_b16 a[196:197], v253 offset:41888
    v_mfma_f32_16x16x32_bf16 v[216:219], a[160:163], a[64:67], v[216:219]
    ds_read_b64_tr_b16 a[198:199], v253 offset:42400
    v_mfma_f32_16x16x32_bf16 v[220:223], a[120:123], a[88:91], v[220:223]
    ds_read_b64_tr_b16 a[200:201], v253 offset:33584
    v_mfma_f32_16x16x32_bf16 v[220:223], a[124:127], a[92:95], v[220:223]
    ds_read_b64_tr_b16 a[202:203], v253 offset:34096
    v_exp_f32 v209, v209
    v_exp_f32 v210, v210
    v_cvt_pk_bf16_f32 v226, v208, v209
    v_exp_f32 v211, v211
    v_exp_f32 v212, v212
    v_cvt_pk_bf16_f32 v227, v210, v211
    v_mfma_f32_16x16x32_bf16 v[208:211], a[140:143], a[92:95], v[240:243]
    s_waitcnt lgkmcnt(12)
    ds_read_b64_tr_b16 a[204:205], v253 offset:41904
    v_mfma_f32_16x16x32_bf16 v[128:131], v[224:227], a[176:179], v[128:131]
    s_waitcnt lgkmcnt(5)
    ds_read_b64_tr_b16 a[206:207], v253 offset:42416
    v_mfma_f32_16x16x32_bf16 v[136:139], v[224:227], a[192:195], v[136:139]
    ds_read_b64_tr_b16 a[208:209], v253 offset:33600
    v_mfma_f32_16x16x32_bf16 v[208:211], a[136:139], a[88:91], v[208:211]
    ds_read_b64_tr_b16 a[210:211], v253 offset:34112
    v_mfma_f32_16x16x32_bf16 v[208:211], a[132:135], a[84:87], v[208:211]
    ds_read_b64_tr_b16 a[212:213], v253 offset:41920
    v_mfma_f32_16x16x32_bf16 v[208:211], a[128:131], a[80:83], v[208:211]
    ds_read_b64_tr_b16 a[214:215], v253 offset:42432
    v_exp_f32 v213, v213
    v_exp_f32 v214, v214
    v_cvt_pk_bf16_f32 v228, v212, v213
    v_exp_f32 v215, v215
    v_exp_f32 v216, v216
    v_cvt_pk_bf16_f32 v229, v214, v215
    v_mfma_f32_16x16x32_bf16 v[212:215], a[144:147], a[80:83], v[240:243]
    ds_read_b64_tr_b16 a[216:217], v253 offset:33616
    v_mfma_f32_16x16x32_bf16 v[212:215], a[148:151], a[84:87], v[212:215]
    ds_read_b64_tr_b16 a[218:219], v253 offset:34128
    v_mfma_f32_16x16x32_bf16 v[212:215], a[152:155], a[88:91], v[212:215]
    ds_read_b64_tr_b16 a[220:221], v253 offset:41936
    v_mfma_f32_16x16x32_bf16 v[212:215], a[156:159], a[92:95], v[212:215]
    s_waitcnt lgkmcnt(5)
    ds_read_b64_tr_b16 a[222:223], v253 offset:42448
    v_mfma_f32_16x16x32_bf16 v[144:147], v[224:227], a[208:211], v[144:147]
    ds_read_b64_tr_b16 a[224:225], v253 offset:33632
    v_exp_f32 v217, v217
    v_exp_f32 v218, v218
    v_cvt_pk_bf16_f32 v230, v216, v217
    v_exp_f32 v219, v219
    v_exp_f32 v220, v220
    v_cvt_pk_bf16_f32 v231, v218, v219
    v_mfma_f32_16x16x32_bf16 v[216:219], a[172:175], a[92:95], v[240:243]
    ds_read_b64_tr_b16 a[226:227], v253 offset:34144
    v_smfmac_f32_16x16x64_bf16 v[244:247], v[248:251], v[224:231], v240
    ds_read_b64_tr_b16 a[228:229], v253 offset:41952
    v_mfma_f32_16x16x32_bf16 v[128:131], v[228:231], a[180:183], v[128:131]
    ds_read_b64_tr_b16 a[230:231], v253 offset:42464
    v_mov_b32_dpp v248, v248 row_ror:2 row_mask:0xf bank_mask:0xf
    v_mfma_f32_16x16x32_bf16 v[132:135], v[228:231], a[188:191], v[132:135]
    ds_read_b64_tr_b16 a[232:233], v253 offset:33648
    v_mov_b32_dpp v249, v249 row_ror:2 row_mask:0xf bank_mask:0xf
    v_mfma_f32_16x16x32_bf16 v[132:135], v[224:227], a[184:187], v[132:135]
    ds_read_b64_tr_b16 a[234:235], v253 offset:34160
    v_mov_b32_dpp v250, v250 row_ror:2 row_mask:0xf bank_mask:0xf
    v_mfma_f32_16x16x32_bf16 v[136:139], v[228:231], a[196:199], v[136:139]
    ds_read_b64_tr_b16 a[236:237], v253 offset:41968
    v_mov_b32_dpp v251, v251 row_ror:2 row_mask:0xf bank_mask:0xf
    v_mfma_f32_16x16x32_bf16 v[140:143], v[228:231], a[204:207], v[140:143]
    ds_read_b64_tr_b16 a[238:239], v253 offset:42480
    v_mfma_f32_16x16x32_bf16 v[140:143], v[224:227], a[200:203], v[140:143]
    s_waitcnt lgkmcnt(12)
    v_exp_f32 v221, v221
    v_mfma_f32_16x16x32_bf16 v[144:147], v[228:231], a[212:215], v[144:147]
    s_waitcnt lgkmcnt(8)
    v_exp_f32 v222, v222
    v_mfma_f32_16x16x32_bf16 v[148:151], v[228:231], a[220:223], v[148:151]
    v_exp_f32 v223, v223
    v_mfma_f32_16x16x32_bf16 v[148:151], v[224:227], a[216:219], v[148:151]
    s_waitcnt lgkmcnt(6)
    v_cvt_pk_bf16_f32 v232, v220, v221
    v_cvt_pk_bf16_f32 v233, v222, v223
    v_mfma_f32_16x16x32_bf16 v[152:155], v[224:227], a[224:227], v[152:155]
    s_waitcnt lgkmcnt(4)
    v_exp_f32 v208, v208
    v_mfma_f32_16x16x32_bf16 v[152:155], v[228:231], a[228:231], v[152:155]
    v_exp_f32 v209, v209
    v_mfma_f32_16x16x32_bf16 v[216:219], a[168:171], a[88:91], v[216:219]
    v_exp_f32 v210, v210
    v_mfma_f32_16x16x32_bf16 v[216:219], a[164:167], a[84:87], v[216:219]
    v_exp_f32 v211, v211
    v_mfma_f32_16x16x32_bf16 v[216:219], a[160:163], a[80:83], v[216:219]
    s_waitcnt lgkmcnt(0)
    v_cvt_pk_bf16_f32 v234, v208, v209
    v_cvt_pk_bf16_f32 v235, v210, v211
    v_mfma_f32_16x16x32_bf16 v[156:159], v[228:231], a[236:239], v[156:159]
    v_exp_f32 v212, v212
    v_mfma_f32_16x16x32_bf16 v[156:159], v[224:227], a[232:235], v[156:159]
    v_bfe_u32 v228, v254, 8, 2
    v_lshl_add_u32 v228, v228, 4, s35
    v_mfma_f32_16x16x32_bf16 v[160:163], v[232:235], a[176:179], v[160:163]
    ds_read_b128 v[228:231], v228 offset:256
    v_add_f32 v227, v244, v245
    v_mfma_f32_16x16x32_bf16 v[220:223], a[112:115], a[0:3], v[240:243]
    v_exp_f32 v213, v213
    v_mfma_f32_16x16x32_bf16 v[168:171], v[232:235], a[192:195], v[168:171]
    v_mov_b32 v226, v227
    v_cvt_pk_bf16_f32 v236, v212, v213
    v_mfma_f32_16x16x32_bf16 v[220:223], a[116:119], a[4:7], v[220:223]
    v_permlane32_swap_b32 v227, v226
    v_mov_b32 v227, v226
    v_mfma_f32_16x16x32_bf16 v[220:223], a[120:123], a[8:11], v[220:223]
    v_exp_f32 v214, v214
    v_mfma_f32_16x16x32_bf16 v[220:223], a[124:127], a[12:15], v[220:223]
    v_exp_f32 v215, v215
    v_mfma_f32_16x16x32_bf16 v[176:179], v[232:235], a[208:211], v[176:179]
    v_permlane16_swap_b32 v226, v227
    v_cvt_pk_bf16_f32 v237, v214, v215
    v_mfma_f32_16x16x32_bf16 v[184:187], v[232:235], a[224:227], v[184:187]
    v_rcp_f32 v227, v226
    v_mfma_f32_16x16x32_bf16 v[208:211], a[140:143], a[12:15], v[240:243]
    v_exp_f32 v216, v216
    v_mfma_f32_16x16x32_bf16 v[208:211], a[136:139], a[8:11], v[208:211]
    v_exp_f32 v217, v217
    v_mfma_f32_16x16x32_bf16 v[208:211], a[132:135], a[4:7], v[208:211]
    v_mov_b32_dpp v227, v227 row_ror:12 row_mask:0x2 bank_mask:0xf
    v_cvt_pk_bf16_f32 v238, v216, v217
    v_mfma_f32_16x16x32_bf16 v[208:211], a[128:131], a[0:3], v[208:211]
    v_exp_f32 v218, v218
    v_mfma_f32_16x16x32_bf16 v[212:215], a[144:147], a[0:3], v[240:243]
    v_exp_f32 v219, v219
    v_mfma_f32_16x16x32_bf16 v[212:215], a[148:151], a[4:7], v[212:215]
    v_mov_b32_dpp v227, v227 row_ror:8 row_mask:0x4 bank_mask:0xf
    v_cvt_pk_bf16_f32 v239, v218, v219
    v_mfma_f32_16x16x32_bf16 v[212:215], a[152:155], a[8:11], v[212:215]
    v_exp_f32 v220, v220
    v_mfma_f32_16x16x32_bf16 v[160:163], v[236:239], a[180:183], v[160:163]
    v_exp_f32 v221, v221
    v_mfma_f32_16x16x32_bf16 v[164:167], v[236:239], a[188:191], v[164:167]
    v_exp_f32 v222, v222
    v_mfma_f32_16x16x32_bf16 v[164:167], v[232:235], a[184:187], v[164:167]
    v_exp_f32 v223, v223
    v_mfma_f32_16x16x32_bf16 v[168:171], v[236:239], a[196:199], v[168:171]
    v_exp_f32 v208, v208
    v_mfma_f32_16x16x32_bf16 v[172:175], v[236:239], a[204:207], v[172:175]
    v_exp_f32 v209, v209
    v_mfma_f32_16x16x32_bf16 v[172:175], v[232:235], a[200:203], v[172:175]
    v_exp_f32 v210, v210
    v_mfma_f32_16x16x32_bf16 v[176:179], v[236:239], a[212:215], v[176:179]
    v_exp_f32 v211, v211
    v_mfma_f32_16x16x32_bf16 v[180:183], v[236:239], a[220:223], v[180:183]
    v_mov_b32_dpp v227, v227 row_ror:4 row_mask:0x8 bank_mask:0xf
    v_mfma_f32_16x16x32_bf16 v[180:183], v[232:235], a[216:219], v[180:183]
    s_nop 0
    v_mov_b32_dpp v224, v227 row_newbcast:0 row_mask:0xf bank_mask:0xf
    v_mov_b32_dpp v225, v227 row_newbcast:1 row_mask:0xf bank_mask:0xf
    v_mfma_f32_16x16x32_bf16 v[184:187], v[236:239], a[228:231], v[184:187]
    v_mov_b32_dpp v226, v227 row_newbcast:2 row_mask:0xf bank_mask:0xf
    v_mov_b32_dpp v227, v227 row_newbcast:3 row_mask:0xf bank_mask:0xf
    v_mfma_f32_16x16x32_bf16 v[188:191], v[236:239], a[236:239], v[188:191]
    s_waitcnt lgkmcnt(0)
    v_mul_f32 v228, v228, v224
    v_mul_f32 v229, v229, v225
    v_mfma_f32_16x16x32_bf16 v[188:191], v[232:235], a[232:235], v[188:191]
    v_mul_f32 v230, v230, v226
    v_mul_f32 v231, v231, v227
    v_mfma_f32_16x16x32_bf16 v[212:215], a[156:159], a[12:15], v[212:215]
    v_pk_fma_f32 v[128:129], v[128:129], v[224:225], v[228:229] neg_lo:[0,0,1] neg_hi:[0,0,1]
    v_pk_fma_f32 v[130:131], v[130:131], v[226:227], v[230:231] neg_lo:[0,0,1] neg_hi:[0,0,1]
    v_pk_fma_f32 v[132:133], v[132:133], v[224:225], v[228:229] neg_lo:[0,0,1] neg_hi:[0,0,1]
    v_pk_fma_f32 v[134:135], v[134:135], v[226:227], v[230:231] neg_lo:[0,0,1] neg_hi:[0,0,1]
    v_pk_fma_f32 v[136:137], v[136:137], v[224:225], v[228:229] neg_lo:[0,0,1] neg_hi:[0,0,1]
    v_pk_fma_f32 v[138:139], v[138:139], v[226:227], v[230:231] neg_lo:[0,0,1] neg_hi:[0,0,1]
    v_pk_fma_f32 v[140:141], v[140:141], v[224:225], v[228:229] neg_lo:[0,0,1] neg_hi:[0,0,1]
    v_pk_fma_f32 v[142:143], v[142:143], v[226:227], v[230:231] neg_lo:[0,0,1] neg_hi:[0,0,1]
    v_pk_fma_f32 v[144:145], v[144:145], v[224:225], v[228:229] neg_lo:[0,0,1] neg_hi:[0,0,1]
    v_pk_fma_f32 v[146:147], v[146:147], v[226:227], v[230:231] neg_lo:[0,0,1] neg_hi:[0,0,1]
    v_pk_fma_f32 v[148:149], v[148:149], v[224:225], v[228:229] neg_lo:[0,0,1] neg_hi:[0,0,1]
    v_pk_fma_f32 v[150:151], v[150:151], v[226:227], v[230:231] neg_lo:[0,0,1] neg_hi:[0,0,1]
    v_pk_fma_f32 v[152:153], v[152:153], v[224:225], v[228:229] neg_lo:[0,0,1] neg_hi:[0,0,1]
    v_pk_fma_f32 v[154:155], v[154:155], v[226:227], v[230:231] neg_lo:[0,0,1] neg_hi:[0,0,1]
    v_pk_fma_f32 v[156:157], v[156:157], v[224:225], v[228:229] neg_lo:[0,0,1] neg_hi:[0,0,1]
    v_pk_fma_f32 v[158:159], v[158:159], v[226:227], v[230:231] neg_lo:[0,0,1] neg_hi:[0,0,1]
    v_smfmac_f32_16x16x64_bf16 v[244:247], v[248:251], v[232:239], v240
    v_cvt_pk_bf16_f32 v224, v128, v132
    v_cvt_pk_bf16_f32 v225, v136, v140
    v_cvt_pk_bf16_f32 v226, v144, v148
    v_mfma_f32_16x16x32_bf16 v[216:219], a[172:175], a[12:15], v[240:243]
    v_cvt_pk_bf16_f32 v227, v152, v156
    v_cvt_pk_bf16_f32 v228, v129, v133
    v_mfma_f32_16x16x32_bf16 v[216:219], a[168:171], a[8:11], v[216:219]
    ds_write_b128 v255, v[224:227] offset:0
    v_mfma_f32_16x16x32_bf16 v[216:219], a[164:167], a[4:7], v[216:219]
    v_cvt_pk_bf16_f32 v229, v137, v141
    v_cvt_pk_bf16_f32 v230, v145, v149
    v_mfma_f32_16x16x32_bf16 v[216:219], a[160:163], a[0:3], v[216:219]
    v_cvt_pk_bf16_f32 v231, v153, v157
    v_cvt_pk_bf16_f32 v224, v130, v134
    v_cvt_pk_bf16_f32 v225, v138, v142
    v_cvt_pk_bf16_f32 v226, v146, v150
    v_cvt_pk_bf16_f32 v227, v154, v158
    v_bfe_u32 v157, v254, 8, 2
    v_bfe_u32 v158, v254, 8, 2
    v_lshl_add_u32 v158, v158, 4, s35
    v_exp_f32 v212, v212
    v_exp_f32 v213, v213
    v_exp_f32 v214, v214
    ds_write_b128 v255, v[228:231] offset:320
    s_nop 1
    v_cvt_pk_bf16_f32 v228, v131, v135
    v_cvt_pk_bf16_f32 v229, v139, v143
    v_cvt_pk_bf16_f32 v230, v147, v151
    v_cvt_pk_bf16_f32 v231, v155, v159
    v_mul_u32_u24 v159, 0x140, v157
    v_bfe_u32 v157, v254, 6, 2
    v_lshl_add_u32 v159, v157, 4, v159
    v_bfe_u32 v157, v254, 4, 1
    v_lshl_add_u32 v159, v157, 3, v159
    v_bfe_u32 v157, v254, 5, 1
    v_lshl_add_u32 v159, v157, 7, v159
    v_add_u32 v159, s76, v159
    v_add_f32 v139, v246, v247
    ds_read_b128 v[132:135], v158 offset:64
    ds_write_b128 v255, v[224:227] offset:640
    ds_read_b128 v[140:143], v158 offset:320
    v_mov_b32 v138, v139
    v_cvt_pk_bf16_f32 v224, v220, v221
    v_cvt_pk_bf16_f32 v225, v222, v223
    v_mfma_f32_16x16x32_bf16 v[220:223], a[144:147], a[16:19], v[240:243]
    ds_write_b128 v255, v[228:231] offset:960
    v_mfma_f32_16x16x32_bf16 v[220:223], a[148:151], a[20:23], v[220:223]
    ds_read_b64_tr_b16 a[64:65], v159 offset:0
    v_permlane32_swap_b32 v139, v138
    v_mfma_f32_16x16x32_bf16 v[220:223], a[152:155], a[24:27], v[220:223]
    ds_read_b64_tr_b16 a[66:67], v159 offset:64
    v_mov_b32 v139, v138
    v_mfma_f32_16x16x32_bf16 v[220:223], a[156:159], a[28:31], v[220:223]
    ds_read_b64_tr_b16 a[68:69], v159 offset:1280
    v_permlane16_swap_b32 v138, v139
    v_rcp_f32 v139, v138
    v_cvt_pk_bf16_f32 v226, v208, v209
    v_cvt_pk_bf16_f32 v227, v210, v211
    v_mfma_f32_16x16x32_bf16 v[208:211], a[172:175], a[28:31], v[240:243]
    ds_read_b64_tr_b16 a[70:71], v159 offset:1344
    v_mov_b32_dpp v139, v139 row_ror:12 row_mask:0x2 bank_mask:0xf
    v_mfma_f32_16x16x32_bf16 v[208:211], a[168:171], a[24:27], v[208:211]
    ds_read_b64_tr_b16 a[72:73], v159 offset:2560
    v_mov_b32_dpp v139, v139 row_ror:8 row_mask:0x4 bank_mask:0xf
    v_mfma_f32_16x16x32_bf16 v[208:211], a[164:167], a[20:23], v[208:211]
    ds_read_b64_tr_b16 a[74:75], v159 offset:2624
    v_mov_b32_dpp v139, v139 row_ror:4 row_mask:0x8 bank_mask:0xf
    v_mfma_f32_16x16x32_bf16 v[208:211], a[160:163], a[16:19], v[208:211]
    ds_read_b64_tr_b16 a[76:77], v159 offset:3840
    v_mov_b32_dpp v136, v139 row_newbcast:0 row_mask:0xf bank_mask:0xf
    v_mfma_f32_16x16x32_bf16 v[0:3], v[224:227], a[176:179], v[0:3]
    ds_read_b64_tr_b16 a[78:79], v159 offset:3904
    v_mov_b32_dpp v137, v139 row_newbcast:1 row_mask:0xf bank_mask:0xf
    v_mfma_f32_16x16x32_bf16 v[8:11], v[224:227], a[192:195], v[8:11]
    v_mov_b32_dpp v138, v139 row_newbcast:2 row_mask:0xf bank_mask:0xf
    v_mov_b32_dpp v139, v139 row_newbcast:3 row_mask:0xf bank_mask:0xf
    v_mfma_f32_16x16x32_bf16 v[16:19], v[224:227], a[208:211], v[16:19]
    s_waitcnt lgkmcnt(6)
    buffer_store_dwordx4 a[64:67], v254, s[24:27], s84 offen offset:0 sc1
    v_mfma_f32_16x16x32_bf16 v[24:27], v[224:227], a[224:227], v[24:27]
    v_mul_f32 v140, v140, v136
    v_mul_f32 v141, v141, v137
    v_mul_f32 v142, v142, v138
    v_mul_f32 v143, v143, v139
    v_pk_fma_f32 v[160:161], v[160:161], v[136:137], v[140:141] neg_lo:[0,0,1] neg_hi:[0,0,1]
    v_pk_fma_f32 v[162:163], v[162:163], v[138:139], v[142:143] neg_lo:[0,0,1] neg_hi:[0,0,1]
    v_pk_fma_f32 v[164:165], v[164:165], v[136:137], v[140:141] neg_lo:[0,0,1] neg_hi:[0,0,1]
    v_pk_fma_f32 v[166:167], v[166:167], v[138:139], v[142:143] neg_lo:[0,0,1] neg_hi:[0,0,1]
    v_pk_fma_f32 v[168:169], v[168:169], v[136:137], v[140:141] neg_lo:[0,0,1] neg_hi:[0,0,1]
    v_pk_fma_f32 v[170:171], v[170:171], v[138:139], v[142:143] neg_lo:[0,0,1] neg_hi:[0,0,1]
    v_pk_fma_f32 v[172:173], v[172:173], v[136:137], v[140:141] neg_lo:[0,0,1] neg_hi:[0,0,1]
    v_pk_fma_f32 v[174:175], v[174:175], v[138:139], v[142:143] neg_lo:[0,0,1] neg_hi:[0,0,1]
    v_pk_fma_f32 v[176:177], v[176:177], v[136:137], v[140:141] neg_lo:[0,0,1] neg_hi:[0,0,1]
    v_pk_fma_f32 v[178:179], v[178:179], v[138:139], v[142:143] neg_lo:[0,0,1] neg_hi:[0,0,1]
    v_pk_fma_f32 v[180:181], v[180:181], v[136:137], v[140:141] neg_lo:[0,0,1] neg_hi:[0,0,1]
    v_pk_fma_f32 v[182:183], v[182:183], v[138:139], v[142:143] neg_lo:[0,0,1] neg_hi:[0,0,1]
    v_pk_fma_f32 v[184:185], v[184:185], v[136:137], v[140:141] neg_lo:[0,0,1] neg_hi:[0,0,1]
    v_pk_fma_f32 v[186:187], v[186:187], v[138:139], v[142:143] neg_lo:[0,0,1] neg_hi:[0,0,1]
    v_pk_fma_f32 v[188:189], v[188:189], v[136:137], v[140:141] neg_lo:[0,0,1] neg_hi:[0,0,1]
    v_pk_fma_f32 v[190:191], v[190:191], v[138:139], v[142:143] neg_lo:[0,0,1] neg_hi:[0,0,1]
    v_cvt_pk_bf16_f32 v144, v160, v164
    v_cvt_pk_bf16_f32 v145, v168, v172
    v_cvt_pk_bf16_f32 v146, v176, v180
    s_waitcnt lgkmcnt(4)
    buffer_store_dwordx4 a[68:71], v254, s[24:27], s84 offen offset:1024 sc1
    ds_read_b128 v[140:143], v158 offset:128
    v_cvt_pk_bf16_f32 v147, v184, v188
    v_cvt_pk_bf16_f32 v148, v161, v165
    v_cvt_pk_bf16_f32 v149, v169, v173
    v_cvt_pk_bf16_f32 v150, v177, v181
    v_cvt_pk_bf16_f32 v151, v185, v189
    v_cvt_pk_bf16_f32 v152, v162, v166
    v_cvt_pk_bf16_f32 v153, v170, v174
    v_cvt_pk_bf16_f32 v154, v178, v182
    v_cvt_pk_bf16_f32 v155, v186, v190
    v_cvt_pk_bf16_f32 v228, v212, v213
    v_exp_f32 v215, v215
    v_exp_f32 v216, v216
    ds_write_b128 v255, v[144:147] offset:5120
    s_waitcnt lgkmcnt(4)
    buffer_store_dwordx4 a[72:75], v254, s[24:27], s84 offen offset:2048 sc1
    v_cvt_pk_bf16_f32 v144, v163, v167
    v_cvt_pk_bf16_f32 v145, v171, v175
    v_cvt_pk_bf16_f32 v146, v179, v183
    v_cvt_pk_bf16_f32 v147, v187, v191
    v_cvt_pk_bf16_f32 v229, v214, v215
    v_mfma_f32_16x16x32_bf16 v[212:215], a[144:147], a[32:35], v[240:243]
    ds_write_b128 v255, v[148:151] offset:5440
    v_mfma_f32_16x16x32_bf16 v[212:215], a[148:151], a[36:39], v[212:215]
    s_waitcnt lgkmcnt(3)
    buffer_store_dwordx4 a[76:79], v254, s[24:27], s84 offen offset:3072 sc1
    v_mfma_f32_16x16x32_bf16 v[212:215], a[152:155], a[40:43], v[212:215]
    ds_write_b128 v255, v[152:155] offset:5760
    v_mfma_f32_16x16x32_bf16 v[212:215], a[156:159], a[44:47], v[212:215]
    v_exp_f32 v217, v217
    v_exp_f32 v218, v218
    v_cvt_pk_bf16_f32 v230, v216, v217
    v_exp_f32 v219, v219
    v_mov_b32_dpp v248, v248 row_ror:6 row_mask:0xf bank_mask:0xf
    v_cvt_pk_bf16_f32 v231, v218, v219
    v_mfma_f32_16x16x32_bf16 v[216:219], a[172:175], a[44:47], v[240:243]
    ds_write_b128 v255, v[144:147] offset:6080
    v_mfma_f32_16x16x32_bf16 v[216:219], a[168:171], a[40:43], v[216:219]
    ds_read_b64_tr_b16 a[80:81], v159 offset:5120
    v_mov_b32_dpp v249, v249 row_ror:6 row_mask:0xf bank_mask:0xf
    v_mfma_f32_16x16x32_bf16 v[216:219], a[164:167], a[36:39], v[216:219]
    ds_read_b64_tr_b16 a[82:83], v159 offset:5184
    v_mov_b32_dpp v250, v250 row_ror:6 row_mask:0xf bank_mask:0xf
    v_mfma_f32_16x16x32_bf16 v[216:219], a[160:163], a[32:35], v[216:219]
    ds_read_b64_tr_b16 a[84:85], v159 offset:6400
    v_mov_b32_dpp v251, v251 row_ror:6 row_mask:0xf bank_mask:0xf
    v_mfma_f32_16x16x32_bf16 v[0:3], v[228:231], a[180:183], v[0:3]
    ds_read_b64_tr_b16 a[86:87], v159 offset:6464
    v_mov_b32 v232, 0
    v_mfma_f32_16x16x32_bf16 v[4:7], v[228:231], a[188:191], v[4:7]
    ds_read_b64_tr_b16 a[88:89], v159 offset:7680
    v_mov_b32 v233, 0
    v_mfma_f32_16x16x32_bf16 v[4:7], v[224:227], a[184:187], v[4:7]
    ds_read_b64_tr_b16 a[90:91], v159 offset:7744
    v_mov_b32 v234, 0
    v_mfma_f32_16x16x32_bf16 v[8:11], v[228:231], a[196:199], v[8:11]
    ds_read_b64_tr_b16 a[92:93], v159 offset:8960
    v_mov_b32 v235, 0
    v_mfma_f32_16x16x32_bf16 v[12:15], v[228:231], a[204:207], v[12:15]
    v_exp_f32 v220, v220
    v_mfma_f32_16x16x32_bf16 v[12:15], v[224:227], a[200:203], v[12:15]
    v_exp_f32 v221, v221
    v_mfma_f32_16x16x32_bf16 v[16:19], v[228:231], a[212:215], v[16:19]
    ds_read_b64_tr_b16 a[94:95], v159 offset:9024
    v_cvt_pk_bf16_f32 v236, v220, v221
    v_mfma_f32_16x16x32_bf16 v[20:23], v[228:231], a[220:223], v[20:23]
    s_waitcnt lgkmcnt(6)
    buffer_store_dwordx4 a[80:83], v254, s[24:27], s85 offen offset:0 sc1
    v_smfmac_f32_16x16x64_bf16 v[244:247], v[248:251], v[224:231], v240
    v_exp_f32 v222, v222
    v_exp_f32 v223, v223
    v_mfma_f32_16x16x32_bf16 v[20:23], v[224:227], a[216:219], v[20:23]
    v_cvt_pk_bf16_f32 v237, v222, v223
    v_mov_b32_dpp v248, v248 row_ror:2 row_mask:0xf bank_mask:0xf
    v_mfma_f32_16x16x32_bf16 v[220:223], a[144:147], a[48:51], v[240:243]
    ds_read_b128 a[144:147], v252 offset:8448
    s_waitcnt lgkmcnt(5)
    buffer_store_dwordx4 a[84:87], v254, s[24:27], s85 offen offset:1024 sc1
    v_mfma_f32_16x16x32_bf16 v[220:223], a[148:151], a[52:55], v[220:223]
    ds_read_b128 a[148:151], v252 offset:8512
    v_mov_b32_dpp v249, v249 row_ror:2 row_mask:0xf bank_mask:0xf
    v_mfma_f32_16x16x32_bf16 v[220:223], a[152:155], a[56:59], v[220:223]
    ds_read_b128 a[152:155], v252 offset:8576
    v_mov_b32_dpp v250, v250 row_ror:2 row_mask:0xf bank_mask:0xf
    v_mfma_f32_16x16x32_bf16 v[24:27], v[228:231], a[228:231], v[24:27]
    v_exp_f32 v208, v208
    v_mfma_f32_16x16x32_bf16 v[220:223], a[156:159], a[60:63], v[220:223]
    s_waitcnt lgkmcnt(5)
    buffer_store_dwordx4 a[88:91], v254, s[24:27], s85 offen offset:2048 sc1
    v_mfma_f32_16x16x32_bf16 v[28:31], v[228:231], a[236:239], v[28:31]
    ds_read_b128 a[156:159], v252 offset:8640
    v_mov_b32_dpp v251, v251 row_ror:2 row_mask:0xf bank_mask:0xf
    v_mfma_f32_16x16x32_bf16 v[28:31], v[224:227], a[232:235], v[28:31]
    v_exp_f32 v209, v209
    v_exp_f32 v210, v210
    v_cvt_pk_bf16_f32 v238, v208, v209
    v_exp_f32 v211, v211
    v_exp_f32 v212, v212
    v_cvt_pk_bf16_f32 v239, v210, v211
    v_mfma_f32_16x16x32_bf16 v[208:211], a[172:175], a[60:63], v[240:243]
    s_waitcnt lgkmcnt(4)
    buffer_store_dwordx4 a[92:95], v254, s[24:27], s85 offen offset:3072 sc1
    v_mfma_f32_16x16x32_bf16 v[208:211], a[168:171], a[56:59], v[208:211]
    ds_read_b128 a[168:171], v252 offset:9088
    v_mov_b32 v224, 0
    v_mfma_f32_16x16x32_bf16 v[208:211], a[164:167], a[52:55], v[208:211]
    ds_read_b128 a[164:167], v252 offset:9024
    v_mov_b32 v225, 0
    v_mfma_f32_16x16x32_bf16 v[208:211], a[160:163], a[48:51], v[208:211]
    ds_read_b128 a[160:163], v252 offset:8960
    v_mov_b32 v226, 0
    v_mfma_f32_16x16x32_bf16 v[32:35], v[236:239], a[180:183], v[32:35]
    ds_read_b128 a[172:175], v252 offset:9152
    v_mov_b32 v227, 0
    v_mfma_f32_16x16x32_bf16 v[36:39], v[236:239], a[188:191], v[36:39]
    v_exp_f32 v213, v213
    v_mfma_f32_16x16x32_bf16 v[40:43], v[236:239], a[196:199], v[40:43]
    v_exp_f32 v214, v214
    v_mfma_f32_16x16x32_bf16 v[44:47], v[236:239], a[204:207], v[44:47]
    v_exp_f32 v215, v215
    v_mfma_f32_16x16x32_bf16 v[48:51], v[236:239], a[212:215], v[48:51]
    v_cvt_pk_bf16_f32 v228, v212, v213
    v_cvt_pk_bf16_f32 v229, v214, v215
    v_mfma_f32_16x16x32_bf16 v[52:55], v[236:239], a[220:223], v[52:55]
    v_exp_f32 v216, v216
    v_mfma_f32_16x16x32_bf16 v[56:59], v[236:239], a[228:231], v[56:59]
    v_exp_f32 v217, v217
    v_mfma_f32_16x16x32_bf16 v[60:63], v[236:239], a[236:239], v[60:63]
    v_exp_f32 v218, v218
    v_mfma_f32_16x16x32_bf16 v[212:215], a[112:115], a[16:19], v[240:243]
    v_exp_f32 v219, v219
    v_mfma_f32_16x16x32_bf16 v[212:215], a[116:119], a[20:23], v[212:215]
    v_cvt_pk_bf16_f32 v230, v216, v217
    v_cvt_pk_bf16_f32 v231, v218, v219
    v_mfma_f32_16x16x32_bf16 v[212:215], a[120:123], a[24:27], v[212:215]
    v_exp_f32 v220, v220
    v_mfma_f32_16x16x32_bf16 v[212:215], a[124:127], a[28:31], v[212:215]
    v_exp_f32 v221, v221
    v_mfma_f32_16x16x32_bf16 v[216:219], a[140:143], a[28:31], v[240:243]
    v_exp_f32 v222, v222
    v_mfma_f32_16x16x32_bf16 v[216:219], a[136:139], a[24:27], v[216:219]
    v_exp_f32 v223, v223
    v_mfma_f32_16x16x32_bf16 v[216:219], a[132:135], a[20:23], v[216:219]
    v_exp_f32 v208, v208
    v_mfma_f32_16x16x32_bf16 v[216:219], a[128:131], a[16:19], v[216:219]
    v_exp_f32 v209, v209
    v_mfma_f32_16x16x32_bf16 v[64:67], v[228:231], a[180:183], v[64:67]
    v_exp_f32 v210, v210
    v_mfma_f32_16x16x32_bf16 v[68:71], v[228:231], a[188:191], v[68:71]
    v_exp_f32 v211, v211
    v_mfma_f32_16x16x32_bf16 v[72:75], v[228:231], a[196:199], v[72:75]
    v_exp_f32 v212, v212
    v_mfma_f32_16x16x32_bf16 v[76:79], v[228:231], a[204:207], v[76:79]
    v_exp_f32 v213, v213
    v_mfma_f32_16x16x32_bf16 v[80:83], v[228:231], a[212:215], v[80:83]
    v_exp_f32 v214, v214
    v_mfma_f32_16x16x32_bf16 v[84:87], v[228:231], a[220:223], v[84:87]
    v_exp_f32 v215, v215
    v_mfma_f32_16x16x32_bf16 v[88:91], v[228:231], a[228:231], v[88:91]
    v_exp_f32 v216, v216
    v_mfma_f32_16x16x32_bf16 v[92:95], v[228:231], a[236:239], v[92:95]
    v_exp_f32 v217, v217
    v_exp_f32 v218, v218
    v_smfmac_f32_16x16x64_bf16 v[244:247], v[248:251], v[232:239], v240
    v_exp_f32 v219, v219
    v_mov_b32_dpp v248, v248 row_ror:2 row_mask:0xf bank_mask:0xf
    v_mov_b32_dpp v249, v249 row_ror:2 row_mask:0xf bank_mask:0xf
    v_mov_b32_dpp v250, v250 row_ror:2 row_mask:0xf bank_mask:0xf
    v_mov_b32_dpp v251, v251 row_ror:2 row_mask:0xf bank_mask:0xf
    v_cvt_pk_bf16_f32 v236, v220, v221
    v_cvt_pk_bf16_f32 v237, v222, v223
    v_smfmac_f32_16x16x64_bf16 v[244:247], v[248:251], v[224:231], v240
    s_waitcnt lgkmcnt(7)
    v_cvt_pk_bf16_f32 v238, v208, v209
    v_cvt_pk_bf16_f32 v239, v210, v211
    v_mov_b32_dpp v248, v248 row_ror:2 row_mask:0xf bank_mask:0xf
    v_mfma_f32_16x16x32_bf16 v[220:223], a[144:147], a[16:19], v[240:243]
    s_waitcnt lgkmcnt(6)
    v_mov_b32_dpp v249, v249 row_ror:2 row_mask:0xf bank_mask:0xf
    v_mov_b32_dpp v250, v250 row_ror:2 row_mask:0xf bank_mask:0xf
    v_mfma_f32_16x16x32_bf16 v[220:223], a[148:151], a[20:23], v[220:223]
    s_waitcnt lgkmcnt(5)
    v_mov_b32_dpp v251, v251 row_ror:2 row_mask:0xf bank_mask:0xf
    v_cvt_pk_bf16_f32 v224, v212, v213
    v_mfma_f32_16x16x32_bf16 v[220:223], a[152:155], a[24:27], v[220:223]
    s_waitcnt lgkmcnt(4)
    v_cvt_pk_bf16_f32 v225, v214, v215
    v_cvt_pk_bf16_f32 v226, v216, v217
    v_mfma_f32_16x16x32_bf16 v[220:223], a[156:159], a[28:31], v[220:223]
    s_waitcnt lgkmcnt(0)
    v_cvt_pk_bf16_f32 v227, v218, v219
    v_mfma_f32_16x16x32_bf16 v[208:211], a[172:175], a[28:31], v[240:243]
    v_mfma_f32_16x16x32_bf16 v[208:211], a[168:171], a[24:27], v[208:211]
    v_mfma_f32_16x16x32_bf16 v[208:211], a[164:167], a[20:23], v[208:211]
    s_nop 2
    v_exp_f32 v220, v220
    v_mfma_f32_16x16x32_bf16 v[208:211], a[160:163], a[16:19], v[208:211]
    v_exp_f32 v221, v221
    v_mfma_f32_16x16x32_bf16 v[96:99], v[236:239], a[180:183], v[96:99]
    ds_read_b64_tr_b16 a[180:181], v253 offset:8320
    v_cvt_pk_bf16_f32 v228, v220, v221
    v_mfma_f32_16x16x32_bf16 v[100:103], v[236:239], a[188:191], v[100:103]
    v_exp_f32 v222, v222
    v_mfma_f32_16x16x32_bf16 v[104:107], v[236:239], a[196:199], v[104:107]
    v_exp_f32 v223, v223
    v_mfma_f32_16x16x32_bf16 v[108:111], v[236:239], a[204:207], v[108:111]
    ds_read_b64_tr_b16 a[182:183], v253 offset:8832
    v_cvt_pk_bf16_f32 v229, v222, v223
    v_mfma_f32_16x16x32_bf16 v[112:115], v[236:239], a[212:215], v[112:115]
    v_exp_f32 v208, v208
    v_mfma_f32_16x16x32_bf16 v[116:119], v[236:239], a[220:223], v[116:119]
    v_exp_f32 v209, v209
    v_mfma_f32_16x16x32_bf16 v[120:123], v[236:239], a[228:231], v[120:123]
    ds_read_b64_tr_b16 a[188:189], v253 offset:8336
    v_cvt_pk_bf16_f32 v230, v208, v209
    v_mfma_f32_16x16x32_bf16 v[124:127], v[236:239], a[236:239], v[124:127]
    v_exp_f32 v210, v210
    v_mfma_f32_16x16x32_bf16 v[32:35], v[224:227], a[176:179], v[32:35]
    v_exp_f32 v211, v211
    v_mfma_f32_16x16x32_bf16 v[212:215], a[112:115], a[32:35], v[240:243]
    ds_read_b64_tr_b16 a[190:191], v253 offset:8848
    v_cvt_pk_bf16_f32 v231, v210, v211
    v_mfma_f32_16x16x32_bf16 v[40:43], v[224:227], a[192:195], v[40:43]
    ds_read_b64_tr_b16 a[196:197], v253 offset:8352
    v_mfma_f32_16x16x32_bf16 v[212:215], a[116:119], a[36:39], v[212:215]
    ds_read_b64_tr_b16 a[198:199], v253 offset:8864
    v_mfma_f32_16x16x32_bf16 v[212:215], a[120:123], a[40:43], v[212:215]
    s_waitcnt lgkmcnt(4)
    ds_read_b64_tr_b16 a[204:205], v253 offset:8368
    v_mfma_f32_16x16x32_bf16 v[32:35], v[228:231], a[180:183], v[32:35]
    ds_read_b64_tr_b16 a[206:207], v253 offset:8880
    v_mfma_f32_16x16x32_bf16 v[212:215], a[124:127], a[44:47], v[212:215]
    ds_read_b64_tr_b16 a[212:213], v253 offset:8384
    v_mfma_f32_16x16x32_bf16 v[48:51], v[224:227], a[208:211], v[48:51]
    ds_read_b64_tr_b16 a[214:215], v253 offset:8896
    v_mfma_f32_16x16x32_bf16 v[56:59], v[224:227], a[224:227], v[56:59]
    ds_read_b64_tr_b16 a[220:221], v253 offset:8400
    v_smfmac_f32_16x16x64_bf16 v[244:247], v[248:251], v[232:239], v240
    s_waitcnt lgkmcnt(7)
    s_nop 0
    v_exp_f32 v212, v212
    v_mov_b32_dpp v248, v248 row_ror:12 row_mask:0xf bank_mask:0xf
    v_mfma_f32_16x16x32_bf16 v[36:39], v[228:231], a[188:191], v[36:39]
    ds_read_b64_tr_b16 a[222:223], v253 offset:8912
    v_mov_b32_dpp v249, v249 row_ror:12 row_mask:0xf bank_mask:0xf
    v_mfma_f32_16x16x32_bf16 v[36:39], v[224:227], a[184:187], v[36:39]
    s_waitcnt lgkmcnt(6)
    ds_read_b64_tr_b16 a[228:229], v253 offset:8416
    v_mov_b32_dpp v250, v250 row_ror:12 row_mask:0xf bank_mask:0xf
    v_mfma_f32_16x16x32_bf16 v[40:43], v[228:231], a[196:199], v[40:43]
    ds_read_b64_tr_b16 a[230:231], v253 offset:8928
    v_mov_b32_dpp v251, v251 row_ror:12 row_mask:0xf bank_mask:0xf
    v_mfma_f32_16x16x32_bf16 v[216:219], a[140:143], a[44:47], v[240:243]
    s_waitcnt lgkmcnt(6)
    v_exp_f32 v213, v213
    v_mfma_f32_16x16x32_bf16 v[44:47], v[228:231], a[204:207], v[44:47]
    ds_read_b64_tr_b16 a[236:237], v253 offset:8432
    v_cvt_pk_bf16_f32 v232, v212, v213
    v_mfma_f32_16x16x32_bf16 v[44:47], v[224:227], a[200:203], v[44:47]
    s_waitcnt lgkmcnt(5)
    v_exp_f32 v214, v214
    v_mfma_f32_16x16x32_bf16 v[48:51], v[228:231], a[212:215], v[48:51]
    v_exp_f32 v215, v215
    v_mfma_f32_16x16x32_bf16 v[216:219], a[136:139], a[40:43], v[216:219]
    ds_read_b64_tr_b16 a[238:239], v253 offset:8944
    v_cvt_pk_bf16_f32 v233, v214, v215
    v_mfma_f32_16x16x32_bf16 v[216:219], a[132:135], a[36:39], v[216:219]
    v_mfma_f32_16x16x32_bf16 v[216:219], a[128:131], a[32:35], v[216:219]
    s_waitcnt lgkmcnt(4)
    v_mfma_f32_16x16x32_bf16 v[52:55], v[228:231], a[220:223], v[52:55]
    v_mfma_f32_16x16x32_bf16 v[52:55], v[224:227], a[216:219], v[52:55]
    v_smfmac_f32_16x16x64_bf16 v[244:247], v[248:251], v[224:231], v240
    s_waitcnt lgkmcnt(2)
    s_nop 2
    v_exp_f32 v216, v216
    v_exp_f32 v217, v217
    v_mfma_f32_16x16x32_bf16 v[56:59], v[228:231], a[228:231], v[56:59]
    v_cvt_pk_bf16_f32 v234, v216, v217
    v_mov_b32_dpp v248, v248 row_ror:2 row_mask:0xf bank_mask:0xf
    v_mfma_f32_16x16x32_bf16 v[220:223], a[144:147], a[32:35], v[240:243]
    v_add_f32 v131, v246, v247
    v_mov_b32 v130, v131
    v_mfma_f32_16x16x32_bf16 v[220:223], a[148:151], a[36:39], v[220:223]
    s_waitcnt lgkmcnt(0)
    v_permlane32_swap_b32 v131, v130
    v_mov_b32 v130, v131
    v_mfma_f32_16x16x32_bf16 v[60:63], v[228:231], a[236:239], v[60:63]
    s_nop 0
    v_permlane16_swap_b32 v131, v130
    v_mov_b32_dpp v249, v249 row_ror:2 row_mask:0xf bank_mask:0xf
    v_mfma_f32_16x16x32_bf16 v[60:63], v[224:227], a[232:235], v[60:63]
    v_rcp_f32 v131, v131
    v_mfma_f32_16x16x32_bf16 v[220:223], a[152:155], a[40:43], v[220:223]
    s_nop 0
    v_mov_b32_dpp v131, v131 row_ror:12 row_mask:0x2 bank_mask:0xf
    v_mov_b32_dpp v250, v250 row_ror:2 row_mask:0xf bank_mask:0xf
    v_mfma_f32_16x16x32_bf16 v[220:223], a[156:159], a[44:47], v[220:223]
    v_mov_b32_dpp v131, v131 row_ror:8 row_mask:0x4 bank_mask:0xf
    v_mov_b32_dpp v251, v251 row_ror:2 row_mask:0xf bank_mask:0xf
    v_mfma_f32_16x16x32_bf16 v[208:211], a[172:175], a[44:47], v[240:243]
    v_exp_f32 v218, v218
    v_mfma_f32_16x16x32_bf16 v[208:211], a[168:171], a[40:43], v[208:211]
    v_exp_f32 v219, v219
    v_mfma_f32_16x16x32_bf16 v[208:211], a[164:167], a[36:39], v[208:211]
    v_mov_b32_dpp v131, v131 row_ror:4 row_mask:0x8 bank_mask:0xf
    v_cvt_pk_bf16_f32 v235, v218, v219
    v_mfma_f32_16x16x32_bf16 v[208:211], a[160:163], a[32:35], v[208:211]
    v_mov_b32_dpp v128, v131 row_newbcast:0 row_mask:0xf bank_mask:0xf
    v_mov_b32_dpp v129, v131 row_newbcast:1 row_mask:0xf bank_mask:0xf
    v_mfma_f32_16x16x32_bf16 v[64:67], v[232:235], a[176:179], v[64:67]
    v_mov_b32_dpp v130, v131 row_newbcast:2 row_mask:0xf bank_mask:0xf
    v_mov_b32_dpp v131, v131 row_newbcast:3 row_mask:0xf bank_mask:0xf
    v_mfma_f32_16x16x32_bf16 v[212:215], a[112:115], a[48:51], v[240:243]
    ds_read_b128 a[112:115], v252 offset:0
    v_mul_f32 v132, v132, v128
    v_mfma_f32_16x16x32_bf16 v[72:75], v[232:235], a[192:195], v[72:75]
    v_mul_f32 v133, v133, v129
    v_mul_f32 v134, v134, v130
    v_mfma_f32_16x16x32_bf16 v[212:215], a[116:119], a[52:55], v[212:215]
    ds_read_b128 a[116:119], v252 offset:64
    v_mul_f32 v135, v135, v131
    v_mfma_f32_16x16x32_bf16 v[212:215], a[120:123], a[56:59], v[212:215]
    v_exp_f32 v220, v220
    v_mfma_f32_16x16x32_bf16 v[212:215], a[124:127], a[60:63], v[212:215]
    v_exp_f32 v221, v221
    v_mfma_f32_16x16x32_bf16 v[80:83], v[232:235], a[208:211], v[80:83]
    ds_read_b128 a[120:123], v252 offset:128
    v_pk_fma_f32 v[32:33], v[32:33], v[128:129], v[132:133] neg_lo:[0,0,1] neg_hi:[0,0,1]
    v_pk_fma_f32 v[34:35], v[34:35], v[130:131], v[134:135] neg_lo:[0,0,1] neg_hi:[0,0,1]
    v_pk_fma_f32 v[36:37], v[36:37], v[128:129], v[132:133] neg_lo:[0,0,1] neg_hi:[0,0,1]
    v_pk_fma_f32 v[38:39], v[38:39], v[130:131], v[134:135] neg_lo:[0,0,1] neg_hi:[0,0,1]
    v_pk_fma_f32 v[40:41], v[40:41], v[128:129], v[132:133] neg_lo:[0,0,1] neg_hi:[0,0,1]
    v_pk_fma_f32 v[42:43], v[42:43], v[130:131], v[134:135] neg_lo:[0,0,1] neg_hi:[0,0,1]
    v_pk_fma_f32 v[44:45], v[44:45], v[128:129], v[132:133] neg_lo:[0,0,1] neg_hi:[0,0,1]
    v_pk_fma_f32 v[46:47], v[46:47], v[130:131], v[134:135] neg_lo:[0,0,1] neg_hi:[0,0,1]
    v_pk_fma_f32 v[48:49], v[48:49], v[128:129], v[132:133] neg_lo:[0,0,1] neg_hi:[0,0,1]
    v_pk_fma_f32 v[50:51], v[50:51], v[130:131], v[134:135] neg_lo:[0,0,1] neg_hi:[0,0,1]
    v_pk_fma_f32 v[52:53], v[52:53], v[128:129], v[132:133] neg_lo:[0,0,1] neg_hi:[0,0,1]
    v_pk_fma_f32 v[54:55], v[54:55], v[130:131], v[134:135] neg_lo:[0,0,1] neg_hi:[0,0,1]
    v_pk_fma_f32 v[56:57], v[56:57], v[128:129], v[132:133] neg_lo:[0,0,1] neg_hi:[0,0,1]
    v_pk_fma_f32 v[58:59], v[58:59], v[130:131], v[134:135] neg_lo:[0,0,1] neg_hi:[0,0,1]
    v_pk_fma_f32 v[60:61], v[60:61], v[128:129], v[132:133] neg_lo:[0,0,1] neg_hi:[0,0,1]
    v_pk_fma_f32 v[62:63], v[62:63], v[130:131], v[134:135] neg_lo:[0,0,1] neg_hi:[0,0,1]
    v_mfma_f32_16x16x32_bf16 v[88:91], v[232:235], a[224:227], v[88:91]
    ds_read_b128 a[124:127], v252 offset:192
    v_cvt_pk_bf16_f32 v144, v32, v36
    v_mfma_f32_16x16x32_bf16 v[216:219], a[140:143], a[60:63], v[240:243]
    ds_read_b128 a[140:143], v252 offset:704
    v_cvt_pk_bf16_f32 v145, v40, v44
    v_mfma_f32_16x16x32_bf16 v[216:219], a[136:139], a[56:59], v[216:219]
    ds_read_b128 a[136:139], v252 offset:640
    v_cvt_pk_bf16_f32 v146, v48, v52
    v_mfma_f32_16x16x32_bf16 v[216:219], a[132:135], a[52:55], v[216:219]
    ds_read_b128 a[132:135], v252 offset:576
    v_cvt_pk_bf16_f32 v147, v56, v60
    v_mfma_f32_16x16x32_bf16 v[216:219], a[128:131], a[48:51], v[216:219]
    ds_write_b128 v255, v[144:147] offset:0
    ds_read_b128 a[128:131], v252 offset:512
    v_cvt_pk_bf16_f32 v148, v33, v37
    v_cvt_pk_bf16_f32 v149, v41, v45
    v_cvt_pk_bf16_f32 v150, v49, v53
    v_cvt_pk_bf16_f32 v151, v57, v61
    v_cvt_pk_bf16_f32 v152, v34, v38
    v_cvt_pk_bf16_f32 v153, v42, v46
    v_cvt_pk_bf16_f32 v154, v50, v54
    v_cvt_pk_bf16_f32 v155, v58, v62
    v_cvt_pk_bf16_f32 v144, v35, v39
    v_cvt_pk_bf16_f32 v145, v43, v47
    v_cvt_pk_bf16_f32 v146, v51, v55
    v_cvt_pk_bf16_f32 v147, v59, v63
    v_cvt_pk_bf16_f32 v236, v220, v221
    v_exp_f32 v222, v222
    v_exp_f32 v223, v223
    ds_write_b128 v255, v[148:151] offset:320
    ds_read_b128 v[132:135], v158 offset:192
    v_cvt_pk_bf16_f32 v237, v222, v223
    v_mfma_f32_16x16x32_bf16 v[220:223], a[144:147], a[48:51], v[240:243]
    v_exp_f32 v208, v208
    v_mfma_f32_16x16x32_bf16 v[220:223], a[148:151], a[52:55], v[220:223]
    ds_write_b128 v255, v[152:155] offset:640
    v_mfma_f32_16x16x32_bf16 v[220:223], a[152:155], a[56:59], v[220:223]
    v_exp_f32 v209, v209
    v_mfma_f32_16x16x32_bf16 v[220:223], a[156:159], a[60:63], v[220:223]
    ds_write_b128 v255, v[144:147] offset:960
    ds_read_b64_tr_b16 a[16:17], v159 offset:0
    v_cvt_pk_bf16_f32 v238, v208, v209
    v_exp_f32 v210, v210
    v_exp_f32 v211, v211
    v_exp_f32 v212, v212
    v_cvt_pk_bf16_f32 v239, v210, v211
    v_mfma_f32_16x16x32_bf16 v[208:211], a[172:175], a[60:63], v[240:243]
    v_exp_f32 v213, v213
    v_mfma_f32_16x16x32_bf16 v[64:67], v[236:239], a[180:183], v[64:67]
    ds_read_b64_tr_b16 a[18:19], v159 offset:64
    v_cvt_pk_bf16_f32 v224, v212, v213
    v_mfma_f32_16x16x32_bf16 v[68:71], v[236:239], a[188:191], v[68:71]
    v_exp_f32 v214, v214
    v_mfma_f32_16x16x32_bf16 v[68:71], v[232:235], a[184:187], v[68:71]
    v_exp_f32 v215, v215
    v_mfma_f32_16x16x32_bf16 v[72:75], v[236:239], a[196:199], v[72:75]
    ds_read_b64_tr_b16 a[20:21], v159 offset:1280
    v_cvt_pk_bf16_f32 v225, v214, v215
    v_mfma_f32_16x16x32_bf16 v[76:79], v[236:239], a[204:207], v[76:79]
    v_exp_f32 v216, v216
    v_mfma_f32_16x16x32_bf16 v[76:79], v[232:235], a[200:203], v[76:79]
    v_exp_f32 v217, v217
    v_mfma_f32_16x16x32_bf16 v[80:83], v[236:239], a[212:215], v[80:83]
    ds_read_b64_tr_b16 a[22:23], v159 offset:1344
    v_cvt_pk_bf16_f32 v226, v216, v217
    v_mfma_f32_16x16x32_bf16 v[84:87], v[236:239], a[220:223], v[84:87]
    v_exp_f32 v218, v218
    v_mfma_f32_16x16x32_bf16 v[84:87], v[232:235], a[216:219], v[84:87]
    v_exp_f32 v219, v219
    v_mfma_f32_16x16x32_bf16 v[88:91], v[236:239], a[228:231], v[88:91]
    ds_read_b64_tr_b16 a[24:25], v159 offset:2560
    s_waitcnt lgkmcnt(3)
    buffer_store_dwordx4 a[16:19], v254, s[24:27], s81 offen offset:0 sc1
    v_smfmac_f32_16x16x64_bf16 v[244:247], v[248:251], v[232:239], v240
    ds_read_b64_tr_b16 a[26:27], v159 offset:2624
    v_cvt_pk_bf16_f32 v227, v218, v219
    v_exp_f32 v220, v220
    v_mfma_f32_16x16x32_bf16 v[92:95], v[236:239], a[236:239], v[92:95]
    ds_read_b64_tr_b16 a[28:29], v159 offset:3840
    v_mov_b32_dpp v248, v248 row_ror:2 row_mask:0xf bank_mask:0xf
    v_mfma_f32_16x16x32_bf16 v[92:95], v[232:235], a[232:235], v[92:95]
    ds_read_b64_tr_b16 a[30:31], v159 offset:3904
    v_add_f32 v139, v244, v245
    v_mfma_f32_16x16x32_bf16 v[208:211], a[168:171], a[56:59], v[208:211]
    v_mov_b32 v138, v139
    v_mov_b32_dpp v249, v249 row_ror:2 row_mask:0xf bank_mask:0xf
    v_mfma_f32_16x16x32_bf16 v[208:211], a[164:167], a[52:55], v[208:211]
    s_waitcnt lgkmcnt(4)
    buffer_store_dwordx4 a[20:23], v254, s[24:27], s81 offen offset:1024 sc1
    v_mfma_f32_16x16x32_bf16 v[208:211], a[160:163], a[48:51], v[208:211]
    v_permlane32_swap_b32 v139, v138
    v_mov_b32 v138, v139
    v_mfma_f32_16x16x32_bf16 v[96:99], v[224:227], a[176:179], v[96:99]
    ds_read_b64_tr_b16 a[176:177], v253 offset:0
    v_permlane16_swap_b32 v139, v138
    v_mfma_f32_16x16x32_bf16 v[104:107], v[224:227], a[192:195], v[104:107]
    ds_read_b64_tr_b16 a[178:179], v253 offset:512
    v_mov_b32_dpp v250, v250 row_ror:2 row_mask:0xf bank_mask:0xf
    v_mfma_f32_16x16x32_bf16 v[112:115], v[224:227], a[208:211], v[112:115]
    s_waitcnt lgkmcnt(4)
    buffer_store_dwordx4 a[24:27], v254, s[24:27], s81 offen offset:2048 sc1
    v_mfma_f32_16x16x32_bf16 v[120:123], v[224:227], a[224:227], v[120:123]
    ds_read_b64_tr_b16 a[192:193], v253 offset:32
    v_mov_b32_dpp v251, v251 row_ror:2 row_mask:0xf bank_mask:0xf
    v_mfma_f32_16x16x32_bf16 v[212:215], a[112:115], a[0:3], v[240:243]
    v_rcp_f32 v139, v138
    v_mfma_f32_16x16x32_bf16 v[212:215], a[116:119], a[4:7], v[212:215]
    ds_read_b64_tr_b16 a[194:195], v253 offset:544
    v_mov_b32_dpp v139, v139 row_ror:12 row_mask:0x2 bank_mask:0xf
    v_mfma_f32_16x16x32_bf16 v[212:215], a[120:123], a[8:11], v[212:215]
    s_waitcnt lgkmcnt(4)
    buffer_store_dwordx4 a[28:31], v254, s[24:27], s81 offen offset:3072 sc1
    v_mfma_f32_16x16x32_bf16 v[212:215], a[124:127], a[12:15], v[212:215]
    ds_read_b64_tr_b16 a[208:209], v253 offset:64
    v_mov_b32_dpp v139, v139 row_ror:8 row_mask:0x4 bank_mask:0xf
    v_mfma_f32_16x16x32_bf16 v[216:219], a[140:143], a[12:15], v[240:243]
    ds_read_b64_tr_b16 a[210:211], v253 offset:576
    v_mov_b32_dpp v139, v139 row_ror:4 row_mask:0x8 bank_mask:0xf
    v_mfma_f32_16x16x32_bf16 v[216:219], a[136:139], a[8:11], v[216:219]
    ds_read_b64_tr_b16 a[224:225], v253 offset:96
    v_mov_b32_dpp v136, v139 row_newbcast:0 row_mask:0xf bank_mask:0xf
    v_mfma_f32_16x16x32_bf16 v[216:219], a[132:135], a[4:7], v[216:219]
    ds_read_b64_tr_b16 a[226:227], v253 offset:608
    v_mov_b32_dpp v137, v139 row_newbcast:1 row_mask:0xf bank_mask:0xf
    v_mfma_f32_16x16x32_bf16 v[216:219], a[128:131], a[0:3], v[216:219]
    v_mov_b32_dpp v138, v139 row_newbcast:2 row_mask:0xf bank_mask:0xf
    v_mov_b32_dpp v139, v139 row_newbcast:3 row_mask:0xf bank_mask:0xf
    v_mul_f32 v140, v140, v136
    v_mul_f32 v141, v141, v137
    v_mul_f32 v142, v142, v138
    v_mul_f32_e64 v143, v143, v139
    v_pk_fma_f32 v[64:65], v[64:65], v[136:137], v[140:141] neg_lo:[0,0,1] neg_hi:[0,0,1]
    v_pk_fma_f32 v[66:67], v[66:67], v[138:139], v[142:143] neg_lo:[0,0,1] neg_hi:[0,0,1]
    v_pk_fma_f32 v[68:69], v[68:69], v[136:137], v[140:141] neg_lo:[0,0,1] neg_hi:[0,0,1]
    v_pk_fma_f32 v[70:71], v[70:71], v[138:139], v[142:143] neg_lo:[0,0,1] neg_hi:[0,0,1]
    v_pk_fma_f32 v[72:73], v[72:73], v[136:137], v[140:141] neg_lo:[0,0,1] neg_hi:[0,0,1]
    v_pk_fma_f32 v[74:75], v[74:75], v[138:139], v[142:143] neg_lo:[0,0,1] neg_hi:[0,0,1]
    v_pk_fma_f32 v[76:77], v[76:77], v[136:137], v[140:141] neg_lo:[0,0,1] neg_hi:[0,0,1]
    v_pk_fma_f32 v[78:79], v[78:79], v[138:139], v[142:143] neg_lo:[0,0,1] neg_hi:[0,0,1]
    v_pk_fma_f32 v[80:81], v[80:81], v[136:137], v[140:141] neg_lo:[0,0,1] neg_hi:[0,0,1]
    v_pk_fma_f32 v[82:83], v[82:83], v[138:139], v[142:143] neg_lo:[0,0,1] neg_hi:[0,0,1]
    v_pk_fma_f32 v[84:85], v[84:85], v[136:137], v[140:141] neg_lo:[0,0,1] neg_hi:[0,0,1]
    v_pk_fma_f32 v[86:87], v[86:87], v[138:139], v[142:143] neg_lo:[0,0,1] neg_hi:[0,0,1]
    v_pk_fma_f32 v[88:89], v[88:89], v[136:137], v[140:141] neg_lo:[0,0,1] neg_hi:[0,0,1]
    v_pk_fma_f32 v[90:91], v[90:91], v[138:139], v[142:143] neg_lo:[0,0,1] neg_hi:[0,0,1]
    v_pk_fma_f32 v[92:93], v[92:93], v[136:137], v[140:141] neg_lo:[0,0,1] neg_hi:[0,0,1]
    v_pk_fma_f32 v[94:95], v[94:95], v[138:139], v[142:143] neg_lo:[0,0,1] neg_hi:[0,0,1]
    v_cvt_pk_bf16_f32 v144, v64, v68
    v_cvt_pk_bf16_f32 v145, v72, v76
    v_cvt_pk_bf16_f32 v146, v80, v84
    v_cvt_pk_bf16_f32 v147, v88, v92
    v_cvt_pk_bf16_f32 v148, v65, v69
    v_cvt_pk_bf16_f32 v149, v73, v77
    v_cvt_pk_bf16_f32 v150, v81, v85
    v_cvt_pk_bf16_f32 v151, v89, v93
    v_cvt_pk_bf16_f32 v152, v66, v70
    v_cvt_pk_bf16_f32 v153, v74, v78
    v_cvt_pk_bf16_f32 v154, v82, v86
    v_cvt_pk_bf16_f32 v155, v90, v94
    v_exp_f32 v221, v221
    ds_read_b128 v[140:143], v158 offset:0
    ds_write_b128 v255, v[144:147] offset:5120
    s_nop 1
    v_cvt_pk_bf16_f32 v144, v67, v71
    v_cvt_pk_bf16_f32 v145, v75, v79
    v_cvt_pk_bf16_f32 v146, v83, v87
    v_cvt_pk_bf16_f32 v147, v91, v95
    v_cvt_pk_bf16_f32 v228, v220, v221
    v_exp_f32 v222, v222
    v_exp_f32 v223, v223
    v_exp_f32 v208, v208
    v_cvt_pk_bf16_f32 v229, v222, v223
    v_mfma_f32_16x16x32_bf16 v[220:223], a[144:147], a[0:3], v[240:243]
    ds_write_b128 v255, v[148:151] offset:5440
    v_mfma_f32_16x16x32_bf16 v[220:223], a[148:151], a[4:7], v[220:223]
    v_exp_f32 v209, v209
    v_mfma_f32_16x16x32_bf16 v[220:223], a[152:155], a[8:11], v[220:223]
    ds_write_b128 v255, v[152:155] offset:5760
    v_mfma_f32_16x16x32_bf16 v[220:223], a[156:159], a[12:15], v[220:223]
    v_cvt_pk_bf16_f32 v230, v208, v209
    v_exp_f32 v210, v210
    v_exp_f32 v211, v211
    v_exp_f32 v212, v212
    v_cvt_pk_bf16_f32 v231, v210, v211
    v_mfma_f32_16x16x32_bf16 v[208:211], a[172:175], a[12:15], v[240:243]
    ds_write_b128 v255, v[144:147] offset:6080
    v_smfmac_f32_16x16x64_bf16 v[244:247], v[248:251], v[224:231], v240
    v_exp_f32 v213, v213
    v_exp_f32 v214, v214
    v_mfma_f32_16x16x32_bf16 v[96:99], v[228:231], a[180:183], v[96:99]
    ds_read_b64_tr_b16 a[32:33], v159 offset:5120
    v_cvt_pk_bf16_f32 v232, v212, v213
    v_mfma_f32_16x16x32_bf16 v[100:103], v[228:231], a[188:191], v[100:103]
    ds_read_b64_tr_b16 a[34:35], v159 offset:5184
    s_nop 0
    v_add_f32 v131, v246, v247
    v_mfma_f32_16x16x32_bf16 v[100:103], v[224:227], a[184:187], v[100:103]
    ds_read_b64_tr_b16 a[36:37], v159 offset:6400
    v_mov_b32 v130, v131
    v_mfma_f32_16x16x32_bf16 v[104:107], v[228:231], a[196:199], v[104:107]
    ds_read_b64_tr_b16 a[38:39], v159 offset:6464
    v_permlane32_swap_b32 v131, v130
    v_mfma_f32_16x16x32_bf16 v[108:111], v[228:231], a[204:207], v[108:111]
    ds_read_b64_tr_b16 a[40:41], v159 offset:7680
    v_mov_b32 v130, v131
    v_mfma_f32_16x16x32_bf16 v[108:111], v[224:227], a[200:203], v[108:111]
    ds_read_b64_tr_b16 a[42:43], v159 offset:7744
    v_permlane16_swap_b32 v131, v130
    v_mfma_f32_16x16x32_bf16 v[112:115], v[228:231], a[212:215], v[112:115]
    ds_read_b64_tr_b16 a[44:45], v159 offset:8960
    v_mov_b32_dpp v248, v248 row_ror:10 row_mask:0xf bank_mask:0xf
    v_mfma_f32_16x16x32_bf16 v[116:119], v[228:231], a[220:223], v[116:119]
    ds_read_b64_tr_b16 a[46:47], v159 offset:9024
    v_mov_b32_dpp v249, v249 row_ror:10 row_mask:0xf bank_mask:0xf
    v_mfma_f32_16x16x32_bf16 v[116:119], v[224:227], a[216:219], v[116:119]
    ds_read_b64_tr_b16 a[184:185], v253 offset:16
    v_mov_b32_dpp v250, v250 row_ror:10 row_mask:0xf bank_mask:0xf
    v_mfma_f32_16x16x32_bf16 v[120:123], v[228:231], a[228:231], v[120:123]
    ds_read_b64_tr_b16 a[186:187], v253 offset:528
    v_mov_b32_dpp v251, v251 row_ror:10 row_mask:0xf bank_mask:0xf
    v_mfma_f32_16x16x32_bf16 v[124:127], v[228:231], a[236:239], v[124:127]
    s_waitcnt lgkmcnt(8)
    buffer_store_dwordx4 a[32:35], v254, s[24:27], s82 offen offset:0 sc1
    v_mfma_f32_16x16x32_bf16 v[124:127], v[224:227], a[232:235], v[124:127]
    v_rcp_f32 v131, v130
    v_mfma_f32_16x16x32_bf16 v[208:211], a[168:171], a[8:11], v[208:211]
    ds_read_b64_tr_b16 a[200:201], v253 offset:48
    v_mov_b32_dpp v131, v131 row_ror:12 row_mask:0x2 bank_mask:0xf
    v_mfma_f32_16x16x32_bf16 v[208:211], a[164:167], a[4:7], v[208:211]
    ds_read_b64_tr_b16 a[202:203], v253 offset:560
    v_mov_b32_dpp v131, v131 row_ror:8 row_mask:0x4 bank_mask:0xf
    v_mfma_f32_16x16x32_bf16 v[208:211], a[160:163], a[0:3], v[208:211]
    s_waitcnt lgkmcnt(8)
    buffer_store_dwordx4 a[36:39], v254, s[24:27], s82 offen offset:1024 sc1
    ds_read_b64_tr_b16 a[216:217], v253 offset:80
    v_mov_b32_dpp v131, v131 row_ror:4 row_mask:0x8 bank_mask:0xf
    v_exp_f32 v215, v215
    s_nop 0
    v_mov_b32_dpp v128, v131 row_newbcast:0 row_mask:0xf bank_mask:0xf
    v_mov_b32_dpp v129, v131 row_newbcast:1 row_mask:0xf bank_mask:0xf
    v_mov_b32_dpp v130, v131 row_newbcast:2 row_mask:0xf bank_mask:0xf
    v_mov_b32_dpp v131, v131 row_newbcast:3 row_mask:0xf bank_mask:0xf
    v_mul_f32 v132, v132, v128
    v_mul_f32 v133, v133, v129
    v_mul_f32 v134, v134, v130
    v_mul_f32 v135, v135, v131
    v_pk_fma_f32 v[96:97], v[96:97], v[128:129], v[132:133] neg_lo:[0,0,1] neg_hi:[0,0,1]
    v_pk_fma_f32 v[98:99], v[98:99], v[130:131], v[134:135] neg_lo:[0,0,1] neg_hi:[0,0,1]
    v_pk_fma_f32 v[100:101], v[100:101], v[128:129], v[132:133] neg_lo:[0,0,1] neg_hi:[0,0,1]
    v_pk_fma_f32 v[102:103], v[102:103], v[130:131], v[134:135] neg_lo:[0,0,1] neg_hi:[0,0,1]
    v_pk_fma_f32 v[104:105], v[104:105], v[128:129], v[132:133] neg_lo:[0,0,1] neg_hi:[0,0,1]
    v_pk_fma_f32 v[106:107], v[106:107], v[130:131], v[134:135] neg_lo:[0,0,1] neg_hi:[0,0,1]
    v_pk_fma_f32 v[108:109], v[108:109], v[128:129], v[132:133] neg_lo:[0,0,1] neg_hi:[0,0,1]
    v_pk_fma_f32 v[110:111], v[110:111], v[130:131], v[134:135] neg_lo:[0,0,1] neg_hi:[0,0,1]
    v_pk_fma_f32 v[112:113], v[112:113], v[128:129], v[132:133] neg_lo:[0,0,1] neg_hi:[0,0,1]
    v_pk_fma_f32 v[114:115], v[114:115], v[130:131], v[134:135] neg_lo:[0,0,1] neg_hi:[0,0,1]
    v_pk_fma_f32 v[116:117], v[116:117], v[128:129], v[132:133] neg_lo:[0,0,1] neg_hi:[0,0,1]
    v_pk_fma_f32 v[118:119], v[118:119], v[130:131], v[134:135] neg_lo:[0,0,1] neg_hi:[0,0,1]
    v_pk_fma_f32 v[120:121], v[120:121], v[128:129], v[132:133] neg_lo:[0,0,1] neg_hi:[0,0,1]
    v_pk_fma_f32 v[122:123], v[122:123], v[130:131], v[134:135] neg_lo:[0,0,1] neg_hi:[0,0,1]
    v_pk_fma_f32 v[124:125], v[124:125], v[128:129], v[132:133] neg_lo:[0,0,1] neg_hi:[0,0,1]
    v_pk_fma_f32 v[126:127], v[126:127], v[130:131], v[134:135] neg_lo:[0,0,1] neg_hi:[0,0,1]
    s_waitcnt lgkmcnt(7)
    buffer_store_dwordx4 a[40:43], v254, s[24:27], s82 offen offset:2048 sc1
    ds_read_b64_tr_b16 a[218:219], v253 offset:592
    v_cvt_pk_bf16_f32 v144, v96, v100
    v_cvt_pk_bf16_f32 v145, v104, v108
    v_cvt_pk_bf16_f32 v146, v112, v116
    v_cvt_pk_bf16_f32 v147, v120, v124
    v_cvt_pk_bf16_f32 v148, v97, v101
    v_cvt_pk_bf16_f32 v149, v105, v109
    v_cvt_pk_bf16_f32 v150, v113, v117
    v_cvt_pk_bf16_f32 v151, v121, v125
    v_cvt_pk_bf16_f32 v152, v98, v102
    v_cvt_pk_bf16_f32 v153, v106, v110
    v_cvt_pk_bf16_f32 v154, v114, v118
    v_cvt_pk_bf16_f32 v155, v122, v126
    v_cvt_pk_bf16_f32 v233, v214, v215
    v_exp_f32 v216, v216
    v_exp_f32_e64 v217, v217
    ds_read_b64_tr_b16 a[232:233], v253 offset:112
    s_waitcnt lgkmcnt(7)
    buffer_store_dwordx4 a[44:47], v254, s[24:27], s82 offen offset:3072 sc1
    ds_read_b64_tr_b16 a[234:235], v253 offset:624
    ds_write_b128 v255, v[144:147] offset:0
    s_nop 1
    v_cvt_pk_bf16_f32 v144, v99, v103
    v_cvt_pk_bf16_f32 v145, v107, v111
    v_cvt_pk_bf16_f32 v146, v115, v119
    v_cvt_pk_bf16_f32 v147, v123, v127
    v_cvt_pk_bf16_f32 v234, v216, v217
    v_exp_f32 v218, v218
    v_exp_f32 v219, v219
    v_exp_f32 v220, v220
    v_cvt_pk_bf16_f32 v235, v218, v219
    v_exp_f32 v221, v221
    s_nop 0
    v_mfma_f32_16x16x32_bf16 v[0:3], v[232:235], a[176:179], v[0:3]
    ds_write_b128 v255, v[148:151] offset:320
    v_mfma_f32_16x16x32_bf16 v[8:11], v[232:235], a[192:195], v[8:11]
    v_exp_f32 v222, v222
    v_mfma_f32_16x16x32_bf16 v[16:19], v[232:235], a[208:211], v[16:19]
    ds_write_b128 v255, v[152:155] offset:640
    v_mfma_f32_16x16x32_bf16 v[24:27], v[232:235], a[224:227], v[24:27]
    v_cvt_pk_bf16_f32 v236, v220, v221
    v_exp_f32 v223, v223
    v_exp_f32 v208, v208
    v_cvt_pk_bf16_f32 v237, v222, v223
    v_exp_f32 v209, v209
    v_exp_f32 v210, v210
    v_cvt_pk_bf16_f32 v238, v208, v209
    v_exp_f32 v211, v211
    s_nop 0
    v_cvt_pk_bf16_f32 v239, v210, v211
    s_nop 1
    v_smfmac_f32_16x16x64_bf16 v[244:247], v[248:251], v[232:239], v240
    ds_write_b128 v255, v[144:147] offset:960
    v_mfma_f32_16x16x32_bf16 v[0:3], v[236:239], a[180:183], v[0:3]
    ds_read_b64_tr_b16 a[48:49], v159 offset:0
    s_nop 4
    v_add_f32 v139, v244, v245
    v_mfma_f32_16x16x32_bf16 v[4:7], v[236:239], a[188:191], v[4:7]
    s_waitcnt lgkmcnt(11)
    ds_read_b64_tr_b16 a[50:51], v159 offset:64
    v_mov_b32 v138, v139
    v_mfma_f32_16x16x32_bf16 v[4:7], v[232:235], a[184:187], v[4:7]
    ds_read_b64_tr_b16 a[52:53], v159 offset:1280
    v_permlane32_swap_b32 v139, v138
    v_mfma_f32_16x16x32_bf16 v[8:11], v[236:239], a[196:199], v[8:11]
    ds_read_b64_tr_b16 a[54:55], v159 offset:1344
    v_mov_b32 v138, v139
    v_mfma_f32_16x16x32_bf16 v[12:15], v[236:239], a[204:207], v[12:15]
    s_waitcnt lgkmcnt(12)
    ds_read_b64_tr_b16 a[56:57], v159 offset:2560
    v_permlane16_swap_b32 v139, v138
    v_mfma_f32_16x16x32_bf16 v[12:15], v[232:235], a[200:203], v[12:15]
    ds_read_b64_tr_b16 a[58:59], v159 offset:2624
    v_add_f32 v248, v244, v245
    v_mfma_f32_16x16x32_bf16 v[16:19], v[236:239], a[212:215], v[16:19]
    ds_read_b64_tr_b16 a[60:61], v159 offset:3840
    v_add_f32 v249, v246, v247
    v_mfma_f32_16x16x32_bf16 v[20:23], v[236:239], a[220:223], v[20:23]
    s_waitcnt lgkmcnt(13)
    ds_read_b64_tr_b16 a[62:63], v159 offset:3904
    v_max_u32 v250, v248, v249
    v_mfma_f32_16x16x32_bf16 v[20:23], v[232:235], a[216:219], v[20:23]
    v_rcp_f32_e64 v139, v139
    v_mfma_f32_16x16x32_bf16 v[24:27], v[236:239], a[228:231], v[24:27]
    s_nop 0
    v_mov_b32_dpp v139, v139 row_ror:12 row_mask:0x2 bank_mask:0xf
    v_min_u32 v251, v248, v249
    v_mfma_f32_16x16x32_bf16 v[28:31], v[236:239], a[236:239], v[28:31]
    s_waitcnt lgkmcnt(6)
    buffer_store_dwordx4 a[48:51], v254, s[24:27], s83 offen offset:0 sc1
    v_mfma_f32_16x16x32_bf16 v[28:31], v[232:235], a[232:235], v[28:31]
    v_mov_b32_dpp v139, v139 row_ror:8 row_mask:0x4 bank_mask:0xf
    s_nop 1
    v_mov_b32_dpp v139, v139 row_ror:4 row_mask:0x8 bank_mask:0xf
    s_nop 1
    v_mov_b32_dpp v136, v139 row_newbcast:0 row_mask:0xf bank_mask:0xf
    v_mov_b32_dpp v137, v139 row_newbcast:1 row_mask:0xf bank_mask:0xf
    v_mov_b32_dpp v138, v139 row_newbcast:2 row_mask:0xf bank_mask:0xf
    v_mov_b32_dpp v139, v139 row_newbcast:3 row_mask:0xf bank_mask:0xf
    v_mul_f32 v140, v140, v136
    v_mul_f32 v141, v141, v137
    v_mul_f32 v142, v142, v138
    v_mul_f32 v143, v143, v139
    v_pk_fma_f32 v[0:1], v[0:1], v[136:137], v[140:141] neg_lo:[0,0,1] neg_hi:[0,0,1]
    v_pk_fma_f32 v[2:3], v[2:3], v[138:139], v[142:143] neg_lo:[0,0,1] neg_hi:[0,0,1]
    v_pk_fma_f32 v[4:5], v[4:5], v[136:137], v[140:141] neg_lo:[0,0,1] neg_hi:[0,0,1]
    v_pk_fma_f32 v[6:7], v[6:7], v[138:139], v[142:143] neg_lo:[0,0,1] neg_hi:[0,0,1]
    v_pk_fma_f32 v[8:9], v[8:9], v[136:137], v[140:141] neg_lo:[0,0,1] neg_hi:[0,0,1]
    v_pk_fma_f32 v[10:11], v[10:11], v[138:139], v[142:143] neg_lo:[0,0,1] neg_hi:[0,0,1]
    v_pk_fma_f32 v[12:13], v[12:13], v[136:137], v[140:141] neg_lo:[0,0,1] neg_hi:[0,0,1]
    v_pk_fma_f32 v[14:15], v[14:15], v[138:139], v[142:143] neg_lo:[0,0,1] neg_hi:[0,0,1]
    v_pk_fma_f32 v[16:17], v[16:17], v[136:137], v[140:141] neg_lo:[0,0,1] neg_hi:[0,0,1]
    v_pk_fma_f32 v[18:19], v[18:19], v[138:139], v[142:143] neg_lo:[0,0,1] neg_hi:[0,0,1]
    v_pk_fma_f32 v[20:21], v[20:21], v[136:137], v[140:141] neg_lo:[0,0,1] neg_hi:[0,0,1]
    v_pk_fma_f32 v[22:23], v[22:23], v[138:139], v[142:143] neg_lo:[0,0,1] neg_hi:[0,0,1]
    v_pk_fma_f32 v[24:25], v[24:25], v[136:137], v[140:141] neg_lo:[0,0,1] neg_hi:[0,0,1]
    v_pk_fma_f32 v[26:27], v[26:27], v[138:139], v[142:143] neg_lo:[0,0,1] neg_hi:[0,0,1]
    v_pk_fma_f32 v[28:29], v[28:29], v[136:137], v[140:141] neg_lo:[0,0,1] neg_hi:[0,0,1]
    v_pk_fma_f32 v[30:31], v[30:31], v[138:139], v[142:143] neg_lo:[0,0,1] neg_hi:[0,0,1]
    s_waitcnt lgkmcnt(4)
    buffer_store_dwordx4 a[52:55], v254, s[24:27], s83 offen offset:1024 sc1
    v_cvt_pk_bf16_f32 v144, v0, v4
    v_cvt_pk_bf16_f32 v145, v8, v12
    v_cvt_pk_bf16_f32 v146, v16, v20
    v_cvt_pk_bf16_f32 v147, v24, v28
    v_cvt_pk_bf16_f32 v148, v1, v5
    v_cvt_pk_bf16_f32 v149, v9, v13
    v_cvt_pk_bf16_f32 v150, v17, v21
    v_cvt_pk_bf16_f32 v151, v25, v29
    v_cvt_pk_bf16_f32 v152, v2, v6
    v_cvt_pk_bf16_f32 v153, v10, v14
    v_cvt_pk_bf16_f32 v154, v18, v22
    v_cvt_pk_bf16_f32 v155, v26, v30
    s_waitcnt lgkmcnt(2)
    buffer_store_dwordx4 a[56:59], v254, s[24:27], s83 offen offset:2048 sc1
    ds_write_b128 v255, v[144:147] offset:5120
    s_nop 1
    v_cvt_pk_bf16_f32 v144, v3, v7
    v_cvt_pk_bf16_f32 v145, v11, v15
    v_cvt_pk_bf16_f32 v146, v19, v23
    v_cvt_pk_bf16_f32 v147, v27, v31
    ds_write_b128 v255, v[148:151] offset:5440
    s_waitcnt lgkmcnt(2)
    buffer_store_dwordx4 a[60:63], v254, s[24:27], s83 offen offset:3072 sc1
    ds_write_b128 v255, v[152:155] offset:5760
    ds_write_b128 v255, v[144:147] offset:6080
    ds_read_b64_tr_b16 a[0:1], v159 offset:5120
    ds_read_b64_tr_b16 a[2:3], v159 offset:5184
    ds_read_b64_tr_b16 a[4:5], v159 offset:6400
    ds_read_b64_tr_b16 a[6:7], v159 offset:6464
    ds_read_b64_tr_b16 a[8:9], v159 offset:7680
    ds_read_b64_tr_b16 a[10:11], v159 offset:7744
    ds_read_b64_tr_b16 a[12:13], v159 offset:8960
    ds_read_b64_tr_b16 a[14:15], v159 offset:9024
    s_waitcnt lgkmcnt(6)
    buffer_store_dwordx4 a[0:3], v254, s[24:27], s80 offen offset:0 sc1
    s_waitcnt lgkmcnt(4)
    buffer_store_dwordx4 a[4:7], v254, s[24:27], s80 offen offset:1024 sc1
    s_waitcnt lgkmcnt(2)
    buffer_store_dwordx4 a[8:11], v254, s[24:27], s80 offen offset:2048 sc1
    s_waitcnt lgkmcnt(0)
    buffer_store_dwordx4 a[12:15], v254, s[24:27], s80 offen offset:3072 sc1
    v_cmp_le_u32 vcc, 0x4e800000, v250
    s_nop 3
    s_mov_b64 s[36:37], vcc
    v_cmp_ge_u32 vcc, 0x30800000, v251
    s_nop 3
    s_or_b64 s[36:37], s[36:37], vcc
    s_mov_b32 s73, 6
    s_cbranch_scc1 L_slow
    s_endpgm
L_slow:
    s_waitcnt vmcnt(0) lgkmcnt(0)
    v_and_b32 v254, 0x3ff, v254
    v_lshrrev_b32 v69, 4, v254
    v_and_b32 v68, 7, v69
    v_lshlrev_b32 v65, 10, v68
    v_and_b32 v68, 8, v69
    v_lshl_add_u32 v65, v68, 5, v65
    v_and_b32 v68, 48, v69
    v_add_u32 v65, v68, v65
    v_and_b32 v68, 15, v69
    v_lshlrev_b32 v67, 8, v68
    v_and_b32 v68, 48, v69
    v_add_u32 v67, v68, v67
    v_bfe_u32 v68, v69, 2, 3
    v_mul_u32_u24 v66, 1040, v68
    v_and_b32 v68, 32, v69
    v_lshl_add_u32 v66, v68, 3, v66
    v_and_b32 v68, 1, v69
    v_lshl_add_u32 v66, v68, 3, v66
    v_and_b32 v68, 2, v69
    v_lshl_add_u32 v66, v68, 6, v66
    v_add_u32 v66, s76, v66
    v_bfe_u32 v68, v254, 8, 2
    v_mul_u32_u24 v70, 0x140, v68
    v_bfe_u32 v68, v254, 6, 2
    v_lshl_add_u32 v70, v68, 4, v70
    v_bfe_u32 v68, v254, 4, 1
    v_lshl_add_u32 v70, v68, 3, v70
    v_bfe_u32 v68, v254, 5, 1
    v_lshl_add_u32 v70, v68, 7, v70
    v_add_u32 v70, s76, v70
    s_mov_b32 s74, 0
L_slow_tile:
    s_lshl_b32 s80, s74, 12
    s_add_u32 s80, s80, s33
    buffer_load_dwordx4 v[136:139], v67, s[12:15], s80 offen offset:0
    buffer_load_dwordx4 v[140:143], v67, s[12:15], s80 offen offset:64
    buffer_load_dwordx4 v[144:147], v67, s[12:15], s80 offen offset:128
    buffer_load_dwordx4 v[148:151], v67, s[12:15], s80 offen offset:192
    s_waitcnt vmcnt(0)
    v_lshlrev_b32 v68, 16, v136
    v_and_b32 v69, s3, v136
    v_mul_f32 v68, s100, v68
    v_mul_f32 v69, s100, v69
    v_cvt_pk_bf16_f32 v136, v68, v69
    v_lshlrev_b32 v68, 16, v137
    v_and_b32 v69, s3, v137
    v_mul_f32 v68, s100, v68
    v_mul_f32 v69, s100, v69
    v_cvt_pk_bf16_f32 v137, v68, v69
    v_lshlrev_b32 v68, 16, v138
    v_and_b32 v69, s3, v138
    v_mul_f32 v68, s100, v68
    v_mul_f32 v69, s100, v69
    v_cvt_pk_bf16_f32 v138, v68, v69
    v_lshlrev_b32 v68, 16, v139
    v_and_b32 v69, s3, v139
    v_mul_f32 v68, s100, v68
    v_mul_f32 v69, s100, v69
    v_cvt_pk_bf16_f32 v139, v68, v69
    v_lshlrev_b32 v68, 16, v140
    v_and_b32 v69, s3, v140
    v_mul_f32 v68, s100, v68
    v_mul_f32 v69, s100, v69
    v_cvt_pk_bf16_f32 v140, v68, v69
    v_lshlrev_b32 v68, 16, v141
    v_and_b32 v69, s3, v141
    v_mul_f32 v68, s100, v68
    v_mul_f32 v69, s100, v69
    v_cvt_pk_bf16_f32 v141, v68, v69
    v_lshlrev_b32 v68, 16, v142
    v_and_b32 v69, s3, v142
    v_mul_f32 v68, s100, v68
    v_mul_f32 v69, s100, v69
    v_cvt_pk_bf16_f32 v142, v68, v69
    v_lshlrev_b32 v68, 16, v143
    v_and_b32 v69, s3, v143
    v_mul_f32 v68, s100, v68
    v_mul_f32 v69, s100, v69
    v_cvt_pk_bf16_f32 v143, v68, v69
    v_lshlrev_b32 v68, 16, v144
    v_and_b32 v69, s3, v144
    v_mul_f32 v68, s100, v68
    v_mul_f32 v69, s100, v69
    v_cvt_pk_bf16_f32 v144, v68, v69
    v_lshlrev_b32 v68, 16, v145
    v_and_b32 v69, s3, v145
    v_mul_f32 v68, s100, v68
    v_mul_f32 v69, s100, v69
    v_cvt_pk_bf16_f32 v145, v68, v69
    v_lshlrev_b32 v68, 16, v146
    v_and_b32 v69, s3, v146
    v_mul_f32 v68, s100, v68
    v_mul_f32 v69, s100, v69
    v_cvt_pk_bf16_f32 v146, v68, v69
    v_lshlrev_b32 v68, 16, v147
    v_and_b32 v69, s3, v147
    v_mul_f32 v68, s100, v68
    v_mul_f32 v69, s100, v69
    v_cvt_pk_bf16_f32 v147, v68, v69
    v_lshlrev_b32 v68, 16, v148
    v_and_b32 v69, s3, v148
    v_mul_f32 v68, s100, v68
    v_mul_f32 v69, s100, v69
    v_cvt_pk_bf16_f32 v148, v68, v69
    v_lshlrev_b32 v68, 16, v149
    v_and_b32 v69, s3, v149
    v_mul_f32 v68, s100, v68
    v_mul_f32 v69, s100, v69
    v_cvt_pk_bf16_f32 v149, v68, v69
    v_lshlrev_b32 v68, 16, v150
    v_and_b32 v69, s3, v150
    v_mul_f32 v68, s100, v68
    v_mul_f32 v69, s100, v69
    v_cvt_pk_bf16_f32 v150, v68, v69
    v_lshlrev_b32 v68, 16, v151
    v_and_b32 v69, s3, v151
    v_mul_f32 v68, s100, v68
    v_mul_f32 v69, s100, v69
    v_cvt_pk_bf16_f32 v151, v68, v69
    v_mov_b32 v68, 0xff800000
    s_mov_b32 s75, 0
L_slow_max:
    buffer_load_dwordx4 v[72:75], v65, s[16:19], s75 offen offset:0
    buffer_load_dwordx4 v[76:79], v65, s[16:19], s75 offen offset:64
    buffer_load_dwordx4 v[80:83], v65, s[16:19], s75 offen offset:128
    buffer_load_dwordx4 v[84:87], v65, s[16:19], s75 offen offset:192
    buffer_load_dwordx4 v[88:91], v65, s[16:19], s75 offen offset:512
    buffer_load_dwordx4 v[92:95], v65, s[16:19], s75 offen offset:576
    buffer_load_dwordx4 v[96:99], v65, s[16:19], s75 offen offset:640
    buffer_load_dwordx4 v[100:103], v65, s[16:19], s75 offen offset:704
    s_waitcnt vmcnt(0)
    v_mfma_f32_16x16x32_bf16 v[152:155], v[72:75], v[136:139], 0
    v_mfma_f32_16x16x32_bf16 v[152:155], v[76:79], v[140:143], v[152:155]
    v_mfma_f32_16x16x32_bf16 v[152:155], v[80:83], v[144:147], v[152:155]
    v_mfma_f32_16x16x32_bf16 v[152:155], v[84:87], v[148:151], v[152:155]
    v_mfma_f32_16x16x32_bf16 v[156:159], v[88:91], v[136:139], 0
    v_mfma_f32_16x16x32_bf16 v[156:159], v[92:95], v[140:143], v[156:159]
    v_mfma_f32_16x16x32_bf16 v[156:159], v[96:99], v[144:147], v[156:159]
    v_mfma_f32_16x16x32_bf16 v[156:159], v[100:103], v[148:151], v[156:159]
    s_nop 7
    v_max3_f32 v68, v68, v152, v153
    v_max3_f32 v68, v68, v154, v155
    v_max3_f32 v68, v68, v156, v157
    v_max3_f32 v68, v68, v158, v159
    s_add_u32 s75, s75, 8192
    s_cmp_lt_u32 s75, 524288
    s_cbranch_scc1 L_slow_max
    v_mov_b32 v69, v68
    s_nop 1
    v_permlane32_swap_b32 v68, v69
    v_max_f32 v68, v68, v69
    v_mov_b32 v69, v68
    s_nop 1
    v_permlane16_swap_b32 v68, v69
    v_max_f32 v68, v68, v69
    v_sub_f32 v240, 0, v68
    v_sub_f32 v241, 0, v68
    v_sub_f32 v242, 0, v68
    v_sub_f32 v243, 0, v68
    v_mov_b32 v0, 0
    v_mov_b32 v1, 0
    v_mov_b32 v2, 0
    v_mov_b32 v3, 0
    v_mov_b32 v4, 0
    v_mov_b32 v5, 0
    v_mov_b32 v6, 0
    v_mov_b32 v7, 0
    v_mov_b32 v8, 0
    v_mov_b32 v9, 0
    v_mov_b32 v10, 0
    v_mov_b32 v11, 0
    v_mov_b32 v12, 0
    v_mov_b32 v13, 0
    v_mov_b32 v14, 0
    v_mov_b32 v15, 0
    v_mov_b32 v16, 0
    v_mov_b32 v17, 0
    v_mov_b32 v18, 0
    v_mov_b32 v19, 0
    v_mov_b32 v20, 0
    v_mov_b32 v21, 0
    v_mov_b32 v22, 0
    v_mov_b32 v23, 0
    v_mov_b32 v24, 0
    v_mov_b32 v25, 0
    v_mov_b32 v26, 0
    v_mov_b32 v27, 0
    v_mov_b32 v28, 0
    v_mov_b32 v29, 0
    v_mov_b32 v30, 0
    v_mov_b32 v31, 0
    v_mov_b32_e64 v64, 0
    s_mov_b32 s75, 0
L_slow_pv:
    buffer_load_dwordx4 v[72:75], v65, s[16:19], s75 offen offset:0
    buffer_load_dwordx4 v[76:79], v65, s[16:19], s75 offen offset:64
    buffer_load_dwordx4 v[80:83], v65, s[16:19], s75 offen offset:128
    buffer_load_dwordx4 v[84:87], v65, s[16:19], s75 offen offset:192
    buffer_load_dwordx4 v[88:91], v65, s[16:19], s75 offen offset:512
    buffer_load_dwordx4 v[92:95], v65, s[16:19], s75 offen offset:576
    buffer_load_dwordx4 v[96:99], v65, s[16:19], s75 offen offset:640
    buffer_load_dwordx4 v[100:103], v65, s[16:19], s75 offen offset:704
    s_add_u32 s35, s75, 4096
    s_add_u32 m0, s76, 0
    s_nop 0
    buffer_load_dwordx4 v254, s[20:23], s75 offen offset:0 lds
    s_add_u32 m0, s76, 16
    s_nop 0
    buffer_load_dwordx4 v254, s[20:23], s75 offen offset:1024 lds
    s_add_u32 m0, s76, 32
    s_nop 0
    buffer_load_dwordx4 v254, s[20:23], s75 offen offset:2048 lds
    s_add_u32 m0, s76, 48
    s_nop 0
    buffer_load_dwordx4 v254, s[20:23], s75 offen offset:3072 lds
    s_add_u32 m0, s76, 4160
    s_nop 0
    buffer_load_dwordx4 v254, s[20:23], s35 offen offset:0 lds
    s_add_u32 m0, s76, 4176
    s_nop 0
    buffer_load_dwordx4 v254, s[20:23], s35 offen offset:1024 lds
    s_add_u32 m0, s76, 4192
    s_nop 0
    buffer_load_dwordx4 v254, s[20:23], s35 offen offset:2048 lds
    s_add_u32 m0, s76, 4208
    s_nop 0
    buffer_load_dwordx4 v254, s[20:23], s35 offen offset:3072 lds
    s_waitcnt vmcnt(0)
    ds_read_b64_tr_b16 v[104:105], v66 offset:0
    ds_read_b64_tr_b16 v[106:107], v66 offset:512
    ds_read_b64_tr_b16 v[108:109], v66 offset:16
    ds_read_b64_tr_b16 v[110:111], v66 offset:528
    ds_read_b64_tr_b16 v[112:113], v66 offset:32
    ds_read_b64_tr_b16 v[114:115], v66 offset:544
    ds_read_b64_tr_b16 v[116:117], v66 offset:48
    ds_read_b64_tr_b16 v[118:119], v66 offset:560
    ds_read_b64_tr_b16 v[120:121], v66 offset:64
    ds_read_b64_tr_b16 v[122:123], v66 offset:576
    ds_read_b64_tr_b16 v[124:125], v66 offset:80
    ds_read_b64_tr_b16 v[126:127], v66 offset:592
    ds_read_b64_tr_b16 v[128:129], v66 offset:96
    ds_read_b64_tr_b16 v[130:131], v66 offset:608
    ds_read_b64_tr_b16 v[132:133], v66 offset:112
    ds_read_b64_tr_b16 v[134:135], v66 offset:624
    v_mfma_f32_16x16x32_bf16 v[152:155], v[72:75], v[136:139], v[240:243]
    v_mfma_f32_16x16x32_bf16 v[152:155], v[76:79], v[140:143], v[152:155]
    v_mfma_f32_16x16x32_bf16 v[152:155], v[80:83], v[144:147], v[152:155]
    v_mfma_f32_16x16x32_bf16 v[152:155], v[84:87], v[148:151], v[152:155]
    v_mfma_f32_16x16x32_bf16 v[156:159], v[88:91], v[136:139], v[240:243]
    v_mfma_f32_16x16x32_bf16 v[156:159], v[92:95], v[140:143], v[156:159]
    v_mfma_f32_16x16x32_bf16 v[156:159], v[96:99], v[144:147], v[156:159]
    v_mfma_f32_16x16x32_bf16 v[156:159], v[100:103], v[148:151], v[156:159]
    s_nop 7
    v_exp_f32 v152, v152
    v_exp_f32 v153, v153
    v_exp_f32 v154, v154
    v_exp_f32 v155, v155
    v_exp_f32 v156, v156
    v_exp_f32 v157, v157
    v_exp_f32 v158, v158
    v_exp_f32 v159, v159
    v_add_f32 v64, v64, v152
    v_add_f32 v64, v64, v153
    v_add_f32 v64, v64, v154
    v_add_f32 v64, v64, v155
    v_add_f32 v64, v64, v156
    v_add_f32 v64, v64, v157
    v_add_f32 v64, v64, v158
    v_add_f32 v64, v64, v159
    v_cvt_pk_bf16_f32 v160, v152, v153
    v_cvt_pk_bf16_f32 v161, v154, v155
    v_cvt_pk_bf16_f32 v162, v156, v157
    v_cvt_pk_bf16_f32 v163, v158, v159
    s_waitcnt lgkmcnt(0)
    s_nop 0
    v_mfma_f32_16x16x32_bf16 v[0:3], v[160:163], v[104:107], v[0:3]
    v_mfma_f32_16x16x32_bf16 v[4:7], v[160:163], v[108:111], v[4:7]
    v_mfma_f32_16x16x32_bf16 v[8:11], v[160:163], v[112:115], v[8:11]
    v_mfma_f32_16x16x32_bf16 v[12:15], v[160:163], v[116:119], v[12:15]
    v_mfma_f32_16x16x32_bf16 v[16:19], v[160:163], v[120:123], v[16:19]
    v_mfma_f32_16x16x32_bf16 v[20:23], v[160:163], v[124:127], v[20:23]
    v_mfma_f32_16x16x32_bf16 v[24:27], v[160:163], v[128:131], v[24:27]
    v_mfma_f32_16x16x32_bf16 v[28:31], v[160:163], v[132:135], v[28:31]
    s_nop 7
    s_add_u32 s75, s75, 8192
    s_cmp_lt_u32 s75, 524288
    s_cbranch_scc1 L_slow_pv
    v_mov_b32 v166, v64
    s_nop 1
    v_permlane32_swap_b32 v64, v166
    v_add_f32 v64, v64, v166
    v_mov_b32 v166, v64
    s_nop 1
    v_permlane16_swap_b32 v64, v166
    v_add_f32 v64, v64, v166
    v_rcp_f32_e64 v167, v64
    s_nop 1
    v_mov_b32_dpp v167, v167 row_ror:12 row_mask:0x2 bank_mask:0xf
    s_nop 1
    v_mov_b32_dpp v167, v167 row_ror:8 row_mask:0x4 bank_mask:0xf
    s_nop 1
    v_mov_b32_dpp v167, v167 row_ror:4 row_mask:0x8 bank_mask:0xf
    s_nop 1
    v_mov_b32_dpp v164, v167 row_newbcast:0 row_mask:0xf bank_mask:0xf
    v_mov_b32_dpp v165, v167 row_newbcast:1 row_mask:0xf bank_mask:0xf
    v_mov_b32_dpp v166, v167 row_newbcast:2 row_mask:0xf bank_mask:0xf
    v_mov_b32_dpp v167, v167 row_newbcast:3 row_mask:0xf bank_mask:0xf
    v_pk_mul_f32 v[0:1], v[0:1], v[164:165]
    v_pk_mul_f32 v[2:3], v[2:3], v[166:167]
    v_pk_mul_f32 v[4:5], v[4:5], v[164:165]
    v_pk_mul_f32 v[6:7], v[6:7], v[166:167]
    v_pk_mul_f32 v[8:9], v[8:9], v[164:165]
    v_pk_mul_f32 v[10:11], v[10:11], v[166:167]
    v_pk_mul_f32 v[12:13], v[12:13], v[164:165]
    v_pk_mul_f32 v[14:15], v[14:15], v[166:167]
    v_pk_mul_f32 v[16:17], v[16:17], v[164:165]
    v_pk_mul_f32 v[18:19], v[18:19], v[166:167]
    v_pk_mul_f32 v[20:21], v[20:21], v[164:165]
    v_pk_mul_f32 v[22:23], v[22:23], v[166:167]
    v_pk_mul_f32 v[24:25], v[24:25], v[164:165]
    v_pk_mul_f32 v[26:27], v[26:27], v[166:167]
    v_pk_mul_f32 v[28:29], v[28:29], v[164:165]
    v_pk_mul_f32 v[30:31], v[30:31], v[166:167]
    v_cvt_pk_bf16_f32 v168, v0, v4
    v_cvt_pk_bf16_f32 v169, v8, v12
    v_cvt_pk_bf16_f32 v170, v16, v20
    v_cvt_pk_bf16_f32 v171, v24, v28
    ds_write_b128 v255, v[168:171] offset:0
    s_nop 1
    v_cvt_pk_bf16_f32 v168, v1, v5
    v_cvt_pk_bf16_f32 v169, v9, v13
    v_cvt_pk_bf16_f32 v170, v17, v21
    v_cvt_pk_bf16_f32 v171, v25, v29
    ds_write_b128 v255, v[168:171] offset:320
    s_nop 1
    v_cvt_pk_bf16_f32 v168, v2, v6
    v_cvt_pk_bf16_f32 v169, v10, v14
    v_cvt_pk_bf16_f32 v170, v18, v22
    v_cvt_pk_bf16_f32 v171, v26, v30
    ds_write_b128 v255, v[168:171] offset:640
    s_nop 1
    v_cvt_pk_bf16_f32 v168, v3, v7
    v_cvt_pk_bf16_f32 v169, v11, v15
    v_cvt_pk_bf16_f32 v170, v19, v23
    v_cvt_pk_bf16_f32 v171, v27, v31
    ds_write_b128 v255, v[168:171] offset:960
    ds_read_b64_tr_b16 a[0:1], v70 offset:0
    ds_read_b64_tr_b16 a[2:3], v70 offset:64
    ds_read_b64_tr_b16 a[4:5], v70 offset:1280
    ds_read_b64_tr_b16 a[6:7], v70 offset:1344
    ds_read_b64_tr_b16 a[8:9], v70 offset:2560
    ds_read_b64_tr_b16 a[10:11], v70 offset:2624
    ds_read_b64_tr_b16 a[12:13], v70 offset:3840
    ds_read_b64_tr_b16 a[14:15], v70 offset:3904
    s_waitcnt lgkmcnt(6)
    buffer_store_dwordx4 a[0:3], v254, s[24:27], s80 offen offset:0 sc1
    s_waitcnt lgkmcnt(4)
    buffer_store_dwordx4 a[4:7], v254, s[24:27], s80 offen offset:1024 sc1
    s_waitcnt lgkmcnt(2)
    buffer_store_dwordx4 a[8:11], v254, s[24:27], s80 offen offset:2048 sc1
    s_waitcnt lgkmcnt(0)
    buffer_store_dwordx4 a[12:15], v254, s[24:27], s80 offen offset:3072 sc1
    s_waitcnt vmcnt(0) lgkmcnt(0)
    s_add_u32 s74, s74, 1
    s_cmp_lt_u32 s74, s73
    s_cbranch_scc1 L_slow_tile
L_fin:
L_end:
    s_endpgm
.section .rodata,"a"
.p2align 6
.amdhsa_kernel standalone__mha_softmax__near_ridge_kernel
  .amdhsa_next_free_vgpr 512
  .amdhsa_next_free_sgpr 102
  .amdhsa_accum_offset 256
  .amdhsa_group_segment_fixed_size 0
  .amdhsa_kernarg_size 48
  .amdhsa_user_sgpr_count 2
  .amdhsa_user_sgpr_kernarg_segment_ptr 1
  .amdhsa_system_sgpr_workgroup_id_x 1
.end_amdhsa_kernel
```
